```python
import torch

def _softmax(x, axis=-1):
    return torch.softmax(x, dim=axis)
def _gelu(x):
    return torch.nn.functional.gelu(x, approximate="tanh")
def _silu(x):
    return torch.nn.functional.silu(x)
def _sigmoid(x):
    return torch.sigmoid(x)
def _layernorm(x, axis=-1, eps=1e-5):
    m = x.mean(dim=axis, keepdim=True)
    v = x.var(dim=axis, keepdim=True, unbiased=False)
    return (x - m) / torch.sqrt(v + eps)
def _scatter_add(tgt, idx, src, axis=0):
    return tgt.clone().index_add_(axis, idx, src)
def _segment_sum(src, seg, n):
    out = torch.zeros((n,) + src.shape[1:], dtype=src.dtype)
    return out.index_add_(0, seg, src)
def _pad(x, pw):
    flat = tuple(v for pair in reversed(pw) for v in pair)
    return torch.nn.functional.pad(x, flat)

kernel_name = 'parallel_sum__compressed_kv_cla__geglu_ffn__prompt'

def setup_inputs():

    _w = (lambda a: (lambda t: t.to(torch.bfloat16) if t.is_floating_point() else t)(torch.as_tensor(a)))
    def _A_setup():
        B, H, Sq, Sk, D, M = 1, 32, 2048, 2048, 128, 576
        Dc = 4 * D
        return {
            "x": _w((lambda *s: torch.randn(*s, dtype=torch.bfloat16) * 0.05)(B, Sq, M)),
            "c_kv": _w((lambda *s: torch.randn(*s, dtype=torch.bfloat16) * 1.6)(B, Sk, Dc)),
            "w_q": _w((lambda *s: torch.randn(*s, dtype=torch.bfloat16) * 0.8)(M, H, D) * (M ** -0.5)),
            "w_uk": _w((lambda *s: torch.randn(*s, dtype=torch.bfloat16) * 0.8)(Dc, H, D) * (Dc ** -0.5)),
            "w_uv": _w((lambda *s: torch.randn(*s, dtype=torch.bfloat16) * 1.6)(Dc, H, D) * (Dc ** -0.5)),
            "w_o": _w((lambda *s: torch.randn(*s, dtype=torch.bfloat16) * 1.6)(H, D, M) * ((H * D) ** -0.5)),
        }
    _A_in = _A_setup()

    def _B_setup():
        B, S, D, F = 1, 2048, 576, 4608
        return {
            "x": _w((lambda *s: torch.randn(*s, dtype=torch.bfloat16) * 0.05)(B, S, D)),
            "w_gate": _w((lambda *s: torch.randn(*s, dtype=torch.bfloat16) * 0.05)(D, F)),
            "w_up": _w((lambda *s: torch.randn(*s, dtype=torch.bfloat16) * 0.05)(D, F)),
            "w_down": _w((lambda *s: torch.randn(*s, dtype=torch.bfloat16) * 0.05)(F, D)),
        }
    _B_in = _B_setup()

    return {
        "A_x": _A_in["x"],
        "A_c_kv": _A_in["c_kv"],
        "A_w_q": _A_in["w_q"],
        "A_w_uk": _A_in["w_uk"],
        "A_w_uv": _A_in["w_uv"],
        "A_w_o": _A_in["w_o"],
        "B_x": _B_in["x"],
        "B_w_gate": _B_in["w_gate"],
        "B_w_up": _B_in["w_up"],
        "B_w_down": _B_in["w_down"],
    }

def reference(A_x, A_c_kv, A_w_q, A_w_uk, A_w_uv, A_w_o, B_x, B_w_gate, B_w_up, B_w_down):
    def _A_ref(x, c_kv, w_q, w_uk, w_uv, w_o):
        B, Sq, M = x.shape[0], x.shape[1], x.shape[2]
        Sk = c_kv.shape[1]
        H, D = w_q.shape[1], w_q.shape[2]
        q = torch.einsum("bqm,mhd->bhqd", x, w_q)
        k = torch.einsum("bkc,chd->bhkd", c_kv, w_uk)
        v = torch.einsum("bkc,chd->bhkd", c_kv, w_uv)
        scores = torch.einsum("bhqd,bhkd->bhqk", q, k) * (D ** -0.5)
        off = Sk - Sq
        qi = torch.arange(Sq)[:, None]
        kj = torch.arange(Sk)[None, :]
        cmask = kj <= (qi + off)
        scores = torch.where(cmask[None, None], scores, -1e9)
        p = _softmax(scores, axis=-1)
        ctx = torch.einsum("bhqk,bhkd->bhqd", p, v)
        return torch.einsum("bhqd,hdm->bqm", ctx, w_o)

    def _B_ref(x, w_gate, w_up, w_down):
        return (_gelu(x @ w_gate) * (x @ w_up)) @ w_down

    x = A_x
    xn = _layernorm(x, axis=-1)
    return x + _A_ref(xn, A_c_kv, A_w_q, A_w_uk, A_w_uv, A_w_o) + _B_ref(xn, B_w_gate, B_w_up, B_w_down)
```

```asm
; @launch grid=(256,1,1) block=(256,1,1) lds=163840
.amdgcn_target "amdgcn-amd-amdhsa--gfx950"
.text
.macro mf d, a, b, c
v_mfma_f32_16x16x32_bf16 \d, \a, \b, \c
.endm
.globl parallel_sum__compressed_kv_cla__geglu_ffn__prompt_kernel
.p2align 8
.type parallel_sum__compressed_kv_cla__geglu_ffn__prompt_kernel,@function
parallel_sum__compressed_kv_cla__geglu_ffn__prompt_kernel:
 s_load_dwordx16 s[4:19], s[0:1], 0x0
 s_load_dwordx8 s[20:27], s[0:1], 0x40
 s_load_dwordx2 s[28:29], s[0:1], 0x60
 s_cmp_ge_u32 s2, 0x100
 s_cbranch_scc1 f_done
 v_lshrrev_b32 v1, 6, v0
 s_nop 0
 v_readfirstlane_b32 s3, v1
 v_mov_b32 v90, v0
 v_and_b32 v1, 63, v0
 v_lshrrev_b32 v2, 4, v1
 v_and_b32 v3, 15, v1
 v_lshlrev_b32 v4, 4, v1
 s_and_b32 s64, s2, 7
 s_lshr_b32 s31, s2, 3
 s_and_b32 s65, s31, 3
 s_lshr_b32 s66, s31, 2
 s_lshl_b32 s67, s64, 2
 s_add_u32 s67, s67, s65
 s_and_b32 s75, s3, 1
 s_lshr_b32 s74, s3, 1
 s_lshl_b32 s70, s3, 10
 s_lshr_b32 s76, s65, 1
 s_getpc_b64 s[98:99]
f_pc:
 s_sub_u32 s98, s98, f_pc-parallel_sum__compressed_kv_cla__geglu_ffn__prompt_kernel
 s_subb_u32 s99, s99, 0
 s_lshr_b32 s100, s2, 3
 s_lshl_b32 s100, s100, 2
 s_add_u32 s100, s100, s3
 s_lshl_b32 s100, s100, 8
 v_and_b32 v94, 1, v1
 v_lshlrev_b32 v94, 7, v94
 v_add_u32 v94, s100, v94
 v_add_u32 v94, 0, v94
 v_min_u32 v94, f_done-parallel_sum__compressed_kv_cla__geglu_ffn__prompt_kernel, v94
 v_add_co_u32 v94, vcc, s98, v94
 v_mov_b32 v95, s99
 s_nop 0
 v_addc_co_u32 v95, vcc, 0, v95, vcc
 global_load_dword a170, v[94:95], off
 v_and_b32 v94, 1, v1
 v_lshlrev_b32 v94, 7, v94
 v_add_u32 v94, s100, v94
 v_add_u32 v94, 0x8000, v94
 v_min_u32 v94, f_done-parallel_sum__compressed_kv_cla__geglu_ffn__prompt_kernel, v94
 v_add_co_u32 v94, vcc, s98, v94
 v_mov_b32 v95, s99
 s_nop 0
 v_addc_co_u32 v95, vcc, 0, v95, vcc
 global_load_dword a170, v[94:95], off
 s_waitcnt lgkmcnt(0)
 s_mov_b32 s44, s4
 s_mov_b32 s45, s5
 s_mov_b32 s46, 0x240000
 s_mov_b32 s47, 0x20000
 s_add_u32 s52, s28, 0x7800000
 s_addc_u32 s53, s29, 0
 s_mov_b32 s54, 0x200000
 s_mov_b32 s55, 0x20000
 v_and_b32 v32, 31, v1
 v_lshrrev_b32 v33, 5, v1
 s_lshl_b32 s30, s2, 3
 s_lshl_b32 s31, s3, 1
 s_add_u32 s30, s30, s31
 v_add_u32 v33, s30, v33
 s_movk_i32 s31, 0x480
 v_mul_lo_u32 v34, v33, s31
 v_lshl_add_u32 v34, v32, 4, v34
 v_cmp_gt_u32 vcc, 8, v32
 v_add_u32 v35, 0x400, v34
 v_mov_b32 v81, 0x7ff00000
 v_cndmask_b32 v35, v81, v35, vcc
 buffer_load_dwordx4 v[40:43], v34, s[44:47], 0 offen
 buffer_load_dwordx4 v[44:47], v34, s[44:47], 0 offen offset:512
 buffer_load_dwordx4 v[48:51], v35, s[44:47], 0 offen
 v_mov_b32 v92, 0
 s_mov_b32 s30, 0x100000
 buffer_load_dword v91, v92, s[52:55], s30 offen sc1
 s_cmp_eq_u32 s76, 1
 s_cselect_b32 s30, s12, s10
 s_cselect_b32 s31, s13, s11
 s_mov_b32 s32, s30
 s_mov_b32 s33, s31
 s_mov_b32 s34, 0x400000
 s_mov_b32 s35, 0x20000
 s_mov_b32 s36, s6
 s_mov_b32 s37, s7
 s_mov_b32 s38, 0x200000
 s_mov_b32 s39, 0x20000
 s_lshl_b32 s77, s64, 1
 s_and_b32 s30, s65, 1
 s_add_u32 s77, s77, s30
 s_lshl_b32 s71, s77, 9
 s_lshl_b32 s72, s66, 18
 v_lshrrev_b32 v96, 5, v1
 s_lshl_b32 s30, s3, 1
 v_add_u32 v96, s30, v96
 v_and_b32 v97, 3, v96
 v_bfe_u32 v98, v1, 1, 4
 v_xor_b32 v98, v98, v97
 v_lshlrev_b32 v96, 13, v96
 v_and_b32 v99, 1, v1
 v_lshl_add_u32 v96, v99, 4, v96
 v_lshl_add_u32 v8, v98, 5, v96
 v_xor_b32 v98, 4, v98
 v_lshl_add_u32 v9, v98, 5, v96
 v_lshrrev_b32 v96, 2, v1
 v_bfe_u32 v97, v1, 4, 1
 v_mul_u32_u24 v97, 3, v97
 v_and_b32 v98, 3, v1
 v_xor_b32 v97, v97, v98
 s_lshl_b32 s30, s3, 4
 v_add_u32 v96, s30, v96
 v_lshlrev_b32 v96, 10, v96
 v_lshl_add_u32 v10, v97, 4, v96
 s_add_u32 m0, s70, 0
 s_add_u32 s60, s71, 0
 s_nop 0
 buffer_load_dwordx4 v8, s[32:35], s60 offen nt lds
 s_add_u32 m0, s70, 0x10000
 s_add_u32 s60, s72, 0
 s_nop 0
 buffer_load_dwordx4 v10, s[36:39], s60 offen lds
 s_add_u32 m0, s70, 0x1000
 s_add_u32 s60, s71, 0x10000
 s_nop 0
 buffer_load_dwordx4 v9, s[32:35], s60 offen nt lds
 s_add_u32 m0, s70, 0x11000
 s_add_u32 s60, s72, 0x10000
 s_nop 0
 buffer_load_dwordx4 v10, s[36:39], s60 offen lds
 s_add_u32 m0, s70, 0x2000
 s_add_u32 s60, s71, 0x20000
 s_nop 0
 buffer_load_dwordx4 v8, s[32:35], s60 offen nt lds
 s_add_u32 m0, s70, 0x12000
 s_add_u32 s60, s72, 0x20000
 s_nop 0
 buffer_load_dwordx4 v10, s[36:39], s60 offen lds
 s_add_u32 m0, s70, 0x3000
 s_add_u32 s60, s71, 0x30000
 s_nop 0
 buffer_load_dwordx4 v9, s[32:35], s60 offen nt lds
 s_add_u32 m0, s70, 0x13000
 s_add_u32 s60, s72, 0x30000
 s_nop 0
 buffer_load_dwordx4 v10, s[36:39], s60 offen lds
 s_lshl_b32 s30, s2, 2
 s_add_u32 s30, s30, s3
 s_lshl_b32 s30, s30, 10
 v_lshlrev_b32 v7, 7, v1
 v_add_u32 v7, s30, v7
 v_cmp_gt_u32 vcc, 8, v1
 v_mov_b32 v97, 0x7ff00000
 s_nop 0
 v_cndmask_b32 v7, v97, v7, vcc
 s_mov_b32 s48, s28
 s_mov_b32 s49, s29
 s_mov_b32 s50, 0x240000
 s_mov_b32 s51, 0x20000
 s_add_u32 s40, s28, 0x400000
 s_addc_u32 s41, s29, 0
 s_mov_b32 s42, 0x2000000
 s_mov_b32 s43, 0x20000
 s_lshl_b32 s30, s77, 1
 s_add_u32 s30, s30, s75
 s_lshl_b32 s73, s30, 20
 s_lshl_b32 s30, s66, 1
 s_add_u32 s30, s30, s74
 s_lshl_b32 s30, s30, 16
 s_add_u32 s73, s73, s30
 s_lshl_b32 s30, s76, 14
 s_add_u32 s73, s73, s30
 v_cmp_gt_u32 vcc, 32, v90
 v_mov_b32 v100, 0x7ff00000
 v_lshlrev_b32 v101, 2, v90
 v_cndmask_b32 v5, v100, v101, vcc
 v_lshrrev_b32 v96, 2, v3
 v_and_b32 v97, 1, v2
 v_lshl_or_b32 v97, v97, 2, v96
 v_lshl_add_u32 v96, v2, 3, v96
 v_lshlrev_b32 v96, 9, v96
 v_and_b32 v98, 3, v3
 v_lshl_add_u32 v96, v98, 3, v96
 s_lshl_b32 s30, s75, 8
 v_add_u32 v96, s30, v96
 v_xor_b32 v98, 0, v97
 v_lshl_add_u32 v11, v98, 5, v96
 v_xor_b32 v98, 1, v97
 v_lshl_add_u32 v12, v98, 5, v96
 v_xor_b32 v98, 2, v97
 v_lshl_add_u32 v13, v98, 5, v96
 v_xor_b32 v98, 3, v97
 v_lshl_add_u32 v14, v98, 5, v96
 v_xor_b32 v98, 4, v97
 v_lshl_add_u32 v15, v98, 5, v96
 v_xor_b32 v98, 5, v97
 v_lshl_add_u32 v16, v98, 5, v96
 v_xor_b32 v98, 6, v97
 v_lshl_add_u32 v17, v98, 5, v96
 v_xor_b32 v98, 7, v97
 v_lshl_add_u32 v18, v98, 5, v96
 s_lshl_b32 s30, s74, 13
 s_add_u32 s30, s30, 0x10000
 v_lshlrev_b32 v96, 6, v3
 v_add_u32 v96, s30, v96
 v_bfe_u32 v97, v3, 2, 1
 v_mul_u32_u24 v97, 3, v97
 v_xor_b32 v97, v97, v2
 v_lshl_add_u32 v19, v97, 4, v96
 s_sub_u32 s30, 15, s66
 s_lshl_b32 s30, s30, 3
 s_add_u32 s68, s30, s3
 s_lshl_b32 s30, s66, 3
 s_add_u32 s69, s30, s3
 s_lshl_b32 s31, s3, 1
 s_sub_u32 s31, 7, s31
 s_mul_i32 s16, s31, 0x4800
 s_mul_i32 s17, s31, 0x44000
 s_mul_i32 s81, s68, 0x4800
 s_mul_i32 s82, s69, 0x4800
 s_cmp_ge_u32 s3, 2
 s_cselect_b32 s30, s20, s18
 s_cselect_b32 s31, s21, s19
 s_mov_b32 s44, s30
 s_mov_b32 s45, s31
 s_mov_b32 s46, 0x510000
 s_mov_b32 s47, 0x20000
 s_lshr_b32 s30, s3, 1
 s_mul_i32 s78, s30, 0x5000
 s_and_b32 s30, s3, 1
 s_mul_i32 s83, s30, 0x280
 s_mul_i32 s30, s30, 0x2800
 s_add_u32 s78, s78, s30
 s_and_b32 s79, s67, 1
 s_mul_i32 s80, s67, 0x120
 s_lshl_b32 s30, s79, 5
 s_sub_u32 s80, s80, s30
 v_add_u32 v96, s83, v1
 v_mul_u32_u24 v97, 0xccd, v96
 v_lshrrev_b32 v97, 16, v97
 v_mul_u32_u24 v98, 20, v97
 v_sub_u32 v98, v96, v98
 v_bfe_u32 v99, v97, 3, 1
 v_lshlrev_b32 v99, 1, v99
 v_xor_b32 v98, v98, v99
 s_movk_i32 s30, 0x2400
 v_mul_lo_u32 v97, v97, s30
 v_lshl_add_u32 v97, v98, 4, v97
 v_add_u32 v20, s80, v97
 v_add_u32 v96, s83, v1
 v_add_u32 v96, 64, v96
 v_mul_u32_u24 v97, 0xccd, v96
 v_lshrrev_b32 v97, 16, v97
 v_mul_u32_u24 v98, 20, v97
 v_sub_u32 v98, v96, v98
 v_bfe_u32 v99, v97, 3, 1
 v_lshlrev_b32 v99, 1, v99
 v_xor_b32 v98, v98, v99
 s_movk_i32 s30, 0x2400
 v_mul_lo_u32 v97, v97, s30
 v_lshl_add_u32 v97, v98, 4, v97
 v_add_u32 v21, s80, v97
 v_add_u32 v96, s83, v1
 v_add_u32 v96, 0x80, v96
 v_mul_u32_u24 v97, 0xccd, v96
 v_lshrrev_b32 v97, 16, v97
 v_mul_u32_u24 v98, 20, v97
 v_sub_u32 v98, v96, v98
 v_bfe_u32 v99, v97, 3, 1
 v_lshlrev_b32 v99, 1, v99
 v_xor_b32 v98, v98, v99
 s_movk_i32 s30, 0x2400
 v_mul_lo_u32 v97, v97, s30
 v_lshl_add_u32 v97, v98, 4, v97
 v_add_u32 v22, s80, v97
 v_add_u32 v96, s83, v1
 v_add_u32 v96, 0xc0, v96
 v_mul_u32_u24 v97, 0xccd, v96
 v_lshrrev_b32 v97, 16, v97
 v_mul_u32_u24 v98, 20, v97
 v_sub_u32 v98, v96, v98
 v_bfe_u32 v99, v97, 3, 1
 v_lshlrev_b32 v99, 1, v99
 v_xor_b32 v98, v98, v99
 s_movk_i32 s30, 0x2400
 v_mul_lo_u32 v97, v97, s30
 v_lshl_add_u32 v97, v98, 4, v97
 v_add_u32 v23, s80, v97
 v_add_u32 v96, s83, v1
 v_add_u32 v96, 0x100, v96
 v_mul_u32_u24 v97, 0xccd, v96
 v_lshrrev_b32 v97, 16, v97
 v_mul_u32_u24 v98, 20, v97
 v_sub_u32 v98, v96, v98
 v_bfe_u32 v99, v97, 3, 1
 v_lshlrev_b32 v99, 1, v99
 v_xor_b32 v98, v98, v99
 s_movk_i32 s30, 0x2400
 v_mul_lo_u32 v97, v97, s30
 v_lshl_add_u32 v97, v98, 4, v97
 v_add_u32 v24, s80, v97
 v_add_u32 v96, s83, v1
 v_add_u32 v96, 0x140, v96
 v_mul_u32_u24 v97, 0xccd, v96
 v_lshrrev_b32 v97, 16, v97
 v_mul_u32_u24 v98, 20, v97
 v_sub_u32 v98, v96, v98
 v_bfe_u32 v99, v97, 3, 1
 v_lshlrev_b32 v99, 1, v99
 v_xor_b32 v98, v98, v99
 s_movk_i32 s30, 0x2400
 v_mul_lo_u32 v97, v97, s30
 v_lshl_add_u32 v97, v98, 4, v97
 v_add_u32 v25, s80, v97
 v_add_u32 v96, s83, v1
 v_add_u32 v96, 0x180, v96
 v_mul_u32_u24 v97, 0xccd, v96
 v_lshrrev_b32 v97, 16, v97
 v_mul_u32_u24 v98, 20, v97
 v_sub_u32 v98, v96, v98
 v_bfe_u32 v99, v97, 3, 1
 v_lshlrev_b32 v99, 1, v99
 v_xor_b32 v98, v98, v99
 s_movk_i32 s30, 0x2400
 v_mul_lo_u32 v97, v97, s30
 v_lshl_add_u32 v97, v98, 4, v97
 v_add_u32 v26, s80, v97
 v_add_u32 v96, s83, v1
 v_add_u32 v96, 0x1c0, v96
 v_mul_u32_u24 v97, 0xccd, v96
 v_lshrrev_b32 v97, 16, v97
 v_mul_u32_u24 v98, 20, v97
 v_sub_u32 v98, v96, v98
 v_bfe_u32 v99, v97, 3, 1
 v_lshlrev_b32 v99, 1, v99
 v_xor_b32 v98, v98, v99
 s_movk_i32 s30, 0x2400
 v_mul_lo_u32 v97, v97, s30
 v_lshl_add_u32 v97, v98, 4, v97
 v_add_u32 v27, s80, v97
 v_add_u32 v96, s83, v1
 v_add_u32 v96, 0x200, v96
 v_mul_u32_u24 v97, 0xccd, v96
 v_lshrrev_b32 v97, 16, v97
 v_mul_u32_u24 v98, 20, v97
 v_sub_u32 v98, v96, v98
 v_bfe_u32 v99, v97, 3, 1
 v_lshlrev_b32 v99, 1, v99
 v_xor_b32 v98, v98, v99
 s_movk_i32 s30, 0x2400
 v_mul_lo_u32 v97, v97, s30
 v_lshl_add_u32 v97, v98, 4, v97
 v_add_u32 v28, s80, v97
 v_add_u32 v96, s83, v1
 v_add_u32 v96, 0x240, v96
 v_mul_u32_u24 v97, 0xccd, v96
 v_lshrrev_b32 v97, 16, v97
 v_mul_u32_u24 v98, 20, v97
 v_sub_u32 v98, v96, v98
 v_bfe_u32 v99, v97, 3, 1
 v_lshlrev_b32 v99, 1, v99
 v_xor_b32 v98, v98, v99
 s_movk_i32 s30, 0x2400
 v_mul_lo_u32 v97, v97, s30
 v_lshl_add_u32 v97, v98, 4, v97
 v_add_u32 v29, s80, v97
 s_add_u32 m0, s70, 0x4000
 s_add_u32 s60, s71, 0x40000
 s_nop 0
 buffer_load_dwordx4 v8, s[32:35], s60 offen nt lds
 s_add_u32 m0, s70, 0x14000
 s_add_u32 s60, s72, 64
 s_nop 0
 buffer_load_dwordx4 v10, s[36:39], s60 offen lds
 s_add_u32 m0, s70, 0x5000
 s_add_u32 s60, s71, 0x50000
 s_nop 0
 buffer_load_dwordx4 v9, s[32:35], s60 offen nt lds
 s_add_u32 m0, s70, 0x15000
 s_add_u32 s60, s72, 0x10040
 s_nop 0
 buffer_load_dwordx4 v10, s[36:39], s60 offen lds
 s_add_u32 m0, s70, 0x6000
 s_add_u32 s60, s71, 0x60000
 s_nop 0
 buffer_load_dwordx4 v8, s[32:35], s60 offen nt lds
 s_add_u32 m0, s70, 0x16000
 s_add_u32 s60, s72, 0x20040
 s_nop 0
 buffer_load_dwordx4 v10, s[36:39], s60 offen lds
 s_add_u32 m0, s70, 0x7000
 s_add_u32 s60, s71, 0x70000
 s_nop 0
 buffer_load_dwordx4 v9, s[32:35], s60 offen nt lds
 s_add_u32 m0, s70, 0x17000
 s_add_u32 s60, s72, 0x30040
 s_nop 0
 buffer_load_dwordx4 v10, s[36:39], s60 offen lds
 v_and_b32 v94, 1, v1
 v_lshlrev_b32 v94, 7, v94
 v_add_u32 v94, s100, v94
 v_add_u32 v94, 0x10000, v94
 v_min_u32 v94, f_done-parallel_sum__compressed_kv_cla__geglu_ffn__prompt_kernel, v94
 v_add_co_u32 v94, vcc, s98, v94
 v_mov_b32 v95, s99
 s_nop 0
 v_addc_co_u32 v95, vcc, 0, v95, vcc
 global_load_dword a170, v[94:95], off
 v_and_b32 v94, 1, v1
 v_lshlrev_b32 v94, 7, v94
 v_add_u32 v94, s100, v94
 v_add_u32 v94, 0x18000, v94
 v_min_u32 v94, f_done-parallel_sum__compressed_kv_cla__geglu_ffn__prompt_kernel, v94
 v_add_co_u32 v94, vcc, s98, v94
 v_mov_b32 v95, s99
 s_nop 0
 v_addc_co_u32 v95, vcc, 0, v95, vcc
 global_load_dword a170, v[94:95], off
 v_cmp_gt_u32 vcc, 8, v32
 s_waitcnt vmcnt(21)
 v_lshlrev_b32 v56, 16, v40
 v_and_b32 v57, 0xffff0000, v40
 v_lshlrev_b32 v58, 16, v41
 v_and_b32 v59, 0xffff0000, v41
 v_lshlrev_b32 v60, 16, v42
 v_and_b32 v61, 0xffff0000, v42
 v_lshlrev_b32 v62, 16, v43
 v_and_b32 v63, 0xffff0000, v43
 s_waitcnt vmcnt(20)
 v_lshlrev_b32 v64, 16, v44
 v_and_b32 v65, 0xffff0000, v44
 v_lshlrev_b32 v66, 16, v45
 v_and_b32 v67, 0xffff0000, v45
 v_lshlrev_b32 v68, 16, v46
 v_and_b32 v69, 0xffff0000, v46
 v_lshlrev_b32 v70, 16, v47
 v_and_b32 v71, 0xffff0000, v47
 s_waitcnt vmcnt(19)
 v_lshlrev_b32 v72, 16, v48
 v_and_b32 v73, 0xffff0000, v48
 v_lshlrev_b32 v74, 16, v49
 v_and_b32 v75, 0xffff0000, v49
 v_lshlrev_b32 v76, 16, v50
 v_and_b32 v77, 0xffff0000, v50
 v_lshlrev_b32 v78, 16, v51
 v_and_b32 v79, 0xffff0000, v51
 v_add_f32 v80, v56, v57
 v_add_f32 v80, v80, v58
 v_add_f32 v80, v80, v59
 v_add_f32 v80, v80, v60
 v_add_f32 v80, v80, v61
 v_add_f32 v80, v80, v62
 v_add_f32 v80, v80, v63
 v_add_f32 v80, v80, v64
 v_add_f32 v80, v80, v65
 v_add_f32 v80, v80, v66
 v_add_f32 v80, v80, v67
 v_add_f32 v80, v80, v68
 v_add_f32 v80, v80, v69
 v_add_f32 v80, v80, v70
 v_add_f32 v80, v80, v71
 v_add_f32 v80, v80, v72
 v_add_f32 v80, v80, v73
 v_add_f32 v80, v80, v74
 v_add_f32 v80, v80, v75
 v_add_f32 v80, v80, v76
 v_add_f32 v80, v80, v77
 v_add_f32 v80, v80, v78
 v_add_f32 v80, v80, v79
 s_nop 1
 v_add_f32_dpp v80, v80, v80 row_ror:8 row_mask:0xf bank_mask:0xf
 s_nop 1
 v_add_f32_dpp v80, v80, v80 row_ror:4 row_mask:0xf bank_mask:0xf
 s_nop 1
 v_add_f32_dpp v80, v80, v80 row_ror:2 row_mask:0xf bank_mask:0xf
 s_nop 1
 v_add_f32_dpp v80, v80, v80 row_ror:1 row_mask:0xf bank_mask:0xf
 v_mov_b32 v82, v80
 s_nop 1
 v_permlane16_swap_b32 v80, v82
 v_add_f32 v80, v80, v82
 v_mul_f32 v80, 0x3ae38e39, v80
 v_sub_f32 v56, v56, v80
 v_sub_f32 v57, v57, v80
 v_sub_f32 v58, v58, v80
 v_sub_f32 v59, v59, v80
 v_sub_f32 v60, v60, v80
 v_sub_f32 v61, v61, v80
 v_sub_f32 v62, v62, v80
 v_sub_f32 v63, v63, v80
 v_sub_f32 v64, v64, v80
 v_sub_f32 v65, v65, v80
 v_sub_f32 v66, v66, v80
 v_sub_f32 v67, v67, v80
 v_sub_f32 v68, v68, v80
 v_sub_f32 v69, v69, v80
 v_sub_f32 v70, v70, v80
 v_sub_f32 v71, v71, v80
 v_sub_f32 v72, v72, v80
 v_sub_f32 v73, v73, v80
 v_sub_f32 v74, v74, v80
 v_sub_f32 v75, v75, v80
 v_sub_f32 v76, v76, v80
 v_sub_f32 v77, v77, v80
 v_sub_f32 v78, v78, v80
 v_sub_f32 v79, v79, v80
 v_cndmask_b32 v72, 0, v72, vcc
 v_cndmask_b32 v73, 0, v73, vcc
 v_cndmask_b32 v74, 0, v74, vcc
 v_cndmask_b32 v75, 0, v75, vcc
 v_cndmask_b32 v76, 0, v76, vcc
 v_cndmask_b32 v77, 0, v77, vcc
 v_cndmask_b32 v78, 0, v78, vcc
 v_cndmask_b32 v79, 0, v79, vcc
 v_mul_f32 v80, v56, v56
 v_fmac_f32 v80, v57, v57
 v_fmac_f32 v80, v58, v58
 v_fmac_f32 v80, v59, v59
 v_fmac_f32 v80, v60, v60
 v_fmac_f32 v80, v61, v61
 v_fmac_f32 v80, v62, v62
 v_fmac_f32 v80, v63, v63
 v_fmac_f32 v80, v64, v64
 v_fmac_f32 v80, v65, v65
 v_fmac_f32 v80, v66, v66
 v_fmac_f32 v80, v67, v67
 v_fmac_f32 v80, v68, v68
 v_fmac_f32 v80, v69, v69
 v_fmac_f32 v80, v70, v70
 v_fmac_f32 v80, v71, v71
 v_fmac_f32 v80, v72, v72
 v_fmac_f32 v80, v73, v73
 v_fmac_f32 v80, v74, v74
 v_fmac_f32 v80, v75, v75
 v_fmac_f32 v80, v76, v76
 v_fmac_f32 v80, v77, v77
 v_fmac_f32 v80, v78, v78
 v_fmac_f32 v80, v79, v79
 s_nop 1
 v_add_f32_dpp v80, v80, v80 row_ror:8 row_mask:0xf bank_mask:0xf
 s_nop 1
 v_add_f32_dpp v80, v80, v80 row_ror:4 row_mask:0xf bank_mask:0xf
 s_nop 1
 v_add_f32_dpp v80, v80, v80 row_ror:2 row_mask:0xf bank_mask:0xf
 s_nop 1
 v_add_f32_dpp v80, v80, v80 row_ror:1 row_mask:0xf bank_mask:0xf
 v_mov_b32 v82, v80
 s_nop 1
 v_permlane16_swap_b32 v80, v82
 v_add_f32 v80, v80, v82
 v_mul_f32 v80, 0x3ae38e39, v80
 v_add_f32 v80, 0x3727c5ac, v80
 v_rsq_f32 v80, v80
 s_nop 0
 v_mul_f32 v56, v56, v80
 v_mul_f32 v57, v57, v80
 v_mul_f32 v58, v58, v80
 v_mul_f32 v59, v59, v80
 v_mul_f32 v60, v60, v80
 v_mul_f32 v61, v61, v80
 v_mul_f32 v62, v62, v80
 v_mul_f32 v63, v63, v80
 v_mul_f32 v64, v64, v80
 v_mul_f32 v65, v65, v80
 v_mul_f32 v66, v66, v80
 v_mul_f32 v67, v67, v80
 v_mul_f32 v68, v68, v80
 v_mul_f32 v69, v69, v80
 v_mul_f32 v70, v70, v80
 v_mul_f32 v71, v71, v80
 v_mul_f32 v72, v72, v80
 v_mul_f32 v73, v73, v80
 v_mul_f32 v74, v74, v80
 v_mul_f32 v75, v75, v80
 v_mul_f32 v76, v76, v80
 v_mul_f32 v77, v77, v80
 v_mul_f32 v78, v78, v80
 v_mul_f32 v79, v79, v80
 v_cvt_pk_bf16_f32 v40, v56, v57
 v_cvt_pk_bf16_f32 v41, v58, v59
 v_cvt_pk_bf16_f32 v42, v60, v61
 v_cvt_pk_bf16_f32 v43, v62, v63
 v_cvt_pk_bf16_f32 v44, v64, v65
 v_cvt_pk_bf16_f32 v45, v66, v67
 v_cvt_pk_bf16_f32 v46, v68, v69
 v_cvt_pk_bf16_f32 v47, v70, v71
 v_cvt_pk_bf16_f32 v48, v72, v73
 v_cvt_pk_bf16_f32 v49, v74, v75
 v_cvt_pk_bf16_f32 v50, v76, v77
 v_cvt_pk_bf16_f32 v51, v78, v79
 v_and_b32 v81, 7, v33
 v_lshlrev_b32 v81, 4, v81
 v_lshl_add_u32 v83, v32, 7, v81
 v_add_u32 v83, 0x20000, v83
 ds_write_b128 v83, v[40:43]
 ds_write_b128 v83, v[44:47] offset:4096
 v_add_u32 v82, 0x2000, v83
 v_mov_b32 v81, 0x24000
 v_cndmask_b32 v82, v81, v82, vcc
 ds_write_b128 v82, v[48:51]
 v_lshrrev_b32 v81, 3, v1
 v_lshrrev_b32 v82, 2, v81
 v_lshlrev_b32 v30, 10, v82
 v_and_b32 v81, 3, v81
 v_lshl_add_u32 v30, v81, 8, v30
 v_and_b32 v81, 7, v1
 v_lshl_add_u32 v30, v81, 4, v30
 s_lshr_b32 s30, s2, 1
 s_mul_i32 s30, s30, 0x4800
 s_and_b32 s31, s2, 1
 s_lshl_b32 s31, s31, 7
 s_add_u32 s30, s30, s31
 s_lshl_b32 s31, s3, 11
 s_add_u32 s30, s30, s31
 v_add_u32 v30, s30, v30
 s_lshl_b32 s30, s3, 10
 s_add_u32 s30, s30, 0x20000
 v_add_u32 v31, s30, v4
 s_waitcnt vmcnt(18)
 v_add_u32 v6, 2, v91
 v_or_b32 v6, 1, v6
 s_cmp_eq_u32 s76, 1
 s_cbranch_scc1 f_v
 s_waitcnt vmcnt(10)
 s_waitcnt lgkmcnt(0)
 s_barrier
 ds_read_b128 a[48:51], v19
 ds_read_b128 a[52:55], v19 offset:1024
 ds_read_b128 a[56:59], v19 offset:2048
 ds_read_b128 a[60:63], v19 offset:3072
 ds_read_b128 a[64:67], v19 offset:4096
 ds_read_b128 a[68:71], v19 offset:5120
 ds_read_b128 a[72:75], v19 offset:6144
 ds_read_b128 a[76:79], v19 offset:7168
 ds_read_b64_tr_b16 a[32:33], v11
 ds_read_b64_tr_b16 a[34:35], v11 offset:2048
 ds_read_b64_tr_b16 a[36:37], v12
 ds_read_b64_tr_b16 a[38:39], v12 offset:2048
 ds_read_b64_tr_b16 a[40:41], v13
 ds_read_b64_tr_b16 a[42:43], v13 offset:2048
 ds_read_b64_tr_b16 a[44:45], v14
 s_waitcnt lgkmcnt(14)
 ds_read_b64_tr_b16 a[46:47], v14 offset:2048
 s_waitcnt lgkmcnt(6)
 mf v[32:35], a[32:35], a[48:51], 0
 s_add_u32 m0, s70, 0x8000
 mf v[64:67], a[32:35], a[52:55], 0
 s_add_u32 s60, s71, 0x80000
 mf v[96:99], a[32:35], a[56:59], 0
 buffer_load_dwordx4 v8, s[32:35], s60 offen nt lds
 mf v[128:131], a[32:35], a[60:63], 0
 s_add_u32 m0, s70, 0x18000
 mf v[160:163], a[32:35], a[64:67], 0
 s_add_u32 s60, s72, 0x80
 mf v[192:195], a[32:35], a[68:71], 0
 buffer_load_dwordx4 v10, s[36:39], s60 offen lds
 mf v[224:227], a[32:35], a[72:75], 0
 s_add_u32 m0, s70, 0x9000
 mf a[0:3], a[32:35], a[76:79], 0
 s_waitcnt lgkmcnt(4)
 s_add_u32 s60, s71, 0x90000
 ds_read_b64_tr_b16 a[32:33], v15
 ds_read_b64_tr_b16 a[34:35], v15 offset:2048
 mf v[36:39], a[36:39], a[48:51], 0
 buffer_load_dwordx4 v9, s[32:35], s60 offen nt lds
 mf v[68:71], a[36:39], a[52:55], 0
 s_add_u32 m0, s70, 0x19000
 mf v[100:103], a[36:39], a[56:59], 0
 s_add_u32 s60, s72, 0x10080
 mf v[132:135], a[36:39], a[60:63], 0
 buffer_load_dwordx4 v10, s[36:39], s60 offen lds
 mf v[164:167], a[36:39], a[64:67], 0
 s_add_u32 m0, s70, 0xa000
 mf v[196:199], a[36:39], a[68:71], 0
 s_add_u32 s60, s71, 0xa0000
 mf v[228:231], a[36:39], a[72:75], 0
 buffer_load_dwordx4 v8, s[32:35], s60 offen nt lds
 mf a[4:7], a[36:39], a[76:79], 0
 s_waitcnt lgkmcnt(4)
 s_add_u32 m0, s70, 0x1a000
 ds_read_b64_tr_b16 a[36:37], v16
 ds_read_b64_tr_b16 a[38:39], v16 offset:2048
 mf v[40:43], a[40:43], a[48:51], 0
 s_add_u32 s60, s72, 0x20080
 mf v[72:75], a[40:43], a[52:55], 0
 buffer_load_dwordx4 v10, s[36:39], s60 offen lds
 mf v[104:107], a[40:43], a[56:59], 0
 s_add_u32 m0, s70, 0xb000
 mf v[136:139], a[40:43], a[60:63], 0
 s_add_u32 s60, s71, 0xb0000
 mf v[168:171], a[40:43], a[64:67], 0
 buffer_load_dwordx4 v9, s[32:35], s60 offen nt lds
 mf v[200:203], a[40:43], a[68:71], 0
 s_add_u32 m0, s70, 0x1b000
 mf v[232:235], a[40:43], a[72:75], 0
 s_add_u32 s60, s72, 0x30080
 mf a[8:11], a[40:43], a[76:79], 0
 s_waitcnt lgkmcnt(4)
 ds_read_b64_tr_b16 a[40:41], v17
 ds_read_b64_tr_b16 a[42:43], v17 offset:2048
 mf v[44:47], a[44:47], a[48:51], 0
 buffer_load_dwordx4 v10, s[36:39], s60 offen lds
 mf v[76:79], a[44:47], a[52:55], 0
 s_add_u32 m0, s70, 0xc000
 mf v[108:111], a[44:47], a[56:59], 0
 s_add_u32 s60, s71, 0xc0000
 mf v[140:143], a[44:47], a[60:63], 0
 buffer_load_dwordx4 v8, s[32:35], s60 offen nt lds
 mf v[172:175], a[44:47], a[64:67], 0
 s_add_u32 m0, s70, 0x1c000
 mf v[204:207], a[44:47], a[68:71], 0
 s_add_u32 s60, s72, 0xc0
 mf v[236:239], a[44:47], a[72:75], 0
 buffer_load_dwordx4 v10, s[36:39], s60 offen lds
 mf a[12:15], a[44:47], a[76:79], 0
 s_waitcnt lgkmcnt(4)
 s_add_u32 m0, s70, 0xd000
 ds_read_b64_tr_b16 a[44:45], v18
 ds_read_b64_tr_b16 a[46:47], v18 offset:2048
 mf v[48:51], a[32:35], a[48:51], 0
 s_add_u32 s60, s71, 0xd0000
 mf v[80:83], a[32:35], a[52:55], 0
 buffer_load_dwordx4 v9, s[32:35], s60 offen nt lds
 mf v[112:115], a[32:35], a[56:59], 0
 s_add_u32 m0, s70, 0x1d000
 mf v[144:147], a[32:35], a[60:63], 0
 s_add_u32 s60, s72, 0x100c0
 mf v[176:179], a[32:35], a[64:67], 0
 buffer_load_dwordx4 v10, s[36:39], s60 offen lds
 mf v[208:211], a[32:35], a[68:71], 0
 s_add_u32 m0, s70, 0xe000
 mf v[240:243], a[32:35], a[72:75], 0
 s_add_u32 s60, s71, 0xe0000
 mf a[16:19], a[32:35], a[76:79], 0
 s_waitcnt vmcnt(14)
 s_waitcnt lgkmcnt(0)
 s_barrier
 mf v[52:55], a[36:39], a[48:51], 0
 ds_read_b64_tr_b16 a[32:33], v11 offset:16384
 ds_read_b64_tr_b16 a[34:35], v11 offset:18432
 mf v[84:87], a[36:39], a[52:55], 0
 ds_read_b128 a[80:83], v19 offset:16384
 ds_read_b128 a[84:87], v19 offset:17408
 mf v[116:119], a[36:39], a[56:59], 0
 ds_read_b128 a[88:91], v19 offset:18432
 mf v[148:151], a[36:39], a[60:63], 0
 ds_read_b128 a[92:95], v19 offset:19456
 mf v[180:183], a[36:39], a[64:67], 0
 ds_read_b128 a[96:99], v19 offset:20480
 ds_read_b128 a[112:115], v31
 mf v[212:215], a[36:39], a[68:71], 0
 ds_read_b128 a[100:103], v19 offset:21504
 mf v[244:247], a[36:39], a[72:75], 0
 ds_read_b128 a[104:107], v19 offset:22528
 mf a[20:23], a[36:39], a[76:79], 0
 ds_read_b64_tr_b16 a[36:37], v12 offset:16384
 ds_read_b64_tr_b16 a[38:39], v12 offset:18432
 mf v[56:59], a[40:43], a[48:51], 0
 ds_read_b128 a[108:111], v19 offset:23552
 mf v[88:91], a[40:43], a[52:55], 0
 buffer_load_dwordx4 v8, s[32:35], s60 offen nt lds
 mf v[120:123], a[40:43], a[56:59], 0
 s_add_u32 m0, s70, 0x1e000
 mf v[152:155], a[40:43], a[60:63], 0
 s_add_u32 s60, s72, 0x200c0
 mf v[184:187], a[40:43], a[64:67], 0
 s_movk_i32 s62, 0
 buffer_load_dwordx4 v10, s[36:39], s60 offen lds
 mf v[216:219], a[40:43], a[68:71], 0
 s_add_u32 m0, s70, 0xf000
 s_waitcnt lgkmcnt(5)
 buffer_store_dwordx4 a[112:115], v30, s[48:51], s62 offen sc1
 mf v[248:251], a[40:43], a[72:75], 0
 s_add_u32 s60, s71, 0xf0000
 mf a[24:27], a[40:43], a[76:79], 0
 ds_read_b64_tr_b16 a[40:41], v13 offset:16384
 ds_read_b64_tr_b16 a[42:43], v13 offset:18432
 mf v[60:63], a[44:47], a[48:51], 0
 buffer_load_dwordx4 v9, s[32:35], s60 offen nt lds
 mf v[92:95], a[44:47], a[52:55], 0
 s_add_u32 m0, s70, 0x1f000
 mf v[124:127], a[44:47], a[56:59], 0
 s_add_u32 s60, s72, 0x300c0
 mf v[156:159], a[44:47], a[60:63], 0
 buffer_load_dwordx4 v10, s[36:39], s60 offen lds
 mf v[188:191], a[44:47], a[64:67], 0
 s_add_u32 m0, s70, 0
 mf v[220:223], a[44:47], a[68:71], 0
 s_add_u32 s60, s71, 0x100000
 ds_read_b128 a[116:119], v31 offset:4096
 mf v[252:255], a[44:47], a[72:75], 0
 buffer_load_dwordx4 v8, s[32:35], s60 offen nt lds
 mf a[28:31], a[44:47], a[76:79], 0
 ds_read_b64_tr_b16 a[44:45], v14 offset:16384
 ds_read_b64_tr_b16 a[46:47], v14 offset:18432
 mf v[32:35], a[32:35], a[80:83], v[32:35]
 mf v[64:67], a[32:35], a[84:87], v[64:67]
 s_add_u32 m0, s70, 0x10000
 mf v[96:99], a[32:35], a[88:91], v[96:99]
 s_add_u32 s60, s72, 0x100
 mf v[128:131], a[32:35], a[92:95], v[128:131]
 buffer_load_dwordx4 v10, s[36:39], s60 offen lds
 mf v[160:163], a[32:35], a[96:99], v[160:163]
 s_waitcnt lgkmcnt(9)
 mf v[192:195], a[32:35], a[100:103], v[192:195]
 s_movk_i32 s62, 0x2000
 s_waitcnt lgkmcnt(2)
 buffer_store_dwordx4 a[116:119], v30, s[48:51], s62 offen sc1
 mf v[224:227], a[32:35], a[104:107], v[224:227]
 s_add_u32 m0, s70, 0x1000
 mf a[0:3], a[32:35], a[108:111], a[0:3]
 s_add_u32 s60, s71, 0x110000
 ds_read_b64_tr_b16 a[32:33], v15 offset:16384
 ds_read_b64_tr_b16 a[34:35], v15 offset:18432
 mf v[36:39], a[36:39], a[80:83], v[36:39]
 buffer_load_dwordx4 v9, s[32:35], s60 offen nt lds
 mf v[68:71], a[36:39], a[84:87], v[68:71]
 mf v[100:103], a[36:39], a[88:91], v[100:103]
 mf v[132:135], a[36:39], a[92:95], v[132:135]
 s_add_u32 m0, s70, 0x11000
 mf v[164:167], a[36:39], a[96:99], v[164:167]
 s_add_u32 s60, s72, 0x10100
 mf v[196:199], a[36:39], a[100:103], v[196:199]
 buffer_load_dwordx4 v10, s[36:39], s60 offen lds
 mf v[228:231], a[36:39], a[104:107], v[228:231]
 s_cmp_eq_u32 s3, 0
 ds_read_b128 a[120:123], v31 offset:8192
 mf a[4:7], a[36:39], a[108:111], a[4:7]
 s_cselect_b32 s62, 0, 0x7ff00000
 ds_read_b64_tr_b16 a[36:37], v16 offset:16384
 ds_read_b64_tr_b16 a[38:39], v16 offset:18432
 mf v[40:43], a[40:43], a[80:83], v[40:43]
 s_add_u32 m0, s70, 0x2000
 v_add_u32 v31, s62, v30
 mf v[72:75], a[40:43], a[84:87], v[72:75]
 s_add_u32 s60, s71, 0x120000
 mf v[104:107], a[40:43], a[88:91], v[104:107]
 buffer_load_dwordx4 v8, s[32:35], s60 offen nt lds
 mf v[136:139], a[40:43], a[92:95], v[136:139]
 mf v[168:171], a[40:43], a[96:99], v[168:171]
 mf v[200:203], a[40:43], a[100:103], v[200:203]
 s_add_u32 m0, s70, 0x12000
 mf v[232:235], a[40:43], a[104:107], v[232:235]
 s_add_u32 s60, s72, 0x20100
 mf a[8:11], a[40:43], a[108:111], a[8:11]
 s_waitcnt lgkmcnt(5)
 ds_read_b64_tr_b16 a[40:41], v17 offset:16384
 ds_read_b64_tr_b16 a[42:43], v17 offset:18432
 mf v[44:47], a[44:47], a[80:83], v[44:47]
 s_movk_i32 s62, 0x4000
 buffer_load_dwordx4 v10, s[36:39], s60 offen lds
 mf v[76:79], a[44:47], a[84:87], v[76:79]
 s_waitcnt lgkmcnt(4)
 buffer_store_dwordx4 a[120:123], v31, s[48:51], s62 offen sc1
 mf v[108:111], a[44:47], a[88:91], v[108:111]
 s_add_u32 m0, s70, 0x3000
 mf v[140:143], a[44:47], a[92:95], v[140:143]
 s_add_u32 s60, s71, 0x130000
 mf v[172:175], a[44:47], a[96:99], v[172:175]
 buffer_load_dwordx4 v9, s[32:35], s60 offen nt lds
 mf v[204:207], a[44:47], a[100:103], v[204:207]
 mf v[236:239], a[44:47], a[104:107], v[236:239]
 mf a[12:15], a[44:47], a[108:111], a[12:15]
 s_add_u32 m0, s70, 0x13000
 ds_read_b64_tr_b16 a[44:45], v18 offset:16384
 ds_read_b64_tr_b16 a[46:47], v18 offset:18432
 mf v[48:51], a[32:35], a[80:83], v[48:51]
 s_add_u32 s60, s72, 0x30100
 mf v[80:83], a[32:35], a[84:87], v[80:83]
 buffer_load_dwordx4 v10, s[36:39], s60 offen lds
 mf v[112:115], a[32:35], a[88:91], v[112:115]
 mf v[144:147], a[32:35], a[92:95], v[144:147]
 mf v[176:179], a[32:35], a[96:99], v[176:179]
 mf v[208:211], a[32:35], a[100:103], v[208:211]
 mf v[240:243], a[32:35], a[104:107], v[240:243]
 mf a[16:19], a[32:35], a[108:111], a[16:19]
 s_waitcnt vmcnt(19)
 s_waitcnt lgkmcnt(0)
 s_barrier
 mf v[52:55], a[36:39], a[80:83], v[52:55]
 s_add_u32 m0, s70, 0x4000
 ds_read_b64_tr_b16 a[32:33], v11 offset:32768
 ds_read_b64_tr_b16 a[34:35], v11 offset:34816
 mf v[84:87], a[36:39], a[84:87], v[84:87]
 s_add_u32 s60, s71, 0x140000
 ds_read_b128 a[48:51], v19 offset:32768
 ds_read_b128 a[52:55], v19 offset:33792
 mf v[116:119], a[36:39], a[88:91], v[116:119]
 ds_read_b128 a[56:59], v19 offset:34816
 mf v[148:151], a[36:39], a[92:95], v[148:151]
 ds_read_b128 a[60:63], v19 offset:35840
 mf v[180:183], a[36:39], a[96:99], v[180:183]
 ds_read_b128 a[64:67], v19 offset:36864
 mf v[212:215], a[36:39], a[100:103], v[212:215]
 ds_read_b128 a[68:71], v19 offset:37888
 mf v[244:247], a[36:39], a[104:107], v[244:247]
 ds_read_b128 a[72:75], v19 offset:38912
 mf a[20:23], a[36:39], a[108:111], a[20:23]
 ds_read_b64_tr_b16 a[36:37], v12 offset:32768
 ds_read_b64_tr_b16 a[38:39], v12 offset:34816
 mf v[56:59], a[40:43], a[80:83], v[56:59]
 ds_read_b128 a[76:79], v19 offset:39936
 mf v[88:91], a[40:43], a[84:87], v[88:91]
 buffer_load_dwordx4 v8, s[32:35], s60 offen nt lds
 mf v[120:123], a[40:43], a[88:91], v[120:123]
 s_add_u32 m0, s70, 0x14000
 mf v[152:155], a[40:43], a[92:95], v[152:155]
 s_add_u32 s60, s72, 0x140
 mf v[184:187], a[40:43], a[96:99], v[184:187]
 buffer_load_dwordx4 v10, s[36:39], s60 offen lds
 mf v[216:219], a[40:43], a[100:103], v[216:219]
 mf v[248:251], a[40:43], a[104:107], v[248:251]
 mf a[24:27], a[40:43], a[108:111], a[24:27]
 s_add_u32 m0, s70, 0x5000
 ds_read_b64_tr_b16 a[40:41], v13 offset:32768
 ds_read_b64_tr_b16 a[42:43], v13 offset:34816
 mf v[60:63], a[44:47], a[80:83], v[60:63]
 s_add_u32 s60, s71, 0x150000
 mf v[92:95], a[44:47], a[84:87], v[92:95]
 buffer_load_dwordx4 v9, s[32:35], s60 offen nt lds
 mf v[124:127], a[44:47], a[88:91], v[124:127]
 mf v[156:159], a[44:47], a[92:95], v[156:159]
 mf v[188:191], a[44:47], a[96:99], v[188:191]
 s_add_u32 m0, s70, 0x15000
 mf v[220:223], a[44:47], a[100:103], v[220:223]
 s_add_u32 s60, s72, 0x10140
 mf v[252:255], a[44:47], a[104:107], v[252:255]
 buffer_load_dwordx4 v10, s[36:39], s60 offen lds
 mf a[28:31], a[44:47], a[108:111], a[28:31]
 ds_read_b64_tr_b16 a[44:45], v14 offset:32768
 s_waitcnt lgkmcnt(14)
 ds_read_b64_tr_b16 a[46:47], v14 offset:34816
 s_waitcnt lgkmcnt(13)
 mf v[32:35], a[32:35], a[48:51], v[32:35]
 s_waitcnt lgkmcnt(12)
 mf v[64:67], a[32:35], a[52:55], v[64:67]
 s_waitcnt lgkmcnt(11)
 s_add_u32 m0, s70, 0x6000
 mf v[96:99], a[32:35], a[56:59], v[96:99]
 s_waitcnt lgkmcnt(10)
 s_add_u32 s60, s71, 0x160000
 mf v[128:131], a[32:35], a[60:63], v[128:131]
 s_waitcnt lgkmcnt(9)
 buffer_load_dwordx4 v8, s[32:35], s60 offen nt lds
 mf v[160:163], a[32:35], a[64:67], v[160:163]
 s_waitcnt lgkmcnt(8)
 mf v[192:195], a[32:35], a[68:71], v[192:195]
 s_waitcnt lgkmcnt(7)
 mf v[224:227], a[32:35], a[72:75], v[224:227]
 s_waitcnt lgkmcnt(4)
 s_add_u32 m0, s70, 0x16000
 mf a[0:3], a[32:35], a[76:79], a[0:3]
 s_add_u32 s60, s72, 0x20140
 ds_read_b64_tr_b16 a[32:33], v15 offset:32768
 ds_read_b64_tr_b16 a[34:35], v15 offset:34816
 mf v[36:39], a[36:39], a[48:51], v[36:39]
 buffer_load_dwordx4 v10, s[36:39], s60 offen lds
 mf v[68:71], a[36:39], a[52:55], v[68:71]
 mf v[100:103], a[36:39], a[56:59], v[100:103]
 mf v[132:135], a[36:39], a[60:63], v[132:135]
 s_add_u32 m0, s70, 0x7000
 mf v[164:167], a[36:39], a[64:67], v[164:167]
 s_add_u32 s60, s71, 0x170000
 mf v[196:199], a[36:39], a[68:71], v[196:199]
 buffer_load_dwordx4 v9, s[32:35], s60 offen nt lds
 mf v[228:231], a[36:39], a[72:75], v[228:231]
 mf a[4:7], a[36:39], a[76:79], a[4:7]
 s_waitcnt lgkmcnt(4)
 ds_read_b64_tr_b16 a[36:37], v16 offset:32768
 ds_read_b64_tr_b16 a[38:39], v16 offset:34816
 mf v[40:43], a[40:43], a[48:51], v[40:43]
 s_add_u32 m0, s70, 0x17000
 mf v[72:75], a[40:43], a[52:55], v[72:75]
 s_add_u32 s60, s72, 0x30140
 mf v[104:107], a[40:43], a[56:59], v[104:107]
 buffer_load_dwordx4 v10, s[36:39], s60 offen lds
 mf v[136:139], a[40:43], a[60:63], v[136:139]
 mf v[168:171], a[40:43], a[64:67], v[168:171]
 mf v[200:203], a[40:43], a[68:71], v[200:203]
 s_mov_b32 s56, s18
 mf v[232:235], a[40:43], a[72:75], v[232:235]
 s_mov_b32 s57, s19
 mf a[8:11], a[40:43], a[76:79], a[8:11]
 s_waitcnt lgkmcnt(4)
 s_mov_b32 s58, 0x510000
 ds_read_b64_tr_b16 a[40:41], v17 offset:32768
 ds_read_b64_tr_b16 a[42:43], v17 offset:34816
 mf v[44:47], a[44:47], a[48:51], v[44:47]
 s_mov_b32 s59, 0x20000
 v_add_u32 v30, 0, v7
 mf v[76:79], a[44:47], a[52:55], v[76:79]
 buffer_load_dword a170, v30, s[56:59], 0 offen
 mf v[108:111], a[44:47], a[56:59], v[108:111]
 mf v[140:143], a[44:47], a[60:63], v[140:143]
 mf v[172:175], a[44:47], a[64:67], v[172:175]
 mf v[204:207], a[44:47], a[68:71], v[204:207]
 mf v[236:239], a[44:47], a[72:75], v[236:239]
 mf a[12:15], a[44:47], a[76:79], a[12:15]
 s_waitcnt lgkmcnt(4)
 ds_read_b64_tr_b16 a[44:45], v18 offset:32768
 ds_read_b64_tr_b16 a[46:47], v18 offset:34816
 mf v[48:51], a[32:35], a[48:51], v[48:51]
 mf v[80:83], a[32:35], a[52:55], v[80:83]
 mf v[112:115], a[32:35], a[56:59], v[112:115]
 mf v[144:147], a[32:35], a[60:63], v[144:147]
 mf v[176:179], a[32:35], a[64:67], v[176:179]
 mf v[208:211], a[32:35], a[68:71], v[208:211]
 mf v[240:243], a[32:35], a[72:75], v[240:243]
 mf a[16:19], a[32:35], a[76:79], a[16:19]
 s_waitcnt vmcnt(19)
 s_waitcnt lgkmcnt(0)
 s_barrier
 mf v[52:55], a[36:39], a[48:51], v[52:55]
 s_add_u32 m0, s70, 0x8000
 ds_read_b64_tr_b16 a[32:33], v11 offset:49152
 ds_read_b64_tr_b16 a[34:35], v11 offset:51200
 mf v[84:87], a[36:39], a[52:55], v[84:87]
 s_add_u32 s60, s71, 0x180000
 ds_read_b128 a[80:83], v19 offset:49152
 ds_read_b128 a[84:87], v19 offset:50176
 mf v[116:119], a[36:39], a[56:59], v[116:119]
 ds_read_b128 a[88:91], v19 offset:51200
 mf v[148:151], a[36:39], a[60:63], v[148:151]
 ds_read_b128 a[92:95], v19 offset:52224
 mf v[180:183], a[36:39], a[64:67], v[180:183]
 ds_read_b128 a[96:99], v19 offset:53248
 mf v[212:215], a[36:39], a[68:71], v[212:215]
 ds_read_b128 a[100:103], v19 offset:54272
 mf v[244:247], a[36:39], a[72:75], v[244:247]
 ds_read_b128 a[104:107], v19 offset:55296
 mf a[20:23], a[36:39], a[76:79], a[20:23]
 ds_read_b64_tr_b16 a[36:37], v12 offset:49152
 ds_read_b64_tr_b16 a[38:39], v12 offset:51200
 mf v[56:59], a[40:43], a[48:51], v[56:59]
 ds_read_b128 a[108:111], v19 offset:56320
 mf v[88:91], a[40:43], a[52:55], v[88:91]
 buffer_load_dwordx4 v8, s[32:35], s60 offen nt lds
 mf v[120:123], a[40:43], a[56:59], v[120:123]
 s_add_u32 m0, s70, 0x18000
 mf v[152:155], a[40:43], a[60:63], v[152:155]
 s_add_u32 s60, s72, 0x180
 mf v[184:187], a[40:43], a[64:67], v[184:187]
 buffer_load_dwordx4 v10, s[36:39], s60 offen lds
 mf v[216:219], a[40:43], a[68:71], v[216:219]
 mf v[248:251], a[40:43], a[72:75], v[248:251]
 mf a[24:27], a[40:43], a[76:79], a[24:27]
 s_add_u32 m0, s70, 0x9000
 ds_read_b64_tr_b16 a[40:41], v13 offset:49152
 ds_read_b64_tr_b16 a[42:43], v13 offset:51200
 mf v[60:63], a[44:47], a[48:51], v[60:63]
 s_add_u32 s60, s71, 0x190000
 mf v[92:95], a[44:47], a[52:55], v[92:95]
 buffer_load_dwordx4 v9, s[32:35], s60 offen nt lds
 mf v[124:127], a[44:47], a[56:59], v[124:127]
 mf v[156:159], a[44:47], a[60:63], v[156:159]
 mf v[188:191], a[44:47], a[64:67], v[188:191]
 s_add_u32 m0, s70, 0x19000
 mf v[220:223], a[44:47], a[68:71], v[220:223]
 s_add_u32 s60, s72, 0x10180
 mf v[252:255], a[44:47], a[72:75], v[252:255]
 buffer_load_dwordx4 v10, s[36:39], s60 offen lds
 mf a[28:31], a[44:47], a[76:79], a[28:31]
 ds_read_b64_tr_b16 a[44:45], v14 offset:49152
 s_waitcnt lgkmcnt(14)
 ds_read_b64_tr_b16 a[46:47], v14 offset:51200
 s_waitcnt lgkmcnt(13)
 mf v[32:35], a[32:35], a[80:83], v[32:35]
 s_waitcnt lgkmcnt(12)
 mf v[64:67], a[32:35], a[84:87], v[64:67]
 s_waitcnt lgkmcnt(11)
 s_add_u32 m0, s70, 0xa000
 mf v[96:99], a[32:35], a[88:91], v[96:99]
 s_waitcnt lgkmcnt(10)
 s_add_u32 s60, s71, 0x1a0000
 mf v[128:131], a[32:35], a[92:95], v[128:131]
 s_waitcnt lgkmcnt(9)
 buffer_load_dwordx4 v8, s[32:35], s60 offen nt lds
 mf v[160:163], a[32:35], a[96:99], v[160:163]
 s_waitcnt lgkmcnt(8)
 mf v[192:195], a[32:35], a[100:103], v[192:195]
 s_waitcnt lgkmcnt(7)
 mf v[224:227], a[32:35], a[104:107], v[224:227]
 s_waitcnt lgkmcnt(4)
 s_add_u32 m0, s70, 0x1a000
 mf a[0:3], a[32:35], a[108:111], a[0:3]
 s_add_u32 s60, s72, 0x20180
 ds_read_b64_tr_b16 a[32:33], v15 offset:49152
 ds_read_b64_tr_b16 a[34:35], v15 offset:51200
 mf v[36:39], a[36:39], a[80:83], v[36:39]
 buffer_load_dwordx4 v10, s[36:39], s60 offen lds
 mf v[68:71], a[36:39], a[84:87], v[68:71]
 mf v[100:103], a[36:39], a[88:91], v[100:103]
 mf v[132:135], a[36:39], a[92:95], v[132:135]
 s_add_u32 m0, s70, 0xb000
 mf v[164:167], a[36:39], a[96:99], v[164:167]
 s_add_u32 s60, s71, 0x1b0000
 mf v[196:199], a[36:39], a[100:103], v[196:199]
 buffer_load_dwordx4 v9, s[32:35], s60 offen nt lds
 mf v[228:231], a[36:39], a[104:107], v[228:231]
 mf a[4:7], a[36:39], a[108:111], a[4:7]
 s_waitcnt lgkmcnt(4)
 ds_read_b64_tr_b16 a[36:37], v16 offset:49152
 ds_read_b64_tr_b16 a[38:39], v16 offset:51200
 mf v[40:43], a[40:43], a[80:83], v[40:43]
 s_add_u32 m0, s70, 0x1b000
 mf v[72:75], a[40:43], a[84:87], v[72:75]
 s_add_u32 s60, s72, 0x30180
 mf v[104:107], a[40:43], a[88:91], v[104:107]
 buffer_load_dwordx4 v10, s[36:39], s60 offen lds
 mf v[136:139], a[40:43], a[92:95], v[136:139]
 mf v[168:171], a[40:43], a[96:99], v[168:171]
 mf v[200:203], a[40:43], a[100:103], v[200:203]
 s_mov_b32 s56, s20
 mf v[232:235], a[40:43], a[104:107], v[232:235]
 s_mov_b32 s57, s21
 mf a[8:11], a[40:43], a[108:111], a[8:11]
 s_waitcnt lgkmcnt(4)
 s_mov_b32 s58, 0x510000
 ds_read_b64_tr_b16 a[40:41], v17 offset:49152
 ds_read_b64_tr_b16 a[42:43], v17 offset:51200
 mf v[44:47], a[44:47], a[80:83], v[44:47]
 s_mov_b32 s59, 0x20000
 v_add_u32 v30, 0, v7
 mf v[76:79], a[44:47], a[84:87], v[76:79]
 buffer_load_dword a170, v30, s[56:59], 0 offen
 mf v[108:111], a[44:47], a[88:91], v[108:111]
 mf v[140:143], a[44:47], a[92:95], v[140:143]
 s_lshl_b32 s62, s2, 7
 mf v[172:175], a[44:47], a[96:99], v[172:175]
 mf v[204:207], a[44:47], a[100:103], v[204:207]
 mf v[236:239], a[44:47], a[104:107], v[236:239]
 mf a[12:15], a[44:47], a[108:111], a[12:15]
 s_waitcnt lgkmcnt(4)
 ds_read_b64_tr_b16 a[44:45], v18 offset:49152
 ds_read_b64_tr_b16 a[46:47], v18 offset:51200
 mf v[48:51], a[32:35], a[80:83], v[48:51]
 mf v[80:83], a[32:35], a[84:87], v[80:83]
 mf v[112:115], a[32:35], a[88:91], v[112:115]
 mf v[144:147], a[32:35], a[92:95], v[144:147]
 mf v[176:179], a[32:35], a[96:99], v[176:179]
 mf v[208:211], a[32:35], a[100:103], v[208:211]
 mf v[240:243], a[32:35], a[104:107], v[240:243]
 mf a[16:19], a[32:35], a[108:111], a[16:19]
 s_waitcnt vmcnt(20)
 s_waitcnt vmcnt(18)
 s_waitcnt lgkmcnt(0)
 s_barrier
 mf v[52:55], a[36:39], a[80:83], v[52:55]
 s_add_u32 m0, s70, 0xc000
 ds_read_b64_tr_b16 a[32:33], v11
 ds_read_b64_tr_b16 a[34:35], v11 offset:2048
 mf v[84:87], a[36:39], a[84:87], v[84:87]
 s_add_u32 s60, s71, 0x1c0000
 ds_read_b128 a[48:51], v19
 ds_read_b128 a[52:55], v19 offset:1024
 mf v[116:119], a[36:39], a[88:91], v[116:119]
 ds_read_b128 a[56:59], v19 offset:2048
 mf v[148:151], a[36:39], a[92:95], v[148:151]
 ds_read_b128 a[60:63], v19 offset:3072
 mf v[180:183], a[36:39], a[96:99], v[180:183]
 ds_read_b128 a[64:67], v19 offset:4096
 mf v[212:215], a[36:39], a[100:103], v[212:215]
 ds_read_b128 a[68:71], v19 offset:5120
 mf v[244:247], a[36:39], a[104:107], v[244:247]
 ds_read_b128 a[72:75], v19 offset:6144
 mf a[20:23], a[36:39], a[108:111], a[20:23]
 ds_read_b64_tr_b16 a[36:37], v12
 ds_read_b64_tr_b16 a[38:39], v12 offset:2048
 mf v[56:59], a[40:43], a[80:83], v[56:59]
 ds_read_b128 a[76:79], v19 offset:7168
 mf v[88:91], a[40:43], a[84:87], v[88:91]
 buffer_load_dwordx4 v8, s[32:35], s60 offen nt lds
 mf v[120:123], a[40:43], a[88:91], v[120:123]
 s_add_u32 m0, s70, 0x1c000
 buffer_store_dword v6, v5, s[52:55], s62 offen sc1
 mf v[152:155], a[40:43], a[92:95], v[152:155]
 s_add_u32 s60, s72, 0x1c0
 mf v[184:187], a[40:43], a[96:99], v[184:187]
 buffer_load_dwordx4 v10, s[36:39], s60 offen lds
 mf v[216:219], a[40:43], a[100:103], v[216:219]
 mf v[248:251], a[40:43], a[104:107], v[248:251]
 mf a[24:27], a[40:43], a[108:111], a[24:27]
 s_add_u32 m0, s70, 0xd000
 ds_read_b64_tr_b16 a[40:41], v13
 ds_read_b64_tr_b16 a[42:43], v13 offset:2048
 mf v[60:63], a[44:47], a[80:83], v[60:63]
 s_add_u32 s60, s71, 0x1d0000
 mf v[92:95], a[44:47], a[84:87], v[92:95]
 buffer_load_dwordx4 v9, s[32:35], s60 offen nt lds
 mf v[124:127], a[44:47], a[88:91], v[124:127]
 mf v[156:159], a[44:47], a[92:95], v[156:159]
 mf v[188:191], a[44:47], a[96:99], v[188:191]
 s_add_u32 m0, s70, 0x1d000
 mf v[220:223], a[44:47], a[100:103], v[220:223]
 s_add_u32 s60, s72, 0x101c0
 mf v[252:255], a[44:47], a[104:107], v[252:255]
 buffer_load_dwordx4 v10, s[36:39], s60 offen lds
 mf a[28:31], a[44:47], a[108:111], a[28:31]
 ds_read_b64_tr_b16 a[44:45], v14
 s_waitcnt lgkmcnt(14)
 ds_read_b64_tr_b16 a[46:47], v14 offset:2048
 s_waitcnt lgkmcnt(13)
 mf v[32:35], a[32:35], a[48:51], v[32:35]
 s_waitcnt lgkmcnt(12)
 mf v[64:67], a[32:35], a[52:55], v[64:67]
 s_waitcnt lgkmcnt(11)
 s_add_u32 m0, s70, 0xe000
 mf v[96:99], a[32:35], a[56:59], v[96:99]
 s_waitcnt lgkmcnt(10)
 s_add_u32 s60, s71, 0x1e0000
 mf v[128:131], a[32:35], a[60:63], v[128:131]
 s_waitcnt lgkmcnt(9)
 buffer_load_dwordx4 v8, s[32:35], s60 offen nt lds
 mf v[160:163], a[32:35], a[64:67], v[160:163]
 s_waitcnt lgkmcnt(8)
 mf v[192:195], a[32:35], a[68:71], v[192:195]
 s_waitcnt lgkmcnt(7)
 mf v[224:227], a[32:35], a[72:75], v[224:227]
 s_waitcnt lgkmcnt(4)
 s_add_u32 m0, s70, 0x1e000
 mf a[0:3], a[32:35], a[76:79], a[0:3]
 s_add_u32 s60, s72, 0x201c0
 ds_read_b64_tr_b16 a[32:33], v15
 ds_read_b64_tr_b16 a[34:35], v15 offset:2048
 mf v[36:39], a[36:39], a[48:51], v[36:39]
 buffer_load_dwordx4 v10, s[36:39], s60 offen lds
 mf v[68:71], a[36:39], a[52:55], v[68:71]
 mf v[100:103], a[36:39], a[56:59], v[100:103]
 mf v[132:135], a[36:39], a[60:63], v[132:135]
 s_add_u32 m0, s70, 0xf000
 mf v[164:167], a[36:39], a[64:67], v[164:167]
 s_add_u32 s60, s71, 0x1f0000
 mf v[196:199], a[36:39], a[68:71], v[196:199]
 buffer_load_dwordx4 v9, s[32:35], s60 offen nt lds
 mf v[228:231], a[36:39], a[72:75], v[228:231]
 mf a[4:7], a[36:39], a[76:79], a[4:7]
 s_waitcnt lgkmcnt(4)
 ds_read_b64_tr_b16 a[36:37], v16
 ds_read_b64_tr_b16 a[38:39], v16 offset:2048
 mf v[40:43], a[40:43], a[48:51], v[40:43]
 s_add_u32 m0, s70, 0x1f000
 mf v[72:75], a[40:43], a[52:55], v[72:75]
 s_add_u32 s60, s72, 0x301c0
 mf v[104:107], a[40:43], a[56:59], v[104:107]
 buffer_load_dwordx4 v10, s[36:39], s60 offen lds
 mf v[136:139], a[40:43], a[60:63], v[136:139]
 mf v[168:171], a[40:43], a[64:67], v[168:171]
 mf v[200:203], a[40:43], a[68:71], v[200:203]
 s_mov_b32 s56, s18
 mf v[232:235], a[40:43], a[72:75], v[232:235]
 s_mov_b32 s57, s19
 mf a[8:11], a[40:43], a[76:79], a[8:11]
 s_waitcnt lgkmcnt(4)
 s_mov_b32 s58, 0x510000
 ds_read_b64_tr_b16 a[40:41], v17
 ds_read_b64_tr_b16 a[42:43], v17 offset:2048
 mf v[44:47], a[44:47], a[48:51], v[44:47]
 s_mov_b32 s59, 0x20000
 v_add_u32 v30, 0x100000, v7
 mf v[76:79], a[44:47], a[52:55], v[76:79]
 buffer_load_dword a170, v30, s[56:59], 0 offen
 mf v[108:111], a[44:47], a[56:59], v[108:111]
 mf v[140:143], a[44:47], a[60:63], v[140:143]
 mf v[172:175], a[44:47], a[64:67], v[172:175]
 mf v[204:207], a[44:47], a[68:71], v[204:207]
 mf v[236:239], a[44:47], a[72:75], v[236:239]
 mf a[12:15], a[44:47], a[76:79], a[12:15]
 s_waitcnt lgkmcnt(4)
 ds_read_b64_tr_b16 a[44:45], v18
 ds_read_b64_tr_b16 a[46:47], v18 offset:2048
 mf v[48:51], a[32:35], a[48:51], v[48:51]
 mf v[80:83], a[32:35], a[52:55], v[80:83]
 mf v[112:115], a[32:35], a[56:59], v[112:115]
 mf v[144:147], a[32:35], a[60:63], v[144:147]
 mf v[176:179], a[32:35], a[64:67], v[176:179]
 mf v[208:211], a[32:35], a[68:71], v[208:211]
 mf v[240:243], a[32:35], a[72:75], v[240:243]
 mf a[16:19], a[32:35], a[76:79], a[16:19]
 s_waitcnt vmcnt(20)
 s_waitcnt lgkmcnt(0)
 s_barrier
 mf v[52:55], a[36:39], a[48:51], v[52:55]
 s_add_u32 m0, s70, 0
 ds_read_b64_tr_b16 a[32:33], v11 offset:16384
 ds_read_b64_tr_b16 a[34:35], v11 offset:18432
 mf v[84:87], a[36:39], a[52:55], v[84:87]
 s_add_u32 s60, s71, 0x200000
 ds_read_b128 a[80:83], v19 offset:16384
 ds_read_b128 a[84:87], v19 offset:17408
 mf v[116:119], a[36:39], a[56:59], v[116:119]
 ds_read_b128 a[88:91], v19 offset:18432
 mf v[148:151], a[36:39], a[60:63], v[148:151]
 ds_read_b128 a[92:95], v19 offset:19456
 mf v[180:183], a[36:39], a[64:67], v[180:183]
 ds_read_b128 a[96:99], v19 offset:20480
 mf v[212:215], a[36:39], a[68:71], v[212:215]
 ds_read_b128 a[100:103], v19 offset:21504
 mf v[244:247], a[36:39], a[72:75], v[244:247]
 ds_read_b128 a[104:107], v19 offset:22528
 mf a[20:23], a[36:39], a[76:79], a[20:23]
 ds_read_b64_tr_b16 a[36:37], v12 offset:16384
 ds_read_b64_tr_b16 a[38:39], v12 offset:18432
 mf v[56:59], a[40:43], a[48:51], v[56:59]
 ds_read_b128 a[108:111], v19 offset:23552
 mf v[88:91], a[40:43], a[52:55], v[88:91]
 buffer_load_dwordx4 v8, s[32:35], s60 offen nt lds
 mf v[120:123], a[40:43], a[56:59], v[120:123]
 s_add_u32 m0, s70, 0x10000
 mf v[152:155], a[40:43], a[60:63], v[152:155]
 s_add_u32 s60, s72, 0x200
 mf v[184:187], a[40:43], a[64:67], v[184:187]
 buffer_load_dwordx4 v10, s[36:39], s60 offen lds
 mf v[216:219], a[40:43], a[68:71], v[216:219]
 mf v[248:251], a[40:43], a[72:75], v[248:251]
 mf a[24:27], a[40:43], a[76:79], a[24:27]
 s_add_u32 m0, s70, 0x1000
 ds_read_b64_tr_b16 a[40:41], v13 offset:16384
 ds_read_b64_tr_b16 a[42:43], v13 offset:18432
 mf v[60:63], a[44:47], a[48:51], v[60:63]
 s_add_u32 s60, s71, 0x210000
 mf v[92:95], a[44:47], a[52:55], v[92:95]
 buffer_load_dwordx4 v9, s[32:35], s60 offen nt lds
 mf v[124:127], a[44:47], a[56:59], v[124:127]
 mf v[156:159], a[44:47], a[60:63], v[156:159]
 mf v[188:191], a[44:47], a[64:67], v[188:191]
 s_add_u32 m0, s70, 0x11000
 mf v[220:223], a[44:47], a[68:71], v[220:223]
 s_add_u32 s60, s72, 0x10200
 mf v[252:255], a[44:47], a[72:75], v[252:255]
 buffer_load_dwordx4 v10, s[36:39], s60 offen lds
 mf a[28:31], a[44:47], a[76:79], a[28:31]
 ds_read_b64_tr_b16 a[44:45], v14 offset:16384
 s_waitcnt lgkmcnt(14)
 ds_read_b64_tr_b16 a[46:47], v14 offset:18432
 s_waitcnt lgkmcnt(13)
 mf v[32:35], a[32:35], a[80:83], v[32:35]
 s_waitcnt lgkmcnt(12)
 mf v[64:67], a[32:35], a[84:87], v[64:67]
 s_waitcnt lgkmcnt(11)
 s_add_u32 m0, s70, 0x2000
 mf v[96:99], a[32:35], a[88:91], v[96:99]
 s_waitcnt lgkmcnt(10)
 s_add_u32 s60, s71, 0x220000
 mf v[128:131], a[32:35], a[92:95], v[128:131]
 s_waitcnt lgkmcnt(9)
 buffer_load_dwordx4 v8, s[32:35], s60 offen nt lds
 mf v[160:163], a[32:35], a[96:99], v[160:163]
 s_waitcnt lgkmcnt(8)
 mf v[192:195], a[32:35], a[100:103], v[192:195]
 s_waitcnt lgkmcnt(7)
 mf v[224:227], a[32:35], a[104:107], v[224:227]
 s_waitcnt lgkmcnt(4)
 s_add_u32 m0, s70, 0x12000
 mf a[0:3], a[32:35], a[108:111], a[0:3]
 s_add_u32 s60, s72, 0x20200
 ds_read_b64_tr_b16 a[32:33], v15 offset:16384
 ds_read_b64_tr_b16 a[34:35], v15 offset:18432
 mf v[36:39], a[36:39], a[80:83], v[36:39]
 buffer_load_dwordx4 v10, s[36:39], s60 offen lds
 mf v[68:71], a[36:39], a[84:87], v[68:71]
 mf v[100:103], a[36:39], a[88:91], v[100:103]
 mf v[132:135], a[36:39], a[92:95], v[132:135]
 s_add_u32 m0, s70, 0x3000
 mf v[164:167], a[36:39], a[96:99], v[164:167]
 s_add_u32 s60, s71, 0x230000
 mf v[196:199], a[36:39], a[100:103], v[196:199]
 buffer_load_dwordx4 v9, s[32:35], s60 offen nt lds
 mf v[228:231], a[36:39], a[104:107], v[228:231]
 mf a[4:7], a[36:39], a[108:111], a[4:7]
 s_waitcnt lgkmcnt(4)
 ds_read_b64_tr_b16 a[36:37], v16 offset:16384
 ds_read_b64_tr_b16 a[38:39], v16 offset:18432
 mf v[40:43], a[40:43], a[80:83], v[40:43]
 s_add_u32 m0, s70, 0x13000
 mf v[72:75], a[40:43], a[84:87], v[72:75]
 s_add_u32 s60, s72, 0x30200
 mf v[104:107], a[40:43], a[88:91], v[104:107]
 buffer_load_dwordx4 v10, s[36:39], s60 offen lds
 mf v[136:139], a[40:43], a[92:95], v[136:139]
 mf v[168:171], a[40:43], a[96:99], v[168:171]
 mf v[200:203], a[40:43], a[100:103], v[200:203]
 s_mov_b32 s56, s20
 mf v[232:235], a[40:43], a[104:107], v[232:235]
 s_mov_b32 s57, s21
 mf a[8:11], a[40:43], a[108:111], a[8:11]
 s_waitcnt lgkmcnt(4)
 s_mov_b32 s58, 0x510000
 ds_read_b64_tr_b16 a[40:41], v17 offset:16384
 ds_read_b64_tr_b16 a[42:43], v17 offset:18432
 mf v[44:47], a[44:47], a[80:83], v[44:47]
 s_mov_b32 s59, 0x20000
 v_add_u32 v30, 0x100000, v7
 mf v[76:79], a[44:47], a[84:87], v[76:79]
 buffer_load_dword a170, v30, s[56:59], 0 offen
 mf v[108:111], a[44:47], a[88:91], v[108:111]
 mf v[140:143], a[44:47], a[92:95], v[140:143]
 mf v[172:175], a[44:47], a[96:99], v[172:175]
 mf v[204:207], a[44:47], a[100:103], v[204:207]
 mf v[236:239], a[44:47], a[104:107], v[236:239]
 mf a[12:15], a[44:47], a[108:111], a[12:15]
 s_waitcnt lgkmcnt(4)
 ds_read_b64_tr_b16 a[44:45], v18 offset:16384
 ds_read_b64_tr_b16 a[46:47], v18 offset:18432
 mf v[48:51], a[32:35], a[80:83], v[48:51]
 mf v[80:83], a[32:35], a[84:87], v[80:83]
 mf v[112:115], a[32:35], a[88:91], v[112:115]
 mf v[144:147], a[32:35], a[92:95], v[144:147]
 mf v[176:179], a[32:35], a[96:99], v[176:179]
 mf v[208:211], a[32:35], a[100:103], v[208:211]
 mf v[240:243], a[32:35], a[104:107], v[240:243]
 mf a[16:19], a[32:35], a[108:111], a[16:19]
 s_waitcnt vmcnt(20)
 s_waitcnt lgkmcnt(0)
 s_barrier
 mf v[52:55], a[36:39], a[80:83], v[52:55]
 s_add_u32 m0, s70, 0x4000
 ds_read_b64_tr_b16 a[32:33], v11 offset:32768
 ds_read_b64_tr_b16 a[34:35], v11 offset:34816
 mf v[84:87], a[36:39], a[84:87], v[84:87]
 s_add_u32 s60, s71, 0x240000
 ds_read_b128 a[48:51], v19 offset:32768
 ds_read_b128 a[52:55], v19 offset:33792
 mf v[116:119], a[36:39], a[88:91], v[116:119]
 ds_read_b128 a[56:59], v19 offset:34816
 mf v[148:151], a[36:39], a[92:95], v[148:151]
 ds_read_b128 a[60:63], v19 offset:35840
 mf v[180:183], a[36:39], a[96:99], v[180:183]
 ds_read_b128 a[64:67], v19 offset:36864
 mf v[212:215], a[36:39], a[100:103], v[212:215]
 ds_read_b128 a[68:71], v19 offset:37888
 mf v[244:247], a[36:39], a[104:107], v[244:247]
 ds_read_b128 a[72:75], v19 offset:38912
 mf a[20:23], a[36:39], a[108:111], a[20:23]
 ds_read_b64_tr_b16 a[36:37], v12 offset:32768
 ds_read_b64_tr_b16 a[38:39], v12 offset:34816
 mf v[56:59], a[40:43], a[80:83], v[56:59]
 ds_read_b128 a[76:79], v19 offset:39936
 mf v[88:91], a[40:43], a[84:87], v[88:91]
 buffer_load_dwordx4 v8, s[32:35], s60 offen nt lds
 mf v[120:123], a[40:43], a[88:91], v[120:123]
 s_add_u32 m0, s70, 0x14000
 mf v[152:155], a[40:43], a[92:95], v[152:155]
 s_add_u32 s60, s72, 0x240
 mf v[184:187], a[40:43], a[96:99], v[184:187]
 buffer_load_dwordx4 v10, s[36:39], s60 offen lds
 mf v[216:219], a[40:43], a[100:103], v[216:219]
 mf v[248:251], a[40:43], a[104:107], v[248:251]
 mf a[24:27], a[40:43], a[108:111], a[24:27]
 s_add_u32 m0, s70, 0x5000
 ds_read_b64_tr_b16 a[40:41], v13 offset:32768
 ds_read_b64_tr_b16 a[42:43], v13 offset:34816
 mf v[60:63], a[44:47], a[80:83], v[60:63]
 s_add_u32 s60, s71, 0x250000
 mf v[92:95], a[44:47], a[84:87], v[92:95]
 buffer_load_dwordx4 v9, s[32:35], s60 offen nt lds
 mf v[124:127], a[44:47], a[88:91], v[124:127]
 mf v[156:159], a[44:47], a[92:95], v[156:159]
 mf v[188:191], a[44:47], a[96:99], v[188:191]
 s_add_u32 m0, s70, 0x15000
 mf v[220:223], a[44:47], a[100:103], v[220:223]
 s_add_u32 s60, s72, 0x10240
 mf v[252:255], a[44:47], a[104:107], v[252:255]
 buffer_load_dwordx4 v10, s[36:39], s60 offen lds
 mf a[28:31], a[44:47], a[108:111], a[28:31]
 ds_read_b64_tr_b16 a[44:45], v14 offset:32768
 s_waitcnt lgkmcnt(14)
 ds_read_b64_tr_b16 a[46:47], v14 offset:34816
 s_waitcnt lgkmcnt(13)
 mf v[32:35], a[32:35], a[48:51], v[32:35]
 s_waitcnt lgkmcnt(12)
 mf v[64:67], a[32:35], a[52:55], v[64:67]
 s_waitcnt lgkmcnt(11)
 s_add_u32 m0, s70, 0x6000
 mf v[96:99], a[32:35], a[56:59], v[96:99]
 s_waitcnt lgkmcnt(10)
 s_add_u32 s60, s71, 0x260000
 mf v[128:131], a[32:35], a[60:63], v[128:131]
 s_waitcnt lgkmcnt(9)
 buffer_load_dwordx4 v8, s[32:35], s60 offen nt lds
 mf v[160:163], a[32:35], a[64:67], v[160:163]
 s_waitcnt lgkmcnt(8)
 mf v[192:195], a[32:35], a[68:71], v[192:195]
 s_waitcnt lgkmcnt(7)
 mf v[224:227], a[32:35], a[72:75], v[224:227]
 s_waitcnt lgkmcnt(4)
 s_add_u32 m0, s70, 0x16000
 mf a[0:3], a[32:35], a[76:79], a[0:3]
 s_add_u32 s60, s72, 0x20240
 ds_read_b64_tr_b16 a[32:33], v15 offset:32768
 ds_read_b64_tr_b16 a[34:35], v15 offset:34816
 mf v[36:39], a[36:39], a[48:51], v[36:39]
 buffer_load_dwordx4 v10, s[36:39], s60 offen lds
 mf v[68:71], a[36:39], a[52:55], v[68:71]
 mf v[100:103], a[36:39], a[56:59], v[100:103]
 mf v[132:135], a[36:39], a[60:63], v[132:135]
 s_add_u32 m0, s70, 0x7000
 mf v[164:167], a[36:39], a[64:67], v[164:167]
 s_add_u32 s60, s71, 0x270000
 mf v[196:199], a[36:39], a[68:71], v[196:199]
 buffer_load_dwordx4 v9, s[32:35], s60 offen nt lds
 mf v[228:231], a[36:39], a[72:75], v[228:231]
 mf a[4:7], a[36:39], a[76:79], a[4:7]
 s_waitcnt lgkmcnt(4)
 ds_read_b64_tr_b16 a[36:37], v16 offset:32768
 ds_read_b64_tr_b16 a[38:39], v16 offset:34816
 mf v[40:43], a[40:43], a[48:51], v[40:43]
 s_add_u32 m0, s70, 0x17000
 mf v[72:75], a[40:43], a[52:55], v[72:75]
 s_add_u32 s60, s72, 0x30240
 mf v[104:107], a[40:43], a[56:59], v[104:107]
 buffer_load_dwordx4 v10, s[36:39], s60 offen lds
 mf v[136:139], a[40:43], a[60:63], v[136:139]
 mf v[168:171], a[40:43], a[64:67], v[168:171]
 mf v[200:203], a[40:43], a[68:71], v[200:203]
 s_mov_b32 s56, s18
 mf v[232:235], a[40:43], a[72:75], v[232:235]
 s_mov_b32 s57, s19
 mf a[8:11], a[40:43], a[76:79], a[8:11]
 s_waitcnt lgkmcnt(4)
 s_mov_b32 s58, 0x510000
 ds_read_b64_tr_b16 a[40:41], v17 offset:32768
 ds_read_b64_tr_b16 a[42:43], v17 offset:34816
 mf v[44:47], a[44:47], a[48:51], v[44:47]
 s_mov_b32 s59, 0x20000
 v_add_u32 v30, 0x200000, v7
 mf v[76:79], a[44:47], a[52:55], v[76:79]
 buffer_load_dword a170, v30, s[56:59], 0 offen
 mf v[108:111], a[44:47], a[56:59], v[108:111]
 mf v[140:143], a[44:47], a[60:63], v[140:143]
 mf v[172:175], a[44:47], a[64:67], v[172:175]
 mf v[204:207], a[44:47], a[68:71], v[204:207]
 mf v[236:239], a[44:47], a[72:75], v[236:239]
 mf a[12:15], a[44:47], a[76:79], a[12:15]
 s_waitcnt lgkmcnt(4)
 ds_read_b64_tr_b16 a[44:45], v18 offset:32768
 ds_read_b64_tr_b16 a[46:47], v18 offset:34816
 mf v[48:51], a[32:35], a[48:51], v[48:51]
 mf v[80:83], a[32:35], a[52:55], v[80:83]
 mf v[112:115], a[32:35], a[56:59], v[112:115]
 mf v[144:147], a[32:35], a[60:63], v[144:147]
 mf v[176:179], a[32:35], a[64:67], v[176:179]
 mf v[208:211], a[32:35], a[68:71], v[208:211]
 mf v[240:243], a[32:35], a[72:75], v[240:243]
 mf a[16:19], a[32:35], a[76:79], a[16:19]
 s_waitcnt vmcnt(19)
 s_waitcnt lgkmcnt(0)
 s_barrier
 mf v[52:55], a[36:39], a[48:51], v[52:55]
 s_add_u32 m0, s70, 0x8000
 ds_read_b64_tr_b16 a[32:33], v11 offset:49152
 ds_read_b64_tr_b16 a[34:35], v11 offset:51200
 mf v[84:87], a[36:39], a[52:55], v[84:87]
 s_add_u32 s60, s71, 0x280000
 ds_read_b128 a[80:83], v19 offset:49152
 ds_read_b128 a[84:87], v19 offset:50176
 mf v[116:119], a[36:39], a[56:59], v[116:119]
 ds_read_b128 a[88:91], v19 offset:51200
 mf v[148:151], a[36:39], a[60:63], v[148:151]
 ds_read_b128 a[92:95], v19 offset:52224
 mf v[180:183], a[36:39], a[64:67], v[180:183]
 ds_read_b128 a[96:99], v19 offset:53248
 mf v[212:215], a[36:39], a[68:71], v[212:215]
 ds_read_b128 a[100:103], v19 offset:54272
 mf v[244:247], a[36:39], a[72:75], v[244:247]
 ds_read_b128 a[104:107], v19 offset:55296
 mf a[20:23], a[36:39], a[76:79], a[20:23]
 ds_read_b64_tr_b16 a[36:37], v12 offset:49152
 ds_read_b64_tr_b16 a[38:39], v12 offset:51200
 mf v[56:59], a[40:43], a[48:51], v[56:59]
 ds_read_b128 a[108:111], v19 offset:56320
 mf v[88:91], a[40:43], a[52:55], v[88:91]
 buffer_load_dwordx4 v8, s[32:35], s60 offen nt lds
 mf v[120:123], a[40:43], a[56:59], v[120:123]
 s_add_u32 m0, s70, 0x18000
 mf v[152:155], a[40:43], a[60:63], v[152:155]
 s_add_u32 s60, s72, 0x280
 mf v[184:187], a[40:43], a[64:67], v[184:187]
 buffer_load_dwordx4 v10, s[36:39], s60 offen lds
 mf v[216:219], a[40:43], a[68:71], v[216:219]
 mf v[248:251], a[40:43], a[72:75], v[248:251]
 mf a[24:27], a[40:43], a[76:79], a[24:27]
 s_add_u32 m0, s70, 0x9000
 ds_read_b64_tr_b16 a[40:41], v13 offset:49152
 ds_read_b64_tr_b16 a[42:43], v13 offset:51200
 mf v[60:63], a[44:47], a[48:51], v[60:63]
 s_add_u32 s60, s71, 0x290000
 mf v[92:95], a[44:47], a[52:55], v[92:95]
 buffer_load_dwordx4 v9, s[32:35], s60 offen nt lds
 mf v[124:127], a[44:47], a[56:59], v[124:127]
 mf v[156:159], a[44:47], a[60:63], v[156:159]
 mf v[188:191], a[44:47], a[64:67], v[188:191]
 s_add_u32 m0, s70, 0x19000
 mf v[220:223], a[44:47], a[68:71], v[220:223]
 s_add_u32 s60, s72, 0x10280
 mf v[252:255], a[44:47], a[72:75], v[252:255]
 buffer_load_dwordx4 v10, s[36:39], s60 offen lds
 mf a[28:31], a[44:47], a[76:79], a[28:31]
 ds_read_b64_tr_b16 a[44:45], v14 offset:49152
 s_waitcnt lgkmcnt(14)
 ds_read_b64_tr_b16 a[46:47], v14 offset:51200
 s_waitcnt lgkmcnt(13)
 mf v[32:35], a[32:35], a[80:83], v[32:35]
 s_waitcnt lgkmcnt(12)
 mf v[64:67], a[32:35], a[84:87], v[64:67]
 s_waitcnt lgkmcnt(11)
 s_add_u32 m0, s70, 0xa000
 mf v[96:99], a[32:35], a[88:91], v[96:99]
 s_waitcnt lgkmcnt(10)
 s_add_u32 s60, s71, 0x2a0000
 mf v[128:131], a[32:35], a[92:95], v[128:131]
 s_waitcnt lgkmcnt(9)
 buffer_load_dwordx4 v8, s[32:35], s60 offen nt lds
 mf v[160:163], a[32:35], a[96:99], v[160:163]
 s_waitcnt lgkmcnt(8)
 mf v[192:195], a[32:35], a[100:103], v[192:195]
 s_waitcnt lgkmcnt(7)
 mf v[224:227], a[32:35], a[104:107], v[224:227]
 s_waitcnt lgkmcnt(4)
 s_add_u32 m0, s70, 0x1a000
 mf a[0:3], a[32:35], a[108:111], a[0:3]
 s_add_u32 s60, s72, 0x20280
 ds_read_b64_tr_b16 a[32:33], v15 offset:49152
 ds_read_b64_tr_b16 a[34:35], v15 offset:51200
 mf v[36:39], a[36:39], a[80:83], v[36:39]
 buffer_load_dwordx4 v10, s[36:39], s60 offen lds
 mf v[68:71], a[36:39], a[84:87], v[68:71]
 mf v[100:103], a[36:39], a[88:91], v[100:103]
 mf v[132:135], a[36:39], a[92:95], v[132:135]
 s_add_u32 m0, s70, 0xb000
 mf v[164:167], a[36:39], a[96:99], v[164:167]
 s_add_u32 s60, s71, 0x2b0000
 mf v[196:199], a[36:39], a[100:103], v[196:199]
 buffer_load_dwordx4 v9, s[32:35], s60 offen nt lds
 mf v[228:231], a[36:39], a[104:107], v[228:231]
 mf a[4:7], a[36:39], a[108:111], a[4:7]
 s_waitcnt lgkmcnt(4)
 ds_read_b64_tr_b16 a[36:37], v16 offset:49152
 ds_read_b64_tr_b16 a[38:39], v16 offset:51200
 mf v[40:43], a[40:43], a[80:83], v[40:43]
 s_add_u32 m0, s70, 0x1b000
 mf v[72:75], a[40:43], a[84:87], v[72:75]
 s_add_u32 s60, s72, 0x30280
 mf v[104:107], a[40:43], a[88:91], v[104:107]
 buffer_load_dwordx4 v10, s[36:39], s60 offen lds
 mf v[136:139], a[40:43], a[92:95], v[136:139]
 mf v[168:171], a[40:43], a[96:99], v[168:171]
 mf v[200:203], a[40:43], a[100:103], v[200:203]
 s_mov_b32 s56, s20
 mf v[232:235], a[40:43], a[104:107], v[232:235]
 s_mov_b32 s57, s21
 mf a[8:11], a[40:43], a[108:111], a[8:11]
 s_waitcnt lgkmcnt(4)
 s_mov_b32 s58, 0x510000
 ds_read_b64_tr_b16 a[40:41], v17 offset:49152
 ds_read_b64_tr_b16 a[42:43], v17 offset:51200
 mf v[44:47], a[44:47], a[80:83], v[44:47]
 s_mov_b32 s59, 0x20000
 v_add_u32 v30, 0x200000, v7
 mf v[76:79], a[44:47], a[84:87], v[76:79]
 buffer_load_dword a170, v30, s[56:59], 0 offen
 mf v[108:111], a[44:47], a[88:91], v[108:111]
 mf v[140:143], a[44:47], a[92:95], v[140:143]
 mf v[172:175], a[44:47], a[96:99], v[172:175]
 mf v[204:207], a[44:47], a[100:103], v[204:207]
 mf v[236:239], a[44:47], a[104:107], v[236:239]
 mf a[12:15], a[44:47], a[108:111], a[12:15]
 s_waitcnt lgkmcnt(4)
 ds_read_b64_tr_b16 a[44:45], v18 offset:49152
 ds_read_b64_tr_b16 a[46:47], v18 offset:51200
 mf v[48:51], a[32:35], a[80:83], v[48:51]
 mf v[80:83], a[32:35], a[84:87], v[80:83]
 mf v[112:115], a[32:35], a[88:91], v[112:115]
 mf v[144:147], a[32:35], a[92:95], v[144:147]
 mf v[176:179], a[32:35], a[96:99], v[176:179]
 mf v[208:211], a[32:35], a[100:103], v[208:211]
 mf v[240:243], a[32:35], a[104:107], v[240:243]
 mf a[16:19], a[32:35], a[108:111], a[16:19]
 s_waitcnt vmcnt(19)
 s_waitcnt lgkmcnt(0)
 s_barrier
 mf v[52:55], a[36:39], a[80:83], v[52:55]
 s_add_u32 m0, s70, 0xc000
 ds_read_b64_tr_b16 a[32:33], v11
 ds_read_b64_tr_b16 a[34:35], v11 offset:2048
 mf v[84:87], a[36:39], a[84:87], v[84:87]
 s_add_u32 s60, s71, 0x2c0000
 ds_read_b128 a[48:51], v19
 ds_read_b128 a[52:55], v19 offset:1024
 mf v[116:119], a[36:39], a[88:91], v[116:119]
 ds_read_b128 a[56:59], v19 offset:2048
 mf v[148:151], a[36:39], a[92:95], v[148:151]
 ds_read_b128 a[60:63], v19 offset:3072
 mf v[180:183], a[36:39], a[96:99], v[180:183]
 ds_read_b128 a[64:67], v19 offset:4096
 mf v[212:215], a[36:39], a[100:103], v[212:215]
 ds_read_b128 a[68:71], v19 offset:5120
 mf v[244:247], a[36:39], a[104:107], v[244:247]
 ds_read_b128 a[72:75], v19 offset:6144
 mf a[20:23], a[36:39], a[108:111], a[20:23]
 ds_read_b64_tr_b16 a[36:37], v12
 ds_read_b64_tr_b16 a[38:39], v12 offset:2048
 mf v[56:59], a[40:43], a[80:83], v[56:59]
 ds_read_b128 a[76:79], v19 offset:7168
 v_and_b32 v30, 1, v1
 mf v[88:91], a[40:43], a[84:87], v[88:91]
 buffer_load_dwordx4 v8, s[32:35], s60 offen nt lds
 mf v[120:123], a[40:43], a[88:91], v[120:123]
 s_add_u32 m0, s70, 0x1c000
 v_lshlrev_b32 v30, 7, v30
 v_add_u32 v30, s100, v30
 mf v[152:155], a[40:43], a[92:95], v[152:155]
 s_add_u32 s60, s72, 0x2c0
 v_add_u32 v30, f_q-parallel_sum__compressed_kv_cla__geglu_ffn__prompt_kernel, v30
 v_min_u32 v30, f_done-parallel_sum__compressed_kv_cla__geglu_ffn__prompt_kernel, v30
 mf v[184:187], a[40:43], a[96:99], v[184:187]
 buffer_load_dwordx4 v10, s[36:39], s60 offen lds
 mf v[216:219], a[40:43], a[100:103], v[216:219]
 v_add_co_u32 v30, vcc, s98, v30
 v_mov_b32 v31, s99
 mf v[248:251], a[40:43], a[104:107], v[248:251]
 v_addc_co_u32 v31, vcc, 0, v31, vcc
 mf a[24:27], a[40:43], a[108:111], a[24:27]
 s_add_u32 m0, s70, 0xd000
 ds_read_b64_tr_b16 a[40:41], v13
 ds_read_b64_tr_b16 a[42:43], v13 offset:2048
 mf v[60:63], a[44:47], a[80:83], v[60:63]
 s_add_u32 s60, s71, 0x2d0000
 global_load_dword a170, v[30:31], off
 mf v[92:95], a[44:47], a[84:87], v[92:95]
 buffer_load_dwordx4 v9, s[32:35], s60 offen nt lds
 mf v[124:127], a[44:47], a[88:91], v[124:127]
 mf v[156:159], a[44:47], a[92:95], v[156:159]
 mf v[188:191], a[44:47], a[96:99], v[188:191]
 s_add_u32 m0, s70, 0x1d000
 mf v[220:223], a[44:47], a[100:103], v[220:223]
 s_add_u32 s60, s72, 0x102c0
 mf v[252:255], a[44:47], a[104:107], v[252:255]
 buffer_load_dwordx4 v10, s[36:39], s60 offen lds
 mf a[28:31], a[44:47], a[108:111], a[28:31]
 ds_read_b64_tr_b16 a[44:45], v14
 s_waitcnt lgkmcnt(14)
 ds_read_b64_tr_b16 a[46:47], v14 offset:2048
 s_waitcnt lgkmcnt(13)
 mf v[32:35], a[32:35], a[48:51], v[32:35]
 s_waitcnt lgkmcnt(12)
 mf v[64:67], a[32:35], a[52:55], v[64:67]
 s_waitcnt lgkmcnt(11)
 s_add_u32 m0, s70, 0xe000
 mf v[96:99], a[32:35], a[56:59], v[96:99]
 s_waitcnt lgkmcnt(10)
 s_add_u32 s60, s71, 0x2e0000
 mf v[128:131], a[32:35], a[60:63], v[128:131]
 s_waitcnt lgkmcnt(9)
 buffer_load_dwordx4 v8, s[32:35], s60 offen nt lds
 mf v[160:163], a[32:35], a[64:67], v[160:163]
 s_waitcnt lgkmcnt(8)
 mf v[192:195], a[32:35], a[68:71], v[192:195]
 s_waitcnt lgkmcnt(7)
 mf v[224:227], a[32:35], a[72:75], v[224:227]
 s_waitcnt lgkmcnt(4)
 s_add_u32 m0, s70, 0x1e000
 mf a[0:3], a[32:35], a[76:79], a[0:3]
 s_add_u32 s60, s72, 0x202c0
 ds_read_b64_tr_b16 a[32:33], v15
 ds_read_b64_tr_b16 a[34:35], v15 offset:2048
 mf v[36:39], a[36:39], a[48:51], v[36:39]
 buffer_load_dwordx4 v10, s[36:39], s60 offen lds
 mf v[68:71], a[36:39], a[52:55], v[68:71]
 mf v[100:103], a[36:39], a[56:59], v[100:103]
 mf v[132:135], a[36:39], a[60:63], v[132:135]
 s_add_u32 m0, s70, 0xf000
 mf v[164:167], a[36:39], a[64:67], v[164:167]
 s_add_u32 s60, s71, 0x2f0000
 mf v[196:199], a[36:39], a[68:71], v[196:199]
 buffer_load_dwordx4 v9, s[32:35], s60 offen nt lds
 mf v[228:231], a[36:39], a[72:75], v[228:231]
 mf a[4:7], a[36:39], a[76:79], a[4:7]
 s_waitcnt lgkmcnt(4)
 ds_read_b64_tr_b16 a[36:37], v16
 ds_read_b64_tr_b16 a[38:39], v16 offset:2048
 mf v[40:43], a[40:43], a[48:51], v[40:43]
 s_add_u32 m0, s70, 0x1f000
 mf v[72:75], a[40:43], a[52:55], v[72:75]
 s_add_u32 s60, s72, 0x302c0
 mf v[104:107], a[40:43], a[56:59], v[104:107]
 buffer_load_dwordx4 v10, s[36:39], s60 offen lds
 mf v[136:139], a[40:43], a[60:63], v[136:139]
 mf v[168:171], a[40:43], a[64:67], v[168:171]
 mf v[200:203], a[40:43], a[68:71], v[200:203]
 s_mov_b32 s56, s18
 mf v[232:235], a[40:43], a[72:75], v[232:235]
 s_mov_b32 s57, s19
 mf a[8:11], a[40:43], a[76:79], a[8:11]
 s_waitcnt lgkmcnt(4)
 s_mov_b32 s58, 0x510000
 ds_read_b64_tr_b16 a[40:41], v17
 ds_read_b64_tr_b16 a[42:43], v17 offset:2048
 mf v[44:47], a[44:47], a[48:51], v[44:47]
 s_mov_b32 s59, 0x20000
 v_add_u32 v30, 0x300000, v7
 mf v[76:79], a[44:47], a[52:55], v[76:79]
 buffer_load_dword a170, v30, s[56:59], 0 offen
 mf v[108:111], a[44:47], a[56:59], v[108:111]
 mf v[140:143], a[44:47], a[60:63], v[140:143]
 mf v[172:175], a[44:47], a[64:67], v[172:175]
 mf v[204:207], a[44:47], a[68:71], v[204:207]
 mf v[236:239], a[44:47], a[72:75], v[236:239]
 mf a[12:15], a[44:47], a[76:79], a[12:15]
 s_waitcnt lgkmcnt(4)
 ds_read_b64_tr_b16 a[44:45], v18
 ds_read_b64_tr_b16 a[46:47], v18 offset:2048
 mf v[48:51], a[32:35], a[48:51], v[48:51]
 mf v[80:83], a[32:35], a[52:55], v[80:83]
 mf v[112:115], a[32:35], a[56:59], v[112:115]
 mf v[144:147], a[32:35], a[60:63], v[144:147]
 mf v[176:179], a[32:35], a[64:67], v[176:179]
 mf v[208:211], a[32:35], a[68:71], v[208:211]
 mf v[240:243], a[32:35], a[72:75], v[240:243]
 mf a[16:19], a[32:35], a[76:79], a[16:19]
 s_waitcnt vmcnt(20)
 s_waitcnt lgkmcnt(0)
 s_barrier
 mf v[52:55], a[36:39], a[48:51], v[52:55]
 s_add_u32 m0, s70, 0
 ds_read_b64_tr_b16 a[32:33], v11 offset:16384
 ds_read_b64_tr_b16 a[34:35], v11 offset:18432
 mf v[84:87], a[36:39], a[52:55], v[84:87]
 s_add_u32 s60, s71, 0x300000
 ds_read_b128 a[80:83], v19 offset:16384
 ds_read_b128 a[84:87], v19 offset:17408
 mf v[116:119], a[36:39], a[56:59], v[116:119]
 ds_read_b128 a[88:91], v19 offset:18432
 mf v[148:151], a[36:39], a[60:63], v[148:151]
 ds_read_b128 a[92:95], v19 offset:19456
 mf v[180:183], a[36:39], a[64:67], v[180:183]
 ds_read_b128 a[96:99], v19 offset:20480
 mf v[212:215], a[36:39], a[68:71], v[212:215]
 ds_read_b128 a[100:103], v19 offset:21504
 mf v[244:247], a[36:39], a[72:75], v[244:247]
 ds_read_b128 a[104:107], v19 offset:22528
 mf a[20:23], a[36:39], a[76:79], a[20:23]
 ds_read_b64_tr_b16 a[36:37], v12 offset:16384
 ds_read_b64_tr_b16 a[38:39], v12 offset:18432
 mf v[56:59], a[40:43], a[48:51], v[56:59]
 ds_read_b128 a[108:111], v19 offset:23552
 mf v[88:91], a[40:43], a[52:55], v[88:91]
 buffer_load_dwordx4 v8, s[32:35], s60 offen nt lds
 mf v[120:123], a[40:43], a[56:59], v[120:123]
 s_add_u32 m0, s70, 0x10000
 mf v[152:155], a[40:43], a[60:63], v[152:155]
 s_add_u32 s60, s72, 0x300
 mf v[184:187], a[40:43], a[64:67], v[184:187]
 buffer_load_dwordx4 v10, s[36:39], s60 offen lds
 mf v[216:219], a[40:43], a[68:71], v[216:219]
 mf v[248:251], a[40:43], a[72:75], v[248:251]
 mf a[24:27], a[40:43], a[76:79], a[24:27]
 s_add_u32 m0, s70, 0x1000
 ds_read_b64_tr_b16 a[40:41], v13 offset:16384
 ds_read_b64_tr_b16 a[42:43], v13 offset:18432
 mf v[60:63], a[44:47], a[48:51], v[60:63]
 s_add_u32 s60, s71, 0x310000
 mf v[92:95], a[44:47], a[52:55], v[92:95]
 buffer_load_dwordx4 v9, s[32:35], s60 offen nt lds
 mf v[124:127], a[44:47], a[56:59], v[124:127]
 mf v[156:159], a[44:47], a[60:63], v[156:159]
 mf v[188:191], a[44:47], a[64:67], v[188:191]
 s_add_u32 m0, s70, 0x11000
 mf v[220:223], a[44:47], a[68:71], v[220:223]
 s_add_u32 s60, s72, 0x10300
 mf v[252:255], a[44:47], a[72:75], v[252:255]
 buffer_load_dwordx4 v10, s[36:39], s60 offen lds
 mf a[28:31], a[44:47], a[76:79], a[28:31]
 ds_read_b64_tr_b16 a[44:45], v14 offset:16384
 s_waitcnt lgkmcnt(14)
 ds_read_b64_tr_b16 a[46:47], v14 offset:18432
 s_waitcnt lgkmcnt(13)
 mf v[32:35], a[32:35], a[80:83], v[32:35]
 s_waitcnt lgkmcnt(12)
 mf v[64:67], a[32:35], a[84:87], v[64:67]
 s_waitcnt lgkmcnt(11)
 s_add_u32 m0, s70, 0x2000
 mf v[96:99], a[32:35], a[88:91], v[96:99]
 s_waitcnt lgkmcnt(10)
 s_add_u32 s60, s71, 0x320000
 mf v[128:131], a[32:35], a[92:95], v[128:131]
 s_waitcnt lgkmcnt(9)
 buffer_load_dwordx4 v8, s[32:35], s60 offen nt lds
 mf v[160:163], a[32:35], a[96:99], v[160:163]
 s_waitcnt lgkmcnt(8)
 mf v[192:195], a[32:35], a[100:103], v[192:195]
 s_waitcnt lgkmcnt(7)
 mf v[224:227], a[32:35], a[104:107], v[224:227]
 s_waitcnt lgkmcnt(4)
 s_add_u32 m0, s70, 0x12000
 mf a[0:3], a[32:35], a[108:111], a[0:3]
 s_add_u32 s60, s72, 0x20300
 ds_read_b64_tr_b16 a[32:33], v15 offset:16384
 ds_read_b64_tr_b16 a[34:35], v15 offset:18432
 mf v[36:39], a[36:39], a[80:83], v[36:39]
 buffer_load_dwordx4 v10, s[36:39], s60 offen lds
 mf v[68:71], a[36:39], a[84:87], v[68:71]
 mf v[100:103], a[36:39], a[88:91], v[100:103]
 mf v[132:135], a[36:39], a[92:95], v[132:135]
 s_add_u32 m0, s70, 0x3000
 mf v[164:167], a[36:39], a[96:99], v[164:167]
 s_add_u32 s60, s71, 0x330000
 mf v[196:199], a[36:39], a[100:103], v[196:199]
 buffer_load_dwordx4 v9, s[32:35], s60 offen nt lds
 mf v[228:231], a[36:39], a[104:107], v[228:231]
 mf a[4:7], a[36:39], a[108:111], a[4:7]
 s_waitcnt lgkmcnt(4)
 ds_read_b64_tr_b16 a[36:37], v16 offset:16384
 ds_read_b64_tr_b16 a[38:39], v16 offset:18432
 mf v[40:43], a[40:43], a[80:83], v[40:43]
 s_add_u32 m0, s70, 0x13000
 mf v[72:75], a[40:43], a[84:87], v[72:75]
 s_add_u32 s60, s72, 0x30300
 mf v[104:107], a[40:43], a[88:91], v[104:107]
 buffer_load_dwordx4 v10, s[36:39], s60 offen lds
 mf v[136:139], a[40:43], a[92:95], v[136:139]
 mf v[168:171], a[40:43], a[96:99], v[168:171]
 mf v[200:203], a[40:43], a[100:103], v[200:203]
 s_mov_b32 s56, s20
 mf v[232:235], a[40:43], a[104:107], v[232:235]
 s_mov_b32 s57, s21
 mf a[8:11], a[40:43], a[108:111], a[8:11]
 s_waitcnt lgkmcnt(4)
 s_mov_b32 s58, 0x510000
 ds_read_b64_tr_b16 a[40:41], v17 offset:16384
 ds_read_b64_tr_b16 a[42:43], v17 offset:18432
 mf v[44:47], a[44:47], a[80:83], v[44:47]
 s_mov_b32 s59, 0x20000
 v_add_u32 v30, 0x300000, v7
 mf v[76:79], a[44:47], a[84:87], v[76:79]
 buffer_load_dword a170, v30, s[56:59], 0 offen
 mf v[108:111], a[44:47], a[88:91], v[108:111]
 mf v[140:143], a[44:47], a[92:95], v[140:143]
 mf v[172:175], a[44:47], a[96:99], v[172:175]
 mf v[204:207], a[44:47], a[100:103], v[204:207]
 mf v[236:239], a[44:47], a[104:107], v[236:239]
 mf a[12:15], a[44:47], a[108:111], a[12:15]
 s_waitcnt lgkmcnt(4)
 ds_read_b64_tr_b16 a[44:45], v18 offset:16384
 ds_read_b64_tr_b16 a[46:47], v18 offset:18432
 mf v[48:51], a[32:35], a[80:83], v[48:51]
 mf v[80:83], a[32:35], a[84:87], v[80:83]
 mf v[112:115], a[32:35], a[88:91], v[112:115]
 mf v[144:147], a[32:35], a[92:95], v[144:147]
 mf v[176:179], a[32:35], a[96:99], v[176:179]
 mf v[208:211], a[32:35], a[100:103], v[208:211]
 mf v[240:243], a[32:35], a[104:107], v[240:243]
 mf a[16:19], a[32:35], a[108:111], a[16:19]
 s_waitcnt vmcnt(20)
 s_waitcnt lgkmcnt(0)
 s_barrier
 mf v[52:55], a[36:39], a[80:83], v[52:55]
 s_add_u32 m0, s70, 0x4000
 ds_read_b64_tr_b16 a[32:33], v11 offset:32768
 ds_read_b64_tr_b16 a[34:35], v11 offset:34816
 mf v[84:87], a[36:39], a[84:87], v[84:87]
 s_add_u32 s60, s71, 0x340000
 ds_read_b128 a[48:51], v19 offset:32768
 ds_read_b128 a[52:55], v19 offset:33792
 mf v[116:119], a[36:39], a[88:91], v[116:119]
 ds_read_b128 a[56:59], v19 offset:34816
 mf v[148:151], a[36:39], a[92:95], v[148:151]
 ds_read_b128 a[60:63], v19 offset:35840
 mf v[180:183], a[36:39], a[96:99], v[180:183]
 ds_read_b128 a[64:67], v19 offset:36864
 mf v[212:215], a[36:39], a[100:103], v[212:215]
 ds_read_b128 a[68:71], v19 offset:37888
 mf v[244:247], a[36:39], a[104:107], v[244:247]
 ds_read_b128 a[72:75], v19 offset:38912
 mf a[20:23], a[36:39], a[108:111], a[20:23]
 ds_read_b64_tr_b16 a[36:37], v12 offset:32768
 ds_read_b64_tr_b16 a[38:39], v12 offset:34816
 mf v[56:59], a[40:43], a[80:83], v[56:59]
 ds_read_b128 a[76:79], v19 offset:39936
 mf v[88:91], a[40:43], a[84:87], v[88:91]
 buffer_load_dwordx4 v8, s[32:35], s60 offen nt lds
 mf v[120:123], a[40:43], a[88:91], v[120:123]
 s_add_u32 m0, s70, 0x14000
 mf v[152:155], a[40:43], a[92:95], v[152:155]
 s_add_u32 s60, s72, 0x340
 mf v[184:187], a[40:43], a[96:99], v[184:187]
 buffer_load_dwordx4 v10, s[36:39], s60 offen lds
 mf v[216:219], a[40:43], a[100:103], v[216:219]
 mf v[248:251], a[40:43], a[104:107], v[248:251]
 mf a[24:27], a[40:43], a[108:111], a[24:27]
 s_add_u32 m0, s70, 0x5000
 ds_read_b64_tr_b16 a[40:41], v13 offset:32768
 ds_read_b64_tr_b16 a[42:43], v13 offset:34816
 mf v[60:63], a[44:47], a[80:83], v[60:63]
 s_add_u32 s60, s71, 0x350000
 mf v[92:95], a[44:47], a[84:87], v[92:95]
 buffer_load_dwordx4 v9, s[32:35], s60 offen nt lds
 mf v[124:127], a[44:47], a[88:91], v[124:127]
 mf v[156:159], a[44:47], a[92:95], v[156:159]
 mf v[188:191], a[44:47], a[96:99], v[188:191]
 s_add_u32 m0, s70, 0x15000
 mf v[220:223], a[44:47], a[100:103], v[220:223]
 s_add_u32 s60, s72, 0x10340
 mf v[252:255], a[44:47], a[104:107], v[252:255]
 buffer_load_dwordx4 v10, s[36:39], s60 offen lds
 mf a[28:31], a[44:47], a[108:111], a[28:31]
 ds_read_b64_tr_b16 a[44:45], v14 offset:32768
 s_waitcnt lgkmcnt(14)
 ds_read_b64_tr_b16 a[46:47], v14 offset:34816
 s_waitcnt lgkmcnt(13)
 mf v[32:35], a[32:35], a[48:51], v[32:35]
 s_waitcnt lgkmcnt(12)
 mf v[64:67], a[32:35], a[52:55], v[64:67]
 s_waitcnt lgkmcnt(11)
 s_add_u32 m0, s70, 0x6000
 mf v[96:99], a[32:35], a[56:59], v[96:99]
 s_waitcnt lgkmcnt(10)
 s_add_u32 s60, s71, 0x360000
 mf v[128:131], a[32:35], a[60:63], v[128:131]
 s_waitcnt lgkmcnt(9)
 buffer_load_dwordx4 v8, s[32:35], s60 offen nt lds
 mf v[160:163], a[32:35], a[64:67], v[160:163]
 s_waitcnt lgkmcnt(8)
 mf v[192:195], a[32:35], a[68:71], v[192:195]
 s_waitcnt lgkmcnt(7)
 mf v[224:227], a[32:35], a[72:75], v[224:227]
 s_waitcnt lgkmcnt(4)
 s_add_u32 m0, s70, 0x16000
 mf a[0:3], a[32:35], a[76:79], a[0:3]
 s_add_u32 s60, s72, 0x20340
 ds_read_b64_tr_b16 a[32:33], v15 offset:32768
 ds_read_b64_tr_b16 a[34:35], v15 offset:34816
 mf v[36:39], a[36:39], a[48:51], v[36:39]
 buffer_load_dwordx4 v10, s[36:39], s60 offen lds
 mf v[68:71], a[36:39], a[52:55], v[68:71]
 mf v[100:103], a[36:39], a[56:59], v[100:103]
 mf v[132:135], a[36:39], a[60:63], v[132:135]
 s_add_u32 m0, s70, 0x7000
 mf v[164:167], a[36:39], a[64:67], v[164:167]
 s_add_u32 s60, s71, 0x370000
 mf v[196:199], a[36:39], a[68:71], v[196:199]
 buffer_load_dwordx4 v9, s[32:35], s60 offen nt lds
 mf v[228:231], a[36:39], a[72:75], v[228:231]
 mf a[4:7], a[36:39], a[76:79], a[4:7]
 s_waitcnt lgkmcnt(4)
 ds_read_b64_tr_b16 a[36:37], v16 offset:32768
 ds_read_b64_tr_b16 a[38:39], v16 offset:34816
 mf v[40:43], a[40:43], a[48:51], v[40:43]
 s_add_u32 m0, s70, 0x17000
 mf v[72:75], a[40:43], a[52:55], v[72:75]
 s_add_u32 s60, s72, 0x30340
 mf v[104:107], a[40:43], a[56:59], v[104:107]
 buffer_load_dwordx4 v10, s[36:39], s60 offen lds
 mf v[136:139], a[40:43], a[60:63], v[136:139]
 mf v[168:171], a[40:43], a[64:67], v[168:171]
 mf v[200:203], a[40:43], a[68:71], v[200:203]
 s_mov_b32 s56, s18
 mf v[232:235], a[40:43], a[72:75], v[232:235]
 s_mov_b32 s57, s19
 mf a[8:11], a[40:43], a[76:79], a[8:11]
 s_waitcnt lgkmcnt(4)
 s_mov_b32 s58, 0x510000
 ds_read_b64_tr_b16 a[40:41], v17 offset:32768
 ds_read_b64_tr_b16 a[42:43], v17 offset:34816
 mf v[44:47], a[44:47], a[48:51], v[44:47]
 s_mov_b32 s59, 0x20000
 v_add_u32 v30, 0x400000, v7
 mf v[76:79], a[44:47], a[52:55], v[76:79]
 buffer_load_dword a170, v30, s[56:59], 0 offen
 mf v[108:111], a[44:47], a[56:59], v[108:111]
 mf v[140:143], a[44:47], a[60:63], v[140:143]
 mf v[172:175], a[44:47], a[64:67], v[172:175]
 mf v[204:207], a[44:47], a[68:71], v[204:207]
 mf v[236:239], a[44:47], a[72:75], v[236:239]
 mf a[12:15], a[44:47], a[76:79], a[12:15]
 s_waitcnt lgkmcnt(4)
 ds_read_b64_tr_b16 a[44:45], v18 offset:32768
 ds_read_b64_tr_b16 a[46:47], v18 offset:34816
 mf v[48:51], a[32:35], a[48:51], v[48:51]
 mf v[80:83], a[32:35], a[52:55], v[80:83]
 mf v[112:115], a[32:35], a[56:59], v[112:115]
 mf v[144:147], a[32:35], a[60:63], v[144:147]
 mf v[176:179], a[32:35], a[64:67], v[176:179]
 mf v[208:211], a[32:35], a[68:71], v[208:211]
 mf v[240:243], a[32:35], a[72:75], v[240:243]
 mf a[16:19], a[32:35], a[76:79], a[16:19]
 s_waitcnt vmcnt(19)
 s_waitcnt lgkmcnt(0)
 s_barrier
 mf v[52:55], a[36:39], a[48:51], v[52:55]
 s_add_u32 m0, s70, 0x8000
 ds_read_b64_tr_b16 a[32:33], v11 offset:49152
 ds_read_b64_tr_b16 a[34:35], v11 offset:51200
 mf v[84:87], a[36:39], a[52:55], v[84:87]
 s_add_u32 s60, s71, 0x380000
 ds_read_b128 a[80:83], v19 offset:49152
 ds_read_b128 a[84:87], v19 offset:50176
 mf v[116:119], a[36:39], a[56:59], v[116:119]
 ds_read_b128 a[88:91], v19 offset:51200
 mf v[148:151], a[36:39], a[60:63], v[148:151]
 ds_read_b128 a[92:95], v19 offset:52224
 mf v[180:183], a[36:39], a[64:67], v[180:183]
 ds_read_b128 a[96:99], v19 offset:53248
 mf v[212:215], a[36:39], a[68:71], v[212:215]
 ds_read_b128 a[100:103], v19 offset:54272
 mf v[244:247], a[36:39], a[72:75], v[244:247]
 ds_read_b128 a[104:107], v19 offset:55296
 mf a[20:23], a[36:39], a[76:79], a[20:23]
 ds_read_b64_tr_b16 a[36:37], v12 offset:49152
 ds_read_b64_tr_b16 a[38:39], v12 offset:51200
 mf v[56:59], a[40:43], a[48:51], v[56:59]
 ds_read_b128 a[108:111], v19 offset:56320
 mf v[88:91], a[40:43], a[52:55], v[88:91]
 buffer_load_dwordx4 v8, s[32:35], s60 offen nt lds
 mf v[120:123], a[40:43], a[56:59], v[120:123]
 s_add_u32 m0, s70, 0x18000
 mf v[152:155], a[40:43], a[60:63], v[152:155]
 s_add_u32 s60, s72, 0x380
 mf v[184:187], a[40:43], a[64:67], v[184:187]
 buffer_load_dwordx4 v10, s[36:39], s60 offen lds
 mf v[216:219], a[40:43], a[68:71], v[216:219]
 mf v[248:251], a[40:43], a[72:75], v[248:251]
 mf a[24:27], a[40:43], a[76:79], a[24:27]
 s_add_u32 m0, s70, 0x9000
 ds_read_b64_tr_b16 a[40:41], v13 offset:49152
 ds_read_b64_tr_b16 a[42:43], v13 offset:51200
 mf v[60:63], a[44:47], a[48:51], v[60:63]
 s_add_u32 s60, s71, 0x390000
 mf v[92:95], a[44:47], a[52:55], v[92:95]
 buffer_load_dwordx4 v9, s[32:35], s60 offen nt lds
 mf v[124:127], a[44:47], a[56:59], v[124:127]
 mf v[156:159], a[44:47], a[60:63], v[156:159]
 mf v[188:191], a[44:47], a[64:67], v[188:191]
 s_add_u32 m0, s70, 0x19000
 mf v[220:223], a[44:47], a[68:71], v[220:223]
 s_add_u32 s60, s72, 0x10380
 mf v[252:255], a[44:47], a[72:75], v[252:255]
 buffer_load_dwordx4 v10, s[36:39], s60 offen lds
 mf a[28:31], a[44:47], a[76:79], a[28:31]
 ds_read_b64_tr_b16 a[44:45], v14 offset:49152
 s_waitcnt lgkmcnt(14)
 ds_read_b64_tr_b16 a[46:47], v14 offset:51200
 s_waitcnt lgkmcnt(13)
 mf v[32:35], a[32:35], a[80:83], v[32:35]
 s_waitcnt lgkmcnt(12)
 mf v[64:67], a[32:35], a[84:87], v[64:67]
 s_waitcnt lgkmcnt(11)
 s_add_u32 m0, s70, 0xa000
 mf v[96:99], a[32:35], a[88:91], v[96:99]
 s_waitcnt lgkmcnt(10)
 s_add_u32 s60, s71, 0x3a0000
 mf v[128:131], a[32:35], a[92:95], v[128:131]
 s_waitcnt lgkmcnt(9)
 buffer_load_dwordx4 v8, s[32:35], s60 offen nt lds
 mf v[160:163], a[32:35], a[96:99], v[160:163]
 s_waitcnt lgkmcnt(8)
 mf v[192:195], a[32:35], a[100:103], v[192:195]
 s_waitcnt lgkmcnt(7)
 mf v[224:227], a[32:35], a[104:107], v[224:227]
 s_waitcnt lgkmcnt(4)
 s_add_u32 m0, s70, 0x1a000
 mf a[0:3], a[32:35], a[108:111], a[0:3]
 s_add_u32 s60, s72, 0x20380
 ds_read_b64_tr_b16 a[32:33], v15 offset:49152
 ds_read_b64_tr_b16 a[34:35], v15 offset:51200
 mf v[36:39], a[36:39], a[80:83], v[36:39]
 buffer_load_dwordx4 v10, s[36:39], s60 offen lds
 mf v[68:71], a[36:39], a[84:87], v[68:71]
 mf v[100:103], a[36:39], a[88:91], v[100:103]
 mf v[132:135], a[36:39], a[92:95], v[132:135]
 s_add_u32 m0, s70, 0xb000
 mf v[164:167], a[36:39], a[96:99], v[164:167]
 s_add_u32 s60, s71, 0x3b0000
 mf v[196:199], a[36:39], a[100:103], v[196:199]
 buffer_load_dwordx4 v9, s[32:35], s60 offen nt lds
 mf v[228:231], a[36:39], a[104:107], v[228:231]
 mf a[4:7], a[36:39], a[108:111], a[4:7]
 s_waitcnt lgkmcnt(4)
 ds_read_b64_tr_b16 a[36:37], v16 offset:49152
 ds_read_b64_tr_b16 a[38:39], v16 offset:51200
 mf v[40:43], a[40:43], a[80:83], v[40:43]
 s_add_u32 m0, s70, 0x1b000
 mf v[72:75], a[40:43], a[84:87], v[72:75]
 s_add_u32 s60, s72, 0x30380
 mf v[104:107], a[40:43], a[88:91], v[104:107]
 buffer_load_dwordx4 v10, s[36:39], s60 offen lds
 mf v[136:139], a[40:43], a[92:95], v[136:139]
 mf v[168:171], a[40:43], a[96:99], v[168:171]
 mf v[200:203], a[40:43], a[100:103], v[200:203]
 s_mov_b32 s56, s20
 mf v[232:235], a[40:43], a[104:107], v[232:235]
 s_mov_b32 s57, s21
 mf a[8:11], a[40:43], a[108:111], a[8:11]
 s_waitcnt lgkmcnt(4)
 s_mov_b32 s58, 0x510000
 ds_read_b64_tr_b16 a[40:41], v17 offset:49152
 ds_read_b64_tr_b16 a[42:43], v17 offset:51200
 mf v[44:47], a[44:47], a[80:83], v[44:47]
 s_mov_b32 s59, 0x20000
 v_add_u32 v30, 0x400000, v7
 mf v[76:79], a[44:47], a[84:87], v[76:79]
 buffer_load_dword a170, v30, s[56:59], 0 offen
 mf v[108:111], a[44:47], a[88:91], v[108:111]
 mf v[140:143], a[44:47], a[92:95], v[140:143]
 mf v[172:175], a[44:47], a[96:99], v[172:175]
 mf v[204:207], a[44:47], a[100:103], v[204:207]
 mf v[236:239], a[44:47], a[104:107], v[236:239]
 mf a[12:15], a[44:47], a[108:111], a[12:15]
 s_waitcnt lgkmcnt(4)
 ds_read_b64_tr_b16 a[44:45], v18 offset:49152
 ds_read_b64_tr_b16 a[46:47], v18 offset:51200
 mf v[48:51], a[32:35], a[80:83], v[48:51]
 mf v[80:83], a[32:35], a[84:87], v[80:83]
 mf v[112:115], a[32:35], a[88:91], v[112:115]
 mf v[144:147], a[32:35], a[92:95], v[144:147]
 mf v[176:179], a[32:35], a[96:99], v[176:179]
 mf v[208:211], a[32:35], a[100:103], v[208:211]
 mf v[240:243], a[32:35], a[104:107], v[240:243]
 mf a[16:19], a[32:35], a[108:111], a[16:19]
 s_waitcnt vmcnt(19)
 s_waitcnt lgkmcnt(0)
 s_barrier
 mf v[52:55], a[36:39], a[80:83], v[52:55]
 s_add_u32 m0, s70, 0xc000
 ds_read_b64_tr_b16 a[32:33], v11
 ds_read_b64_tr_b16 a[34:35], v11 offset:2048
 mf v[84:87], a[36:39], a[84:87], v[84:87]
 s_add_u32 s60, s71, 0x3c0000
 ds_read_b128 a[48:51], v19
 ds_read_b128 a[52:55], v19 offset:1024
 mf v[116:119], a[36:39], a[88:91], v[116:119]
 ds_read_b128 a[56:59], v19 offset:2048
 mf v[148:151], a[36:39], a[92:95], v[148:151]
 ds_read_b128 a[60:63], v19 offset:3072
 mf v[180:183], a[36:39], a[96:99], v[180:183]
 ds_read_b128 a[64:67], v19 offset:4096
 mf v[212:215], a[36:39], a[100:103], v[212:215]
 ds_read_b128 a[68:71], v19 offset:5120
 mf v[244:247], a[36:39], a[104:107], v[244:247]
 ds_read_b128 a[72:75], v19 offset:6144
 mf a[20:23], a[36:39], a[108:111], a[20:23]
 ds_read_b64_tr_b16 a[36:37], v12
 ds_read_b64_tr_b16 a[38:39], v12 offset:2048
 mf v[56:59], a[40:43], a[80:83], v[56:59]
 ds_read_b128 a[76:79], v19 offset:7168
 mf v[88:91], a[40:43], a[84:87], v[88:91]
 buffer_load_dwordx4 v8, s[32:35], s60 offen nt lds
 mf v[120:123], a[40:43], a[88:91], v[120:123]
 s_add_u32 m0, s70, 0x1c000
 mf v[152:155], a[40:43], a[92:95], v[152:155]
 s_add_u32 s60, s72, 0x3c0
 mf v[184:187], a[40:43], a[96:99], v[184:187]
 buffer_load_dwordx4 v10, s[36:39], s60 offen lds
 mf v[216:219], a[40:43], a[100:103], v[216:219]
 mf v[248:251], a[40:43], a[104:107], v[248:251]
 mf a[24:27], a[40:43], a[108:111], a[24:27]
 s_add_u32 m0, s70, 0xd000
 ds_read_b64_tr_b16 a[40:41], v13
 ds_read_b64_tr_b16 a[42:43], v13 offset:2048
 mf v[60:63], a[44:47], a[80:83], v[60:63]
 s_add_u32 s60, s71, 0x3d0000
 mf v[92:95], a[44:47], a[84:87], v[92:95]
 buffer_load_dwordx4 v9, s[32:35], s60 offen nt lds
 mf v[124:127], a[44:47], a[88:91], v[124:127]
 mf v[156:159], a[44:47], a[92:95], v[156:159]
 mf v[188:191], a[44:47], a[96:99], v[188:191]
 s_add_u32 m0, s70, 0x1d000
 mf v[220:223], a[44:47], a[100:103], v[220:223]
 s_add_u32 s60, s72, 0x103c0
 mf v[252:255], a[44:47], a[104:107], v[252:255]
 buffer_load_dwordx4 v10, s[36:39], s60 offen lds
 mf a[28:31], a[44:47], a[108:111], a[28:31]
 ds_read_b64_tr_b16 a[44:45], v14
 s_waitcnt lgkmcnt(14)
 ds_read_b64_tr_b16 a[46:47], v14 offset:2048
 s_waitcnt lgkmcnt(13)
 mf v[32:35], a[32:35], a[48:51], v[32:35]
 s_waitcnt lgkmcnt(12)
 mf v[64:67], a[32:35], a[52:55], v[64:67]
 s_waitcnt lgkmcnt(11)
 s_add_u32 m0, s70, 0xe000
 mf v[96:99], a[32:35], a[56:59], v[96:99]
 s_waitcnt lgkmcnt(10)
 s_add_u32 s60, s71, 0x3e0000
 mf v[128:131], a[32:35], a[60:63], v[128:131]
 s_waitcnt lgkmcnt(9)
 buffer_load_dwordx4 v8, s[32:35], s60 offen nt lds
 mf v[160:163], a[32:35], a[64:67], v[160:163]
 s_waitcnt lgkmcnt(8)
 mf v[192:195], a[32:35], a[68:71], v[192:195]
 s_waitcnt lgkmcnt(7)
 mf v[224:227], a[32:35], a[72:75], v[224:227]
 s_waitcnt lgkmcnt(4)
 s_add_u32 m0, s70, 0x1e000
 mf a[0:3], a[32:35], a[76:79], a[0:3]
 s_add_u32 s60, s72, 0x203c0
 ds_read_b64_tr_b16 a[32:33], v15
 ds_read_b64_tr_b16 a[34:35], v15 offset:2048
 mf v[36:39], a[36:39], a[48:51], v[36:39]
 buffer_load_dwordx4 v10, s[36:39], s60 offen lds
 mf v[68:71], a[36:39], a[52:55], v[68:71]
 mf v[100:103], a[36:39], a[56:59], v[100:103]
 mf v[132:135], a[36:39], a[60:63], v[132:135]
 s_add_u32 m0, s70, 0xf000
 mf v[164:167], a[36:39], a[64:67], v[164:167]
 s_add_u32 s60, s71, 0x3f0000
 mf v[196:199], a[36:39], a[68:71], v[196:199]
 buffer_load_dwordx4 v9, s[32:35], s60 offen nt lds
 mf v[228:231], a[36:39], a[72:75], v[228:231]
 mf a[4:7], a[36:39], a[76:79], a[4:7]
 s_waitcnt lgkmcnt(4)
 ds_read_b64_tr_b16 a[36:37], v16
 ds_read_b64_tr_b16 a[38:39], v16 offset:2048
 mf v[40:43], a[40:43], a[48:51], v[40:43]
 s_add_u32 m0, s70, 0x1f000
 mf v[72:75], a[40:43], a[52:55], v[72:75]
 s_add_u32 s60, s72, 0x303c0
 mf v[104:107], a[40:43], a[56:59], v[104:107]
 buffer_load_dwordx4 v10, s[36:39], s60 offen lds
 mf v[136:139], a[40:43], a[60:63], v[136:139]
 mf v[168:171], a[40:43], a[64:67], v[168:171]
 mf v[200:203], a[40:43], a[68:71], v[200:203]
 s_mov_b32 s56, s18
 mf v[232:235], a[40:43], a[72:75], v[232:235]
 s_mov_b32 s57, s19
 mf a[8:11], a[40:43], a[76:79], a[8:11]
 s_waitcnt lgkmcnt(4)
 s_mov_b32 s58, 0x510000
 ds_read_b64_tr_b16 a[40:41], v17
 ds_read_b64_tr_b16 a[42:43], v17 offset:2048
 mf v[44:47], a[44:47], a[48:51], v[44:47]
 s_mov_b32 s59, 0x20000
 v_add_u32 v30, 0x500000, v7
 mf v[76:79], a[44:47], a[52:55], v[76:79]
 buffer_load_dword a170, v30, s[56:59], 0 offen
 mf v[108:111], a[44:47], a[56:59], v[108:111]
 mf v[140:143], a[44:47], a[60:63], v[140:143]
 mf v[172:175], a[44:47], a[64:67], v[172:175]
 mf v[204:207], a[44:47], a[68:71], v[204:207]
 mf v[236:239], a[44:47], a[72:75], v[236:239]
 mf a[12:15], a[44:47], a[76:79], a[12:15]
 s_waitcnt lgkmcnt(4)
 ds_read_b64_tr_b16 a[44:45], v18
 ds_read_b64_tr_b16 a[46:47], v18 offset:2048
 mf v[48:51], a[32:35], a[48:51], v[48:51]
 mf v[80:83], a[32:35], a[52:55], v[80:83]
 mf v[112:115], a[32:35], a[56:59], v[112:115]
 mf v[144:147], a[32:35], a[60:63], v[144:147]
 mf v[176:179], a[32:35], a[64:67], v[176:179]
 mf v[208:211], a[32:35], a[68:71], v[208:211]
 mf v[240:243], a[32:35], a[72:75], v[240:243]
 mf a[16:19], a[32:35], a[76:79], a[16:19]
 s_waitcnt vmcnt(19)
 s_waitcnt lgkmcnt(0)
 s_barrier
 mf v[52:55], a[36:39], a[48:51], v[52:55]
 ds_read_b64_tr_b16 a[32:33], v11 offset:16384
 ds_read_b64_tr_b16 a[34:35], v11 offset:18432
 mf v[84:87], a[36:39], a[52:55], v[84:87]
 ds_read_b128 a[80:83], v19 offset:16384
 ds_read_b128 a[84:87], v19 offset:17408
 mf v[116:119], a[36:39], a[56:59], v[116:119]
 ds_read_b128 a[88:91], v19 offset:18432
 mf v[148:151], a[36:39], a[60:63], v[148:151]
 ds_read_b128 a[92:95], v19 offset:19456
 v_and_b32 v8, 15, v1
 mf v[180:183], a[36:39], a[64:67], v[180:183]
 ds_read_b128 a[96:99], v19 offset:20480
 v_lshlrev_b32 v8, 7, v8
 mf v[212:215], a[36:39], a[68:71], v[212:215]
 s_sub_u32 s30, 15, s66
 ds_read_b128 a[100:103], v19 offset:21504
 v_bfe_u32 v9, v1, 4, 1
 mf v[244:247], a[36:39], a[72:75], v[244:247]
 s_sub_u32 s31, s66, s30
 ds_read_b128 a[104:107], v19 offset:22528
 mf a[20:23], a[36:39], a[76:79], a[20:23]
 s_lshl_b32 s31, s31, 11
 ds_read_b64_tr_b16 a[36:37], v12 offset:16384
 ds_read_b64_tr_b16 a[38:39], v12 offset:18432
 mf v[56:59], a[40:43], a[48:51], v[56:59]
 s_lshl_b32 s30, s30, 11
 ds_read_b128 a[108:111], v19 offset:23552
 v_mul_lo_u32 v9, v9, s31
 mf v[88:91], a[40:43], a[52:55], v[88:91]
 v_add_u32 v8, v8, v9
 v_add_u32 v8, s30, v8
 mf v[120:123], a[40:43], a[56:59], v[120:123]
 buffer_load_dword v10, v8, s[52:55], 0 offen sc1
 mf v[152:155], a[40:43], a[60:63], v[152:155]
 mf v[184:187], a[40:43], a[64:67], v[184:187]
 mf v[216:219], a[40:43], a[68:71], v[216:219]
 mf v[248:251], a[40:43], a[72:75], v[248:251]
 mf a[24:27], a[40:43], a[76:79], a[24:27]
 ds_read_b64_tr_b16 a[40:41], v13 offset:16384
 ds_read_b64_tr_b16 a[42:43], v13 offset:18432
 mf v[60:63], a[44:47], a[48:51], v[60:63]
 mf v[92:95], a[44:47], a[52:55], v[92:95]
 mf v[124:127], a[44:47], a[56:59], v[124:127]
 mf v[156:159], a[44:47], a[60:63], v[156:159]
 mf v[188:191], a[44:47], a[64:67], v[188:191]
 mf v[220:223], a[44:47], a[68:71], v[220:223]
 mf v[252:255], a[44:47], a[72:75], v[252:255]
 mf a[28:31], a[44:47], a[76:79], a[28:31]
 ds_read_b64_tr_b16 a[44:45], v14 offset:16384
 s_waitcnt lgkmcnt(14)
 ds_read_b64_tr_b16 a[46:47], v14 offset:18432
 s_waitcnt lgkmcnt(13)
 mf v[32:35], a[32:35], a[80:83], v[32:35]
 s_waitcnt lgkmcnt(12)
 mf v[64:67], a[32:35], a[84:87], v[64:67]
 s_waitcnt lgkmcnt(11)
 mf v[96:99], a[32:35], a[88:91], v[96:99]
 s_waitcnt lgkmcnt(10)
 mf v[128:131], a[32:35], a[92:95], v[128:131]
 s_waitcnt lgkmcnt(9)
 mf v[160:163], a[32:35], a[96:99], v[160:163]
 s_waitcnt lgkmcnt(8)
 mf v[192:195], a[32:35], a[100:103], v[192:195]
 s_waitcnt lgkmcnt(7)
 mf v[224:227], a[32:35], a[104:107], v[224:227]
 s_waitcnt lgkmcnt(4)
 mf a[0:3], a[32:35], a[108:111], a[0:3]
 ds_read_b64_tr_b16 a[32:33], v15 offset:16384
 ds_read_b64_tr_b16 a[34:35], v15 offset:18432
 mf v[36:39], a[36:39], a[80:83], v[36:39]
 mf v[68:71], a[36:39], a[84:87], v[68:71]
 mf v[100:103], a[36:39], a[88:91], v[100:103]
 mf v[132:135], a[36:39], a[92:95], v[132:135]
 mf v[164:167], a[36:39], a[96:99], v[164:167]
 mf v[196:199], a[36:39], a[100:103], v[196:199]
 mf v[228:231], a[36:39], a[104:107], v[228:231]
 mf a[4:7], a[36:39], a[108:111], a[4:7]
 s_waitcnt lgkmcnt(4)
 ds_read_b64_tr_b16 a[36:37], v16 offset:16384
 ds_read_b64_tr_b16 a[38:39], v16 offset:18432
 mf v[40:43], a[40:43], a[80:83], v[40:43]
 mf v[72:75], a[40:43], a[84:87], v[72:75]
 mf v[104:107], a[40:43], a[88:91], v[104:107]
 mf v[136:139], a[40:43], a[92:95], v[136:139]
 mf v[168:171], a[40:43], a[96:99], v[168:171]
 mf v[200:203], a[40:43], a[100:103], v[200:203]
 s_mov_b32 s56, s20
 mf v[232:235], a[40:43], a[104:107], v[232:235]
 s_mov_b32 s57, s21
 mf a[8:11], a[40:43], a[108:111], a[8:11]
 s_waitcnt lgkmcnt(4)
 s_mov_b32 s58, 0x510000
 ds_read_b64_tr_b16 a[40:41], v17 offset:16384
 ds_read_b64_tr_b16 a[42:43], v17 offset:18432
 mf v[44:47], a[44:47], a[80:83], v[44:47]
 s_mov_b32 s59, 0x20000
 v_add_u32 v30, 0x500000, v7
 mf v[76:79], a[44:47], a[84:87], v[76:79]
 buffer_load_dword a170, v30, s[56:59], 0 offen
 mf v[108:111], a[44:47], a[88:91], v[108:111]
 mf v[140:143], a[44:47], a[92:95], v[140:143]
 mf v[172:175], a[44:47], a[96:99], v[172:175]
 mf v[204:207], a[44:47], a[100:103], v[204:207]
 mf v[236:239], a[44:47], a[104:107], v[236:239]
 mf a[12:15], a[44:47], a[108:111], a[12:15]
 s_waitcnt lgkmcnt(4)
 ds_read_b64_tr_b16 a[44:45], v18 offset:16384
 ds_read_b64_tr_b16 a[46:47], v18 offset:18432
 mf v[48:51], a[32:35], a[80:83], v[48:51]
 mf v[80:83], a[32:35], a[84:87], v[80:83]
 mf v[112:115], a[32:35], a[88:91], v[112:115]
 mf v[144:147], a[32:35], a[92:95], v[144:147]
 mf v[176:179], a[32:35], a[96:99], v[176:179]
 mf v[208:211], a[32:35], a[100:103], v[208:211]
 mf v[240:243], a[32:35], a[104:107], v[240:243]
 mf a[16:19], a[32:35], a[108:111], a[16:19]
 s_waitcnt vmcnt(12)
 s_waitcnt lgkmcnt(0)
 s_barrier
 mf v[52:55], a[36:39], a[80:83], v[52:55]
 ds_read_b64_tr_b16 a[32:33], v11 offset:32768
 ds_read_b64_tr_b16 a[34:35], v11 offset:34816
 mf v[84:87], a[36:39], a[84:87], v[84:87]
 ds_read_b128 a[48:51], v19 offset:32768
 ds_read_b128 a[52:55], v19 offset:33792
 s_waitcnt vmcnt(1)
 v_cmp_eq_u32 vcc, v6, v10
 s_nop 3
 s_cmp_eq_u64 vcc, -1
 s_cbranch_scc0 f_ln0_spin
f_ln0_ok:
 mf v[116:119], a[36:39], a[88:91], v[116:119]
 s_add_u32 s61, s81, 0
 ds_read_b128 a[56:59], v19 offset:34816
 mf v[148:151], a[36:39], a[92:95], v[148:151]
 ds_read_b128 a[60:63], v19 offset:35840
 mf v[180:183], a[36:39], a[96:99], v[180:183]
 ds_read_b128 a[64:67], v19 offset:36864
 mf v[212:215], a[36:39], a[100:103], v[212:215]
 ds_read_b128 a[68:71], v19 offset:37888
 mf v[244:247], a[36:39], a[104:107], v[244:247]
 ds_read_b128 a[72:75], v19 offset:38912
 mf a[20:23], a[36:39], a[108:111], a[20:23]
 ds_read_b64_tr_b16 a[36:37], v12 offset:32768
 ds_read_b64_tr_b16 a[38:39], v12 offset:34816
 mf v[56:59], a[40:43], a[80:83], v[56:59]
 ds_read_b128 a[76:79], v19 offset:39936
 mf v[88:91], a[40:43], a[84:87], v[88:91]
 buffer_load_dwordx4 a[192:195], v4, s[48:51], s61 offen
 mf v[120:123], a[40:43], a[88:91], v[120:123]
 mf v[152:155], a[40:43], a[92:95], v[152:155]
 s_add_u32 s61, s81, s16
 mf v[184:187], a[40:43], a[96:99], v[184:187]
 s_add_u32 s61, s61, 0
 buffer_load_dwordx4 a[196:199], v4, s[48:51], s61 offen
 mf v[216:219], a[40:43], a[100:103], v[216:219]
 mf v[248:251], a[40:43], a[104:107], v[248:251]
 s_add_u32 s61, s82, 0
 buffer_load_dwordx4 a[200:203], v4, s[48:51], s61 offen
 mf a[24:27], a[40:43], a[108:111], a[24:27]
 ds_read_b64_tr_b16 a[40:41], v13 offset:32768
 ds_read_b64_tr_b16 a[42:43], v13 offset:34816
 mf v[60:63], a[44:47], a[80:83], v[60:63]
 s_add_u32 s61, s82, s16
 mf v[92:95], a[44:47], a[84:87], v[92:95]
 s_add_u32 s61, s61, 0
 buffer_load_dwordx4 a[204:207], v4, s[48:51], s61 offen
 mf v[124:127], a[44:47], a[88:91], v[124:127]
 mf v[156:159], a[44:47], a[92:95], v[156:159]
 s_add_u32 s61, s81, 0
 buffer_load_dwordx4 a[208:211], v4, s[48:51], s61 offen offset:1024
 mf v[188:191], a[44:47], a[96:99], v[188:191]
 mf v[220:223], a[44:47], a[100:103], v[220:223]
 s_add_u32 s61, s81, s16
 mf v[252:255], a[44:47], a[104:107], v[252:255]
 s_add_u32 s61, s61, 0
 buffer_load_dwordx4 a[212:215], v4, s[48:51], s61 offen offset:1024
 mf a[28:31], a[44:47], a[108:111], a[28:31]
 ds_read_b64_tr_b16 a[44:45], v14 offset:32768
 s_waitcnt lgkmcnt(14)
 ds_read_b64_tr_b16 a[46:47], v14 offset:34816
 s_waitcnt lgkmcnt(13)
 mf v[32:35], a[32:35], a[48:51], v[32:35]
 s_waitcnt lgkmcnt(12)
 s_add_u32 s61, s82, 0
 buffer_load_dwordx4 a[216:219], v4, s[48:51], s61 offen offset:1024
 mf v[64:67], a[32:35], a[52:55], v[64:67]
 s_waitcnt lgkmcnt(11)
 mf v[96:99], a[32:35], a[56:59], v[96:99]
 s_waitcnt lgkmcnt(10)
 s_add_u32 s61, s82, s16
 mf v[128:131], a[32:35], a[60:63], v[128:131]
 s_waitcnt lgkmcnt(9)
 s_add_u32 s61, s61, 0
 buffer_load_dwordx4 a[220:223], v4, s[48:51], s61 offen offset:1024
 mf v[160:163], a[32:35], a[64:67], v[160:163]
 s_waitcnt lgkmcnt(8)
 mf v[192:195], a[32:35], a[68:71], v[192:195]
 s_waitcnt lgkmcnt(7)
 s_add_u32 s61, s81, 0x800
 buffer_load_dwordx4 a[224:227], v4, s[48:51], s61 offen
 mf v[224:227], a[32:35], a[72:75], v[224:227]
 s_waitcnt lgkmcnt(4)
 mf a[0:3], a[32:35], a[76:79], a[0:3]
 s_add_u32 s61, s81, s16
 ds_read_b64_tr_b16 a[32:33], v15 offset:32768
 ds_read_b64_tr_b16 a[34:35], v15 offset:34816
 mf v[36:39], a[36:39], a[48:51], v[36:39]
 s_add_u32 s61, s61, 0x800
 buffer_load_dwordx4 a[228:231], v4, s[48:51], s61 offen
 mf v[68:71], a[36:39], a[52:55], v[68:71]
 mf v[100:103], a[36:39], a[56:59], v[100:103]
 s_add_u32 s61, s82, 0x800
 buffer_load_dwordx4 a[232:235], v4, s[48:51], s61 offen
 mf v[132:135], a[36:39], a[60:63], v[132:135]
 mf v[164:167], a[36:39], a[64:67], v[164:167]
 s_add_u32 s61, s82, s16
 mf v[196:199], a[36:39], a[68:71], v[196:199]
 s_add_u32 s61, s61, 0x800
 buffer_load_dwordx4 a[236:239], v4, s[48:51], s61 offen
 mf v[228:231], a[36:39], a[72:75], v[228:231]
 mf a[4:7], a[36:39], a[76:79], a[4:7]
 s_waitcnt lgkmcnt(4)
 s_add_u32 s61, s81, 0x800
 ds_read_b64_tr_b16 a[36:37], v16 offset:32768
 ds_read_b64_tr_b16 a[38:39], v16 offset:34816
 mf v[40:43], a[40:43], a[48:51], v[40:43]
 buffer_load_dwordx4 a[240:243], v4, s[48:51], s61 offen offset:1024
 mf v[72:75], a[40:43], a[52:55], v[72:75]
 mf v[104:107], a[40:43], a[56:59], v[104:107]
 s_add_u32 s61, s81, s16
 mf v[136:139], a[40:43], a[60:63], v[136:139]
 s_add_u32 s61, s61, 0x800
 buffer_load_dwordx4 a[244:247], v4, s[48:51], s61 offen offset:1024
 mf v[168:171], a[40:43], a[64:67], v[168:171]
 mf v[200:203], a[40:43], a[68:71], v[200:203]
 s_add_u32 s61, s82, 0x800
 buffer_load_dwordx4 a[248:251], v4, s[48:51], s61 offen offset:1024
 mf v[232:235], a[40:43], a[72:75], v[232:235]
 mf a[8:11], a[40:43], a[76:79], a[8:11]
 s_waitcnt lgkmcnt(4)
 s_add_u32 s61, s82, s16
 ds_read_b64_tr_b16 a[40:41], v17 offset:32768
 ds_read_b64_tr_b16 a[42:43], v17 offset:34816
 mf v[44:47], a[44:47], a[48:51], v[44:47]
 s_add_u32 s61, s61, 0x800
 buffer_load_dwordx4 a[252:255], v4, s[48:51], s61 offen offset:1024
 mf v[76:79], a[44:47], a[52:55], v[76:79]
 mf v[108:111], a[44:47], a[56:59], v[108:111]
 mf v[140:143], a[44:47], a[60:63], v[140:143]
 mf v[172:175], a[44:47], a[64:67], v[172:175]
 mf v[204:207], a[44:47], a[68:71], v[204:207]
 mf v[236:239], a[44:47], a[72:75], v[236:239]
 mf a[12:15], a[44:47], a[76:79], a[12:15]
 s_waitcnt lgkmcnt(4)
 ds_read_b64_tr_b16 a[44:45], v18 offset:32768
 ds_read_b64_tr_b16 a[46:47], v18 offset:34816
 mf v[48:51], a[32:35], a[48:51], v[48:51]
 mf v[80:83], a[32:35], a[52:55], v[80:83]
 mf v[112:115], a[32:35], a[56:59], v[112:115]
 mf v[144:147], a[32:35], a[60:63], v[144:147]
 mf v[176:179], a[32:35], a[64:67], v[176:179]
 mf v[208:211], a[32:35], a[68:71], v[208:211]
 mf v[240:243], a[32:35], a[72:75], v[240:243]
 mf a[16:19], a[32:35], a[76:79], a[16:19]
 s_waitcnt lgkmcnt(0)
 s_barrier
 mf v[52:55], a[36:39], a[48:51], v[52:55]
 ds_read_b64_tr_b16 a[32:33], v11 offset:49152
 ds_read_b64_tr_b16 a[34:35], v11 offset:51200
 mf v[84:87], a[36:39], a[52:55], v[84:87]
 s_mov_b32 s63, 0
 ds_read_b128 a[80:83], v19 offset:49152
 ds_read_b128 a[84:87], v19 offset:50176
 mf v[116:119], a[36:39], a[56:59], v[116:119]
 s_add_u32 m0, s78, 0
 ds_read_b128 a[88:91], v19 offset:51200
 mf v[148:151], a[36:39], a[60:63], v[148:151]
 ds_read_b128 a[92:95], v19 offset:52224
 mf v[180:183], a[36:39], a[64:67], v[180:183]
 ds_read_b128 a[96:99], v19 offset:53248
 mf v[212:215], a[36:39], a[68:71], v[212:215]
 ds_read_b128 a[100:103], v19 offset:54272
 mf v[244:247], a[36:39], a[72:75], v[244:247]
 ds_read_b128 a[104:107], v19 offset:55296
 mf a[20:23], a[36:39], a[76:79], a[20:23]
 ds_read_b64_tr_b16 a[36:37], v12 offset:49152
 ds_read_b64_tr_b16 a[38:39], v12 offset:51200
 mf v[56:59], a[40:43], a[48:51], v[56:59]
 ds_read_b128 a[108:111], v19 offset:56320
 mf v[88:91], a[40:43], a[52:55], v[88:91]
 buffer_load_dwordx4 v20, s[44:47], s63 offen lds
 mf v[120:123], a[40:43], a[56:59], v[120:123]
 mf v[152:155], a[40:43], a[60:63], v[152:155]
 s_add_u32 m0, s78, 0x400
 mf v[184:187], a[40:43], a[64:67], v[184:187]
 buffer_load_dwordx4 v21, s[44:47], s63 offen lds
 mf v[216:219], a[40:43], a[68:71], v[216:219]
 mf v[248:251], a[40:43], a[72:75], v[248:251]
 s_add_u32 m0, s78, 0x800
 mf a[24:27], a[40:43], a[76:79], a[24:27]
 ds_read_b64_tr_b16 a[40:41], v13 offset:49152
 ds_read_b64_tr_b16 a[42:43], v13 offset:51200
 mf v[60:63], a[44:47], a[48:51], v[60:63]
 buffer_load_dwordx4 v22, s[44:47], s63 offen lds
 mf v[92:95], a[44:47], a[52:55], v[92:95]
 mf v[124:127], a[44:47], a[56:59], v[124:127]
 s_add_u32 m0, s78, 0xc00
 mf v[156:159], a[44:47], a[60:63], v[156:159]
 buffer_load_dwordx4 v23, s[44:47], s63 offen lds
 mf v[188:191], a[44:47], a[64:67], v[188:191]
 mf v[220:223], a[44:47], a[68:71], v[220:223]
 s_add_u32 m0, s78, 0x1000
 mf v[252:255], a[44:47], a[72:75], v[252:255]
 buffer_load_dwordx4 v24, s[44:47], s63 offen lds
 mf a[28:31], a[44:47], a[76:79], a[28:31]
 ds_read_b64_tr_b16 a[44:45], v14 offset:49152
 s_waitcnt lgkmcnt(14)
 ds_read_b64_tr_b16 a[46:47], v14 offset:51200
 s_waitcnt lgkmcnt(13)
 mf v[32:35], a[32:35], a[80:83], v[32:35]
 s_waitcnt lgkmcnt(12)
 s_add_u32 m0, s78, 0x1400
 mf v[64:67], a[32:35], a[84:87], v[64:67]
 s_waitcnt lgkmcnt(11)
 buffer_load_dwordx4 v25, s[44:47], s63 offen lds
 mf v[96:99], a[32:35], a[88:91], v[96:99]
 s_waitcnt lgkmcnt(10)
 mf v[128:131], a[32:35], a[92:95], v[128:131]
 s_waitcnt lgkmcnt(9)
 s_add_u32 m0, s78, 0x1800
 mf v[160:163], a[32:35], a[96:99], v[160:163]
 s_waitcnt lgkmcnt(8)
 buffer_load_dwordx4 v26, s[44:47], s63 offen lds
 mf v[192:195], a[32:35], a[100:103], v[192:195]
 s_waitcnt lgkmcnt(7)
 mf v[224:227], a[32:35], a[104:107], v[224:227]
 s_waitcnt lgkmcnt(4)
 s_add_u32 m0, s78, 0x1c00
 mf a[0:3], a[32:35], a[108:111], a[0:3]
 ds_read_b64_tr_b16 a[32:33], v15 offset:49152
 ds_read_b64_tr_b16 a[34:35], v15 offset:51200
 mf v[36:39], a[36:39], a[80:83], v[36:39]
 buffer_load_dwordx4 v27, s[44:47], s63 offen lds
 mf v[68:71], a[36:39], a[84:87], v[68:71]
 mf v[100:103], a[36:39], a[88:91], v[100:103]
 s_add_u32 m0, s78, 0x2000
 mf v[132:135], a[36:39], a[92:95], v[132:135]
 buffer_load_dwordx4 v28, s[44:47], s63 offen lds
 mf v[164:167], a[36:39], a[96:99], v[164:167]
 mf v[196:199], a[36:39], a[100:103], v[196:199]
 s_add_u32 m0, s78, 0x2400
 mf v[228:231], a[36:39], a[104:107], v[228:231]
 buffer_load_dwordx4 v29, s[44:47], s63 offen lds
 mf a[4:7], a[36:39], a[108:111], a[4:7]
 s_waitcnt lgkmcnt(4)
 ds_read_b64_tr_b16 a[36:37], v16 offset:49152
 ds_read_b64_tr_b16 a[38:39], v16 offset:51200
 mf v[40:43], a[40:43], a[80:83], v[40:43]
 mf v[72:75], a[40:43], a[84:87], v[72:75]
 mf v[104:107], a[40:43], a[88:91], v[104:107]
 v_cvt_pk_bf16_f32 v32, v32, v33
 v_cvt_pk_bf16_f32 v33, v34, v35
 mf v[136:139], a[40:43], a[92:95], v[136:139]
 v_cvt_pk_bf16_f32 v34, v36, v37
 v_cvt_pk_bf16_f32 v35, v38, v39
 mf v[168:171], a[40:43], a[96:99], v[168:171]
 v_cvt_pk_bf16_f32 v64, v64, v65
 v_cvt_pk_bf16_f32 v65, v66, v67
 mf v[200:203], a[40:43], a[100:103], v[200:203]
 v_cvt_pk_bf16_f32 v66, v68, v69
 v_cvt_pk_bf16_f32 v67, v70, v71
 mf v[232:235], a[40:43], a[104:107], v[232:235]
 v_cvt_pk_bf16_f32 v96, v96, v97
 v_cvt_pk_bf16_f32 v97, v98, v99
 mf a[8:11], a[40:43], a[108:111], a[8:11]
 s_waitcnt lgkmcnt(4)
 ds_read_b64_tr_b16 a[40:41], v17 offset:49152
 ds_read_b64_tr_b16 a[42:43], v17 offset:51200
 mf v[44:47], a[44:47], a[80:83], v[44:47]
 v_cvt_pk_bf16_f32 v98, v100, v101
 v_cvt_pk_bf16_f32 v99, v102, v103
 mf v[76:79], a[44:47], a[84:87], v[76:79]
 v_cvt_pk_bf16_f32 v128, v128, v129
 v_cvt_pk_bf16_f32 v129, v130, v131
 mf v[108:111], a[44:47], a[88:91], v[108:111]
 v_cvt_pk_bf16_f32 v130, v132, v133
 v_cvt_pk_bf16_f32 v131, v134, v135
 mf v[140:143], a[44:47], a[92:95], v[140:143]
 v_cvt_pk_bf16_f32 v160, v160, v161
 v_cvt_pk_bf16_f32 v161, v162, v163
 mf v[172:175], a[44:47], a[96:99], v[172:175]
 v_cvt_pk_bf16_f32 v162, v164, v165
 v_cvt_pk_bf16_f32 v163, v166, v167
 mf v[204:207], a[44:47], a[100:103], v[204:207]
 v_cvt_pk_bf16_f32 v192, v192, v193
 v_cvt_pk_bf16_f32 v193, v194, v195
 mf v[236:239], a[44:47], a[104:107], v[236:239]
 v_cvt_pk_bf16_f32 v194, v196, v197
 v_cvt_pk_bf16_f32 v195, v198, v199
 mf a[12:15], a[44:47], a[108:111], a[12:15]
 s_waitcnt lgkmcnt(4)
 ds_read_b64_tr_b16 a[44:45], v18 offset:49152
 ds_read_b64_tr_b16 a[46:47], v18 offset:51200
 mf v[48:51], a[32:35], a[80:83], v[48:51]
 v_cvt_pk_bf16_f32 v224, v224, v225
 v_cvt_pk_bf16_f32 v225, v226, v227
 mf v[80:83], a[32:35], a[84:87], v[80:83]
 v_cvt_pk_bf16_f32 v226, v228, v229
 v_cvt_pk_bf16_f32 v227, v230, v231
 mf v[112:115], a[32:35], a[88:91], v[112:115]
 v_cvt_pk_bf16_f32 v40, v40, v41
 v_cvt_pk_bf16_f32 v41, v42, v43
 mf v[144:147], a[32:35], a[92:95], v[144:147]
 v_cvt_pk_bf16_f32 v42, v44, v45
 v_cvt_pk_bf16_f32 v43, v46, v47
 mf v[176:179], a[32:35], a[96:99], v[176:179]
 v_cvt_pk_bf16_f32 v72, v72, v73
 v_cvt_pk_bf16_f32 v73, v74, v75
 mf v[208:211], a[32:35], a[100:103], v[208:211]
 v_cvt_pk_bf16_f32 v74, v76, v77
 v_cvt_pk_bf16_f32 v75, v78, v79
 mf v[240:243], a[32:35], a[104:107], v[240:243]
 v_cvt_pk_bf16_f32 v104, v104, v105
 v_cvt_pk_bf16_f32 v105, v106, v107
 mf a[16:19], a[32:35], a[108:111], a[16:19]
 s_waitcnt lgkmcnt(4)
 v_cvt_pk_bf16_f32 v106, v108, v109
 v_cvt_pk_bf16_f32 v107, v110, v111
 mf v[52:55], a[36:39], a[80:83], v[52:55]
 v_cvt_pk_bf16_f32 v136, v136, v137
 v_cvt_pk_bf16_f32 v137, v138, v139
 mf v[84:87], a[36:39], a[84:87], v[84:87]
 v_cvt_pk_bf16_f32 v138, v140, v141
 v_cvt_pk_bf16_f32 v139, v142, v143
 mf v[116:119], a[36:39], a[88:91], v[116:119]
 v_cvt_pk_bf16_f32 v168, v168, v169
 v_cvt_pk_bf16_f32 v169, v170, v171
 mf v[148:151], a[36:39], a[92:95], v[148:151]
 v_cvt_pk_bf16_f32 v170, v172, v173
 v_cvt_pk_bf16_f32 v171, v174, v175
 mf v[180:183], a[36:39], a[96:99], v[180:183]
 v_cvt_pk_bf16_f32 v200, v200, v201
 v_cvt_pk_bf16_f32 v201, v202, v203
 mf v[212:215], a[36:39], a[100:103], v[212:215]
 v_cvt_pk_bf16_f32 v202, v204, v205
 v_cvt_pk_bf16_f32 v203, v206, v207
 mf v[244:247], a[36:39], a[104:107], v[244:247]
 v_cvt_pk_bf16_f32 v232, v232, v233
 v_cvt_pk_bf16_f32 v233, v234, v235
 mf a[20:23], a[36:39], a[108:111], a[20:23]
 s_waitcnt lgkmcnt(2)
 v_cvt_pk_bf16_f32 v234, v236, v237
 v_cvt_pk_bf16_f32 v235, v238, v239
 mf v[56:59], a[40:43], a[80:83], v[56:59]
 mf v[88:91], a[40:43], a[84:87], v[88:91]
 mf v[120:123], a[40:43], a[88:91], v[120:123]
 v_cvt_pk_bf16_f32 v48, v48, v49
 v_cvt_pk_bf16_f32 v49, v50, v51
 mf v[152:155], a[40:43], a[92:95], v[152:155]
 v_cvt_pk_bf16_f32 v50, v52, v53
 v_cvt_pk_bf16_f32 v51, v54, v55
 mf v[184:187], a[40:43], a[96:99], v[184:187]
 v_cvt_pk_bf16_f32 v80, v80, v81
 v_cvt_pk_bf16_f32 v81, v82, v83
 mf v[216:219], a[40:43], a[100:103], v[216:219]
 v_cvt_pk_bf16_f32 v82, v84, v85
 v_cvt_pk_bf16_f32 v83, v86, v87
 mf v[248:251], a[40:43], a[104:107], v[248:251]
 v_cvt_pk_bf16_f32 v112, v112, v113
 v_cvt_pk_bf16_f32 v113, v114, v115
 mf a[24:27], a[40:43], a[108:111], a[24:27]
 s_waitcnt lgkmcnt(0)
 v_cvt_pk_bf16_f32 v114, v116, v117
 v_cvt_pk_bf16_f32 v115, v118, v119
 mf v[60:63], a[44:47], a[80:83], v[60:63]
 v_cvt_pk_bf16_f32 v144, v144, v145
 v_cvt_pk_bf16_f32 v145, v146, v147
 mf v[92:95], a[44:47], a[84:87], v[92:95]
 v_cvt_pk_bf16_f32 v146, v148, v149
 v_cvt_pk_bf16_f32 v147, v150, v151
 mf v[124:127], a[44:47], a[88:91], v[124:127]
 v_cvt_pk_bf16_f32 v176, v176, v177
 v_cvt_pk_bf16_f32 v177, v178, v179
 mf v[156:159], a[44:47], a[92:95], v[156:159]
 v_cvt_pk_bf16_f32 v178, v180, v181
 v_cvt_pk_bf16_f32 v179, v182, v183
 mf v[188:191], a[44:47], a[96:99], v[188:191]
 v_cvt_pk_bf16_f32 v208, v208, v209
 v_cvt_pk_bf16_f32 v209, v210, v211
 mf v[220:223], a[44:47], a[100:103], v[220:223]
 v_cvt_pk_bf16_f32 v210, v212, v213
 v_cvt_pk_bf16_f32 v211, v214, v215
 mf v[252:255], a[44:47], a[104:107], v[252:255]
 v_cvt_pk_bf16_f32 v240, v240, v241
 v_cvt_pk_bf16_f32 v241, v242, v243
 mf a[28:31], a[44:47], a[108:111], a[28:31]
 v_cvt_pk_bf16_f32 v242, v244, v245
 v_cvt_pk_bf16_f32 v243, v246, v247
 s_barrier
 v_accvgpr_read_b32 v8, a0
 v_accvgpr_read_b32 v9, a1
 v_accvgpr_read_b32 v10, a2
 v_accvgpr_read_b32 v11, a3
 v_accvgpr_read_b32 v12, a4
 v_accvgpr_read_b32 v13, a5
 v_accvgpr_read_b32 v14, a6
 v_accvgpr_read_b32 v15, a7
 v_cvt_pk_bf16_f32 v8, v8, v9
 v_cvt_pk_bf16_f32 v9, v10, v11
 v_cvt_pk_bf16_f32 v10, v12, v13
 v_cvt_pk_bf16_f32 v11, v14, v15
 s_add_u32 s62, s73, 0xb000
 buffer_store_dwordx4 v[8:11], v4, s[40:43], s62 offen sc1
 s_nop 1
 v_accvgpr_read_b32 v8, a8
 v_accvgpr_read_b32 v9, a9
 v_accvgpr_read_b32 v10, a10
 v_accvgpr_read_b32 v11, a11
 v_accvgpr_read_b32 v12, a12
 v_accvgpr_read_b32 v13, a13
 v_accvgpr_read_b32 v14, a14
 v_accvgpr_read_b32 v15, a15
 v_cvt_pk_bf16_f32 v8, v8, v9
 v_cvt_pk_bf16_f32 v9, v10, v11
 v_cvt_pk_bf16_f32 v10, v12, v13
 v_cvt_pk_bf16_f32 v11, v14, v15
 s_add_u32 s62, s73, 0xb000
 buffer_store_dwordx4 v[8:11], v4, s[40:43], s62 offen offset:1024 sc1
 s_nop 1
 v_accvgpr_read_b32 v8, a16
 v_accvgpr_read_b32 v9, a17
 v_accvgpr_read_b32 v10, a18
 v_accvgpr_read_b32 v11, a19
 v_accvgpr_read_b32 v12, a20
 v_accvgpr_read_b32 v13, a21
 v_accvgpr_read_b32 v14, a22
 v_accvgpr_read_b32 v15, a23
 v_cvt_pk_bf16_f32 v8, v8, v9
 v_cvt_pk_bf16_f32 v9, v10, v11
 v_cvt_pk_bf16_f32 v10, v12, v13
 v_cvt_pk_bf16_f32 v11, v14, v15
 s_add_u32 s62, s73, 0xb000
 buffer_store_dwordx4 v[8:11], v4, s[40:43], s62 offen offset:2048 sc1
 s_nop 1
 v_accvgpr_read_b32 v8, a24
 v_accvgpr_read_b32 v9, a25
 v_accvgpr_read_b32 v10, a26
 v_accvgpr_read_b32 v11, a27
 v_accvgpr_read_b32 v12, a28
 v_accvgpr_read_b32 v13, a29
 v_accvgpr_read_b32 v14, a30
 v_accvgpr_read_b32 v15, a31
 v_cvt_pk_bf16_f32 v8, v8, v9
 v_cvt_pk_bf16_f32 v9, v10, v11
 v_cvt_pk_bf16_f32 v10, v12, v13
 v_cvt_pk_bf16_f32 v11, v14, v15
 s_add_u32 s62, s73, 0xb000
 buffer_store_dwordx4 v[8:11], v4, s[40:43], s62 offen offset:3072 sc1
 v_cvt_pk_bf16_f32 v56, v56, v57
 v_cvt_pk_bf16_f32 v57, v58, v59
 v_cvt_pk_bf16_f32 v58, v60, v61
 v_cvt_pk_bf16_f32 v59, v62, v63
 v_cvt_pk_bf16_f32 v88, v88, v89
 v_cvt_pk_bf16_f32 v89, v90, v91
 v_cvt_pk_bf16_f32 v90, v92, v93
 v_cvt_pk_bf16_f32 v91, v94, v95
 v_cvt_pk_bf16_f32 v120, v120, v121
 v_cvt_pk_bf16_f32 v121, v122, v123
 v_cvt_pk_bf16_f32 v122, v124, v125
 v_cvt_pk_bf16_f32 v123, v126, v127
 v_cvt_pk_bf16_f32 v152, v152, v153
 v_cvt_pk_bf16_f32 v153, v154, v155
 v_cvt_pk_bf16_f32 v154, v156, v157
 v_cvt_pk_bf16_f32 v155, v158, v159
 v_cvt_pk_bf16_f32 v184, v184, v185
 v_cvt_pk_bf16_f32 v185, v186, v187
 v_cvt_pk_bf16_f32 v186, v188, v189
 v_cvt_pk_bf16_f32 v187, v190, v191
 v_cvt_pk_bf16_f32 v216, v216, v217
 v_cvt_pk_bf16_f32 v217, v218, v219
 v_cvt_pk_bf16_f32 v218, v220, v221
 v_cvt_pk_bf16_f32 v219, v222, v223
 v_cvt_pk_bf16_f32 v248, v248, v249
 v_cvt_pk_bf16_f32 v249, v250, v251
 v_cvt_pk_bf16_f32 v250, v252, v253
 v_cvt_pk_bf16_f32 v251, v254, v255
 s_branch f_q
f_v:
 s_waitcnt vmcnt(10)
 s_waitcnt lgkmcnt(0)
 s_barrier
 ds_read_b128 a[48:51], v19
 ds_read_b128 a[52:55], v19 offset:1024
 ds_read_b128 a[56:59], v19 offset:2048
 ds_read_b128 a[60:63], v19 offset:3072
 ds_read_b128 a[64:67], v19 offset:4096
 ds_read_b128 a[68:71], v19 offset:5120
 ds_read_b128 a[72:75], v19 offset:6144
 ds_read_b128 a[76:79], v19 offset:7168
 ds_read_b64_tr_b16 a[32:33], v11
 ds_read_b64_tr_b16 a[34:35], v11 offset:2048
 ds_read_b64_tr_b16 a[36:37], v12
 ds_read_b64_tr_b16 a[38:39], v12 offset:2048
 ds_read_b64_tr_b16 a[40:41], v13
 ds_read_b64_tr_b16 a[42:43], v13 offset:2048
 ds_read_b64_tr_b16 a[44:45], v14
 s_waitcnt lgkmcnt(14)
 ds_read_b64_tr_b16 a[46:47], v14 offset:2048
 s_waitcnt lgkmcnt(6)
 mf v[32:35], a[48:51], a[32:35], 0
 s_add_u32 m0, s70, 0x8000
 mf v[36:39], a[52:55], a[32:35], 0
 s_add_u32 s60, s71, 0x80000
 mf v[96:99], a[56:59], a[32:35], 0
 buffer_load_dwordx4 v8, s[32:35], s60 offen nt lds
 mf v[100:103], a[60:63], a[32:35], 0
 s_add_u32 m0, s70, 0x18000
 mf v[160:163], a[64:67], a[32:35], 0
 s_add_u32 s60, s72, 0x80
 mf v[164:167], a[68:71], a[32:35], 0
 buffer_load_dwordx4 v10, s[36:39], s60 offen lds
 mf v[224:227], a[72:75], a[32:35], 0
 s_add_u32 m0, s70, 0x9000
 mf v[228:231], a[76:79], a[32:35], 0
 s_waitcnt lgkmcnt(4)
 s_add_u32 s60, s71, 0x90000
 ds_read_b64_tr_b16 a[32:33], v15
 ds_read_b64_tr_b16 a[34:35], v15 offset:2048
 mf v[40:43], a[48:51], a[36:39], 0
 buffer_load_dwordx4 v9, s[32:35], s60 offen nt lds
 mf v[44:47], a[52:55], a[36:39], 0
 s_add_u32 m0, s70, 0x19000
 mf v[104:107], a[56:59], a[36:39], 0
 s_add_u32 s60, s72, 0x10080
 mf v[108:111], a[60:63], a[36:39], 0
 buffer_load_dwordx4 v10, s[36:39], s60 offen lds
 mf v[168:171], a[64:67], a[36:39], 0
 s_add_u32 m0, s70, 0xa000
 mf v[172:175], a[68:71], a[36:39], 0
 s_add_u32 s60, s71, 0xa0000
 mf v[232:235], a[72:75], a[36:39], 0
 buffer_load_dwordx4 v8, s[32:35], s60 offen nt lds
 mf v[236:239], a[76:79], a[36:39], 0
 s_waitcnt lgkmcnt(4)
 s_add_u32 m0, s70, 0x1a000
 ds_read_b64_tr_b16 a[36:37], v16
 ds_read_b64_tr_b16 a[38:39], v16 offset:2048
 mf v[48:51], a[48:51], a[40:43], 0
 s_add_u32 s60, s72, 0x20080
 mf v[52:55], a[52:55], a[40:43], 0
 buffer_load_dwordx4 v10, s[36:39], s60 offen lds
 mf v[112:115], a[56:59], a[40:43], 0
 s_add_u32 m0, s70, 0xb000
 mf v[116:119], a[60:63], a[40:43], 0
 s_add_u32 s60, s71, 0xb0000
 mf v[176:179], a[64:67], a[40:43], 0
 buffer_load_dwordx4 v9, s[32:35], s60 offen nt lds
 mf v[180:183], a[68:71], a[40:43], 0
 s_add_u32 m0, s70, 0x1b000
 mf v[240:243], a[72:75], a[40:43], 0
 s_add_u32 s60, s72, 0x30080
 mf v[244:247], a[76:79], a[40:43], 0
 s_waitcnt lgkmcnt(4)
 ds_read_b64_tr_b16 a[40:41], v17
 ds_read_b64_tr_b16 a[42:43], v17 offset:2048
 mf v[56:59], a[48:51], a[44:47], 0
 buffer_load_dwordx4 v10, s[36:39], s60 offen lds
 mf v[60:63], a[52:55], a[44:47], 0
 s_add_u32 m0, s70, 0xc000
 mf v[120:123], a[56:59], a[44:47], 0
 s_add_u32 s60, s71, 0xc0000
 mf v[124:127], a[60:63], a[44:47], 0
 buffer_load_dwordx4 v8, s[32:35], s60 offen nt lds
 mf v[184:187], a[64:67], a[44:47], 0
 s_add_u32 m0, s70, 0x1c000
 mf v[188:191], a[68:71], a[44:47], 0
 s_add_u32 s60, s72, 0xc0
 mf v[248:251], a[72:75], a[44:47], 0
 buffer_load_dwordx4 v10, s[36:39], s60 offen lds
 mf v[252:255], a[76:79], a[44:47], 0
 s_waitcnt lgkmcnt(4)
 s_add_u32 m0, s70, 0xd000
 ds_read_b64_tr_b16 a[44:45], v18
 ds_read_b64_tr_b16 a[46:47], v18 offset:2048
 mf v[64:67], a[48:51], a[32:35], 0
 s_add_u32 s60, s71, 0xd0000
 mf v[68:71], a[52:55], a[32:35], 0
 buffer_load_dwordx4 v9, s[32:35], s60 offen nt lds
 mf v[128:131], a[56:59], a[32:35], 0
 s_add_u32 m0, s70, 0x1d000
 mf v[132:135], a[60:63], a[32:35], 0
 s_add_u32 s60, s72, 0x100c0
 mf v[192:195], a[64:67], a[32:35], 0
 buffer_load_dwordx4 v10, s[36:39], s60 offen lds
 mf v[196:199], a[68:71], a[32:35], 0
 s_add_u32 m0, s70, 0xe000
 mf a[0:3], a[72:75], a[32:35], 0
 s_add_u32 s60, s71, 0xe0000
 mf a[4:7], a[76:79], a[32:35], 0
 s_waitcnt vmcnt(14)
 s_waitcnt lgkmcnt(0)
 s_barrier
 mf v[72:75], a[48:51], a[36:39], 0
 ds_read_b64_tr_b16 a[32:33], v11 offset:16384
 ds_read_b64_tr_b16 a[34:35], v11 offset:18432
 mf v[76:79], a[52:55], a[36:39], 0
 ds_read_b128 a[80:83], v19 offset:16384
 ds_read_b128 a[84:87], v19 offset:17408
 mf v[136:139], a[56:59], a[36:39], 0
 ds_read_b128 a[88:91], v19 offset:18432
 mf v[140:143], a[60:63], a[36:39], 0
 ds_read_b128 a[92:95], v19 offset:19456
 mf v[200:203], a[64:67], a[36:39], 0
 ds_read_b128 a[96:99], v19 offset:20480
 ds_read_b128 a[112:115], v31
 mf v[204:207], a[68:71], a[36:39], 0
 ds_read_b128 a[100:103], v19 offset:21504
 mf a[8:11], a[72:75], a[36:39], 0
 ds_read_b128 a[104:107], v19 offset:22528
 mf a[12:15], a[76:79], a[36:39], 0
 ds_read_b64_tr_b16 a[36:37], v12 offset:16384
 ds_read_b64_tr_b16 a[38:39], v12 offset:18432
 mf v[80:83], a[48:51], a[40:43], 0
 ds_read_b128 a[108:111], v19 offset:23552
 mf v[84:87], a[52:55], a[40:43], 0
 buffer_load_dwordx4 v8, s[32:35], s60 offen nt lds
 mf v[144:147], a[56:59], a[40:43], 0
 s_add_u32 m0, s70, 0x1e000
 mf v[148:151], a[60:63], a[40:43], 0
 s_add_u32 s60, s72, 0x200c0
 mf v[208:211], a[64:67], a[40:43], 0
 s_movk_i32 s62, 0
 buffer_load_dwordx4 v10, s[36:39], s60 offen lds
 mf v[212:215], a[68:71], a[40:43], 0
 s_add_u32 m0, s70, 0xf000
 s_waitcnt lgkmcnt(5)
 buffer_store_dwordx4 a[112:115], v30, s[48:51], s62 offen sc1
 mf a[16:19], a[72:75], a[40:43], 0
 s_add_u32 s60, s71, 0xf0000
 mf a[20:23], a[76:79], a[40:43], 0
 ds_read_b64_tr_b16 a[40:41], v13 offset:16384
 ds_read_b64_tr_b16 a[42:43], v13 offset:18432
 mf v[88:91], a[48:51], a[44:47], 0
 buffer_load_dwordx4 v9, s[32:35], s60 offen nt lds
 mf v[92:95], a[52:55], a[44:47], 0
 s_add_u32 m0, s70, 0x1f000
 mf v[152:155], a[56:59], a[44:47], 0
 s_add_u32 s60, s72, 0x300c0
 mf v[156:159], a[60:63], a[44:47], 0
 buffer_load_dwordx4 v10, s[36:39], s60 offen lds
 mf v[216:219], a[64:67], a[44:47], 0
 s_add_u32 m0, s70, 0
 mf v[220:223], a[68:71], a[44:47], 0
 s_add_u32 s60, s71, 0x100000
 ds_read_b128 a[116:119], v31 offset:4096
 mf a[24:27], a[72:75], a[44:47], 0
 buffer_load_dwordx4 v8, s[32:35], s60 offen nt lds
 mf a[28:31], a[76:79], a[44:47], 0
 ds_read_b64_tr_b16 a[44:45], v14 offset:16384
 ds_read_b64_tr_b16 a[46:47], v14 offset:18432
 mf v[32:35], a[80:83], a[32:35], v[32:35]
 mf v[36:39], a[84:87], a[32:35], v[36:39]
 s_add_u32 m0, s70, 0x10000
 mf v[96:99], a[88:91], a[32:35], v[96:99]
 s_add_u32 s60, s72, 0x100
 mf v[100:103], a[92:95], a[32:35], v[100:103]
 buffer_load_dwordx4 v10, s[36:39], s60 offen lds
 mf v[160:163], a[96:99], a[32:35], v[160:163]
 s_waitcnt lgkmcnt(9)
 mf v[164:167], a[100:103], a[32:35], v[164:167]
 s_movk_i32 s62, 0x2000
 s_waitcnt lgkmcnt(2)
 buffer_store_dwordx4 a[116:119], v30, s[48:51], s62 offen sc1
 mf v[224:227], a[104:107], a[32:35], v[224:227]
 s_add_u32 m0, s70, 0x1000
 mf v[228:231], a[108:111], a[32:35], v[228:231]
 s_add_u32 s60, s71, 0x110000
 ds_read_b64_tr_b16 a[32:33], v15 offset:16384
 ds_read_b64_tr_b16 a[34:35], v15 offset:18432
 mf v[40:43], a[80:83], a[36:39], v[40:43]
 buffer_load_dwordx4 v9, s[32:35], s60 offen nt lds
 mf v[44:47], a[84:87], a[36:39], v[44:47]
 mf v[104:107], a[88:91], a[36:39], v[104:107]
 mf v[108:111], a[92:95], a[36:39], v[108:111]
 s_add_u32 m0, s70, 0x11000
 mf v[168:171], a[96:99], a[36:39], v[168:171]
 s_add_u32 s60, s72, 0x10100
 mf v[172:175], a[100:103], a[36:39], v[172:175]
 buffer_load_dwordx4 v10, s[36:39], s60 offen lds
 mf v[232:235], a[104:107], a[36:39], v[232:235]
 s_cmp_eq_u32 s3, 0
 ds_read_b128 a[120:123], v31 offset:8192
 mf v[236:239], a[108:111], a[36:39], v[236:239]
 s_cselect_b32 s62, 0, 0x7ff00000
 ds_read_b64_tr_b16 a[36:37], v16 offset:16384
 ds_read_b64_tr_b16 a[38:39], v16 offset:18432
 mf v[48:51], a[80:83], a[40:43], v[48:51]
 s_add_u32 m0, s70, 0x2000
 v_add_u32 v31, s62, v30
 mf v[52:55], a[84:87], a[40:43], v[52:55]
 s_add_u32 s60, s71, 0x120000
 mf v[112:115], a[88:91], a[40:43], v[112:115]
 buffer_load_dwordx4 v8, s[32:35], s60 offen nt lds
 mf v[116:119], a[92:95], a[40:43], v[116:119]
 mf v[176:179], a[96:99], a[40:43], v[176:179]
 mf v[180:183], a[100:103], a[40:43], v[180:183]
 s_add_u32 m0, s70, 0x12000
 mf v[240:243], a[104:107], a[40:43], v[240:243]
 s_add_u32 s60, s72, 0x20100
 mf v[244:247], a[108:111], a[40:43], v[244:247]
 s_waitcnt lgkmcnt(5)
 ds_read_b64_tr_b16 a[40:41], v17 offset:16384
 ds_read_b64_tr_b16 a[42:43], v17 offset:18432
 mf v[56:59], a[80:83], a[44:47], v[56:59]
 s_movk_i32 s62, 0x4000
 buffer_load_dwordx4 v10, s[36:39], s60 offen lds
 mf v[60:63], a[84:87], a[44:47], v[60:63]
 s_waitcnt lgkmcnt(4)
 buffer_store_dwordx4 a[120:123], v31, s[48:51], s62 offen sc1
 mf v[120:123], a[88:91], a[44:47], v[120:123]
 s_add_u32 m0, s70, 0x3000
 mf v[124:127], a[92:95], a[44:47], v[124:127]
 s_add_u32 s60, s71, 0x130000
 mf v[184:187], a[96:99], a[44:47], v[184:187]
 buffer_load_dwordx4 v9, s[32:35], s60 offen nt lds
 mf v[188:191], a[100:103], a[44:47], v[188:191]
 mf v[248:251], a[104:107], a[44:47], v[248:251]
 mf v[252:255], a[108:111], a[44:47], v[252:255]
 s_add_u32 m0, s70, 0x13000
 ds_read_b64_tr_b16 a[44:45], v18 offset:16384
 ds_read_b64_tr_b16 a[46:47], v18 offset:18432
 mf v[64:67], a[80:83], a[32:35], v[64:67]
 s_add_u32 s60, s72, 0x30100
 mf v[68:71], a[84:87], a[32:35], v[68:71]
 buffer_load_dwordx4 v10, s[36:39], s60 offen lds
 mf v[128:131], a[88:91], a[32:35], v[128:131]
 mf v[132:135], a[92:95], a[32:35], v[132:135]
 mf v[192:195], a[96:99], a[32:35], v[192:195]
 mf v[196:199], a[100:103], a[32:35], v[196:199]
 mf a[0:3], a[104:107], a[32:35], a[0:3]
 mf a[4:7], a[108:111], a[32:35], a[4:7]
 s_waitcnt vmcnt(19)
 s_waitcnt lgkmcnt(0)
 s_barrier
 mf v[72:75], a[80:83], a[36:39], v[72:75]
 s_add_u32 m0, s70, 0x4000
 ds_read_b64_tr_b16 a[32:33], v11 offset:32768
 ds_read_b64_tr_b16 a[34:35], v11 offset:34816
 mf v[76:79], a[84:87], a[36:39], v[76:79]
 s_add_u32 s60, s71, 0x140000
 ds_read_b128 a[48:51], v19 offset:32768
 ds_read_b128 a[52:55], v19 offset:33792
 mf v[136:139], a[88:91], a[36:39], v[136:139]
 ds_read_b128 a[56:59], v19 offset:34816
 mf v[140:143], a[92:95], a[36:39], v[140:143]
 ds_read_b128 a[60:63], v19 offset:35840
 mf v[200:203], a[96:99], a[36:39], v[200:203]
 ds_read_b128 a[64:67], v19 offset:36864
 mf v[204:207], a[100:103], a[36:39], v[204:207]
 ds_read_b128 a[68:71], v19 offset:37888
 mf a[8:11], a[104:107], a[36:39], a[8:11]
 ds_read_b128 a[72:75], v19 offset:38912
 mf a[12:15], a[108:111], a[36:39], a[12:15]
 ds_read_b64_tr_b16 a[36:37], v12 offset:32768
 ds_read_b64_tr_b16 a[38:39], v12 offset:34816
 mf v[80:83], a[80:83], a[40:43], v[80:83]
 ds_read_b128 a[76:79], v19 offset:39936
 mf v[84:87], a[84:87], a[40:43], v[84:87]
 buffer_load_dwordx4 v8, s[32:35], s60 offen nt lds
 mf v[144:147], a[88:91], a[40:43], v[144:147]
 s_add_u32 m0, s70, 0x14000
 mf v[148:151], a[92:95], a[40:43], v[148:151]
 s_add_u32 s60, s72, 0x140
 mf v[208:211], a[96:99], a[40:43], v[208:211]
 buffer_load_dwordx4 v10, s[36:39], s60 offen lds
 mf v[212:215], a[100:103], a[40:43], v[212:215]
 mf a[16:19], a[104:107], a[40:43], a[16:19]
 mf a[20:23], a[108:111], a[40:43], a[20:23]
 s_add_u32 m0, s70, 0x5000
 ds_read_b64_tr_b16 a[40:41], v13 offset:32768
 ds_read_b64_tr_b16 a[42:43], v13 offset:34816
 mf v[88:91], a[80:83], a[44:47], v[88:91]
 s_add_u32 s60, s71, 0x150000
 mf v[92:95], a[84:87], a[44:47], v[92:95]
 buffer_load_dwordx4 v9, s[32:35], s60 offen nt lds
 mf v[152:155], a[88:91], a[44:47], v[152:155]
 mf v[156:159], a[92:95], a[44:47], v[156:159]
 mf v[216:219], a[96:99], a[44:47], v[216:219]
 s_add_u32 m0, s70, 0x15000
 mf v[220:223], a[100:103], a[44:47], v[220:223]
 s_add_u32 s60, s72, 0x10140
 mf a[24:27], a[104:107], a[44:47], a[24:27]
 buffer_load_dwordx4 v10, s[36:39], s60 offen lds
 mf a[28:31], a[108:111], a[44:47], a[28:31]
 ds_read_b64_tr_b16 a[44:45], v14 offset:32768
 s_waitcnt lgkmcnt(14)
 ds_read_b64_tr_b16 a[46:47], v14 offset:34816
 s_waitcnt lgkmcnt(13)
 mf v[32:35], a[48:51], a[32:35], v[32:35]
 s_waitcnt lgkmcnt(12)
 mf v[36:39], a[52:55], a[32:35], v[36:39]
 s_waitcnt lgkmcnt(11)
 s_add_u32 m0, s70, 0x6000
 mf v[96:99], a[56:59], a[32:35], v[96:99]
 s_waitcnt lgkmcnt(10)
 s_add_u32 s60, s71, 0x160000
 mf v[100:103], a[60:63], a[32:35], v[100:103]
 s_waitcnt lgkmcnt(9)
 buffer_load_dwordx4 v8, s[32:35], s60 offen nt lds
 mf v[160:163], a[64:67], a[32:35], v[160:163]
 s_waitcnt lgkmcnt(8)
 mf v[164:167], a[68:71], a[32:35], v[164:167]
 s_waitcnt lgkmcnt(7)
 mf v[224:227], a[72:75], a[32:35], v[224:227]
 s_waitcnt lgkmcnt(4)
 s_add_u32 m0, s70, 0x16000
 mf v[228:231], a[76:79], a[32:35], v[228:231]
 s_add_u32 s60, s72, 0x20140
 ds_read_b64_tr_b16 a[32:33], v15 offset:32768
 ds_read_b64_tr_b16 a[34:35], v15 offset:34816
 mf v[40:43], a[48:51], a[36:39], v[40:43]
 buffer_load_dwordx4 v10, s[36:39], s60 offen lds
 mf v[44:47], a[52:55], a[36:39], v[44:47]
 mf v[104:107], a[56:59], a[36:39], v[104:107]
 mf v[108:111], a[60:63], a[36:39], v[108:111]
 s_add_u32 m0, s70, 0x7000
 mf v[168:171], a[64:67], a[36:39], v[168:171]
 s_add_u32 s60, s71, 0x170000
 mf v[172:175], a[68:71], a[36:39], v[172:175]
 buffer_load_dwordx4 v9, s[32:35], s60 offen nt lds
 mf v[232:235], a[72:75], a[36:39], v[232:235]
 mf v[236:239], a[76:79], a[36:39], v[236:239]
 s_waitcnt lgkmcnt(4)
 ds_read_b64_tr_b16 a[36:37], v16 offset:32768
 ds_read_b64_tr_b16 a[38:39], v16 offset:34816
 mf v[48:51], a[48:51], a[40:43], v[48:51]
 s_add_u32 m0, s70, 0x17000
 mf v[52:55], a[52:55], a[40:43], v[52:55]
 s_add_u32 s60, s72, 0x30140
 mf v[112:115], a[56:59], a[40:43], v[112:115]
 buffer_load_dwordx4 v10, s[36:39], s60 offen lds
 mf v[116:119], a[60:63], a[40:43], v[116:119]
 mf v[176:179], a[64:67], a[40:43], v[176:179]
 mf v[180:183], a[68:71], a[40:43], v[180:183]
 s_mov_b32 s56, s18
 mf v[240:243], a[72:75], a[40:43], v[240:243]
 s_mov_b32 s57, s19
 mf v[244:247], a[76:79], a[40:43], v[244:247]
 s_waitcnt lgkmcnt(4)
 s_mov_b32 s58, 0x510000
 ds_read_b64_tr_b16 a[40:41], v17 offset:32768
 ds_read_b64_tr_b16 a[42:43], v17 offset:34816
 mf v[56:59], a[48:51], a[44:47], v[56:59]
 s_mov_b32 s59, 0x20000
 v_add_u32 v30, 0, v7
 mf v[60:63], a[52:55], a[44:47], v[60:63]
 buffer_load_dword a170, v30, s[56:59], 0 offen
 mf v[120:123], a[56:59], a[44:47], v[120:123]
 mf v[124:127], a[60:63], a[44:47], v[124:127]
 mf v[184:187], a[64:67], a[44:47], v[184:187]
 mf v[188:191], a[68:71], a[44:47], v[188:191]
 mf v[248:251], a[72:75], a[44:47], v[248:251]
 mf v[252:255], a[76:79], a[44:47], v[252:255]
 s_waitcnt lgkmcnt(4)
 ds_read_b64_tr_b16 a[44:45], v18 offset:32768
 ds_read_b64_tr_b16 a[46:47], v18 offset:34816
 mf v[64:67], a[48:51], a[32:35], v[64:67]
 mf v[68:71], a[52:55], a[32:35], v[68:71]
 mf v[128:131], a[56:59], a[32:35], v[128:131]
 mf v[132:135], a[60:63], a[32:35], v[132:135]
 mf v[192:195], a[64:67], a[32:35], v[192:195]
 mf v[196:199], a[68:71], a[32:35], v[196:199]
 mf a[0:3], a[72:75], a[32:35], a[0:3]
 mf a[4:7], a[76:79], a[32:35], a[4:7]
 s_waitcnt vmcnt(19)
 s_waitcnt lgkmcnt(0)
 s_barrier
 mf v[72:75], a[48:51], a[36:39], v[72:75]
 s_add_u32 m0, s70, 0x8000
 ds_read_b64_tr_b16 a[32:33], v11 offset:49152
 ds_read_b64_tr_b16 a[34:35], v11 offset:51200
 mf v[76:79], a[52:55], a[36:39], v[76:79]
 s_add_u32 s60, s71, 0x180000
 ds_read_b128 a[80:83], v19 offset:49152
 ds_read_b128 a[84:87], v19 offset:50176
 mf v[136:139], a[56:59], a[36:39], v[136:139]
 ds_read_b128 a[88:91], v19 offset:51200
 mf v[140:143], a[60:63], a[36:39], v[140:143]
 ds_read_b128 a[92:95], v19 offset:52224
 mf v[200:203], a[64:67], a[36:39], v[200:203]
 ds_read_b128 a[96:99], v19 offset:53248
 mf v[204:207], a[68:71], a[36:39], v[204:207]
 ds_read_b128 a[100:103], v19 offset:54272
 mf a[8:11], a[72:75], a[36:39], a[8:11]
 ds_read_b128 a[104:107], v19 offset:55296
 mf a[12:15], a[76:79], a[36:39], a[12:15]
 ds_read_b64_tr_b16 a[36:37], v12 offset:49152
 ds_read_b64_tr_b16 a[38:39], v12 offset:51200
 mf v[80:83], a[48:51], a[40:43], v[80:83]
 ds_read_b128 a[108:111], v19 offset:56320
 mf v[84:87], a[52:55], a[40:43], v[84:87]
 buffer_load_dwordx4 v8, s[32:35], s60 offen nt lds
 mf v[144:147], a[56:59], a[40:43], v[144:147]
 s_add_u32 m0, s70, 0x18000
 mf v[148:151], a[60:63], a[40:43], v[148:151]
 s_add_u32 s60, s72, 0x180
 mf v[208:211], a[64:67], a[40:43], v[208:211]
 buffer_load_dwordx4 v10, s[36:39], s60 offen lds
 mf v[212:215], a[68:71], a[40:43], v[212:215]
 mf a[16:19], a[72:75], a[40:43], a[16:19]
 mf a[20:23], a[76:79], a[40:43], a[20:23]
 s_add_u32 m0, s70, 0x9000
 ds_read_b64_tr_b16 a[40:41], v13 offset:49152
 ds_read_b64_tr_b16 a[42:43], v13 offset:51200
 mf v[88:91], a[48:51], a[44:47], v[88:91]
 s_add_u32 s60, s71, 0x190000
 mf v[92:95], a[52:55], a[44:47], v[92:95]
 buffer_load_dwordx4 v9, s[32:35], s60 offen nt lds
 mf v[152:155], a[56:59], a[44:47], v[152:155]
 mf v[156:159], a[60:63], a[44:47], v[156:159]
 mf v[216:219], a[64:67], a[44:47], v[216:219]
 s_add_u32 m0, s70, 0x19000
 mf v[220:223], a[68:71], a[44:47], v[220:223]
 s_add_u32 s60, s72, 0x10180
 mf a[24:27], a[72:75], a[44:47], a[24:27]
 buffer_load_dwordx4 v10, s[36:39], s60 offen lds
 mf a[28:31], a[76:79], a[44:47], a[28:31]
 ds_read_b64_tr_b16 a[44:45], v14 offset:49152
 s_waitcnt lgkmcnt(14)
 ds_read_b64_tr_b16 a[46:47], v14 offset:51200
 s_waitcnt lgkmcnt(13)
 mf v[32:35], a[80:83], a[32:35], v[32:35]
 s_waitcnt lgkmcnt(12)
 mf v[36:39], a[84:87], a[32:35], v[36:39]
 s_waitcnt lgkmcnt(11)
 s_add_u32 m0, s70, 0xa000
 mf v[96:99], a[88:91], a[32:35], v[96:99]
 s_waitcnt lgkmcnt(10)
 s_add_u32 s60, s71, 0x1a0000
 mf v[100:103], a[92:95], a[32:35], v[100:103]
 s_waitcnt lgkmcnt(9)
 buffer_load_dwordx4 v8, s[32:35], s60 offen nt lds
 mf v[160:163], a[96:99], a[32:35], v[160:163]
 s_waitcnt lgkmcnt(8)
 mf v[164:167], a[100:103], a[32:35], v[164:167]
 s_waitcnt lgkmcnt(7)
 mf v[224:227], a[104:107], a[32:35], v[224:227]
 s_waitcnt lgkmcnt(4)
 s_add_u32 m0, s70, 0x1a000
 mf v[228:231], a[108:111], a[32:35], v[228:231]
 s_add_u32 s60, s72, 0x20180
 ds_read_b64_tr_b16 a[32:33], v15 offset:49152
 ds_read_b64_tr_b16 a[34:35], v15 offset:51200
 mf v[40:43], a[80:83], a[36:39], v[40:43]
 buffer_load_dwordx4 v10, s[36:39], s60 offen lds
 mf v[44:47], a[84:87], a[36:39], v[44:47]
 mf v[104:107], a[88:91], a[36:39], v[104:107]
 mf v[108:111], a[92:95], a[36:39], v[108:111]
 s_add_u32 m0, s70, 0xb000
 mf v[168:171], a[96:99], a[36:39], v[168:171]
 s_add_u32 s60, s71, 0x1b0000
 mf v[172:175], a[100:103], a[36:39], v[172:175]
 buffer_load_dwordx4 v9, s[32:35], s60 offen nt lds
 mf v[232:235], a[104:107], a[36:39], v[232:235]
 mf v[236:239], a[108:111], a[36:39], v[236:239]
 s_waitcnt lgkmcnt(4)
 ds_read_b64_tr_b16 a[36:37], v16 offset:49152
 ds_read_b64_tr_b16 a[38:39], v16 offset:51200
 mf v[48:51], a[80:83], a[40:43], v[48:51]
 s_add_u32 m0, s70, 0x1b000
 mf v[52:55], a[84:87], a[40:43], v[52:55]
 s_add_u32 s60, s72, 0x30180
 mf v[112:115], a[88:91], a[40:43], v[112:115]
 buffer_load_dwordx4 v10, s[36:39], s60 offen lds
 mf v[116:119], a[92:95], a[40:43], v[116:119]
 mf v[176:179], a[96:99], a[40:43], v[176:179]
 mf v[180:183], a[100:103], a[40:43], v[180:183]
 s_mov_b32 s56, s20
 mf v[240:243], a[104:107], a[40:43], v[240:243]
 s_mov_b32 s57, s21
 mf v[244:247], a[108:111], a[40:43], v[244:247]
 s_waitcnt lgkmcnt(4)
 s_mov_b32 s58, 0x510000
 ds_read_b64_tr_b16 a[40:41], v17 offset:49152
 ds_read_b64_tr_b16 a[42:43], v17 offset:51200
 mf v[56:59], a[80:83], a[44:47], v[56:59]
 s_mov_b32 s59, 0x20000
 v_add_u32 v30, 0, v7
 mf v[60:63], a[84:87], a[44:47], v[60:63]
 buffer_load_dword a170, v30, s[56:59], 0 offen
 mf v[120:123], a[88:91], a[44:47], v[120:123]
 mf v[124:127], a[92:95], a[44:47], v[124:127]
 s_lshl_b32 s62, s2, 7
 mf v[184:187], a[96:99], a[44:47], v[184:187]
 mf v[188:191], a[100:103], a[44:47], v[188:191]
 mf v[248:251], a[104:107], a[44:47], v[248:251]
 mf v[252:255], a[108:111], a[44:47], v[252:255]
 s_waitcnt lgkmcnt(4)
 ds_read_b64_tr_b16 a[44:45], v18 offset:49152
 ds_read_b64_tr_b16 a[46:47], v18 offset:51200
 mf v[64:67], a[80:83], a[32:35], v[64:67]
 mf v[68:71], a[84:87], a[32:35], v[68:71]
 mf v[128:131], a[88:91], a[32:35], v[128:131]
 mf v[132:135], a[92:95], a[32:35], v[132:135]
 mf v[192:195], a[96:99], a[32:35], v[192:195]
 mf v[196:199], a[100:103], a[32:35], v[196:199]
 mf a[0:3], a[104:107], a[32:35], a[0:3]
 mf a[4:7], a[108:111], a[32:35], a[4:7]
 s_waitcnt vmcnt(20)
 s_waitcnt vmcnt(18)
 s_waitcnt lgkmcnt(0)
 s_barrier
 mf v[72:75], a[80:83], a[36:39], v[72:75]
 s_add_u32 m0, s70, 0xc000
 ds_read_b64_tr_b16 a[32:33], v11
 ds_read_b64_tr_b16 a[34:35], v11 offset:2048
 mf v[76:79], a[84:87], a[36:39], v[76:79]
 s_add_u32 s60, s71, 0x1c0000
 ds_read_b128 a[48:51], v19
 ds_read_b128 a[52:55], v19 offset:1024
 mf v[136:139], a[88:91], a[36:39], v[136:139]
 ds_read_b128 a[56:59], v19 offset:2048
 mf v[140:143], a[92:95], a[36:39], v[140:143]
 ds_read_b128 a[60:63], v19 offset:3072
 mf v[200:203], a[96:99], a[36:39], v[200:203]
 ds_read_b128 a[64:67], v19 offset:4096
 mf v[204:207], a[100:103], a[36:39], v[204:207]
 ds_read_b128 a[68:71], v19 offset:5120
 mf a[8:11], a[104:107], a[36:39], a[8:11]
 ds_read_b128 a[72:75], v19 offset:6144
 mf a[12:15], a[108:111], a[36:39], a[12:15]
 ds_read_b64_tr_b16 a[36:37], v12
 ds_read_b64_tr_b16 a[38:39], v12 offset:2048
 mf v[80:83], a[80:83], a[40:43], v[80:83]
 ds_read_b128 a[76:79], v19 offset:7168
 mf v[84:87], a[84:87], a[40:43], v[84:87]
 buffer_load_dwordx4 v8, s[32:35], s60 offen nt lds
 mf v[144:147], a[88:91], a[40:43], v[144:147]
 s_add_u32 m0, s70, 0x1c000
 buffer_store_dword v6, v5, s[52:55], s62 offen sc1
 mf v[148:151], a[92:95], a[40:43], v[148:151]
 s_add_u32 s60, s72, 0x1c0
 mf v[208:211], a[96:99], a[40:43], v[208:211]
 buffer_load_dwordx4 v10, s[36:39], s60 offen lds
 mf v[212:215], a[100:103], a[40:43], v[212:215]
 mf a[16:19], a[104:107], a[40:43], a[16:19]
 mf a[20:23], a[108:111], a[40:43], a[20:23]
 s_add_u32 m0, s70, 0xd000
 ds_read_b64_tr_b16 a[40:41], v13
 ds_read_b64_tr_b16 a[42:43], v13 offset:2048
 mf v[88:91], a[80:83], a[44:47], v[88:91]
 s_add_u32 s60, s71, 0x1d0000
 mf v[92:95], a[84:87], a[44:47], v[92:95]
 buffer_load_dwordx4 v9, s[32:35], s60 offen nt lds
 mf v[152:155], a[88:91], a[44:47], v[152:155]
 mf v[156:159], a[92:95], a[44:47], v[156:159]
 mf v[216:219], a[96:99], a[44:47], v[216:219]
 s_add_u32 m0, s70, 0x1d000
 mf v[220:223], a[100:103], a[44:47], v[220:223]
 s_add_u32 s60, s72, 0x101c0
 mf a[24:27], a[104:107], a[44:47], a[24:27]
 buffer_load_dwordx4 v10, s[36:39], s60 offen lds
 mf a[28:31], a[108:111], a[44:47], a[28:31]
 ds_read_b64_tr_b16 a[44:45], v14
 s_waitcnt lgkmcnt(14)
 ds_read_b64_tr_b16 a[46:47], v14 offset:2048
 s_waitcnt lgkmcnt(13)
 mf v[32:35], a[48:51], a[32:35], v[32:35]
 s_waitcnt lgkmcnt(12)
 mf v[36:39], a[52:55], a[32:35], v[36:39]
 s_waitcnt lgkmcnt(11)
 s_add_u32 m0, s70, 0xe000
 mf v[96:99], a[56:59], a[32:35], v[96:99]
 s_waitcnt lgkmcnt(10)
 s_add_u32 s60, s71, 0x1e0000
 mf v[100:103], a[60:63], a[32:35], v[100:103]
 s_waitcnt lgkmcnt(9)
 buffer_load_dwordx4 v8, s[32:35], s60 offen nt lds
 mf v[160:163], a[64:67], a[32:35], v[160:163]
 s_waitcnt lgkmcnt(8)
 mf v[164:167], a[68:71], a[32:35], v[164:167]
 s_waitcnt lgkmcnt(7)
 mf v[224:227], a[72:75], a[32:35], v[224:227]
 s_waitcnt lgkmcnt(4)
 s_add_u32 m0, s70, 0x1e000
 mf v[228:231], a[76:79], a[32:35], v[228:231]
 s_add_u32 s60, s72, 0x201c0
 ds_read_b64_tr_b16 a[32:33], v15
 ds_read_b64_tr_b16 a[34:35], v15 offset:2048
 mf v[40:43], a[48:51], a[36:39], v[40:43]
 buffer_load_dwordx4 v10, s[36:39], s60 offen lds
 mf v[44:47], a[52:55], a[36:39], v[44:47]
 mf v[104:107], a[56:59], a[36:39], v[104:107]
 mf v[108:111], a[60:63], a[36:39], v[108:111]
 s_add_u32 m0, s70, 0xf000
 mf v[168:171], a[64:67], a[36:39], v[168:171]
 s_add_u32 s60, s71, 0x1f0000
 mf v[172:175], a[68:71], a[36:39], v[172:175]
 buffer_load_dwordx4 v9, s[32:35], s60 offen nt lds
 mf v[232:235], a[72:75], a[36:39], v[232:235]
 mf v[236:239], a[76:79], a[36:39], v[236:239]
 s_waitcnt lgkmcnt(4)
 ds_read_b64_tr_b16 a[36:37], v16
 ds_read_b64_tr_b16 a[38:39], v16 offset:2048
 mf v[48:51], a[48:51], a[40:43], v[48:51]
 s_add_u32 m0, s70, 0x1f000
 mf v[52:55], a[52:55], a[40:43], v[52:55]
 s_add_u32 s60, s72, 0x301c0
 mf v[112:115], a[56:59], a[40:43], v[112:115]
 buffer_load_dwordx4 v10, s[36:39], s60 offen lds
 mf v[116:119], a[60:63], a[40:43], v[116:119]
 mf v[176:179], a[64:67], a[40:43], v[176:179]
 mf v[180:183], a[68:71], a[40:43], v[180:183]
 s_mov_b32 s56, s18
 mf v[240:243], a[72:75], a[40:43], v[240:243]
 s_mov_b32 s57, s19
 mf v[244:247], a[76:79], a[40:43], v[244:247]
 s_waitcnt lgkmcnt(4)
 s_mov_b32 s58, 0x510000
 ds_read_b64_tr_b16 a[40:41], v17
 ds_read_b64_tr_b16 a[42:43], v17 offset:2048
 mf v[56:59], a[48:51], a[44:47], v[56:59]
 s_mov_b32 s59, 0x20000
 v_add_u32 v30, 0x100000, v7
 mf v[60:63], a[52:55], a[44:47], v[60:63]
 buffer_load_dword a170, v30, s[56:59], 0 offen
 mf v[120:123], a[56:59], a[44:47], v[120:123]
 mf v[124:127], a[60:63], a[44:47], v[124:127]
 mf v[184:187], a[64:67], a[44:47], v[184:187]
 mf v[188:191], a[68:71], a[44:47], v[188:191]
 mf v[248:251], a[72:75], a[44:47], v[248:251]
 mf v[252:255], a[76:79], a[44:47], v[252:255]
 s_waitcnt lgkmcnt(4)
 ds_read_b64_tr_b16 a[44:45], v18
 ds_read_b64_tr_b16 a[46:47], v18 offset:2048
 mf v[64:67], a[48:51], a[32:35], v[64:67]
 mf v[68:71], a[52:55], a[32:35], v[68:71]
 mf v[128:131], a[56:59], a[32:35], v[128:131]
 mf v[132:135], a[60:63], a[32:35], v[132:135]
 mf v[192:195], a[64:67], a[32:35], v[192:195]
 mf v[196:199], a[68:71], a[32:35], v[196:199]
 mf a[0:3], a[72:75], a[32:35], a[0:3]
 mf a[4:7], a[76:79], a[32:35], a[4:7]
 s_waitcnt vmcnt(20)
 s_waitcnt lgkmcnt(0)
 s_barrier
 mf v[72:75], a[48:51], a[36:39], v[72:75]
 s_add_u32 m0, s70, 0
 ds_read_b64_tr_b16 a[32:33], v11 offset:16384
 ds_read_b64_tr_b16 a[34:35], v11 offset:18432
 mf v[76:79], a[52:55], a[36:39], v[76:79]
 s_add_u32 s60, s71, 0x200000
 ds_read_b128 a[80:83], v19 offset:16384
 ds_read_b128 a[84:87], v19 offset:17408
 mf v[136:139], a[56:59], a[36:39], v[136:139]
 ds_read_b128 a[88:91], v19 offset:18432
 mf v[140:143], a[60:63], a[36:39], v[140:143]
 ds_read_b128 a[92:95], v19 offset:19456
 mf v[200:203], a[64:67], a[36:39], v[200:203]
 ds_read_b128 a[96:99], v19 offset:20480
 mf v[204:207], a[68:71], a[36:39], v[204:207]
 ds_read_b128 a[100:103], v19 offset:21504
 mf a[8:11], a[72:75], a[36:39], a[8:11]
 ds_read_b128 a[104:107], v19 offset:22528
 mf a[12:15], a[76:79], a[36:39], a[12:15]
 ds_read_b64_tr_b16 a[36:37], v12 offset:16384
 ds_read_b64_tr_b16 a[38:39], v12 offset:18432
 mf v[80:83], a[48:51], a[40:43], v[80:83]
 ds_read_b128 a[108:111], v19 offset:23552
 mf v[84:87], a[52:55], a[40:43], v[84:87]
 buffer_load_dwordx4 v8, s[32:35], s60 offen nt lds
 mf v[144:147], a[56:59], a[40:43], v[144:147]
 s_add_u32 m0, s70, 0x10000
 mf v[148:151], a[60:63], a[40:43], v[148:151]
 s_add_u32 s60, s72, 0x200
 mf v[208:211], a[64:67], a[40:43], v[208:211]
 buffer_load_dwordx4 v10, s[36:39], s60 offen lds
 mf v[212:215], a[68:71], a[40:43], v[212:215]
 mf a[16:19], a[72:75], a[40:43], a[16:19]
 mf a[20:23], a[76:79], a[40:43], a[20:23]
 s_add_u32 m0, s70, 0x1000
 ds_read_b64_tr_b16 a[40:41], v13 offset:16384
 ds_read_b64_tr_b16 a[42:43], v13 offset:18432
 mf v[88:91], a[48:51], a[44:47], v[88:91]
 s_add_u32 s60, s71, 0x210000
 mf v[92:95], a[52:55], a[44:47], v[92:95]
 buffer_load_dwordx4 v9, s[32:35], s60 offen nt lds
 mf v[152:155], a[56:59], a[44:47], v[152:155]
 mf v[156:159], a[60:63], a[44:47], v[156:159]
 mf v[216:219], a[64:67], a[44:47], v[216:219]
 s_add_u32 m0, s70, 0x11000
 mf v[220:223], a[68:71], a[44:47], v[220:223]
 s_add_u32 s60, s72, 0x10200
 mf a[24:27], a[72:75], a[44:47], a[24:27]
 buffer_load_dwordx4 v10, s[36:39], s60 offen lds
 mf a[28:31], a[76:79], a[44:47], a[28:31]
 ds_read_b64_tr_b16 a[44:45], v14 offset:16384
 s_waitcnt lgkmcnt(14)
 ds_read_b64_tr_b16 a[46:47], v14 offset:18432
 s_waitcnt lgkmcnt(13)
 mf v[32:35], a[80:83], a[32:35], v[32:35]
 s_waitcnt lgkmcnt(12)
 mf v[36:39], a[84:87], a[32:35], v[36:39]
 s_waitcnt lgkmcnt(11)
 s_add_u32 m0, s70, 0x2000
 mf v[96:99], a[88:91], a[32:35], v[96:99]
 s_waitcnt lgkmcnt(10)
 s_add_u32 s60, s71, 0x220000
 mf v[100:103], a[92:95], a[32:35], v[100:103]
 s_waitcnt lgkmcnt(9)
 buffer_load_dwordx4 v8, s[32:35], s60 offen nt lds
 mf v[160:163], a[96:99], a[32:35], v[160:163]
 s_waitcnt lgkmcnt(8)
 mf v[164:167], a[100:103], a[32:35], v[164:167]
 s_waitcnt lgkmcnt(7)
 mf v[224:227], a[104:107], a[32:35], v[224:227]
 s_waitcnt lgkmcnt(4)
 s_add_u32 m0, s70, 0x12000
 mf v[228:231], a[108:111], a[32:35], v[228:231]
 s_add_u32 s60, s72, 0x20200
 ds_read_b64_tr_b16 a[32:33], v15 offset:16384
 ds_read_b64_tr_b16 a[34:35], v15 offset:18432
 mf v[40:43], a[80:83], a[36:39], v[40:43]
 buffer_load_dwordx4 v10, s[36:39], s60 offen lds
 mf v[44:47], a[84:87], a[36:39], v[44:47]
 mf v[104:107], a[88:91], a[36:39], v[104:107]
 mf v[108:111], a[92:95], a[36:39], v[108:111]
 s_add_u32 m0, s70, 0x3000
 mf v[168:171], a[96:99], a[36:39], v[168:171]
 s_add_u32 s60, s71, 0x230000
 mf v[172:175], a[100:103], a[36:39], v[172:175]
 buffer_load_dwordx4 v9, s[32:35], s60 offen nt lds
 mf v[232:235], a[104:107], a[36:39], v[232:235]
 mf v[236:239], a[108:111], a[36:39], v[236:239]
 s_waitcnt lgkmcnt(4)
 ds_read_b64_tr_b16 a[36:37], v16 offset:16384
 ds_read_b64_tr_b16 a[38:39], v16 offset:18432
 mf v[48:51], a[80:83], a[40:43], v[48:51]
 s_add_u32 m0, s70, 0x13000
 mf v[52:55], a[84:87], a[40:43], v[52:55]
 s_add_u32 s60, s72, 0x30200
 mf v[112:115], a[88:91], a[40:43], v[112:115]
 buffer_load_dwordx4 v10, s[36:39], s60 offen lds
 mf v[116:119], a[92:95], a[40:43], v[116:119]
 mf v[176:179], a[96:99], a[40:43], v[176:179]
 mf v[180:183], a[100:103], a[40:43], v[180:183]
 s_mov_b32 s56, s20
 mf v[240:243], a[104:107], a[40:43], v[240:243]
 s_mov_b32 s57, s21
 mf v[244:247], a[108:111], a[40:43], v[244:247]
 s_waitcnt lgkmcnt(4)
 s_mov_b32 s58, 0x510000
 ds_read_b64_tr_b16 a[40:41], v17 offset:16384
 ds_read_b64_tr_b16 a[42:43], v17 offset:18432
 mf v[56:59], a[80:83], a[44:47], v[56:59]
 s_mov_b32 s59, 0x20000
 v_add_u32 v30, 0x100000, v7
 mf v[60:63], a[84:87], a[44:47], v[60:63]
 buffer_load_dword a170, v30, s[56:59], 0 offen
 mf v[120:123], a[88:91], a[44:47], v[120:123]
 mf v[124:127], a[92:95], a[44:47], v[124:127]
 mf v[184:187], a[96:99], a[44:47], v[184:187]
 mf v[188:191], a[100:103], a[44:47], v[188:191]
 mf v[248:251], a[104:107], a[44:47], v[248:251]
 mf v[252:255], a[108:111], a[44:47], v[252:255]
 s_waitcnt lgkmcnt(4)
 ds_read_b64_tr_b16 a[44:45], v18 offset:16384
 ds_read_b64_tr_b16 a[46:47], v18 offset:18432
 mf v[64:67], a[80:83], a[32:35], v[64:67]
 mf v[68:71], a[84:87], a[32:35], v[68:71]
 mf v[128:131], a[88:91], a[32:35], v[128:131]
 mf v[132:135], a[92:95], a[32:35], v[132:135]
 mf v[192:195], a[96:99], a[32:35], v[192:195]
 mf v[196:199], a[100:103], a[32:35], v[196:199]
 mf a[0:3], a[104:107], a[32:35], a[0:3]
 mf a[4:7], a[108:111], a[32:35], a[4:7]
 s_waitcnt vmcnt(20)
 s_waitcnt lgkmcnt(0)
 s_barrier
 mf v[72:75], a[80:83], a[36:39], v[72:75]
 s_add_u32 m0, s70, 0x4000
 ds_read_b64_tr_b16 a[32:33], v11 offset:32768
 ds_read_b64_tr_b16 a[34:35], v11 offset:34816
 mf v[76:79], a[84:87], a[36:39], v[76:79]
 s_add_u32 s60, s71, 0x240000
 ds_read_b128 a[48:51], v19 offset:32768
 ds_read_b128 a[52:55], v19 offset:33792
 mf v[136:139], a[88:91], a[36:39], v[136:139]
 ds_read_b128 a[56:59], v19 offset:34816
 mf v[140:143], a[92:95], a[36:39], v[140:143]
 ds_read_b128 a[60:63], v19 offset:35840
 mf v[200:203], a[96:99], a[36:39], v[200:203]
 ds_read_b128 a[64:67], v19 offset:36864
 mf v[204:207], a[100:103], a[36:39], v[204:207]
 ds_read_b128 a[68:71], v19 offset:37888
 mf a[8:11], a[104:107], a[36:39], a[8:11]
 ds_read_b128 a[72:75], v19 offset:38912
 mf a[12:15], a[108:111], a[36:39], a[12:15]
 ds_read_b64_tr_b16 a[36:37], v12 offset:32768
 ds_read_b64_tr_b16 a[38:39], v12 offset:34816
 mf v[80:83], a[80:83], a[40:43], v[80:83]
 ds_read_b128 a[76:79], v19 offset:39936
 mf v[84:87], a[84:87], a[40:43], v[84:87]
 buffer_load_dwordx4 v8, s[32:35], s60 offen nt lds
 mf v[144:147], a[88:91], a[40:43], v[144:147]
 s_add_u32 m0, s70, 0x14000
 mf v[148:151], a[92:95], a[40:43], v[148:151]
 s_add_u32 s60, s72, 0x240
 mf v[208:211], a[96:99], a[40:43], v[208:211]
 buffer_load_dwordx4 v10, s[36:39], s60 offen lds
 mf v[212:215], a[100:103], a[40:43], v[212:215]
 mf a[16:19], a[104:107], a[40:43], a[16:19]
 mf a[20:23], a[108:111], a[40:43], a[20:23]
 s_add_u32 m0, s70, 0x5000
 ds_read_b64_tr_b16 a[40:41], v13 offset:32768
 ds_read_b64_tr_b16 a[42:43], v13 offset:34816
 mf v[88:91], a[80:83], a[44:47], v[88:91]
 s_add_u32 s60, s71, 0x250000
 mf v[92:95], a[84:87], a[44:47], v[92:95]
 buffer_load_dwordx4 v9, s[32:35], s60 offen nt lds
 mf v[152:155], a[88:91], a[44:47], v[152:155]
 mf v[156:159], a[92:95], a[44:47], v[156:159]
 mf v[216:219], a[96:99], a[44:47], v[216:219]
 s_add_u32 m0, s70, 0x15000
 mf v[220:223], a[100:103], a[44:47], v[220:223]
 s_add_u32 s60, s72, 0x10240
 mf a[24:27], a[104:107], a[44:47], a[24:27]
 buffer_load_dwordx4 v10, s[36:39], s60 offen lds
 mf a[28:31], a[108:111], a[44:47], a[28:31]
 ds_read_b64_tr_b16 a[44:45], v14 offset:32768
 s_waitcnt lgkmcnt(14)
 ds_read_b64_tr_b16 a[46:47], v14 offset:34816
 s_waitcnt lgkmcnt(13)
 mf v[32:35], a[48:51], a[32:35], v[32:35]
 s_waitcnt lgkmcnt(12)
 mf v[36:39], a[52:55], a[32:35], v[36:39]
 s_waitcnt lgkmcnt(11)
 s_add_u32 m0, s70, 0x6000
 mf v[96:99], a[56:59], a[32:35], v[96:99]
 s_waitcnt lgkmcnt(10)
 s_add_u32 s60, s71, 0x260000
 mf v[100:103], a[60:63], a[32:35], v[100:103]
 s_waitcnt lgkmcnt(9)
 buffer_load_dwordx4 v8, s[32:35], s60 offen nt lds
 mf v[160:163], a[64:67], a[32:35], v[160:163]
 s_waitcnt lgkmcnt(8)
 mf v[164:167], a[68:71], a[32:35], v[164:167]
 s_waitcnt lgkmcnt(7)
 mf v[224:227], a[72:75], a[32:35], v[224:227]
 s_waitcnt lgkmcnt(4)
 s_add_u32 m0, s70, 0x16000
 mf v[228:231], a[76:79], a[32:35], v[228:231]
 s_add_u32 s60, s72, 0x20240
 ds_read_b64_tr_b16 a[32:33], v15 offset:32768
 ds_read_b64_tr_b16 a[34:35], v15 offset:34816
 mf v[40:43], a[48:51], a[36:39], v[40:43]
 buffer_load_dwordx4 v10, s[36:39], s60 offen lds
 mf v[44:47], a[52:55], a[36:39], v[44:47]
 mf v[104:107], a[56:59], a[36:39], v[104:107]
 mf v[108:111], a[60:63], a[36:39], v[108:111]
 s_add_u32 m0, s70, 0x7000
 mf v[168:171], a[64:67], a[36:39], v[168:171]
 s_add_u32 s60, s71, 0x270000
 mf v[172:175], a[68:71], a[36:39], v[172:175]
 buffer_load_dwordx4 v9, s[32:35], s60 offen nt lds
 mf v[232:235], a[72:75], a[36:39], v[232:235]
 mf v[236:239], a[76:79], a[36:39], v[236:239]
 s_waitcnt lgkmcnt(4)
 ds_read_b64_tr_b16 a[36:37], v16 offset:32768
 ds_read_b64_tr_b16 a[38:39], v16 offset:34816
 mf v[48:51], a[48:51], a[40:43], v[48:51]
 s_add_u32 m0, s70, 0x17000
 mf v[52:55], a[52:55], a[40:43], v[52:55]
 s_add_u32 s60, s72, 0x30240
 mf v[112:115], a[56:59], a[40:43], v[112:115]
 buffer_load_dwordx4 v10, s[36:39], s60 offen lds
 mf v[116:119], a[60:63], a[40:43], v[116:119]
 mf v[176:179], a[64:67], a[40:43], v[176:179]
 mf v[180:183], a[68:71], a[40:43], v[180:183]
 s_mov_b32 s56, s18
 mf v[240:243], a[72:75], a[40:43], v[240:243]
 s_mov_b32 s57, s19
 mf v[244:247], a[76:79], a[40:43], v[244:247]
 s_waitcnt lgkmcnt(4)
 s_mov_b32 s58, 0x510000
 ds_read_b64_tr_b16 a[40:41], v17 offset:32768
 ds_read_b64_tr_b16 a[42:43], v17 offset:34816
 mf v[56:59], a[48:51], a[44:47], v[56:59]
 s_mov_b32 s59, 0x20000
 v_add_u32 v30, 0x200000, v7
 mf v[60:63], a[52:55], a[44:47], v[60:63]
 buffer_load_dword a170, v30, s[56:59], 0 offen
 mf v[120:123], a[56:59], a[44:47], v[120:123]
 mf v[124:127], a[60:63], a[44:47], v[124:127]
 mf v[184:187], a[64:67], a[44:47], v[184:187]
 mf v[188:191], a[68:71], a[44:47], v[188:191]
 mf v[248:251], a[72:75], a[44:47], v[248:251]
 mf v[252:255], a[76:79], a[44:47], v[252:255]
 s_waitcnt lgkmcnt(4)
 ds_read_b64_tr_b16 a[44:45], v18 offset:32768
 ds_read_b64_tr_b16 a[46:47], v18 offset:34816
 mf v[64:67], a[48:51], a[32:35], v[64:67]
 mf v[68:71], a[52:55], a[32:35], v[68:71]
 mf v[128:131], a[56:59], a[32:35], v[128:131]
 mf v[132:135], a[60:63], a[32:35], v[132:135]
 mf v[192:195], a[64:67], a[32:35], v[192:195]
 mf v[196:199], a[68:71], a[32:35], v[196:199]
 mf a[0:3], a[72:75], a[32:35], a[0:3]
 mf a[4:7], a[76:79], a[32:35], a[4:7]
 s_waitcnt vmcnt(19)
 s_waitcnt lgkmcnt(0)
 s_barrier
 mf v[72:75], a[48:51], a[36:39], v[72:75]
 s_add_u32 m0, s70, 0x8000
 ds_read_b64_tr_b16 a[32:33], v11 offset:49152
 ds_read_b64_tr_b16 a[34:35], v11 offset:51200
 mf v[76:79], a[52:55], a[36:39], v[76:79]
 s_add_u32 s60, s71, 0x280000
 ds_read_b128 a[80:83], v19 offset:49152
 ds_read_b128 a[84:87], v19 offset:50176
 mf v[136:139], a[56:59], a[36:39], v[136:139]
 ds_read_b128 a[88:91], v19 offset:51200
 mf v[140:143], a[60:63], a[36:39], v[140:143]
 ds_read_b128 a[92:95], v19 offset:52224
 mf v[200:203], a[64:67], a[36:39], v[200:203]
 ds_read_b128 a[96:99], v19 offset:53248
 mf v[204:207], a[68:71], a[36:39], v[204:207]
 ds_read_b128 a[100:103], v19 offset:54272
 mf a[8:11], a[72:75], a[36:39], a[8:11]
 ds_read_b128 a[104:107], v19 offset:55296
 mf a[12:15], a[76:79], a[36:39], a[12:15]
 ds_read_b64_tr_b16 a[36:37], v12 offset:49152
 ds_read_b64_tr_b16 a[38:39], v12 offset:51200
 mf v[80:83], a[48:51], a[40:43], v[80:83]
 ds_read_b128 a[108:111], v19 offset:56320
 mf v[84:87], a[52:55], a[40:43], v[84:87]
 buffer_load_dwordx4 v8, s[32:35], s60 offen nt lds
 mf v[144:147], a[56:59], a[40:43], v[144:147]
 s_add_u32 m0, s70, 0x18000
 mf v[148:151], a[60:63], a[40:43], v[148:151]
 s_add_u32 s60, s72, 0x280
 mf v[208:211], a[64:67], a[40:43], v[208:211]
 buffer_load_dwordx4 v10, s[36:39], s60 offen lds
 mf v[212:215], a[68:71], a[40:43], v[212:215]
 mf a[16:19], a[72:75], a[40:43], a[16:19]
 mf a[20:23], a[76:79], a[40:43], a[20:23]
 s_add_u32 m0, s70, 0x9000
 ds_read_b64_tr_b16 a[40:41], v13 offset:49152
 ds_read_b64_tr_b16 a[42:43], v13 offset:51200
 mf v[88:91], a[48:51], a[44:47], v[88:91]
 s_add_u32 s60, s71, 0x290000
 mf v[92:95], a[52:55], a[44:47], v[92:95]
 buffer_load_dwordx4 v9, s[32:35], s60 offen nt lds
 mf v[152:155], a[56:59], a[44:47], v[152:155]
 mf v[156:159], a[60:63], a[44:47], v[156:159]
 mf v[216:219], a[64:67], a[44:47], v[216:219]
 s_add_u32 m0, s70, 0x19000
 mf v[220:223], a[68:71], a[44:47], v[220:223]
 s_add_u32 s60, s72, 0x10280
 mf a[24:27], a[72:75], a[44:47], a[24:27]
 buffer_load_dwordx4 v10, s[36:39], s60 offen lds
 mf a[28:31], a[76:79], a[44:47], a[28:31]
 ds_read_b64_tr_b16 a[44:45], v14 offset:49152
 s_waitcnt lgkmcnt(14)
 ds_read_b64_tr_b16 a[46:47], v14 offset:51200
 s_waitcnt lgkmcnt(13)
 mf v[32:35], a[80:83], a[32:35], v[32:35]
 s_waitcnt lgkmcnt(12)
 mf v[36:39], a[84:87], a[32:35], v[36:39]
 s_waitcnt lgkmcnt(11)
 s_add_u32 m0, s70, 0xa000
 mf v[96:99], a[88:91], a[32:35], v[96:99]
 s_waitcnt lgkmcnt(10)
 s_add_u32 s60, s71, 0x2a0000
 mf v[100:103], a[92:95], a[32:35], v[100:103]
 s_waitcnt lgkmcnt(9)
 buffer_load_dwordx4 v8, s[32:35], s60 offen nt lds
 mf v[160:163], a[96:99], a[32:35], v[160:163]
 s_waitcnt lgkmcnt(8)
 mf v[164:167], a[100:103], a[32:35], v[164:167]
 s_waitcnt lgkmcnt(7)
 mf v[224:227], a[104:107], a[32:35], v[224:227]
 s_waitcnt lgkmcnt(4)
 s_add_u32 m0, s70, 0x1a000
 mf v[228:231], a[108:111], a[32:35], v[228:231]
 s_add_u32 s60, s72, 0x20280
 ds_read_b64_tr_b16 a[32:33], v15 offset:49152
 ds_read_b64_tr_b16 a[34:35], v15 offset:51200
 mf v[40:43], a[80:83], a[36:39], v[40:43]
 buffer_load_dwordx4 v10, s[36:39], s60 offen lds
 mf v[44:47], a[84:87], a[36:39], v[44:47]
 mf v[104:107], a[88:91], a[36:39], v[104:107]
 mf v[108:111], a[92:95], a[36:39], v[108:111]
 s_add_u32 m0, s70, 0xb000
 mf v[168:171], a[96:99], a[36:39], v[168:171]
 s_add_u32 s60, s71, 0x2b0000
 mf v[172:175], a[100:103], a[36:39], v[172:175]
 buffer_load_dwordx4 v9, s[32:35], s60 offen nt lds
 mf v[232:235], a[104:107], a[36:39], v[232:235]
 mf v[236:239], a[108:111], a[36:39], v[236:239]
 s_waitcnt lgkmcnt(4)
 ds_read_b64_tr_b16 a[36:37], v16 offset:49152
 ds_read_b64_tr_b16 a[38:39], v16 offset:51200
 mf v[48:51], a[80:83], a[40:43], v[48:51]
 s_add_u32 m0, s70, 0x1b000
 mf v[52:55], a[84:87], a[40:43], v[52:55]
 s_add_u32 s60, s72, 0x30280
 mf v[112:115], a[88:91], a[40:43], v[112:115]
 buffer_load_dwordx4 v10, s[36:39], s60 offen lds
 mf v[116:119], a[92:95], a[40:43], v[116:119]
 mf v[176:179], a[96:99], a[40:43], v[176:179]
 mf v[180:183], a[100:103], a[40:43], v[180:183]
 s_mov_b32 s56, s20
 mf v[240:243], a[104:107], a[40:43], v[240:243]
 s_mov_b32 s57, s21
 mf v[244:247], a[108:111], a[40:43], v[244:247]
 s_waitcnt lgkmcnt(4)
 s_mov_b32 s58, 0x510000
 ds_read_b64_tr_b16 a[40:41], v17 offset:49152
 ds_read_b64_tr_b16 a[42:43], v17 offset:51200
 mf v[56:59], a[80:83], a[44:47], v[56:59]
 s_mov_b32 s59, 0x20000
 v_add_u32 v30, 0x200000, v7
 mf v[60:63], a[84:87], a[44:47], v[60:63]
 buffer_load_dword a170, v30, s[56:59], 0 offen
 mf v[120:123], a[88:91], a[44:47], v[120:123]
 mf v[124:127], a[92:95], a[44:47], v[124:127]
 mf v[184:187], a[96:99], a[44:47], v[184:187]
 mf v[188:191], a[100:103], a[44:47], v[188:191]
 mf v[248:251], a[104:107], a[44:47], v[248:251]
 mf v[252:255], a[108:111], a[44:47], v[252:255]
 s_waitcnt lgkmcnt(4)
 ds_read_b64_tr_b16 a[44:45], v18 offset:49152
 ds_read_b64_tr_b16 a[46:47], v18 offset:51200
 mf v[64:67], a[80:83], a[32:35], v[64:67]
 mf v[68:71], a[84:87], a[32:35], v[68:71]
 mf v[128:131], a[88:91], a[32:35], v[128:131]
 mf v[132:135], a[92:95], a[32:35], v[132:135]
 mf v[192:195], a[96:99], a[32:35], v[192:195]
 mf v[196:199], a[100:103], a[32:35], v[196:199]
 mf a[0:3], a[104:107], a[32:35], a[0:3]
 mf a[4:7], a[108:111], a[32:35], a[4:7]
 s_waitcnt vmcnt(19)
 s_waitcnt lgkmcnt(0)
 s_barrier
 mf v[72:75], a[80:83], a[36:39], v[72:75]
 s_add_u32 m0, s70, 0xc000
 ds_read_b64_tr_b16 a[32:33], v11
 ds_read_b64_tr_b16 a[34:35], v11 offset:2048
 mf v[76:79], a[84:87], a[36:39], v[76:79]
 s_add_u32 s60, s71, 0x2c0000
 ds_read_b128 a[48:51], v19
 ds_read_b128 a[52:55], v19 offset:1024
 mf v[136:139], a[88:91], a[36:39], v[136:139]
 ds_read_b128 a[56:59], v19 offset:2048
 mf v[140:143], a[92:95], a[36:39], v[140:143]
 ds_read_b128 a[60:63], v19 offset:3072
 mf v[200:203], a[96:99], a[36:39], v[200:203]
 ds_read_b128 a[64:67], v19 offset:4096
 mf v[204:207], a[100:103], a[36:39], v[204:207]
 ds_read_b128 a[68:71], v19 offset:5120
 mf a[8:11], a[104:107], a[36:39], a[8:11]
 ds_read_b128 a[72:75], v19 offset:6144
 mf a[12:15], a[108:111], a[36:39], a[12:15]
 ds_read_b64_tr_b16 a[36:37], v12
 ds_read_b64_tr_b16 a[38:39], v12 offset:2048
 mf v[80:83], a[80:83], a[40:43], v[80:83]
 ds_read_b128 a[76:79], v19 offset:7168
 v_and_b32 v30, 1, v1
 mf v[84:87], a[84:87], a[40:43], v[84:87]
 buffer_load_dwordx4 v8, s[32:35], s60 offen nt lds
 mf v[144:147], a[88:91], a[40:43], v[144:147]
 s_add_u32 m0, s70, 0x1c000
 v_lshlrev_b32 v30, 7, v30
 v_add_u32 v30, s100, v30
 mf v[148:151], a[92:95], a[40:43], v[148:151]
 s_add_u32 s60, s72, 0x2c0
 v_add_u32 v30, f_q-parallel_sum__compressed_kv_cla__geglu_ffn__prompt_kernel, v30
 v_min_u32 v30, f_done-parallel_sum__compressed_kv_cla__geglu_ffn__prompt_kernel, v30
 mf v[208:211], a[96:99], a[40:43], v[208:211]
 buffer_load_dwordx4 v10, s[36:39], s60 offen lds
 mf v[212:215], a[100:103], a[40:43], v[212:215]
 v_add_co_u32 v30, vcc, s98, v30
 v_mov_b32 v31, s99
 mf a[16:19], a[104:107], a[40:43], a[16:19]
 v_addc_co_u32 v31, vcc, 0, v31, vcc
 mf a[20:23], a[108:111], a[40:43], a[20:23]
 s_add_u32 m0, s70, 0xd000
 ds_read_b64_tr_b16 a[40:41], v13
 ds_read_b64_tr_b16 a[42:43], v13 offset:2048
 mf v[88:91], a[80:83], a[44:47], v[88:91]
 s_add_u32 s60, s71, 0x2d0000
 global_load_dword a170, v[30:31], off
 mf v[92:95], a[84:87], a[44:47], v[92:95]
 buffer_load_dwordx4 v9, s[32:35], s60 offen nt lds
 mf v[152:155], a[88:91], a[44:47], v[152:155]
 mf v[156:159], a[92:95], a[44:47], v[156:159]
 mf v[216:219], a[96:99], a[44:47], v[216:219]
 s_add_u32 m0, s70, 0x1d000
 mf v[220:223], a[100:103], a[44:47], v[220:223]
 s_add_u32 s60, s72, 0x102c0
 mf a[24:27], a[104:107], a[44:47], a[24:27]
 buffer_load_dwordx4 v10, s[36:39], s60 offen lds
 mf a[28:31], a[108:111], a[44:47], a[28:31]
 ds_read_b64_tr_b16 a[44:45], v14
 s_waitcnt lgkmcnt(14)
 ds_read_b64_tr_b16 a[46:47], v14 offset:2048
 s_waitcnt lgkmcnt(13)
 mf v[32:35], a[48:51], a[32:35], v[32:35]
 s_waitcnt lgkmcnt(12)
 mf v[36:39], a[52:55], a[32:35], v[36:39]
 s_waitcnt lgkmcnt(11)
 s_add_u32 m0, s70, 0xe000
 mf v[96:99], a[56:59], a[32:35], v[96:99]
 s_waitcnt lgkmcnt(10)
 s_add_u32 s60, s71, 0x2e0000
 mf v[100:103], a[60:63], a[32:35], v[100:103]
 s_waitcnt lgkmcnt(9)
 buffer_load_dwordx4 v8, s[32:35], s60 offen nt lds
 mf v[160:163], a[64:67], a[32:35], v[160:163]
 s_waitcnt lgkmcnt(8)
 mf v[164:167], a[68:71], a[32:35], v[164:167]
 s_waitcnt lgkmcnt(7)
 mf v[224:227], a[72:75], a[32:35], v[224:227]
 s_waitcnt lgkmcnt(4)
 s_add_u32 m0, s70, 0x1e000
 mf v[228:231], a[76:79], a[32:35], v[228:231]
 s_add_u32 s60, s72, 0x202c0
 ds_read_b64_tr_b16 a[32:33], v15
 ds_read_b64_tr_b16 a[34:35], v15 offset:2048
 mf v[40:43], a[48:51], a[36:39], v[40:43]
 buffer_load_dwordx4 v10, s[36:39], s60 offen lds
 mf v[44:47], a[52:55], a[36:39], v[44:47]
 mf v[104:107], a[56:59], a[36:39], v[104:107]
 mf v[108:111], a[60:63], a[36:39], v[108:111]
 s_add_u32 m0, s70, 0xf000
 mf v[168:171], a[64:67], a[36:39], v[168:171]
 s_add_u32 s60, s71, 0x2f0000
 mf v[172:175], a[68:71], a[36:39], v[172:175]
 buffer_load_dwordx4 v9, s[32:35], s60 offen nt lds
 mf v[232:235], a[72:75], a[36:39], v[232:235]
 mf v[236:239], a[76:79], a[36:39], v[236:239]
 s_waitcnt lgkmcnt(4)
 ds_read_b64_tr_b16 a[36:37], v16
 ds_read_b64_tr_b16 a[38:39], v16 offset:2048
 mf v[48:51], a[48:51], a[40:43], v[48:51]
 s_add_u32 m0, s70, 0x1f000
 mf v[52:55], a[52:55], a[40:43], v[52:55]
 s_add_u32 s60, s72, 0x302c0
 mf v[112:115], a[56:59], a[40:43], v[112:115]
 buffer_load_dwordx4 v10, s[36:39], s60 offen lds
 mf v[116:119], a[60:63], a[40:43], v[116:119]
 mf v[176:179], a[64:67], a[40:43], v[176:179]
 mf v[180:183], a[68:71], a[40:43], v[180:183]
 s_mov_b32 s56, s18
 mf v[240:243], a[72:75], a[40:43], v[240:243]
 s_mov_b32 s57, s19
 mf v[244:247], a[76:79], a[40:43], v[244:247]
 s_waitcnt lgkmcnt(4)
 s_mov_b32 s58, 0x510000
 ds_read_b64_tr_b16 a[40:41], v17
 ds_read_b64_tr_b16 a[42:43], v17 offset:2048
 mf v[56:59], a[48:51], a[44:47], v[56:59]
 s_mov_b32 s59, 0x20000
 v_add_u32 v30, 0x300000, v7
 mf v[60:63], a[52:55], a[44:47], v[60:63]
 buffer_load_dword a170, v30, s[56:59], 0 offen
 mf v[120:123], a[56:59], a[44:47], v[120:123]
 mf v[124:127], a[60:63], a[44:47], v[124:127]
 mf v[184:187], a[64:67], a[44:47], v[184:187]
 mf v[188:191], a[68:71], a[44:47], v[188:191]
 mf v[248:251], a[72:75], a[44:47], v[248:251]
 mf v[252:255], a[76:79], a[44:47], v[252:255]
 s_waitcnt lgkmcnt(4)
 ds_read_b64_tr_b16 a[44:45], v18
 ds_read_b64_tr_b16 a[46:47], v18 offset:2048
 mf v[64:67], a[48:51], a[32:35], v[64:67]
 mf v[68:71], a[52:55], a[32:35], v[68:71]
 mf v[128:131], a[56:59], a[32:35], v[128:131]
 mf v[132:135], a[60:63], a[32:35], v[132:135]
 mf v[192:195], a[64:67], a[32:35], v[192:195]
 mf v[196:199], a[68:71], a[32:35], v[196:199]
 mf a[0:3], a[72:75], a[32:35], a[0:3]
 mf a[4:7], a[76:79], a[32:35], a[4:7]
 s_waitcnt vmcnt(20)
 s_waitcnt lgkmcnt(0)
 s_barrier
 mf v[72:75], a[48:51], a[36:39], v[72:75]
 s_add_u32 m0, s70, 0
 ds_read_b64_tr_b16 a[32:33], v11 offset:16384
 ds_read_b64_tr_b16 a[34:35], v11 offset:18432
 mf v[76:79], a[52:55], a[36:39], v[76:79]
 s_add_u32 s60, s71, 0x300000
 ds_read_b128 a[80:83], v19 offset:16384
 ds_read_b128 a[84:87], v19 offset:17408
 mf v[136:139], a[56:59], a[36:39], v[136:139]
 ds_read_b128 a[88:91], v19 offset:18432
 mf v[140:143], a[60:63], a[36:39], v[140:143]
 ds_read_b128 a[92:95], v19 offset:19456
 mf v[200:203], a[64:67], a[36:39], v[200:203]
 ds_read_b128 a[96:99], v19 offset:20480
 mf v[204:207], a[68:71], a[36:39], v[204:207]
 ds_read_b128 a[100:103], v19 offset:21504
 mf a[8:11], a[72:75], a[36:39], a[8:11]
 ds_read_b128 a[104:107], v19 offset:22528
 mf a[12:15], a[76:79], a[36:39], a[12:15]
 ds_read_b64_tr_b16 a[36:37], v12 offset:16384
 ds_read_b64_tr_b16 a[38:39], v12 offset:18432
 mf v[80:83], a[48:51], a[40:43], v[80:83]
 ds_read_b128 a[108:111], v19 offset:23552
 mf v[84:87], a[52:55], a[40:43], v[84:87]
 buffer_load_dwordx4 v8, s[32:35], s60 offen nt lds
 mf v[144:147], a[56:59], a[40:43], v[144:147]
 s_add_u32 m0, s70, 0x10000
 mf v[148:151], a[60:63], a[40:43], v[148:151]
 s_add_u32 s60, s72, 0x300
 mf v[208:211], a[64:67], a[40:43], v[208:211]
 buffer_load_dwordx4 v10, s[36:39], s60 offen lds
 mf v[212:215], a[68:71], a[40:43], v[212:215]
 mf a[16:19], a[72:75], a[40:43], a[16:19]
 mf a[20:23], a[76:79], a[40:43], a[20:23]
 s_add_u32 m0, s70, 0x1000
 ds_read_b64_tr_b16 a[40:41], v13 offset:16384
 ds_read_b64_tr_b16 a[42:43], v13 offset:18432
 mf v[88:91], a[48:51], a[44:47], v[88:91]
 s_add_u32 s60, s71, 0x310000
 mf v[92:95], a[52:55], a[44:47], v[92:95]
 buffer_load_dwordx4 v9, s[32:35], s60 offen nt lds
 mf v[152:155], a[56:59], a[44:47], v[152:155]
 mf v[156:159], a[60:63], a[44:47], v[156:159]
 mf v[216:219], a[64:67], a[44:47], v[216:219]
 s_add_u32 m0, s70, 0x11000
 mf v[220:223], a[68:71], a[44:47], v[220:223]
 s_add_u32 s60, s72, 0x10300
 mf a[24:27], a[72:75], a[44:47], a[24:27]
 buffer_load_dwordx4 v10, s[36:39], s60 offen lds
 mf a[28:31], a[76:79], a[44:47], a[28:31]
 ds_read_b64_tr_b16 a[44:45], v14 offset:16384
 s_waitcnt lgkmcnt(14)
 ds_read_b64_tr_b16 a[46:47], v14 offset:18432
 s_waitcnt lgkmcnt(13)
 mf v[32:35], a[80:83], a[32:35], v[32:35]
 s_waitcnt lgkmcnt(12)
 mf v[36:39], a[84:87], a[32:35], v[36:39]
 s_waitcnt lgkmcnt(11)
 s_add_u32 m0, s70, 0x2000
 mf v[96:99], a[88:91], a[32:35], v[96:99]
 s_waitcnt lgkmcnt(10)
 s_add_u32 s60, s71, 0x320000
 mf v[100:103], a[92:95], a[32:35], v[100:103]
 s_waitcnt lgkmcnt(9)
 buffer_load_dwordx4 v8, s[32:35], s60 offen nt lds
 mf v[160:163], a[96:99], a[32:35], v[160:163]
 s_waitcnt lgkmcnt(8)
 mf v[164:167], a[100:103], a[32:35], v[164:167]
 s_waitcnt lgkmcnt(7)
 mf v[224:227], a[104:107], a[32:35], v[224:227]
 s_waitcnt lgkmcnt(4)
 s_add_u32 m0, s70, 0x12000
 mf v[228:231], a[108:111], a[32:35], v[228:231]
 s_add_u32 s60, s72, 0x20300
 ds_read_b64_tr_b16 a[32:33], v15 offset:16384
 ds_read_b64_tr_b16 a[34:35], v15 offset:18432
 mf v[40:43], a[80:83], a[36:39], v[40:43]
 buffer_load_dwordx4 v10, s[36:39], s60 offen lds
 mf v[44:47], a[84:87], a[36:39], v[44:47]
 mf v[104:107], a[88:91], a[36:39], v[104:107]
 mf v[108:111], a[92:95], a[36:39], v[108:111]
 s_add_u32 m0, s70, 0x3000
 mf v[168:171], a[96:99], a[36:39], v[168:171]
 s_add_u32 s60, s71, 0x330000
 mf v[172:175], a[100:103], a[36:39], v[172:175]
 buffer_load_dwordx4 v9, s[32:35], s60 offen nt lds
 mf v[232:235], a[104:107], a[36:39], v[232:235]
 mf v[236:239], a[108:111], a[36:39], v[236:239]
 s_waitcnt lgkmcnt(4)
 ds_read_b64_tr_b16 a[36:37], v16 offset:16384
 ds_read_b64_tr_b16 a[38:39], v16 offset:18432
 mf v[48:51], a[80:83], a[40:43], v[48:51]
 s_add_u32 m0, s70, 0x13000
 mf v[52:55], a[84:87], a[40:43], v[52:55]
 s_add_u32 s60, s72, 0x30300
 mf v[112:115], a[88:91], a[40:43], v[112:115]
 buffer_load_dwordx4 v10, s[36:39], s60 offen lds
 mf v[116:119], a[92:95], a[40:43], v[116:119]
 mf v[176:179], a[96:99], a[40:43], v[176:179]
 mf v[180:183], a[100:103], a[40:43], v[180:183]
 s_mov_b32 s56, s20
 mf v[240:243], a[104:107], a[40:43], v[240:243]
 s_mov_b32 s57, s21
 mf v[244:247], a[108:111], a[40:43], v[244:247]
 s_waitcnt lgkmcnt(4)
 s_mov_b32 s58, 0x510000
 ds_read_b64_tr_b16 a[40:41], v17 offset:16384
 ds_read_b64_tr_b16 a[42:43], v17 offset:18432
 mf v[56:59], a[80:83], a[44:47], v[56:59]
 s_mov_b32 s59, 0x20000
 v_add_u32 v30, 0x300000, v7
 mf v[60:63], a[84:87], a[44:47], v[60:63]
 buffer_load_dword a170, v30, s[56:59], 0 offen
 mf v[120:123], a[88:91], a[44:47], v[120:123]
 mf v[124:127], a[92:95], a[44:47], v[124:127]
 mf v[184:187], a[96:99], a[44:47], v[184:187]
 mf v[188:191], a[100:103], a[44:47], v[188:191]
 mf v[248:251], a[104:107], a[44:47], v[248:251]
 mf v[252:255], a[108:111], a[44:47], v[252:255]
 s_waitcnt lgkmcnt(4)
 ds_read_b64_tr_b16 a[44:45], v18 offset:16384
 ds_read_b64_tr_b16 a[46:47], v18 offset:18432
 mf v[64:67], a[80:83], a[32:35], v[64:67]
 mf v[68:71], a[84:87], a[32:35], v[68:71]
 mf v[128:131], a[88:91], a[32:35], v[128:131]
 mf v[132:135], a[92:95], a[32:35], v[132:135]
 mf v[192:195], a[96:99], a[32:35], v[192:195]
 mf v[196:199], a[100:103], a[32:35], v[196:199]
 mf a[0:3], a[104:107], a[32:35], a[0:3]
 mf a[4:7], a[108:111], a[32:35], a[4:7]
 s_waitcnt vmcnt(20)
 s_waitcnt lgkmcnt(0)
 s_barrier
 mf v[72:75], a[80:83], a[36:39], v[72:75]
 s_add_u32 m0, s70, 0x4000
 ds_read_b64_tr_b16 a[32:33], v11 offset:32768
 ds_read_b64_tr_b16 a[34:35], v11 offset:34816
 mf v[76:79], a[84:87], a[36:39], v[76:79]
 s_add_u32 s60, s71, 0x340000
 ds_read_b128 a[48:51], v19 offset:32768
 ds_read_b128 a[52:55], v19 offset:33792
 mf v[136:139], a[88:91], a[36:39], v[136:139]
 ds_read_b128 a[56:59], v19 offset:34816
 mf v[140:143], a[92:95], a[36:39], v[140:143]
 ds_read_b128 a[60:63], v19 offset:35840
 mf v[200:203], a[96:99], a[36:39], v[200:203]
 ds_read_b128 a[64:67], v19 offset:36864
 mf v[204:207], a[100:103], a[36:39], v[204:207]
 ds_read_b128 a[68:71], v19 offset:37888
 mf a[8:11], a[104:107], a[36:39], a[8:11]
 ds_read_b128 a[72:75], v19 offset:38912
 mf a[12:15], a[108:111], a[36:39], a[12:15]
 ds_read_b64_tr_b16 a[36:37], v12 offset:32768
 ds_read_b64_tr_b16 a[38:39], v12 offset:34816
 mf v[80:83], a[80:83], a[40:43], v[80:83]
 ds_read_b128 a[76:79], v19 offset:39936
 mf v[84:87], a[84:87], a[40:43], v[84:87]
 buffer_load_dwordx4 v8, s[32:35], s60 offen nt lds
 mf v[144:147], a[88:91], a[40:43], v[144:147]
 s_add_u32 m0, s70, 0x14000
 mf v[148:151], a[92:95], a[40:43], v[148:151]
 s_add_u32 s60, s72, 0x340
 mf v[208:211], a[96:99], a[40:43], v[208:211]
 buffer_load_dwordx4 v10, s[36:39], s60 offen lds
 mf v[212:215], a[100:103], a[40:43], v[212:215]
 mf a[16:19], a[104:107], a[40:43], a[16:19]
 mf a[20:23], a[108:111], a[40:43], a[20:23]
 s_add_u32 m0, s70, 0x5000
 ds_read_b64_tr_b16 a[40:41], v13 offset:32768
 ds_read_b64_tr_b16 a[42:43], v13 offset:34816
 mf v[88:91], a[80:83], a[44:47], v[88:91]
 s_add_u32 s60, s71, 0x350000
 mf v[92:95], a[84:87], a[44:47], v[92:95]
 buffer_load_dwordx4 v9, s[32:35], s60 offen nt lds
 mf v[152:155], a[88:91], a[44:47], v[152:155]
 mf v[156:159], a[92:95], a[44:47], v[156:159]
 mf v[216:219], a[96:99], a[44:47], v[216:219]
 s_add_u32 m0, s70, 0x15000
 mf v[220:223], a[100:103], a[44:47], v[220:223]
 s_add_u32 s60, s72, 0x10340
 mf a[24:27], a[104:107], a[44:47], a[24:27]
 buffer_load_dwordx4 v10, s[36:39], s60 offen lds
 mf a[28:31], a[108:111], a[44:47], a[28:31]
 ds_read_b64_tr_b16 a[44:45], v14 offset:32768
 s_waitcnt lgkmcnt(14)
 ds_read_b64_tr_b16 a[46:47], v14 offset:34816
 s_waitcnt lgkmcnt(13)
 mf v[32:35], a[48:51], a[32:35], v[32:35]
 s_waitcnt lgkmcnt(12)
 mf v[36:39], a[52:55], a[32:35], v[36:39]
 s_waitcnt lgkmcnt(11)
 s_add_u32 m0, s70, 0x6000
 mf v[96:99], a[56:59], a[32:35], v[96:99]
 s_waitcnt lgkmcnt(10)
 s_add_u32 s60, s71, 0x360000
 mf v[100:103], a[60:63], a[32:35], v[100:103]
 s_waitcnt lgkmcnt(9)
 buffer_load_dwordx4 v8, s[32:35], s60 offen nt lds
 mf v[160:163], a[64:67], a[32:35], v[160:163]
 s_waitcnt lgkmcnt(8)
 mf v[164:167], a[68:71], a[32:35], v[164:167]
 s_waitcnt lgkmcnt(7)
 mf v[224:227], a[72:75], a[32:35], v[224:227]
 s_waitcnt lgkmcnt(4)
 s_add_u32 m0, s70, 0x16000
 mf v[228:231], a[76:79], a[32:35], v[228:231]
 s_add_u32 s60, s72, 0x20340
 ds_read_b64_tr_b16 a[32:33], v15 offset:32768
 ds_read_b64_tr_b16 a[34:35], v15 offset:34816
 mf v[40:43], a[48:51], a[36:39], v[40:43]
 buffer_load_dwordx4 v10, s[36:39], s60 offen lds
 mf v[44:47], a[52:55], a[36:39], v[44:47]
 mf v[104:107], a[56:59], a[36:39], v[104:107]
 mf v[108:111], a[60:63], a[36:39], v[108:111]
 s_add_u32 m0, s70, 0x7000
 mf v[168:171], a[64:67], a[36:39], v[168:171]
 s_add_u32 s60, s71, 0x370000
 mf v[172:175], a[68:71], a[36:39], v[172:175]
 buffer_load_dwordx4 v9, s[32:35], s60 offen nt lds
 mf v[232:235], a[72:75], a[36:39], v[232:235]
 mf v[236:239], a[76:79], a[36:39], v[236:239]
 s_waitcnt lgkmcnt(4)
 ds_read_b64_tr_b16 a[36:37], v16 offset:32768
 ds_read_b64_tr_b16 a[38:39], v16 offset:34816
 mf v[48:51], a[48:51], a[40:43], v[48:51]
 s_add_u32 m0, s70, 0x17000
 mf v[52:55], a[52:55], a[40:43], v[52:55]
 s_add_u32 s60, s72, 0x30340
 mf v[112:115], a[56:59], a[40:43], v[112:115]
 buffer_load_dwordx4 v10, s[36:39], s60 offen lds
 mf v[116:119], a[60:63], a[40:43], v[116:119]
 mf v[176:179], a[64:67], a[40:43], v[176:179]
 mf v[180:183], a[68:71], a[40:43], v[180:183]
 s_mov_b32 s56, s18
 mf v[240:243], a[72:75], a[40:43], v[240:243]
 s_mov_b32 s57, s19
 mf v[244:247], a[76:79], a[40:43], v[244:247]
 s_waitcnt lgkmcnt(4)
 s_mov_b32 s58, 0x510000
 ds_read_b64_tr_b16 a[40:41], v17 offset:32768
 ds_read_b64_tr_b16 a[42:43], v17 offset:34816
 mf v[56:59], a[48:51], a[44:47], v[56:59]
 s_mov_b32 s59, 0x20000
 v_add_u32 v30, 0x400000, v7
 mf v[60:63], a[52:55], a[44:47], v[60:63]
 buffer_load_dword a170, v30, s[56:59], 0 offen
 mf v[120:123], a[56:59], a[44:47], v[120:123]
 mf v[124:127], a[60:63], a[44:47], v[124:127]
 mf v[184:187], a[64:67], a[44:47], v[184:187]
 mf v[188:191], a[68:71], a[44:47], v[188:191]
 mf v[248:251], a[72:75], a[44:47], v[248:251]
 mf v[252:255], a[76:79], a[44:47], v[252:255]
 s_waitcnt lgkmcnt(4)
 ds_read_b64_tr_b16 a[44:45], v18 offset:32768
 ds_read_b64_tr_b16 a[46:47], v18 offset:34816
 mf v[64:67], a[48:51], a[32:35], v[64:67]
 mf v[68:71], a[52:55], a[32:35], v[68:71]
 mf v[128:131], a[56:59], a[32:35], v[128:131]
 mf v[132:135], a[60:63], a[32:35], v[132:135]
 mf v[192:195], a[64:67], a[32:35], v[192:195]
 mf v[196:199], a[68:71], a[32:35], v[196:199]
 mf a[0:3], a[72:75], a[32:35], a[0:3]
 mf a[4:7], a[76:79], a[32:35], a[4:7]
 s_waitcnt vmcnt(19)
 s_waitcnt lgkmcnt(0)
 s_barrier
 mf v[72:75], a[48:51], a[36:39], v[72:75]
 s_add_u32 m0, s70, 0x8000
 ds_read_b64_tr_b16 a[32:33], v11 offset:49152
 ds_read_b64_tr_b16 a[34:35], v11 offset:51200
 mf v[76:79], a[52:55], a[36:39], v[76:79]
 s_add_u32 s60, s71, 0x380000
 ds_read_b128 a[80:83], v19 offset:49152
 ds_read_b128 a[84:87], v19 offset:50176
 mf v[136:139], a[56:59], a[36:39], v[136:139]
 ds_read_b128 a[88:91], v19 offset:51200
 mf v[140:143], a[60:63], a[36:39], v[140:143]
 ds_read_b128 a[92:95], v19 offset:52224
 mf v[200:203], a[64:67], a[36:39], v[200:203]
 ds_read_b128 a[96:99], v19 offset:53248
 mf v[204:207], a[68:71], a[36:39], v[204:207]
 ds_read_b128 a[100:103], v19 offset:54272
 mf a[8:11], a[72:75], a[36:39], a[8:11]
 ds_read_b128 a[104:107], v19 offset:55296
 mf a[12:15], a[76:79], a[36:39], a[12:15]
 ds_read_b64_tr_b16 a[36:37], v12 offset:49152
 ds_read_b64_tr_b16 a[38:39], v12 offset:51200
 mf v[80:83], a[48:51], a[40:43], v[80:83]
 ds_read_b128 a[108:111], v19 offset:56320
 mf v[84:87], a[52:55], a[40:43], v[84:87]
 buffer_load_dwordx4 v8, s[32:35], s60 offen nt lds
 mf v[144:147], a[56:59], a[40:43], v[144:147]
 s_add_u32 m0, s70, 0x18000
 mf v[148:151], a[60:63], a[40:43], v[148:151]
 s_add_u32 s60, s72, 0x380
 mf v[208:211], a[64:67], a[40:43], v[208:211]
 buffer_load_dwordx4 v10, s[36:39], s60 offen lds
 mf v[212:215], a[68:71], a[40:43], v[212:215]
 mf a[16:19], a[72:75], a[40:43], a[16:19]
 mf a[20:23], a[76:79], a[40:43], a[20:23]
 s_add_u32 m0, s70, 0x9000
 ds_read_b64_tr_b16 a[40:41], v13 offset:49152
 ds_read_b64_tr_b16 a[42:43], v13 offset:51200
 mf v[88:91], a[48:51], a[44:47], v[88:91]
 s_add_u32 s60, s71, 0x390000
 mf v[92:95], a[52:55], a[44:47], v[92:95]
 buffer_load_dwordx4 v9, s[32:35], s60 offen nt lds
 mf v[152:155], a[56:59], a[44:47], v[152:155]
 mf v[156:159], a[60:63], a[44:47], v[156:159]
 mf v[216:219], a[64:67], a[44:47], v[216:219]
 s_add_u32 m0, s70, 0x19000
 mf v[220:223], a[68:71], a[44:47], v[220:223]
 s_add_u32 s60, s72, 0x10380
 mf a[24:27], a[72:75], a[44:47], a[24:27]
 buffer_load_dwordx4 v10, s[36:39], s60 offen lds
 mf a[28:31], a[76:79], a[44:47], a[28:31]
 ds_read_b64_tr_b16 a[44:45], v14 offset:49152
 s_waitcnt lgkmcnt(14)
 ds_read_b64_tr_b16 a[46:47], v14 offset:51200
 s_waitcnt lgkmcnt(13)
 mf v[32:35], a[80:83], a[32:35], v[32:35]
 s_waitcnt lgkmcnt(12)
 mf v[36:39], a[84:87], a[32:35], v[36:39]
 s_waitcnt lgkmcnt(11)
 s_add_u32 m0, s70, 0xa000
 mf v[96:99], a[88:91], a[32:35], v[96:99]
 s_waitcnt lgkmcnt(10)
 s_add_u32 s60, s71, 0x3a0000
 mf v[100:103], a[92:95], a[32:35], v[100:103]
 s_waitcnt lgkmcnt(9)
 buffer_load_dwordx4 v8, s[32:35], s60 offen nt lds
 mf v[160:163], a[96:99], a[32:35], v[160:163]
 s_waitcnt lgkmcnt(8)
 mf v[164:167], a[100:103], a[32:35], v[164:167]
 s_waitcnt lgkmcnt(7)
 mf v[224:227], a[104:107], a[32:35], v[224:227]
 s_waitcnt lgkmcnt(4)
 s_add_u32 m0, s70, 0x1a000
 mf v[228:231], a[108:111], a[32:35], v[228:231]
 s_add_u32 s60, s72, 0x20380
 ds_read_b64_tr_b16 a[32:33], v15 offset:49152
 ds_read_b64_tr_b16 a[34:35], v15 offset:51200
 mf v[40:43], a[80:83], a[36:39], v[40:43]
 buffer_load_dwordx4 v10, s[36:39], s60 offen lds
 mf v[44:47], a[84:87], a[36:39], v[44:47]
 mf v[104:107], a[88:91], a[36:39], v[104:107]
 mf v[108:111], a[92:95], a[36:39], v[108:111]
 s_add_u32 m0, s70, 0xb000
 mf v[168:171], a[96:99], a[36:39], v[168:171]
 s_add_u32 s60, s71, 0x3b0000
 mf v[172:175], a[100:103], a[36:39], v[172:175]
 buffer_load_dwordx4 v9, s[32:35], s60 offen nt lds
 mf v[232:235], a[104:107], a[36:39], v[232:235]
 mf v[236:239], a[108:111], a[36:39], v[236:239]
 s_waitcnt lgkmcnt(4)
 ds_read_b64_tr_b16 a[36:37], v16 offset:49152
 ds_read_b64_tr_b16 a[38:39], v16 offset:51200
 mf v[48:51], a[80:83], a[40:43], v[48:51]
 s_add_u32 m0, s70, 0x1b000
 mf v[52:55], a[84:87], a[40:43], v[52:55]
 s_add_u32 s60, s72, 0x30380
 mf v[112:115], a[88:91], a[40:43], v[112:115]
 buffer_load_dwordx4 v10, s[36:39], s60 offen lds
 mf v[116:119], a[92:95], a[40:43], v[116:119]
 mf v[176:179], a[96:99], a[40:43], v[176:179]
 mf v[180:183], a[100:103], a[40:43], v[180:183]
 s_mov_b32 s56, s20
 mf v[240:243], a[104:107], a[40:43], v[240:243]
 s_mov_b32 s57, s21
 mf v[244:247], a[108:111], a[40:43], v[244:247]
 s_waitcnt lgkmcnt(4)
 s_mov_b32 s58, 0x510000
 ds_read_b64_tr_b16 a[40:41], v17 offset:49152
 ds_read_b64_tr_b16 a[42:43], v17 offset:51200
 mf v[56:59], a[80:83], a[44:47], v[56:59]
 s_mov_b32 s59, 0x20000
 v_add_u32 v30, 0x400000, v7
 mf v[60:63], a[84:87], a[44:47], v[60:63]
 buffer_load_dword a170, v30, s[56:59], 0 offen
 mf v[120:123], a[88:91], a[44:47], v[120:123]
 mf v[124:127], a[92:95], a[44:47], v[124:127]
 mf v[184:187], a[96:99], a[44:47], v[184:187]
 mf v[188:191], a[100:103], a[44:47], v[188:191]
 mf v[248:251], a[104:107], a[44:47], v[248:251]
 mf v[252:255], a[108:111], a[44:47], v[252:255]
 s_waitcnt lgkmcnt(4)
 ds_read_b64_tr_b16 a[44:45], v18 offset:49152
 ds_read_b64_tr_b16 a[46:47], v18 offset:51200
 mf v[64:67], a[80:83], a[32:35], v[64:67]
 mf v[68:71], a[84:87], a[32:35], v[68:71]
 mf v[128:131], a[88:91], a[32:35], v[128:131]
 mf v[132:135], a[92:95], a[32:35], v[132:135]
 mf v[192:195], a[96:99], a[32:35], v[192:195]
 mf v[196:199], a[100:103], a[32:35], v[196:199]
 mf a[0:3], a[104:107], a[32:35], a[0:3]
 mf a[4:7], a[108:111], a[32:35], a[4:7]
 s_waitcnt vmcnt(19)
 s_waitcnt lgkmcnt(0)
 s_barrier
 mf v[72:75], a[80:83], a[36:39], v[72:75]
 s_add_u32 m0, s70, 0xc000
 ds_read_b64_tr_b16 a[32:33], v11
 ds_read_b64_tr_b16 a[34:35], v11 offset:2048
 mf v[76:79], a[84:87], a[36:39], v[76:79]
 s_add_u32 s60, s71, 0x3c0000
 ds_read_b128 a[48:51], v19
 ds_read_b128 a[52:55], v19 offset:1024
 mf v[136:139], a[88:91], a[36:39], v[136:139]
 ds_read_b128 a[56:59], v19 offset:2048
 mf v[140:143], a[92:95], a[36:39], v[140:143]
 ds_read_b128 a[60:63], v19 offset:3072
 mf v[200:203], a[96:99], a[36:39], v[200:203]
 ds_read_b128 a[64:67], v19 offset:4096
 mf v[204:207], a[100:103], a[36:39], v[204:207]
 ds_read_b128 a[68:71], v19 offset:5120
 mf a[8:11], a[104:107], a[36:39], a[8:11]
 ds_read_b128 a[72:75], v19 offset:6144
 mf a[12:15], a[108:111], a[36:39], a[12:15]
 ds_read_b64_tr_b16 a[36:37], v12
 ds_read_b64_tr_b16 a[38:39], v12 offset:2048
 mf v[80:83], a[80:83], a[40:43], v[80:83]
 ds_read_b128 a[76:79], v19 offset:7168
 mf v[84:87], a[84:87], a[40:43], v[84:87]
 buffer_load_dwordx4 v8, s[32:35], s60 offen nt lds
 mf v[144:147], a[88:91], a[40:43], v[144:147]
 s_add_u32 m0, s70, 0x1c000
 mf v[148:151], a[92:95], a[40:43], v[148:151]
 s_add_u32 s60, s72, 0x3c0
 mf v[208:211], a[96:99], a[40:43], v[208:211]
 buffer_load_dwordx4 v10, s[36:39], s60 offen lds
 mf v[212:215], a[100:103], a[40:43], v[212:215]
 mf a[16:19], a[104:107], a[40:43], a[16:19]
 mf a[20:23], a[108:111], a[40:43], a[20:23]
 s_add_u32 m0, s70, 0xd000
 ds_read_b64_tr_b16 a[40:41], v13
 ds_read_b64_tr_b16 a[42:43], v13 offset:2048
 mf v[88:91], a[80:83], a[44:47], v[88:91]
 s_add_u32 s60, s71, 0x3d0000
 mf v[92:95], a[84:87], a[44:47], v[92:95]
 buffer_load_dwordx4 v9, s[32:35], s60 offen nt lds
 mf v[152:155], a[88:91], a[44:47], v[152:155]
 mf v[156:159], a[92:95], a[44:47], v[156:159]
 mf v[216:219], a[96:99], a[44:47], v[216:219]
 s_add_u32 m0, s70, 0x1d000
 mf v[220:223], a[100:103], a[44:47], v[220:223]
 s_add_u32 s60, s72, 0x103c0
 mf a[24:27], a[104:107], a[44:47], a[24:27]
 buffer_load_dwordx4 v10, s[36:39], s60 offen lds
 mf a[28:31], a[108:111], a[44:47], a[28:31]
 ds_read_b64_tr_b16 a[44:45], v14
 s_waitcnt lgkmcnt(14)
 ds_read_b64_tr_b16 a[46:47], v14 offset:2048
 s_waitcnt lgkmcnt(13)
 mf v[32:35], a[48:51], a[32:35], v[32:35]
 s_waitcnt lgkmcnt(12)
 mf v[36:39], a[52:55], a[32:35], v[36:39]
 s_waitcnt lgkmcnt(11)
 s_add_u32 m0, s70, 0xe000
 mf v[96:99], a[56:59], a[32:35], v[96:99]
 s_waitcnt lgkmcnt(10)
 s_add_u32 s60, s71, 0x3e0000
 mf v[100:103], a[60:63], a[32:35], v[100:103]
 s_waitcnt lgkmcnt(9)
 buffer_load_dwordx4 v8, s[32:35], s60 offen nt lds
 mf v[160:163], a[64:67], a[32:35], v[160:163]
 s_waitcnt lgkmcnt(8)
 mf v[164:167], a[68:71], a[32:35], v[164:167]
 s_waitcnt lgkmcnt(7)
 mf v[224:227], a[72:75], a[32:35], v[224:227]
 s_waitcnt lgkmcnt(4)
 s_add_u32 m0, s70, 0x1e000
 mf v[228:231], a[76:79], a[32:35], v[228:231]
 s_add_u32 s60, s72, 0x203c0
 ds_read_b64_tr_b16 a[32:33], v15
 ds_read_b64_tr_b16 a[34:35], v15 offset:2048
 mf v[40:43], a[48:51], a[36:39], v[40:43]
 buffer_load_dwordx4 v10, s[36:39], s60 offen lds
 mf v[44:47], a[52:55], a[36:39], v[44:47]
 mf v[104:107], a[56:59], a[36:39], v[104:107]
 mf v[108:111], a[60:63], a[36:39], v[108:111]
 s_add_u32 m0, s70, 0xf000
 mf v[168:171], a[64:67], a[36:39], v[168:171]
 s_add_u32 s60, s71, 0x3f0000
 mf v[172:175], a[68:71], a[36:39], v[172:175]
 buffer_load_dwordx4 v9, s[32:35], s60 offen nt lds
 mf v[232:235], a[72:75], a[36:39], v[232:235]
 mf v[236:239], a[76:79], a[36:39], v[236:239]
 s_waitcnt lgkmcnt(4)
 ds_read_b64_tr_b16 a[36:37], v16
 ds_read_b64_tr_b16 a[38:39], v16 offset:2048
 mf v[48:51], a[48:51], a[40:43], v[48:51]
 s_add_u32 m0, s70, 0x1f000
 mf v[52:55], a[52:55], a[40:43], v[52:55]
 s_add_u32 s60, s72, 0x303c0
 mf v[112:115], a[56:59], a[40:43], v[112:115]
 buffer_load_dwordx4 v10, s[36:39], s60 offen lds
 mf v[116:119], a[60:63], a[40:43], v[116:119]
 mf v[176:179], a[64:67], a[40:43], v[176:179]
 mf v[180:183], a[68:71], a[40:43], v[180:183]
 s_mov_b32 s56, s18
 mf v[240:243], a[72:75], a[40:43], v[240:243]
 s_mov_b32 s57, s19
 mf v[244:247], a[76:79], a[40:43], v[244:247]
 s_waitcnt lgkmcnt(4)
 s_mov_b32 s58, 0x510000
 ds_read_b64_tr_b16 a[40:41], v17
 ds_read_b64_tr_b16 a[42:43], v17 offset:2048
 mf v[56:59], a[48:51], a[44:47], v[56:59]
 s_mov_b32 s59, 0x20000
 v_add_u32 v30, 0x500000, v7
 mf v[60:63], a[52:55], a[44:47], v[60:63]
 buffer_load_dword a170, v30, s[56:59], 0 offen
 mf v[120:123], a[56:59], a[44:47], v[120:123]
 mf v[124:127], a[60:63], a[44:47], v[124:127]
 mf v[184:187], a[64:67], a[44:47], v[184:187]
 mf v[188:191], a[68:71], a[44:47], v[188:191]
 mf v[248:251], a[72:75], a[44:47], v[248:251]
 mf v[252:255], a[76:79], a[44:47], v[252:255]
 s_waitcnt lgkmcnt(4)
 ds_read_b64_tr_b16 a[44:45], v18
 ds_read_b64_tr_b16 a[46:47], v18 offset:2048
 mf v[64:67], a[48:51], a[32:35], v[64:67]
 mf v[68:71], a[52:55], a[32:35], v[68:71]
 mf v[128:131], a[56:59], a[32:35], v[128:131]
 mf v[132:135], a[60:63], a[32:35], v[132:135]
 mf v[192:195], a[64:67], a[32:35], v[192:195]
 mf v[196:199], a[68:71], a[32:35], v[196:199]
 mf a[0:3], a[72:75], a[32:35], a[0:3]
 mf a[4:7], a[76:79], a[32:35], a[4:7]
 s_waitcnt vmcnt(19)
 s_waitcnt lgkmcnt(0)
 s_barrier
 mf v[72:75], a[48:51], a[36:39], v[72:75]
 ds_read_b64_tr_b16 a[32:33], v11 offset:16384
 ds_read_b64_tr_b16 a[34:35], v11 offset:18432
 mf v[76:79], a[52:55], a[36:39], v[76:79]
 ds_read_b128 a[80:83], v19 offset:16384
 ds_read_b128 a[84:87], v19 offset:17408
 mf v[136:139], a[56:59], a[36:39], v[136:139]
 ds_read_b128 a[88:91], v19 offset:18432
 mf v[140:143], a[60:63], a[36:39], v[140:143]
 ds_read_b128 a[92:95], v19 offset:19456
 v_and_b32 v8, 15, v1
 mf v[200:203], a[64:67], a[36:39], v[200:203]
 ds_read_b128 a[96:99], v19 offset:20480
 v_lshlrev_b32 v8, 7, v8
 mf v[204:207], a[68:71], a[36:39], v[204:207]
 s_sub_u32 s30, 15, s66
 ds_read_b128 a[100:103], v19 offset:21504
 v_bfe_u32 v9, v1, 4, 1
 mf a[8:11], a[72:75], a[36:39], a[8:11]
 s_sub_u32 s31, s66, s30
 ds_read_b128 a[104:107], v19 offset:22528
 mf a[12:15], a[76:79], a[36:39], a[12:15]
 s_lshl_b32 s31, s31, 11
 ds_read_b64_tr_b16 a[36:37], v12 offset:16384
 ds_read_b64_tr_b16 a[38:39], v12 offset:18432
 mf v[80:83], a[48:51], a[40:43], v[80:83]
 s_lshl_b32 s30, s30, 11
 ds_read_b128 a[108:111], v19 offset:23552
 v_mul_lo_u32 v9, v9, s31
 mf v[84:87], a[52:55], a[40:43], v[84:87]
 v_add_u32 v8, v8, v9
 v_add_u32 v8, s30, v8
 mf v[144:147], a[56:59], a[40:43], v[144:147]
 buffer_load_dword v10, v8, s[52:55], 0 offen sc1
 mf v[148:151], a[60:63], a[40:43], v[148:151]
 mf v[208:211], a[64:67], a[40:43], v[208:211]
 mf v[212:215], a[68:71], a[40:43], v[212:215]
 mf a[16:19], a[72:75], a[40:43], a[16:19]
 mf a[20:23], a[76:79], a[40:43], a[20:23]
 ds_read_b64_tr_b16 a[40:41], v13 offset:16384
 ds_read_b64_tr_b16 a[42:43], v13 offset:18432
 mf v[88:91], a[48:51], a[44:47], v[88:91]
 mf v[92:95], a[52:55], a[44:47], v[92:95]
 mf v[152:155], a[56:59], a[44:47], v[152:155]
 mf v[156:159], a[60:63], a[44:47], v[156:159]
 mf v[216:219], a[64:67], a[44:47], v[216:219]
 mf v[220:223], a[68:71], a[44:47], v[220:223]
 mf a[24:27], a[72:75], a[44:47], a[24:27]
 mf a[28:31], a[76:79], a[44:47], a[28:31]
 ds_read_b64_tr_b16 a[44:45], v14 offset:16384
 s_waitcnt lgkmcnt(14)
 ds_read_b64_tr_b16 a[46:47], v14 offset:18432
 s_waitcnt lgkmcnt(13)
 mf v[32:35], a[80:83], a[32:35], v[32:35]
 s_waitcnt lgkmcnt(12)
 mf v[36:39], a[84:87], a[32:35], v[36:39]
 s_waitcnt lgkmcnt(11)
 mf v[96:99], a[88:91], a[32:35], v[96:99]
 s_waitcnt lgkmcnt(10)
 mf v[100:103], a[92:95], a[32:35], v[100:103]
 s_waitcnt lgkmcnt(9)
 mf v[160:163], a[96:99], a[32:35], v[160:163]
 s_waitcnt lgkmcnt(8)
 mf v[164:167], a[100:103], a[32:35], v[164:167]
 s_waitcnt lgkmcnt(7)
 mf v[224:227], a[104:107], a[32:35], v[224:227]
 s_waitcnt lgkmcnt(4)
 mf v[228:231], a[108:111], a[32:35], v[228:231]
 ds_read_b64_tr_b16 a[32:33], v15 offset:16384
 ds_read_b64_tr_b16 a[34:35], v15 offset:18432
 mf v[40:43], a[80:83], a[36:39], v[40:43]
 mf v[44:47], a[84:87], a[36:39], v[44:47]
 mf v[104:107], a[88:91], a[36:39], v[104:107]
 mf v[108:111], a[92:95], a[36:39], v[108:111]
 mf v[168:171], a[96:99], a[36:39], v[168:171]
 mf v[172:175], a[100:103], a[36:39], v[172:175]
 mf v[232:235], a[104:107], a[36:39], v[232:235]
 mf v[236:239], a[108:111], a[36:39], v[236:239]
 s_waitcnt lgkmcnt(4)
 ds_read_b64_tr_b16 a[36:37], v16 offset:16384
 ds_read_b64_tr_b16 a[38:39], v16 offset:18432
 mf v[48:51], a[80:83], a[40:43], v[48:51]
 mf v[52:55], a[84:87], a[40:43], v[52:55]
 mf v[112:115], a[88:91], a[40:43], v[112:115]
 mf v[116:119], a[92:95], a[40:43], v[116:119]
 mf v[176:179], a[96:99], a[40:43], v[176:179]
 mf v[180:183], a[100:103], a[40:43], v[180:183]
 s_mov_b32 s56, s20
 mf v[240:243], a[104:107], a[40:43], v[240:243]
 s_mov_b32 s57, s21
 mf v[244:247], a[108:111], a[40:43], v[244:247]
 s_waitcnt lgkmcnt(4)
 s_mov_b32 s58, 0x510000
 ds_read_b64_tr_b16 a[40:41], v17 offset:16384
 ds_read_b64_tr_b16 a[42:43], v17 offset:18432
 mf v[56:59], a[80:83], a[44:47], v[56:59]
 s_mov_b32 s59, 0x20000
 v_add_u32 v30, 0x500000, v7
 mf v[60:63], a[84:87], a[44:47], v[60:63]
 buffer_load_dword a170, v30, s[56:59], 0 offen
 mf v[120:123], a[88:91], a[44:47], v[120:123]
 mf v[124:127], a[92:95], a[44:47], v[124:127]
 mf v[184:187], a[96:99], a[44:47], v[184:187]
 mf v[188:191], a[100:103], a[44:47], v[188:191]
 mf v[248:251], a[104:107], a[44:47], v[248:251]
 mf v[252:255], a[108:111], a[44:47], v[252:255]
 s_waitcnt lgkmcnt(4)
 ds_read_b64_tr_b16 a[44:45], v18 offset:16384
 ds_read_b64_tr_b16 a[46:47], v18 offset:18432
 mf v[64:67], a[80:83], a[32:35], v[64:67]
 mf v[68:71], a[84:87], a[32:35], v[68:71]
 mf v[128:131], a[88:91], a[32:35], v[128:131]
 mf v[132:135], a[92:95], a[32:35], v[132:135]
 mf v[192:195], a[96:99], a[32:35], v[192:195]
 mf v[196:199], a[100:103], a[32:35], v[196:199]
 mf a[0:3], a[104:107], a[32:35], a[0:3]
 mf a[4:7], a[108:111], a[32:35], a[4:7]
 s_waitcnt vmcnt(12)
 s_waitcnt lgkmcnt(0)
 s_barrier
 mf v[72:75], a[80:83], a[36:39], v[72:75]
 ds_read_b64_tr_b16 a[32:33], v11 offset:32768
 ds_read_b64_tr_b16 a[34:35], v11 offset:34816
 mf v[76:79], a[84:87], a[36:39], v[76:79]
 ds_read_b128 a[48:51], v19 offset:32768
 ds_read_b128 a[52:55], v19 offset:33792
 s_waitcnt vmcnt(1)
 v_cmp_eq_u32 vcc, v6, v10
 s_nop 3
 s_cmp_eq_u64 vcc, -1
 s_cbranch_scc0 f_ln1_spin
f_ln1_ok:
 mf v[136:139], a[88:91], a[36:39], v[136:139]
 s_add_u32 s61, s81, 0
 ds_read_b128 a[56:59], v19 offset:34816
 mf v[140:143], a[92:95], a[36:39], v[140:143]
 ds_read_b128 a[60:63], v19 offset:35840
 mf v[200:203], a[96:99], a[36:39], v[200:203]
 ds_read_b128 a[64:67], v19 offset:36864
 mf v[204:207], a[100:103], a[36:39], v[204:207]
 ds_read_b128 a[68:71], v19 offset:37888
 mf a[8:11], a[104:107], a[36:39], a[8:11]
 ds_read_b128 a[72:75], v19 offset:38912
 mf a[12:15], a[108:111], a[36:39], a[12:15]
 ds_read_b64_tr_b16 a[36:37], v12 offset:32768
 ds_read_b64_tr_b16 a[38:39], v12 offset:34816
 mf v[80:83], a[80:83], a[40:43], v[80:83]
 ds_read_b128 a[76:79], v19 offset:39936
 mf v[84:87], a[84:87], a[40:43], v[84:87]
 buffer_load_dwordx4 a[192:195], v4, s[48:51], s61 offen
 mf v[144:147], a[88:91], a[40:43], v[144:147]
 mf v[148:151], a[92:95], a[40:43], v[148:151]
 s_add_u32 s61, s81, s16
 mf v[208:211], a[96:99], a[40:43], v[208:211]
 s_add_u32 s61, s61, 0
 buffer_load_dwordx4 a[196:199], v4, s[48:51], s61 offen
 mf v[212:215], a[100:103], a[40:43], v[212:215]
 mf a[16:19], a[104:107], a[40:43], a[16:19]
 s_add_u32 s61, s82, 0
 buffer_load_dwordx4 a[200:203], v4, s[48:51], s61 offen
 mf a[20:23], a[108:111], a[40:43], a[20:23]
 ds_read_b64_tr_b16 a[40:41], v13 offset:32768
 ds_read_b64_tr_b16 a[42:43], v13 offset:34816
 mf v[88:91], a[80:83], a[44:47], v[88:91]
 s_add_u32 s61, s82, s16
 mf v[92:95], a[84:87], a[44:47], v[92:95]
 s_add_u32 s61, s61, 0
 buffer_load_dwordx4 a[204:207], v4, s[48:51], s61 offen
 mf v[152:155], a[88:91], a[44:47], v[152:155]
 mf v[156:159], a[92:95], a[44:47], v[156:159]
 s_add_u32 s61, s81, 0
 buffer_load_dwordx4 a[208:211], v4, s[48:51], s61 offen offset:1024
 mf v[216:219], a[96:99], a[44:47], v[216:219]
 mf v[220:223], a[100:103], a[44:47], v[220:223]
 s_add_u32 s61, s81, s16
 mf a[24:27], a[104:107], a[44:47], a[24:27]
 s_add_u32 s61, s61, 0
 buffer_load_dwordx4 a[212:215], v4, s[48:51], s61 offen offset:1024
 mf a[28:31], a[108:111], a[44:47], a[28:31]
 ds_read_b64_tr_b16 a[44:45], v14 offset:32768
 s_waitcnt lgkmcnt(14)
 ds_read_b64_tr_b16 a[46:47], v14 offset:34816
 s_waitcnt lgkmcnt(13)
 mf v[32:35], a[48:51], a[32:35], v[32:35]
 s_waitcnt lgkmcnt(12)
 s_add_u32 s61, s82, 0
 buffer_load_dwordx4 a[216:219], v4, s[48:51], s61 offen offset:1024
 mf v[36:39], a[52:55], a[32:35], v[36:39]
 s_waitcnt lgkmcnt(11)
 mf v[96:99], a[56:59], a[32:35], v[96:99]
 s_waitcnt lgkmcnt(10)
 s_add_u32 s61, s82, s16
 mf v[100:103], a[60:63], a[32:35], v[100:103]
 s_waitcnt lgkmcnt(9)
 s_add_u32 s61, s61, 0
 buffer_load_dwordx4 a[220:223], v4, s[48:51], s61 offen offset:1024
 mf v[160:163], a[64:67], a[32:35], v[160:163]
 s_waitcnt lgkmcnt(8)
 mf v[164:167], a[68:71], a[32:35], v[164:167]
 s_waitcnt lgkmcnt(7)
 s_add_u32 s61, s81, 0x800
 buffer_load_dwordx4 a[224:227], v4, s[48:51], s61 offen
 mf v[224:227], a[72:75], a[32:35], v[224:227]
 s_waitcnt lgkmcnt(4)
 mf v[228:231], a[76:79], a[32:35], v[228:231]
 s_add_u32 s61, s81, s16
 ds_read_b64_tr_b16 a[32:33], v15 offset:32768
 ds_read_b64_tr_b16 a[34:35], v15 offset:34816
 mf v[40:43], a[48:51], a[36:39], v[40:43]
 s_add_u32 s61, s61, 0x800
 buffer_load_dwordx4 a[228:231], v4, s[48:51], s61 offen
 mf v[44:47], a[52:55], a[36:39], v[44:47]
 mf v[104:107], a[56:59], a[36:39], v[104:107]
 s_add_u32 s61, s82, 0x800
 buffer_load_dwordx4 a[232:235], v4, s[48:51], s61 offen
 mf v[108:111], a[60:63], a[36:39], v[108:111]
 mf v[168:171], a[64:67], a[36:39], v[168:171]
 s_add_u32 s61, s82, s16
 mf v[172:175], a[68:71], a[36:39], v[172:175]
 s_add_u32 s61, s61, 0x800
 buffer_load_dwordx4 a[236:239], v4, s[48:51], s61 offen
 mf v[232:235], a[72:75], a[36:39], v[232:235]
 mf v[236:239], a[76:79], a[36:39], v[236:239]
 s_waitcnt lgkmcnt(4)
 s_add_u32 s61, s81, 0x800
 ds_read_b64_tr_b16 a[36:37], v16 offset:32768
 ds_read_b64_tr_b16 a[38:39], v16 offset:34816
 mf v[48:51], a[48:51], a[40:43], v[48:51]
 buffer_load_dwordx4 a[240:243], v4, s[48:51], s61 offen offset:1024
 mf v[52:55], a[52:55], a[40:43], v[52:55]
 mf v[112:115], a[56:59], a[40:43], v[112:115]
 s_add_u32 s61, s81, s16
 mf v[116:119], a[60:63], a[40:43], v[116:119]
 s_add_u32 s61, s61, 0x800
 buffer_load_dwordx4 a[244:247], v4, s[48:51], s61 offen offset:1024
 mf v[176:179], a[64:67], a[40:43], v[176:179]
 mf v[180:183], a[68:71], a[40:43], v[180:183]
 s_add_u32 s61, s82, 0x800
 buffer_load_dwordx4 a[248:251], v4, s[48:51], s61 offen offset:1024
 mf v[240:243], a[72:75], a[40:43], v[240:243]
 mf v[244:247], a[76:79], a[40:43], v[244:247]
 s_waitcnt lgkmcnt(4)
 s_add_u32 s61, s82, s16
 ds_read_b64_tr_b16 a[40:41], v17 offset:32768
 ds_read_b64_tr_b16 a[42:43], v17 offset:34816
 mf v[56:59], a[48:51], a[44:47], v[56:59]
 s_add_u32 s61, s61, 0x800
 buffer_load_dwordx4 a[252:255], v4, s[48:51], s61 offen offset:1024
 mf v[60:63], a[52:55], a[44:47], v[60:63]
 mf v[120:123], a[56:59], a[44:47], v[120:123]
 mf v[124:127], a[60:63], a[44:47], v[124:127]
 mf v[184:187], a[64:67], a[44:47], v[184:187]
 mf v[188:191], a[68:71], a[44:47], v[188:191]
 mf v[248:251], a[72:75], a[44:47], v[248:251]
 mf v[252:255], a[76:79], a[44:47], v[252:255]
 s_waitcnt lgkmcnt(4)
 ds_read_b64_tr_b16 a[44:45], v18 offset:32768
 ds_read_b64_tr_b16 a[46:47], v18 offset:34816
 mf v[64:67], a[48:51], a[32:35], v[64:67]
 mf v[68:71], a[52:55], a[32:35], v[68:71]
 mf v[128:131], a[56:59], a[32:35], v[128:131]
 mf v[132:135], a[60:63], a[32:35], v[132:135]
 mf v[192:195], a[64:67], a[32:35], v[192:195]
 mf v[196:199], a[68:71], a[32:35], v[196:199]
 mf a[0:3], a[72:75], a[32:35], a[0:3]
 mf a[4:7], a[76:79], a[32:35], a[4:7]
 s_waitcnt lgkmcnt(0)
 s_barrier
 mf v[72:75], a[48:51], a[36:39], v[72:75]
 ds_read_b64_tr_b16 a[32:33], v11 offset:49152
 ds_read_b64_tr_b16 a[34:35], v11 offset:51200
 mf v[76:79], a[52:55], a[36:39], v[76:79]
 s_mov_b32 s63, 0
 ds_read_b128 a[80:83], v19 offset:49152
 ds_read_b128 a[84:87], v19 offset:50176
 mf v[136:139], a[56:59], a[36:39], v[136:139]
 s_add_u32 m0, s78, 0
 ds_read_b128 a[88:91], v19 offset:51200
 mf v[140:143], a[60:63], a[36:39], v[140:143]
 ds_read_b128 a[92:95], v19 offset:52224
 mf v[200:203], a[64:67], a[36:39], v[200:203]
 ds_read_b128 a[96:99], v19 offset:53248
 mf v[204:207], a[68:71], a[36:39], v[204:207]
 ds_read_b128 a[100:103], v19 offset:54272
 mf a[8:11], a[72:75], a[36:39], a[8:11]
 ds_read_b128 a[104:107], v19 offset:55296
 mf a[12:15], a[76:79], a[36:39], a[12:15]
 ds_read_b64_tr_b16 a[36:37], v12 offset:49152
 ds_read_b64_tr_b16 a[38:39], v12 offset:51200
 mf v[80:83], a[48:51], a[40:43], v[80:83]
 ds_read_b128 a[108:111], v19 offset:56320
 mf v[84:87], a[52:55], a[40:43], v[84:87]
 buffer_load_dwordx4 v20, s[44:47], s63 offen lds
 mf v[144:147], a[56:59], a[40:43], v[144:147]
 mf v[148:151], a[60:63], a[40:43], v[148:151]
 s_add_u32 m0, s78, 0x400
 mf v[208:211], a[64:67], a[40:43], v[208:211]
 buffer_load_dwordx4 v21, s[44:47], s63 offen lds
 mf v[212:215], a[68:71], a[40:43], v[212:215]
 mf a[16:19], a[72:75], a[40:43], a[16:19]
 s_add_u32 m0, s78, 0x800
 mf a[20:23], a[76:79], a[40:43], a[20:23]
 ds_read_b64_tr_b16 a[40:41], v13 offset:49152
 ds_read_b64_tr_b16 a[42:43], v13 offset:51200
 mf v[88:91], a[48:51], a[44:47], v[88:91]
 buffer_load_dwordx4 v22, s[44:47], s63 offen lds
 mf v[92:95], a[52:55], a[44:47], v[92:95]
 mf v[152:155], a[56:59], a[44:47], v[152:155]
 s_add_u32 m0, s78, 0xc00
 mf v[156:159], a[60:63], a[44:47], v[156:159]
 buffer_load_dwordx4 v23, s[44:47], s63 offen lds
 mf v[216:219], a[64:67], a[44:47], v[216:219]
 mf v[220:223], a[68:71], a[44:47], v[220:223]
 s_add_u32 m0, s78, 0x1000
 mf a[24:27], a[72:75], a[44:47], a[24:27]
 buffer_load_dwordx4 v24, s[44:47], s63 offen lds
 mf a[28:31], a[76:79], a[44:47], a[28:31]
 ds_read_b64_tr_b16 a[44:45], v14 offset:49152
 s_waitcnt lgkmcnt(14)
 ds_read_b64_tr_b16 a[46:47], v14 offset:51200
 s_waitcnt lgkmcnt(13)
 mf v[32:35], a[80:83], a[32:35], v[32:35]
 s_waitcnt lgkmcnt(12)
 s_add_u32 m0, s78, 0x1400
 mf v[36:39], a[84:87], a[32:35], v[36:39]
 s_waitcnt lgkmcnt(11)
 buffer_load_dwordx4 v25, s[44:47], s63 offen lds
 mf v[96:99], a[88:91], a[32:35], v[96:99]
 s_waitcnt lgkmcnt(10)
 mf v[100:103], a[92:95], a[32:35], v[100:103]
 s_waitcnt lgkmcnt(9)
 s_add_u32 m0, s78, 0x1800
 mf v[160:163], a[96:99], a[32:35], v[160:163]
 s_waitcnt lgkmcnt(8)
 buffer_load_dwordx4 v26, s[44:47], s63 offen lds
 mf v[164:167], a[100:103], a[32:35], v[164:167]
 s_waitcnt lgkmcnt(7)
 mf v[224:227], a[104:107], a[32:35], v[224:227]
 s_waitcnt lgkmcnt(4)
 s_add_u32 m0, s78, 0x1c00
 mf v[228:231], a[108:111], a[32:35], v[228:231]
 ds_read_b64_tr_b16 a[32:33], v15 offset:49152
 ds_read_b64_tr_b16 a[34:35], v15 offset:51200
 mf v[40:43], a[80:83], a[36:39], v[40:43]
 buffer_load_dwordx4 v27, s[44:47], s63 offen lds
 mf v[44:47], a[84:87], a[36:39], v[44:47]
 mf v[104:107], a[88:91], a[36:39], v[104:107]
 s_add_u32 m0, s78, 0x2000
 mf v[108:111], a[92:95], a[36:39], v[108:111]
 buffer_load_dwordx4 v28, s[44:47], s63 offen lds
 mf v[168:171], a[96:99], a[36:39], v[168:171]
 v_cvt_pk_bf16_f32 v32, v32, v33
 v_cvt_pk_bf16_f32 v33, v34, v35
 mf v[172:175], a[100:103], a[36:39], v[172:175]
 s_add_u32 m0, s78, 0x2400
 v_cvt_pk_bf16_f32 v34, v36, v37
 v_cvt_pk_bf16_f32 v35, v38, v39
 mf v[232:235], a[104:107], a[36:39], v[232:235]
 buffer_load_dwordx4 v29, s[44:47], s63 offen lds
 mf v[236:239], a[108:111], a[36:39], v[236:239]
 s_waitcnt lgkmcnt(4)
 ds_read_b64_tr_b16 a[36:37], v16 offset:49152
 ds_read_b64_tr_b16 a[38:39], v16 offset:51200
 mf v[48:51], a[80:83], a[40:43], v[48:51]
 v_cvt_pk_bf16_f32 v96, v96, v97
 v_cvt_pk_bf16_f32 v97, v98, v99
 mf v[52:55], a[84:87], a[40:43], v[52:55]
 v_cvt_pk_bf16_f32 v98, v100, v101
 v_cvt_pk_bf16_f32 v99, v102, v103
 mf v[112:115], a[88:91], a[40:43], v[112:115]
 v_cvt_pk_bf16_f32 v160, v160, v161
 v_cvt_pk_bf16_f32 v161, v162, v163
 mf v[116:119], a[92:95], a[40:43], v[116:119]
 v_cvt_pk_bf16_f32 v40, v40, v41
 v_cvt_pk_bf16_f32 v41, v42, v43
 mf v[176:179], a[96:99], a[40:43], v[176:179]
 v_cvt_pk_bf16_f32 v42, v44, v45
 v_cvt_pk_bf16_f32 v43, v46, v47
 mf v[180:183], a[100:103], a[40:43], v[180:183]
 v_cvt_pk_bf16_f32 v104, v104, v105
 v_cvt_pk_bf16_f32 v105, v106, v107
 mf v[240:243], a[104:107], a[40:43], v[240:243]
 v_cvt_pk_bf16_f32 v106, v108, v109
 v_cvt_pk_bf16_f32 v107, v110, v111
 mf v[244:247], a[108:111], a[40:43], v[244:247]
 s_waitcnt lgkmcnt(4)
 ds_read_b64_tr_b16 a[40:41], v17 offset:49152
 ds_read_b64_tr_b16 a[42:43], v17 offset:51200
 mf v[56:59], a[80:83], a[44:47], v[56:59]
 v_cvt_pk_bf16_f32 v162, v164, v165
 v_cvt_pk_bf16_f32 v163, v166, v167
 mf v[60:63], a[84:87], a[44:47], v[60:63]
 v_cvt_pk_bf16_f32 v168, v168, v169
 v_cvt_pk_bf16_f32 v169, v170, v171
 mf v[120:123], a[88:91], a[44:47], v[120:123]
 v_cvt_pk_bf16_f32 v170, v172, v173
 v_cvt_pk_bf16_f32 v171, v174, v175
 mf v[124:127], a[92:95], a[44:47], v[124:127]
 v_cvt_pk_bf16_f32 v48, v48, v49
 v_cvt_pk_bf16_f32 v49, v50, v51
 mf v[184:187], a[96:99], a[44:47], v[184:187]
 v_cvt_pk_bf16_f32 v50, v52, v53
 v_cvt_pk_bf16_f32 v51, v54, v55
 mf v[188:191], a[100:103], a[44:47], v[188:191]
 v_cvt_pk_bf16_f32 v112, v112, v113
 v_cvt_pk_bf16_f32 v113, v114, v115
 mf v[248:251], a[104:107], a[44:47], v[248:251]
 v_cvt_pk_bf16_f32 v114, v116, v117
 v_cvt_pk_bf16_f32 v115, v118, v119
 mf v[252:255], a[108:111], a[44:47], v[252:255]
 s_waitcnt lgkmcnt(4)
 ds_read_b64_tr_b16 a[44:45], v18 offset:49152
 ds_read_b64_tr_b16 a[46:47], v18 offset:51200
 mf v[64:67], a[80:83], a[32:35], v[64:67]
 v_cvt_pk_bf16_f32 v176, v176, v177
 v_cvt_pk_bf16_f32 v177, v178, v179
 mf v[68:71], a[84:87], a[32:35], v[68:71]
 v_cvt_pk_bf16_f32 v178, v180, v181
 v_cvt_pk_bf16_f32 v179, v182, v183
 mf v[128:131], a[88:91], a[32:35], v[128:131]
 v_cvt_pk_bf16_f32 v224, v224, v225
 v_cvt_pk_bf16_f32 v225, v226, v227
 mf v[132:135], a[92:95], a[32:35], v[132:135]
 v_cvt_pk_bf16_f32 v56, v56, v57
 v_cvt_pk_bf16_f32 v57, v58, v59
 mf v[192:195], a[96:99], a[32:35], v[192:195]
 v_cvt_pk_bf16_f32 v58, v60, v61
 v_cvt_pk_bf16_f32 v59, v62, v63
 mf v[196:199], a[100:103], a[32:35], v[196:199]
 v_cvt_pk_bf16_f32 v120, v120, v121
 v_cvt_pk_bf16_f32 v121, v122, v123
 mf a[0:3], a[104:107], a[32:35], a[0:3]
 v_cvt_pk_bf16_f32 v122, v124, v125
 v_cvt_pk_bf16_f32 v123, v126, v127
 mf a[4:7], a[108:111], a[32:35], a[4:7]
 s_waitcnt lgkmcnt(4)
 v_cvt_pk_bf16_f32 v184, v184, v185
 v_cvt_pk_bf16_f32 v185, v186, v187
 mf v[72:75], a[80:83], a[36:39], v[72:75]
 v_cvt_pk_bf16_f32 v186, v188, v189
 v_cvt_pk_bf16_f32 v187, v190, v191
 mf v[76:79], a[84:87], a[36:39], v[76:79]
 v_cvt_pk_bf16_f32 v226, v228, v229
 v_cvt_pk_bf16_f32 v227, v230, v231
 mf v[136:139], a[88:91], a[36:39], v[136:139]
 v_cvt_pk_bf16_f32 v232, v232, v233
 v_cvt_pk_bf16_f32 v233, v234, v235
 mf v[140:143], a[92:95], a[36:39], v[140:143]
 v_cvt_pk_bf16_f32 v64, v64, v65
 v_cvt_pk_bf16_f32 v65, v66, v67
 mf v[200:203], a[96:99], a[36:39], v[200:203]
 v_cvt_pk_bf16_f32 v66, v68, v69
 v_cvt_pk_bf16_f32 v67, v70, v71
 mf v[204:207], a[100:103], a[36:39], v[204:207]
 v_cvt_pk_bf16_f32 v128, v128, v129
 v_cvt_pk_bf16_f32 v129, v130, v131
 mf a[8:11], a[104:107], a[36:39], a[8:11]
 v_cvt_pk_bf16_f32 v130, v132, v133
 v_cvt_pk_bf16_f32 v131, v134, v135
 mf a[12:15], a[108:111], a[36:39], a[12:15]
 s_waitcnt lgkmcnt(2)
 v_cvt_pk_bf16_f32 v192, v192, v193
 v_cvt_pk_bf16_f32 v193, v194, v195
 mf v[80:83], a[80:83], a[40:43], v[80:83]
 v_cvt_pk_bf16_f32 v194, v196, v197
 v_cvt_pk_bf16_f32 v195, v198, v199
 mf v[84:87], a[84:87], a[40:43], v[84:87]
 v_cvt_pk_bf16_f32 v234, v236, v237
 v_cvt_pk_bf16_f32 v235, v238, v239
 mf v[144:147], a[88:91], a[40:43], v[144:147]
 v_cvt_pk_bf16_f32 v240, v240, v241
 v_cvt_pk_bf16_f32 v241, v242, v243
 mf v[148:151], a[92:95], a[40:43], v[148:151]
 v_cvt_pk_bf16_f32 v72, v72, v73
 v_cvt_pk_bf16_f32 v73, v74, v75
 mf v[208:211], a[96:99], a[40:43], v[208:211]
 v_cvt_pk_bf16_f32 v74, v76, v77
 v_cvt_pk_bf16_f32 v75, v78, v79
 mf v[212:215], a[100:103], a[40:43], v[212:215]
 v_cvt_pk_bf16_f32 v136, v136, v137
 v_cvt_pk_bf16_f32 v137, v138, v139
 mf a[16:19], a[104:107], a[40:43], a[16:19]
 v_cvt_pk_bf16_f32 v138, v140, v141
 v_cvt_pk_bf16_f32 v139, v142, v143
 mf a[20:23], a[108:111], a[40:43], a[20:23]
 s_waitcnt lgkmcnt(0)
 v_cvt_pk_bf16_f32 v200, v200, v201
 v_cvt_pk_bf16_f32 v201, v202, v203
 mf v[88:91], a[80:83], a[44:47], v[88:91]
 v_cvt_pk_bf16_f32 v202, v204, v205
 v_cvt_pk_bf16_f32 v203, v206, v207
 mf v[92:95], a[84:87], a[44:47], v[92:95]
 v_cvt_pk_bf16_f32 v242, v244, v245
 v_cvt_pk_bf16_f32 v243, v246, v247
 mf v[152:155], a[88:91], a[44:47], v[152:155]
 v_cvt_pk_bf16_f32 v248, v248, v249
 v_cvt_pk_bf16_f32 v249, v250, v251
 mf v[156:159], a[92:95], a[44:47], v[156:159]
 v_cvt_pk_bf16_f32 v80, v80, v81
 v_cvt_pk_bf16_f32 v81, v82, v83
 mf v[216:219], a[96:99], a[44:47], v[216:219]
 v_cvt_pk_bf16_f32 v82, v84, v85
 v_cvt_pk_bf16_f32 v83, v86, v87
 mf v[220:223], a[100:103], a[44:47], v[220:223]
 v_cvt_pk_bf16_f32 v250, v252, v253
 v_cvt_pk_bf16_f32 v251, v254, v255
 mf a[24:27], a[104:107], a[44:47], a[24:27]
 mf a[28:31], a[108:111], a[44:47], a[28:31]
 s_barrier
 v_accvgpr_read_b32 v8, a0
 v_accvgpr_read_b32 v9, a1
 v_accvgpr_read_b32 v10, a2
 v_accvgpr_read_b32 v11, a3
 v_accvgpr_read_b32 v12, a4
 v_accvgpr_read_b32 v13, a5
 v_accvgpr_read_b32 v14, a6
 v_accvgpr_read_b32 v15, a7
 v_cvt_pk_bf16_f32 v8, v8, v9
 v_cvt_pk_bf16_f32 v9, v10, v11
 v_cvt_pk_bf16_f32 v10, v12, v13
 v_cvt_pk_bf16_f32 v11, v14, v15
 s_add_u32 s62, s73, 0xb000
 buffer_store_dwordx4 v[8:11], v4, s[40:43], s62 offen sc1
 s_nop 1
 v_accvgpr_read_b32 v8, a8
 v_accvgpr_read_b32 v9, a9
 v_accvgpr_read_b32 v10, a10
 v_accvgpr_read_b32 v11, a11
 v_accvgpr_read_b32 v12, a12
 v_accvgpr_read_b32 v13, a13
 v_accvgpr_read_b32 v14, a14
 v_accvgpr_read_b32 v15, a15
 v_cvt_pk_bf16_f32 v8, v8, v9
 v_cvt_pk_bf16_f32 v9, v10, v11
 v_cvt_pk_bf16_f32 v10, v12, v13
 v_cvt_pk_bf16_f32 v11, v14, v15
 s_add_u32 s62, s73, 0xb000
 buffer_store_dwordx4 v[8:11], v4, s[40:43], s62 offen offset:1024 sc1
 s_nop 1
 v_accvgpr_read_b32 v8, a16
 v_accvgpr_read_b32 v9, a17
 v_accvgpr_read_b32 v10, a18
 v_accvgpr_read_b32 v11, a19
 v_accvgpr_read_b32 v12, a20
 v_accvgpr_read_b32 v13, a21
 v_accvgpr_read_b32 v14, a22
 v_accvgpr_read_b32 v15, a23
 v_cvt_pk_bf16_f32 v8, v8, v9
 v_cvt_pk_bf16_f32 v9, v10, v11
 v_cvt_pk_bf16_f32 v10, v12, v13
 v_cvt_pk_bf16_f32 v11, v14, v15
 s_add_u32 s62, s73, 0xb000
 buffer_store_dwordx4 v[8:11], v4, s[40:43], s62 offen offset:2048 sc1
 s_nop 1
 v_accvgpr_read_b32 v8, a24
 v_accvgpr_read_b32 v9, a25
 v_accvgpr_read_b32 v10, a26
 v_accvgpr_read_b32 v11, a27
 v_accvgpr_read_b32 v12, a28
 v_accvgpr_read_b32 v13, a29
 v_accvgpr_read_b32 v14, a30
 v_accvgpr_read_b32 v15, a31
 v_cvt_pk_bf16_f32 v8, v8, v9
 v_cvt_pk_bf16_f32 v9, v10, v11
 v_cvt_pk_bf16_f32 v10, v12, v13
 v_cvt_pk_bf16_f32 v11, v14, v15
 s_add_u32 s62, s73, 0xb000
 buffer_store_dwordx4 v[8:11], v4, s[40:43], s62 offen offset:3072 sc1
 v_cvt_pk_bf16_f32 v88, v88, v89
 v_cvt_pk_bf16_f32 v89, v90, v91
 v_cvt_pk_bf16_f32 v90, v92, v93
 v_cvt_pk_bf16_f32 v91, v94, v95
 v_cvt_pk_bf16_f32 v144, v144, v145
 v_cvt_pk_bf16_f32 v145, v146, v147
 v_cvt_pk_bf16_f32 v146, v148, v149
 v_cvt_pk_bf16_f32 v147, v150, v151
 v_cvt_pk_bf16_f32 v152, v152, v153
 v_cvt_pk_bf16_f32 v153, v154, v155
 v_cvt_pk_bf16_f32 v154, v156, v157
 v_cvt_pk_bf16_f32 v155, v158, v159
 v_cvt_pk_bf16_f32 v208, v208, v209
 v_cvt_pk_bf16_f32 v209, v210, v211
 v_cvt_pk_bf16_f32 v210, v212, v213
 v_cvt_pk_bf16_f32 v211, v214, v215
 v_cvt_pk_bf16_f32 v216, v216, v217
 v_cvt_pk_bf16_f32 v217, v218, v219
 v_cvt_pk_bf16_f32 v218, v220, v221
 v_cvt_pk_bf16_f32 v219, v222, v223
f_q:
 s_nop 1
 v_lshrrev_b32 v16, 2, v3
 v_lshl_add_u32 v16, v2, 3, v16
 v_mul_u32_u24 v16, 0x140, v16
 v_and_b32 v17, 3, v3
 v_lshl_add_u32 v16, v17, 3, v16
 v_and_b32 v17, 1, v2
 s_add_u32 s30, s79, 0
 v_xor_b32 v18, s30, v17
 v_lshl_add_u32 v18, v18, 5, v16
 v_add_u32 v12, 0x14000, v18
 v_add_u32 v10, 0xa000, v18
 v_mov_b32 v8, v18
 s_add_u32 s30, s79, 1
 v_xor_b32 v18, s30, v17
 v_lshl_add_u32 v18, v18, 5, v16
 v_add_u32 v13, 0x14000, v18
 v_add_u32 v11, 0xa000, v18
 v_mov_b32 v9, v18
 s_mov_b32 s32, s8
 s_mov_b32 s33, s9
 s_mov_b32 s34, 0x480000
 s_mov_b32 s35, 0x20000
 v_lshrrev_b32 v16, 4, v1
 s_lshr_b32 s30, s3, 1
 s_lshl_b32 s30, s30, 2
 v_or_b32 v17, s30, v16
 v_bfe_u32 v18, v1, 1, 3
 v_xor_b32 v18, v18, v17
 s_lshl_b32 s30, s3, 2
 v_add_u32 v16, s30, v16
 v_lshlrev_b32 v16, 13, v16
 v_and_b32 v19, 1, v1
 v_lshl_add_u32 v16, v19, 4, v16
 v_lshl_add_u32 v16, v18, 5, v16
 s_lshl_b32 s30, s67, 8
 v_add_u32 v15, s30, v16
 s_lshl_b32 s86, s3, 10
 s_mul_i32 s31, s67, 9
 s_lshr_b32 s31, s31, 1
 s_add_u32 s31, s31, 0x80
 s_lshl_b32 s31, s31, 10
 s_mul_i32 s84, s68, 0x44000
 s_add_u32 s84, s84, s31
 s_mul_i32 s85, s69, 0x44000
 s_add_u32 s85, s85, s31
 s_waitcnt vmcnt(4)
 s_barrier
 ds_read_b64_tr_b16 a[176:177], v8
 ds_read_b64_tr_b16 a[178:179], v8 offset:1280
 ds_read_b64_tr_b16 a[180:181], v8 offset:20480
 ds_read_b64_tr_b16 a[182:183], v8 offset:21760
 ds_read_b64_tr_b16 a[184:185], v9
 ds_read_b64_tr_b16 a[186:187], v9 offset:1280
 ds_read_b64_tr_b16 a[188:189], v9 offset:20480
 ds_read_b64_tr_b16 a[190:191], v9 offset:21760
 s_waitcnt lgkmcnt(6)
 mf v[36:39], a[176:179], a[192:195], 0
 s_mov_b32 s60, 0x90000
 mf v[44:47], a[176:179], a[196:199], 0
 s_add_u32 m0, s78, 0xa000
 mf v[52:55], a[176:179], a[200:203], 0
 buffer_load_dwordx4 v20, s[44:47], s60 offen lds
 mf v[60:63], a[176:179], a[204:207], 0
 s_waitcnt lgkmcnt(4)
 ds_read_b64_tr_b16 a[176:177], v8 offset:64
 ds_read_b64_tr_b16 a[178:179], v8 offset:1344
 mf v[68:71], a[180:183], a[192:195], 0
 mf v[76:79], a[180:183], a[196:199], 0
 s_add_u32 m0, s78, 0xa400
 mf v[84:87], a[180:183], a[200:203], 0
 buffer_load_dwordx4 v21, s[44:47], s60 offen lds
 mf v[92:95], a[180:183], a[204:207], 0
 s_waitcnt lgkmcnt(4)
 ds_read_b64_tr_b16 a[180:181], v8 offset:20544
 ds_read_b64_tr_b16 a[182:183], v8 offset:21824
 mf v[100:103], a[184:187], a[192:195], 0
 mf v[108:111], a[184:187], a[196:199], 0
 mf v[116:119], a[184:187], a[200:203], 0
 s_add_u32 m0, s78, 0xa800
 mf v[124:127], a[184:187], a[204:207], 0
 s_waitcnt lgkmcnt(4)
 ds_read_b64_tr_b16 a[184:185], v9 offset:64
 ds_read_b64_tr_b16 a[186:187], v9 offset:1344
 mf v[132:135], a[188:191], a[192:195], 0
 buffer_load_dwordx4 v22, s[44:47], s60 offen lds
 mf v[140:143], a[188:191], a[196:199], 0
 mf v[148:151], a[188:191], a[200:203], 0
 mf v[156:159], a[188:191], a[204:207], 0
 s_waitcnt lgkmcnt(4)
 s_add_u32 m0, s78, 0xac00
 ds_read_b64_tr_b16 a[188:189], v9 offset:20544
 ds_read_b64_tr_b16 a[190:191], v9 offset:21824
 mf v[164:167], a[176:179], a[192:195], 0
 buffer_load_dwordx4 v23, s[44:47], s60 offen lds
 mf v[172:175], a[176:179], a[196:199], 0
 mf v[180:183], a[176:179], a[200:203], 0
 mf v[188:191], a[176:179], a[204:207], 0
 s_waitcnt lgkmcnt(4)
 ds_read_b64_tr_b16 a[176:177], v8 offset:128
 ds_read_b64_tr_b16 a[178:179], v8 offset:1408
 mf v[196:199], a[180:183], a[192:195], 0
 s_add_u32 m0, s78, 0xb000
 mf v[204:207], a[180:183], a[196:199], 0
 buffer_load_dwordx4 v24, s[44:47], s60 offen lds
 mf v[212:215], a[180:183], a[200:203], 0
 mf v[220:223], a[180:183], a[204:207], 0
 s_waitcnt lgkmcnt(4)
 ds_read_b64_tr_b16 a[180:181], v8 offset:20608
 ds_read_b64_tr_b16 a[182:183], v8 offset:21888
 mf v[228:231], a[184:187], a[192:195], 0
 mf v[236:239], a[184:187], a[196:199], 0
 s_add_u32 m0, s78, 0xb400
 mf v[244:247], a[184:187], a[200:203], 0
 buffer_load_dwordx4 v25, s[44:47], s60 offen lds
 mf v[252:255], a[184:187], a[204:207], 0
 s_waitcnt lgkmcnt(4)
 ds_read_b64_tr_b16 a[184:185], v9 offset:128
 ds_read_b64_tr_b16 a[186:187], v9 offset:1408
 mf a[0:3], a[188:191], a[192:195], 0
 mf a[4:7], a[188:191], a[196:199], 0
 mf a[8:11], a[188:191], a[200:203], 0
 s_add_u32 m0, s78, 0xb800
 mf a[12:15], a[188:191], a[204:207], 0
 s_waitcnt lgkmcnt(4)
 ds_read_b64_tr_b16 a[188:189], v9 offset:20608
 ds_read_b64_tr_b16 a[190:191], v9 offset:21888
 mf a[16:19], a[176:179], a[192:195], 0
 buffer_load_dwordx4 v26, s[44:47], s60 offen lds
 mf a[20:23], a[176:179], a[196:199], 0
 mf a[24:27], a[176:179], a[200:203], 0
 mf a[28:31], a[176:179], a[204:207], 0
 s_waitcnt lgkmcnt(4)
 s_add_u32 m0, s78, 0xbc00
 ds_read_b64_tr_b16 a[176:177], v8 offset:192
 ds_read_b64_tr_b16 a[178:179], v8 offset:1472
 mf a[32:35], a[180:183], a[192:195], 0
 buffer_load_dwordx4 v27, s[44:47], s60 offen lds
 mf a[36:39], a[180:183], a[196:199], 0
 mf a[40:43], a[180:183], a[200:203], 0
 mf a[44:47], a[180:183], a[204:207], 0
 s_waitcnt lgkmcnt(4)
 ds_read_b64_tr_b16 a[180:181], v8 offset:20672
 ds_read_b64_tr_b16 a[182:183], v8 offset:21952
 mf a[48:51], a[184:187], a[192:195], 0
 s_add_u32 m0, s78, 0xc000
 mf a[52:55], a[184:187], a[196:199], 0
 buffer_load_dwordx4 v28, s[44:47], s60 offen lds
 mf a[56:59], a[184:187], a[200:203], 0
 mf a[60:63], a[184:187], a[204:207], 0
 s_waitcnt lgkmcnt(4)
 ds_read_b64_tr_b16 a[184:185], v9 offset:192
 ds_read_b64_tr_b16 a[186:187], v9 offset:1472
 mf a[64:67], a[188:191], a[192:195], 0
 mf a[68:71], a[188:191], a[196:199], 0
 s_add_u32 m0, s78, 0xc400
 mf a[72:75], a[188:191], a[200:203], 0
 buffer_load_dwordx4 v29, s[44:47], s60 offen lds
 mf a[76:79], a[188:191], a[204:207], 0
 s_waitcnt lgkmcnt(4)
 ds_read_b64_tr_b16 a[188:189], v9 offset:20672
 ds_read_b64_tr_b16 a[190:191], v9 offset:21952
 mf a[80:83], a[176:179], a[192:195], 0
 mf a[84:87], a[176:179], a[196:199], 0
 mf a[88:91], a[176:179], a[200:203], 0
 s_mov_b32 s60, 0x120000
 mf a[92:95], a[176:179], a[204:207], 0
 s_waitcnt lgkmcnt(4)
 s_add_u32 m0, s78, 0x14000
 ds_read_b64_tr_b16 a[176:177], v8 offset:256
 ds_read_b64_tr_b16 a[178:179], v8 offset:1536
 mf a[96:99], a[180:183], a[192:195], 0
 buffer_load_dwordx4 v20, s[44:47], s60 offen lds
 mf a[100:103], a[180:183], a[196:199], 0
 mf a[104:107], a[180:183], a[200:203], 0
 mf a[108:111], a[180:183], a[204:207], 0
 s_waitcnt lgkmcnt(4)
 s_add_u32 m0, s78, 0x14400
 ds_read_b64_tr_b16 a[180:181], v8 offset:20736
 ds_read_b64_tr_b16 a[182:183], v8 offset:22016
 mf a[112:115], a[184:187], a[192:195], 0
 buffer_load_dwordx4 v21, s[44:47], s60 offen lds
 mf a[116:119], a[184:187], a[196:199], 0
 mf a[120:123], a[184:187], a[200:203], 0
 mf a[124:127], a[184:187], a[204:207], 0
 s_waitcnt lgkmcnt(4)
 ds_read_b64_tr_b16 a[184:185], v8 offset:10240
 ds_read_b64_tr_b16 a[186:187], v8 offset:11520
 mf a[128:131], a[188:191], a[192:195], 0
 s_add_u32 m0, s78, 0x14800
 mf a[132:135], a[188:191], a[196:199], 0
 buffer_load_dwordx4 v22, s[44:47], s60 offen lds
 mf a[136:139], a[188:191], a[200:203], 0
 mf a[140:143], a[188:191], a[204:207], 0
 s_waitcnt lgkmcnt(4)
 ds_read_b64_tr_b16 a[188:189], v8 offset:30720
 ds_read_b64_tr_b16 a[190:191], v8 offset:32000
 mf a[144:147], a[176:179], a[192:195], 0
 mf a[148:151], a[176:179], a[196:199], 0
 s_add_u32 m0, s78, 0x14c00
 mf a[152:155], a[176:179], a[200:203], 0
 buffer_load_dwordx4 v23, s[44:47], s60 offen lds
 mf a[156:159], a[176:179], a[204:207], 0
 s_waitcnt lgkmcnt(4)
 ds_read_b64_tr_b16 a[176:177], v9 offset:10240
 ds_read_b64_tr_b16 a[178:179], v9 offset:11520
 mf a[160:163], a[180:183], a[192:195], 0
 mf a[164:167], a[180:183], a[196:199], 0
 mf a[168:171], a[180:183], a[200:203], 0
 s_add_u32 m0, s78, 0x15000
 mf a[172:175], a[180:183], a[204:207], 0
 s_waitcnt lgkmcnt(4)
 ds_read_b64_tr_b16 a[180:181], v9 offset:30720
 ds_read_b64_tr_b16 a[182:183], v9 offset:32000
 mf v[36:39], a[184:187], a[208:211], v[36:39]
 buffer_load_dwordx4 v24, s[44:47], s60 offen lds
 mf v[44:47], a[184:187], a[212:215], v[44:47]
 mf v[52:55], a[184:187], a[216:219], v[52:55]
 mf v[60:63], a[184:187], a[220:223], v[60:63]
 s_waitcnt lgkmcnt(4)
 s_add_u32 m0, s78, 0x15400
 ds_read_b64_tr_b16 a[184:185], v8 offset:10304
 ds_read_b64_tr_b16 a[186:187], v8 offset:11584
 mf v[68:71], a[188:191], a[208:211], v[68:71]
 buffer_load_dwordx4 v25, s[44:47], s60 offen lds
 mf v[76:79], a[188:191], a[212:215], v[76:79]
 mf v[84:87], a[188:191], a[216:219], v[84:87]
 mf v[92:95], a[188:191], a[220:223], v[92:95]
 s_waitcnt lgkmcnt(4)
 ds_read_b64_tr_b16 a[188:189], v8 offset:30784
 ds_read_b64_tr_b16 a[190:191], v8 offset:32064
 mf v[100:103], a[176:179], a[208:211], v[100:103]
 s_add_u32 m0, s78, 0x15800
 mf v[108:111], a[176:179], a[212:215], v[108:111]
 buffer_load_dwordx4 v26, s[44:47], s60 offen lds
 mf v[116:119], a[176:179], a[216:219], v[116:119]
 mf v[124:127], a[176:179], a[220:223], v[124:127]
 s_waitcnt lgkmcnt(4)
 ds_read_b64_tr_b16 a[176:177], v9 offset:10304
 ds_read_b64_tr_b16 a[178:179], v9 offset:11584
 mf v[132:135], a[180:183], a[208:211], v[132:135]
 mf v[140:143], a[180:183], a[212:215], v[140:143]
 s_add_u32 m0, s78, 0x15c00
 mf v[148:151], a[180:183], a[216:219], v[148:151]
 buffer_load_dwordx4 v27, s[44:47], s60 offen lds
 mf v[156:159], a[180:183], a[220:223], v[156:159]
 s_waitcnt lgkmcnt(4)
 ds_read_b64_tr_b16 a[180:181], v9 offset:30784
 ds_read_b64_tr_b16 a[182:183], v9 offset:32064
 mf v[164:167], a[184:187], a[208:211], v[164:167]
 mf v[172:175], a[184:187], a[212:215], v[172:175]
 mf v[180:183], a[184:187], a[216:219], v[180:183]
 s_add_u32 m0, s78, 0x16000
 mf v[188:191], a[184:187], a[220:223], v[188:191]
 s_waitcnt lgkmcnt(4)
 ds_read_b64_tr_b16 a[184:185], v8 offset:10368
 ds_read_b64_tr_b16 a[186:187], v8 offset:11648
 mf v[196:199], a[188:191], a[208:211], v[196:199]
 buffer_load_dwordx4 v28, s[44:47], s60 offen lds
 mf v[204:207], a[188:191], a[212:215], v[204:207]
 mf v[212:215], a[188:191], a[216:219], v[212:215]
 mf v[220:223], a[188:191], a[220:223], v[220:223]
 s_waitcnt lgkmcnt(4)
 s_add_u32 m0, s78, 0x16400
 ds_read_b64_tr_b16 a[188:189], v8 offset:30848
 ds_read_b64_tr_b16 a[190:191], v8 offset:32128
 mf v[228:231], a[176:179], a[208:211], v[228:231]
 s_add_u32 s62, s73, 0
 buffer_load_dwordx4 v29, s[44:47], s60 offen lds
 mf v[236:239], a[176:179], a[212:215], v[236:239]
 buffer_store_dwordx4 v[32:35], v4, s[40:43], s62 offen sc1
 mf v[244:247], a[176:179], a[216:219], v[244:247]
 mf v[252:255], a[176:179], a[220:223], v[252:255]
 s_waitcnt lgkmcnt(4)
 ds_read_b64_tr_b16 a[176:177], v9 offset:10368
 ds_read_b64_tr_b16 a[178:179], v9 offset:11648
 mf a[0:3], a[180:183], a[208:211], a[0:3]
 mf a[4:7], a[180:183], a[212:215], a[4:7]
 mf a[8:11], a[180:183], a[216:219], a[8:11]
 mf a[12:15], a[180:183], a[220:223], a[12:15]
 s_waitcnt lgkmcnt(4)
 ds_read_b64_tr_b16 a[180:181], v9 offset:30848
 ds_read_b64_tr_b16 a[182:183], v9 offset:32128
 mf a[16:19], a[184:187], a[208:211], a[16:19]
 mf a[20:23], a[184:187], a[212:215], a[20:23]
 mf a[24:27], a[184:187], a[216:219], a[24:27]
 mf a[28:31], a[184:187], a[220:223], a[28:31]
 s_waitcnt lgkmcnt(4)
 ds_read_b64_tr_b16 a[184:185], v8 offset:10432
 ds_read_b64_tr_b16 a[186:187], v8 offset:11712
 mf a[32:35], a[188:191], a[208:211], a[32:35]
 mf a[36:39], a[188:191], a[212:215], a[36:39]
 s_add_u32 s62, s73, 0
 buffer_store_dwordx4 v[40:43], v4, s[40:43], s62 offen offset:1024 sc1
 mf a[40:43], a[188:191], a[216:219], a[40:43]
 mf a[44:47], a[188:191], a[220:223], a[44:47]
 s_waitcnt lgkmcnt(4)
 ds_read_b64_tr_b16 a[188:189], v8 offset:30912
 ds_read_b64_tr_b16 a[190:191], v8 offset:32192
 mf a[48:51], a[176:179], a[208:211], a[48:51]
 mf a[52:55], a[176:179], a[212:215], a[52:55]
 mf a[56:59], a[176:179], a[216:219], a[56:59]
 mf a[60:63], a[176:179], a[220:223], a[60:63]
 s_waitcnt lgkmcnt(4)
 ds_read_b64_tr_b16 a[176:177], v9 offset:10432
 ds_read_b64_tr_b16 a[178:179], v9 offset:11712
 mf a[64:67], a[180:183], a[208:211], a[64:67]
 mf a[68:71], a[180:183], a[212:215], a[68:71]
 mf a[72:75], a[180:183], a[216:219], a[72:75]
 mf a[76:79], a[180:183], a[220:223], a[76:79]
 s_waitcnt lgkmcnt(4)
 ds_read_b64_tr_b16 a[180:181], v9 offset:30912
 ds_read_b64_tr_b16 a[182:183], v9 offset:32192
 mf a[80:83], a[184:187], a[208:211], a[80:83]
 mf a[84:87], a[184:187], a[212:215], a[84:87]
 mf a[88:91], a[184:187], a[216:219], a[88:91]
 mf a[92:95], a[184:187], a[220:223], a[92:95]
 s_waitcnt lgkmcnt(4)
 ds_read_b64_tr_b16 a[184:185], v8 offset:10496
 ds_read_b64_tr_b16 a[186:187], v8 offset:11776
 mf a[96:99], a[188:191], a[208:211], a[96:99]
 mf a[100:103], a[188:191], a[212:215], a[100:103]
 mf a[104:107], a[188:191], a[216:219], a[104:107]
 mf a[108:111], a[188:191], a[220:223], a[108:111]
 s_waitcnt lgkmcnt(4)
 ds_read_b64_tr_b16 a[188:189], v8 offset:30976
 ds_read_b64_tr_b16 a[190:191], v8 offset:32256
 mf a[112:115], a[176:179], a[208:211], a[112:115]
 mf a[116:119], a[176:179], a[212:215], a[116:119]
 mf a[120:123], a[176:179], a[216:219], a[120:123]
 mf a[124:127], a[176:179], a[220:223], a[124:127]
 s_waitcnt lgkmcnt(4)
 mf a[128:131], a[180:183], a[208:211], a[128:131]
 mf a[132:135], a[180:183], a[212:215], a[132:135]
 s_waitcnt vmcnt(12)
 s_waitcnt lgkmcnt(0)
 s_barrier
 mf a[136:139], a[180:183], a[216:219], a[136:139]
 ds_read_b64_tr_b16 a[176:177], v10
 ds_read_b64_tr_b16 a[178:179], v10 offset:1280
 mf a[140:143], a[180:183], a[220:223], a[140:143]
 ds_read_b64_tr_b16 a[180:181], v10 offset:20480
 ds_read_b64_tr_b16 a[182:183], v10 offset:21760
 mf a[144:147], a[184:187], a[208:211], a[144:147]
 mf a[148:151], a[184:187], a[212:215], a[148:151]
 mf a[152:155], a[184:187], a[216:219], a[152:155]
 mf a[156:159], a[184:187], a[220:223], a[156:159]
 ds_read_b64_tr_b16 a[184:185], v11
 ds_read_b64_tr_b16 a[186:187], v11 offset:1280
 mf a[160:163], a[188:191], a[208:211], a[160:163]
 mf a[164:167], a[188:191], a[212:215], a[164:167]
 mf a[168:171], a[188:191], a[216:219], a[168:171]
 mf a[172:175], a[188:191], a[220:223], a[172:175]
 s_waitcnt lgkmcnt(4)
 ds_read_b64_tr_b16 a[188:189], v11 offset:20480
 ds_read_b64_tr_b16 a[190:191], v11 offset:21760
 mf v[36:39], a[176:179], a[224:227], v[36:39]
 s_add_u32 s61, s81, 0x1000
 buffer_load_dwordx4 a[192:195], v4, s[48:51], s61 offen
 mf v[44:47], a[176:179], a[228:231], v[44:47]
 mf v[52:55], a[176:179], a[232:235], v[52:55]
 s_add_u32 s61, s81, s16
 mf v[60:63], a[176:179], a[236:239], v[60:63]
 s_waitcnt lgkmcnt(4)
 s_add_u32 s61, s61, 0x1000
 ds_read_b64_tr_b16 a[176:177], v10 offset:64
 ds_read_b64_tr_b16 a[178:179], v10 offset:1344
 mf v[68:71], a[180:183], a[224:227], v[68:71]
 buffer_load_dwordx4 a[196:199], v4, s[48:51], s61 offen
 mf v[76:79], a[180:183], a[228:231], v[76:79]
 mf v[84:87], a[180:183], a[232:235], v[84:87]
 s_add_u32 s61, s82, 0x1000
 buffer_load_dwordx4 a[200:203], v4, s[48:51], s61 offen
 mf v[92:95], a[180:183], a[236:239], v[92:95]
 s_waitcnt lgkmcnt(4)
 ds_read_b64_tr_b16 a[180:181], v10 offset:20544
 ds_read_b64_tr_b16 a[182:183], v10 offset:21824
 mf v[100:103], a[184:187], a[224:227], v[100:103]
 s_add_u32 s61, s82, s16
 mf v[108:111], a[184:187], a[228:231], v[108:111]
 s_add_u32 s61, s61, 0x1000
 buffer_load_dwordx4 a[204:207], v4, s[48:51], s61 offen
 mf v[116:119], a[184:187], a[232:235], v[116:119]
 mf v[124:127], a[184:187], a[236:239], v[124:127]
 s_waitcnt lgkmcnt(4)
 s_add_u32 s61, s81, 0x1000
 ds_read_b64_tr_b16 a[184:185], v11 offset:64
 ds_read_b64_tr_b16 a[186:187], v11 offset:1344
 mf v[132:135], a[188:191], a[224:227], v[132:135]
 buffer_load_dwordx4 a[208:211], v4, s[48:51], s61 offen offset:1024
 mf v[140:143], a[188:191], a[228:231], v[140:143]
 mf v[148:151], a[188:191], a[232:235], v[148:151]
 s_add_u32 s61, s81, s16
 mf v[156:159], a[188:191], a[236:239], v[156:159]
 s_waitcnt lgkmcnt(4)
 s_add_u32 s61, s61, 0x1000
 ds_read_b64_tr_b16 a[188:189], v11 offset:20544
 ds_read_b64_tr_b16 a[190:191], v11 offset:21824
 mf v[164:167], a[176:179], a[224:227], v[164:167]
 buffer_load_dwordx4 a[212:215], v4, s[48:51], s61 offen offset:1024
 mf v[172:175], a[176:179], a[228:231], v[172:175]
 mf v[180:183], a[176:179], a[232:235], v[180:183]
 s_add_u32 s61, s82, 0x1000
 buffer_load_dwordx4 a[216:219], v4, s[48:51], s61 offen offset:1024
 mf v[188:191], a[176:179], a[236:239], v[188:191]
 s_waitcnt lgkmcnt(4)
 ds_read_b64_tr_b16 a[176:177], v10 offset:128
 ds_read_b64_tr_b16 a[178:179], v10 offset:1408
 mf v[196:199], a[180:183], a[224:227], v[196:199]
 s_add_u32 s61, s82, s16
 mf v[204:207], a[180:183], a[228:231], v[204:207]
 s_add_u32 s61, s61, 0x1000
 buffer_load_dwordx4 a[220:223], v4, s[48:51], s61 offen offset:1024
 mf v[212:215], a[180:183], a[232:235], v[212:215]
 s_mov_b32 s56, s8
 mf v[220:223], a[180:183], a[236:239], v[220:223]
 s_waitcnt lgkmcnt(4)
 s_mov_b32 s57, s9
 ds_read_b64_tr_b16 a[180:181], v10 offset:20608
 ds_read_b64_tr_b16 a[182:183], v10 offset:21888
 mf v[228:231], a[184:187], a[224:227], v[228:231]
 s_mov_b32 s58, 0x480000
 mf v[236:239], a[184:187], a[228:231], v[236:239]
 s_mov_b32 s59, 0x20000
 v_add_u32 v17, 0, v7
 mf v[244:247], a[184:187], a[232:235], v[244:247]
 buffer_load_dword v16, v17, s[56:59], 0 offen
 mf v[252:255], a[184:187], a[236:239], v[252:255]
 s_waitcnt lgkmcnt(4)
 ds_read_b64_tr_b16 a[184:185], v11 offset:128
 ds_read_b64_tr_b16 a[186:187], v11 offset:1408
 mf a[0:3], a[188:191], a[224:227], a[0:3]
 s_mov_b32 s60, 0x1b0000
 mf a[4:7], a[188:191], a[228:231], a[4:7]
 s_add_u32 m0, s78, 0
 mf a[8:11], a[188:191], a[232:235], a[8:11]
 buffer_load_dwordx4 v20, s[44:47], s60 offen lds
 mf a[12:15], a[188:191], a[236:239], a[12:15]
 s_waitcnt lgkmcnt(4)
 ds_read_b64_tr_b16 a[188:189], v11 offset:20608
 ds_read_b64_tr_b16 a[190:191], v11 offset:21888
 mf a[16:19], a[176:179], a[224:227], a[16:19]
 mf a[20:23], a[176:179], a[228:231], a[20:23]
 s_add_u32 m0, s78, 0x400
 mf a[24:27], a[176:179], a[232:235], a[24:27]
 buffer_load_dwordx4 v21, s[44:47], s60 offen lds
 mf a[28:31], a[176:179], a[236:239], a[28:31]
 s_waitcnt lgkmcnt(4)
 ds_read_b64_tr_b16 a[176:177], v10 offset:192
 ds_read_b64_tr_b16 a[178:179], v10 offset:1472
 mf a[32:35], a[180:183], a[224:227], a[32:35]
 mf a[36:39], a[180:183], a[228:231], a[36:39]
 mf a[40:43], a[180:183], a[232:235], a[40:43]
 s_add_u32 m0, s78, 0x800
 mf a[44:47], a[180:183], a[236:239], a[44:47]
 s_waitcnt lgkmcnt(4)
 ds_read_b64_tr_b16 a[180:181], v10 offset:20672
 ds_read_b64_tr_b16 a[182:183], v10 offset:21952
 mf a[48:51], a[184:187], a[224:227], a[48:51]
 buffer_load_dwordx4 v22, s[44:47], s60 offen lds
 mf a[52:55], a[184:187], a[228:231], a[52:55]
 mf a[56:59], a[184:187], a[232:235], a[56:59]
 mf a[60:63], a[184:187], a[236:239], a[60:63]
 s_waitcnt lgkmcnt(4)
 s_add_u32 m0, s78, 0xc00
 ds_read_b64_tr_b16 a[184:185], v11 offset:192
 ds_read_b64_tr_b16 a[186:187], v11 offset:1472
 mf a[64:67], a[188:191], a[224:227], a[64:67]
 buffer_load_dwordx4 v23, s[44:47], s60 offen lds
 mf a[68:71], a[188:191], a[228:231], a[68:71]
 mf a[72:75], a[188:191], a[232:235], a[72:75]
 mf a[76:79], a[188:191], a[236:239], a[76:79]
 s_waitcnt lgkmcnt(4)
 ds_read_b64_tr_b16 a[188:189], v11 offset:20672
 ds_read_b64_tr_b16 a[190:191], v11 offset:21952
 mf a[80:83], a[176:179], a[224:227], a[80:83]
 s_add_u32 m0, s78, 0x1000
 mf a[84:87], a[176:179], a[228:231], a[84:87]
 buffer_load_dwordx4 v24, s[44:47], s60 offen lds
 mf a[88:91], a[176:179], a[232:235], a[88:91]
 mf a[92:95], a[176:179], a[236:239], a[92:95]
 s_waitcnt lgkmcnt(4)
 ds_read_b64_tr_b16 a[176:177], v10 offset:256
 ds_read_b64_tr_b16 a[178:179], v10 offset:1536
 mf a[96:99], a[180:183], a[224:227], a[96:99]
 mf a[100:103], a[180:183], a[228:231], a[100:103]
 s_add_u32 m0, s78, 0x1400
 mf a[104:107], a[180:183], a[232:235], a[104:107]
 buffer_load_dwordx4 v25, s[44:47], s60 offen lds
 mf a[108:111], a[180:183], a[236:239], a[108:111]
 s_waitcnt lgkmcnt(4)
 ds_read_b64_tr_b16 a[180:181], v10 offset:20736
 ds_read_b64_tr_b16 a[182:183], v10 offset:22016
 mf a[112:115], a[184:187], a[224:227], a[112:115]
 mf a[116:119], a[184:187], a[228:231], a[116:119]
 mf a[120:123], a[184:187], a[232:235], a[120:123]
 s_add_u32 m0, s78, 0x1800
 mf a[124:127], a[184:187], a[236:239], a[124:127]
 s_waitcnt lgkmcnt(4)
 ds_read_b64_tr_b16 a[184:185], v10 offset:10240
 ds_read_b64_tr_b16 a[186:187], v10 offset:11520
 mf a[128:131], a[188:191], a[224:227], a[128:131]
 buffer_load_dwordx4 v26, s[44:47], s60 offen lds
 mf a[132:135], a[188:191], a[228:231], a[132:135]
 mf a[136:139], a[188:191], a[232:235], a[136:139]
 mf a[140:143], a[188:191], a[236:239], a[140:143]
 s_waitcnt lgkmcnt(4)
 s_add_u32 m0, s78, 0x1c00
 ds_read_b64_tr_b16 a[188:189], v10 offset:30720
 ds_read_b64_tr_b16 a[190:191], v10 offset:32000
 mf a[144:147], a[176:179], a[224:227], a[144:147]
 buffer_load_dwordx4 v27, s[44:47], s60 offen lds
 mf a[148:151], a[176:179], a[228:231], a[148:151]
 mf a[152:155], a[176:179], a[232:235], a[152:155]
 mf a[156:159], a[176:179], a[236:239], a[156:159]
 s_waitcnt lgkmcnt(4)
 ds_read_b64_tr_b16 a[176:177], v11 offset:10240
 ds_read_b64_tr_b16 a[178:179], v11 offset:11520
 mf a[160:163], a[180:183], a[224:227], a[160:163]
 s_add_u32 m0, s78, 0x2000
 mf a[164:167], a[180:183], a[228:231], a[164:167]
 buffer_load_dwordx4 v28, s[44:47], s60 offen lds
 mf a[168:171], a[180:183], a[232:235], a[168:171]
 mf a[172:175], a[180:183], a[236:239], a[172:175]
 s_waitcnt lgkmcnt(4)
 ds_read_b64_tr_b16 a[180:181], v11 offset:30720
 ds_read_b64_tr_b16 a[182:183], v11 offset:32000
 mf v[36:39], a[184:187], a[240:243], v[36:39]
 mf v[44:47], a[184:187], a[244:247], v[44:47]
 s_add_u32 m0, s78, 0x2400
 mf v[52:55], a[184:187], a[248:251], v[52:55]
 buffer_load_dwordx4 v29, s[44:47], s60 offen lds
 mf v[60:63], a[184:187], a[252:255], v[60:63]
 s_waitcnt lgkmcnt(4)
 ds_read_b64_tr_b16 a[184:185], v10 offset:10304
 ds_read_b64_tr_b16 a[186:187], v10 offset:11584
 mf v[68:71], a[188:191], a[240:243], v[68:71]
 mf v[76:79], a[188:191], a[244:247], v[76:79]
 mf v[84:87], a[188:191], a[248:251], v[84:87]
 mf v[92:95], a[188:191], a[252:255], v[92:95]
 s_waitcnt lgkmcnt(4)
 ds_read_b64_tr_b16 a[188:189], v10 offset:30784
 ds_read_b64_tr_b16 a[190:191], v10 offset:32064
 mf v[100:103], a[176:179], a[240:243], v[100:103]
 mf v[108:111], a[176:179], a[244:247], v[108:111]
 mf v[116:119], a[176:179], a[248:251], v[116:119]
 mf v[124:127], a[176:179], a[252:255], v[124:127]
 s_waitcnt lgkmcnt(4)
 ds_read_b64_tr_b16 a[176:177], v11 offset:10304
 ds_read_b64_tr_b16 a[178:179], v11 offset:11584
 mf v[132:135], a[180:183], a[240:243], v[132:135]
 mf v[140:143], a[180:183], a[244:247], v[140:143]
 mf v[148:151], a[180:183], a[248:251], v[148:151]
 mf v[156:159], a[180:183], a[252:255], v[156:159]
 s_waitcnt lgkmcnt(4)
 ds_read_b64_tr_b16 a[180:181], v11 offset:30784
 ds_read_b64_tr_b16 a[182:183], v11 offset:32064
 mf v[164:167], a[184:187], a[240:243], v[164:167]
 mf v[172:175], a[184:187], a[244:247], v[172:175]
 mf v[180:183], a[184:187], a[248:251], v[180:183]
 mf v[188:191], a[184:187], a[252:255], v[188:191]
 s_waitcnt lgkmcnt(4)
 ds_read_b64_tr_b16 a[184:185], v10 offset:10368
 ds_read_b64_tr_b16 a[186:187], v10 offset:11648
 mf v[196:199], a[188:191], a[240:243], v[196:199]
 mf v[204:207], a[188:191], a[244:247], v[204:207]
 mf v[212:215], a[188:191], a[248:251], v[212:215]
 mf v[220:223], a[188:191], a[252:255], v[220:223]
 s_waitcnt lgkmcnt(4)
 ds_read_b64_tr_b16 a[188:189], v10 offset:30848
 ds_read_b64_tr_b16 a[190:191], v10 offset:32128
 mf v[228:231], a[176:179], a[240:243], v[228:231]
 s_add_u32 s62, s73, 0
 buffer_store_dwordx4 v[48:51], v4, s[40:43], s62 offen offset:2048 sc1
 mf v[236:239], a[176:179], a[244:247], v[236:239]
 mf v[244:247], a[176:179], a[248:251], v[244:247]
 mf v[252:255], a[176:179], a[252:255], v[252:255]
 s_waitcnt lgkmcnt(4)
 ds_read_b64_tr_b16 a[176:177], v11 offset:10368
 ds_read_b64_tr_b16 a[178:179], v11 offset:11648
 mf a[0:3], a[180:183], a[240:243], a[0:3]
 mf a[4:7], a[180:183], a[244:247], a[4:7]
 mf a[8:11], a[180:183], a[248:251], a[8:11]
 mf a[12:15], a[180:183], a[252:255], a[12:15]
 s_waitcnt lgkmcnt(4)
 ds_read_b64_tr_b16 a[180:181], v11 offset:30848
 ds_read_b64_tr_b16 a[182:183], v11 offset:32128
 mf a[16:19], a[184:187], a[240:243], a[16:19]
 mf a[20:23], a[184:187], a[244:247], a[20:23]
 mf a[24:27], a[184:187], a[248:251], a[24:27]
 mf a[28:31], a[184:187], a[252:255], a[28:31]
 s_waitcnt lgkmcnt(4)
 ds_read_b64_tr_b16 a[184:185], v10 offset:10432
 ds_read_b64_tr_b16 a[186:187], v10 offset:11712
 mf a[32:35], a[188:191], a[240:243], a[32:35]
 s_add_u32 s62, s73, 0
 buffer_store_dwordx4 v[56:59], v4, s[40:43], s62 offen offset:3072 sc1
 mf a[36:39], a[188:191], a[244:247], a[36:39]
 mf a[40:43], a[188:191], a[248:251], a[40:43]
 mf a[44:47], a[188:191], a[252:255], a[44:47]
 s_waitcnt lgkmcnt(4)
 ds_read_b64_tr_b16 a[188:189], v10 offset:30912
 ds_read_b64_tr_b16 a[190:191], v10 offset:32192
 mf a[48:51], a[176:179], a[240:243], a[48:51]
 mf a[52:55], a[176:179], a[244:247], a[52:55]
 mf a[56:59], a[176:179], a[248:251], a[56:59]
 mf a[60:63], a[176:179], a[252:255], a[60:63]
 s_waitcnt lgkmcnt(4)
 ds_read_b64_tr_b16 a[176:177], v11 offset:10432
 ds_read_b64_tr_b16 a[178:179], v11 offset:11712
 mf a[64:67], a[180:183], a[240:243], a[64:67]
 mf a[68:71], a[180:183], a[244:247], a[68:71]
 mf a[72:75], a[180:183], a[248:251], a[72:75]
 mf a[76:79], a[180:183], a[252:255], a[76:79]
 s_waitcnt lgkmcnt(4)
 ds_read_b64_tr_b16 a[180:181], v11 offset:30912
 ds_read_b64_tr_b16 a[182:183], v11 offset:32192
 mf a[80:83], a[184:187], a[240:243], a[80:83]
 s_add_u32 s62, s73, 0x1000
 buffer_store_dwordx4 v[64:67], v4, s[40:43], s62 offen sc1
 mf a[84:87], a[184:187], a[244:247], a[84:87]
 mf a[88:91], a[184:187], a[248:251], a[88:91]
 mf a[92:95], a[184:187], a[252:255], a[92:95]
 s_waitcnt lgkmcnt(4)
 ds_read_b64_tr_b16 a[184:185], v10 offset:10496
 ds_read_b64_tr_b16 a[186:187], v10 offset:11776
 mf a[96:99], a[188:191], a[240:243], a[96:99]
 mf a[100:103], a[188:191], a[244:247], a[100:103]
 mf a[104:107], a[188:191], a[248:251], a[104:107]
 mf a[108:111], a[188:191], a[252:255], a[108:111]
 s_waitcnt lgkmcnt(4)
 ds_read_b64_tr_b16 a[188:189], v10 offset:30976
 ds_read_b64_tr_b16 a[190:191], v10 offset:32256
 mf a[112:115], a[176:179], a[240:243], a[112:115]
 mf a[116:119], a[176:179], a[244:247], a[116:119]
 mf a[120:123], a[176:179], a[248:251], a[120:123]
 mf a[124:127], a[176:179], a[252:255], a[124:127]
 s_waitcnt lgkmcnt(4)
 mf a[128:131], a[180:183], a[240:243], a[128:131]
 mf a[132:135], a[180:183], a[244:247], a[132:135]
 s_waitcnt vmcnt(24)
 s_waitcnt lgkmcnt(0)
 s_barrier
 mf a[136:139], a[180:183], a[248:251], a[136:139]
 ds_read_b64_tr_b16 a[176:177], v12
 ds_read_b64_tr_b16 a[178:179], v12 offset:1280
 mf a[140:143], a[180:183], a[252:255], a[140:143]
 ds_read_b64_tr_b16 a[180:181], v12 offset:20480
 ds_read_b64_tr_b16 a[182:183], v12 offset:21760
 mf a[144:147], a[184:187], a[240:243], a[144:147]
 mf a[148:151], a[184:187], a[244:247], a[148:151]
 mf a[152:155], a[184:187], a[248:251], a[152:155]
 mf a[156:159], a[184:187], a[252:255], a[156:159]
 ds_read_b64_tr_b16 a[184:185], v13
 ds_read_b64_tr_b16 a[186:187], v13 offset:1280
 mf a[160:163], a[188:191], a[240:243], a[160:163]
 mf a[164:167], a[188:191], a[244:247], a[164:167]
 mf a[168:171], a[188:191], a[248:251], a[168:171]
 mf a[172:175], a[188:191], a[252:255], a[172:175]
 s_waitcnt vmcnt(21) lgkmcnt(4)
 ds_read_b64_tr_b16 a[188:189], v13 offset:20480
 ds_read_b64_tr_b16 a[190:191], v13 offset:21760
 mf v[36:39], a[176:179], a[192:195], v[36:39]
 s_waitcnt vmcnt(20)
 s_add_u32 s61, s81, 0x1800
 buffer_load_dwordx4 a[224:227], v4, s[48:51], s61 offen
 mf v[44:47], a[176:179], a[196:199], v[44:47]
 s_waitcnt vmcnt(20)
 mf v[52:55], a[176:179], a[200:203], v[52:55]
 s_waitcnt vmcnt(19)
 s_add_u32 s61, s81, s16
 mf v[60:63], a[176:179], a[204:207], v[60:63]
 s_waitcnt lgkmcnt(4)
 s_add_u32 s61, s61, 0x1800
 ds_read_b64_tr_b16 a[176:177], v12 offset:64
 ds_read_b64_tr_b16 a[178:179], v12 offset:1344
 mf v[68:71], a[180:183], a[192:195], v[68:71]
 buffer_load_dwordx4 a[228:231], v4, s[48:51], s61 offen
 mf v[76:79], a[180:183], a[196:199], v[76:79]
 mf v[84:87], a[180:183], a[200:203], v[84:87]
 s_add_u32 s61, s82, 0x1800
 buffer_load_dwordx4 a[232:235], v4, s[48:51], s61 offen
 mf v[92:95], a[180:183], a[204:207], v[92:95]
 s_waitcnt lgkmcnt(4)
 ds_read_b64_tr_b16 a[180:181], v12 offset:20544
 ds_read_b64_tr_b16 a[182:183], v12 offset:21824
 mf v[100:103], a[184:187], a[192:195], v[100:103]
 s_add_u32 s61, s82, s16
 mf v[108:111], a[184:187], a[196:199], v[108:111]
 s_add_u32 s61, s61, 0x1800
 buffer_load_dwordx4 a[236:239], v4, s[48:51], s61 offen
 mf v[116:119], a[184:187], a[200:203], v[116:119]
 mf v[124:127], a[184:187], a[204:207], v[124:127]
 s_waitcnt lgkmcnt(4)
 s_add_u32 s61, s81, 0x1800
 ds_read_b64_tr_b16 a[184:185], v13 offset:64
 ds_read_b64_tr_b16 a[186:187], v13 offset:1344
 mf v[132:135], a[188:191], a[192:195], v[132:135]
 buffer_load_dwordx4 a[240:243], v4, s[48:51], s61 offen offset:1024
 mf v[140:143], a[188:191], a[196:199], v[140:143]
 mf v[148:151], a[188:191], a[200:203], v[148:151]
 s_add_u32 s61, s81, s16
 mf v[156:159], a[188:191], a[204:207], v[156:159]
 s_waitcnt lgkmcnt(4)
 s_add_u32 s61, s61, 0x1800
 ds_read_b64_tr_b16 a[188:189], v13 offset:20544
 ds_read_b64_tr_b16 a[190:191], v13 offset:21824
 mf v[164:167], a[176:179], a[192:195], v[164:167]
 buffer_load_dwordx4 a[244:247], v4, s[48:51], s61 offen offset:1024
 mf v[172:175], a[176:179], a[196:199], v[172:175]
 mf v[180:183], a[176:179], a[200:203], v[180:183]
 s_add_u32 s61, s82, 0x1800
 buffer_load_dwordx4 a[248:251], v4, s[48:51], s61 offen offset:1024
 mf v[188:191], a[176:179], a[204:207], v[188:191]
 s_waitcnt lgkmcnt(4)
 ds_read_b64_tr_b16 a[176:177], v12 offset:128
 ds_read_b64_tr_b16 a[178:179], v12 offset:1408
 mf v[196:199], a[180:183], a[192:195], v[196:199]
 s_add_u32 s61, s82, s16
 mf v[204:207], a[180:183], a[196:199], v[204:207]
 s_add_u32 s61, s61, 0x1800
 buffer_load_dwordx4 a[252:255], v4, s[48:51], s61 offen offset:1024
 mf v[212:215], a[180:183], a[200:203], v[212:215]
 s_mov_b32 s56, s8
 mf v[220:223], a[180:183], a[204:207], v[220:223]
 s_waitcnt lgkmcnt(4)
 s_mov_b32 s57, s9
 ds_read_b64_tr_b16 a[180:181], v12 offset:20608
 ds_read_b64_tr_b16 a[182:183], v12 offset:21888
 mf v[228:231], a[184:187], a[192:195], v[228:231]
 s_mov_b32 s58, 0x480000
 mf v[236:239], a[184:187], a[196:199], v[236:239]
 s_mov_b32 s59, 0x20000
 v_add_u32 v17, 0x100000, v7
 mf v[244:247], a[184:187], a[200:203], v[244:247]
 buffer_load_dword v16, v17, s[56:59], 0 offen
 mf v[252:255], a[184:187], a[204:207], v[252:255]
 s_waitcnt lgkmcnt(4)
 ds_read_b64_tr_b16 a[184:185], v13 offset:128
 ds_read_b64_tr_b16 a[186:187], v13 offset:1408
 mf a[0:3], a[188:191], a[192:195], a[0:3]
 s_mov_b32 s60, 0x240000
 mf a[4:7], a[188:191], a[196:199], a[4:7]
 s_add_u32 m0, s78, 0xa000
 mf a[8:11], a[188:191], a[200:203], a[8:11]
 buffer_load_dwordx4 v20, s[44:47], s60 offen lds
 mf a[12:15], a[188:191], a[204:207], a[12:15]
 s_waitcnt lgkmcnt(4)
 ds_read_b64_tr_b16 a[188:189], v13 offset:20608
 ds_read_b64_tr_b16 a[190:191], v13 offset:21888
 mf a[16:19], a[176:179], a[192:195], a[16:19]
 mf a[20:23], a[176:179], a[196:199], a[20:23]
 s_add_u32 m0, s78, 0xa400
 mf a[24:27], a[176:179], a[200:203], a[24:27]
 buffer_load_dwordx4 v21, s[44:47], s60 offen lds
 mf a[28:31], a[176:179], a[204:207], a[28:31]
 s_waitcnt lgkmcnt(4)
 ds_read_b64_tr_b16 a[176:177], v12 offset:192
 ds_read_b64_tr_b16 a[178:179], v12 offset:1472
 mf a[32:35], a[180:183], a[192:195], a[32:35]
 mf a[36:39], a[180:183], a[196:199], a[36:39]
 mf a[40:43], a[180:183], a[200:203], a[40:43]
 s_add_u32 m0, s78, 0xa800
 mf a[44:47], a[180:183], a[204:207], a[44:47]
 s_waitcnt lgkmcnt(4)
 ds_read_b64_tr_b16 a[180:181], v12 offset:20672
 ds_read_b64_tr_b16 a[182:183], v12 offset:21952
 mf a[48:51], a[184:187], a[192:195], a[48:51]
 buffer_load_dwordx4 v22, s[44:47], s60 offen lds
 mf a[52:55], a[184:187], a[196:199], a[52:55]
 mf a[56:59], a[184:187], a[200:203], a[56:59]
 mf a[60:63], a[184:187], a[204:207], a[60:63]
 s_waitcnt lgkmcnt(4)
 s_add_u32 m0, s78, 0xac00
 ds_read_b64_tr_b16 a[184:185], v13 offset:192
 ds_read_b64_tr_b16 a[186:187], v13 offset:1472
 mf a[64:67], a[188:191], a[192:195], a[64:67]
 buffer_load_dwordx4 v23, s[44:47], s60 offen lds
 mf a[68:71], a[188:191], a[196:199], a[68:71]
 mf a[72:75], a[188:191], a[200:203], a[72:75]
 mf a[76:79], a[188:191], a[204:207], a[76:79]
 s_waitcnt lgkmcnt(4)
 ds_read_b64_tr_b16 a[188:189], v13 offset:20672
 ds_read_b64_tr_b16 a[190:191], v13 offset:21952
 mf a[80:83], a[176:179], a[192:195], a[80:83]
 s_add_u32 m0, s78, 0xb000
 mf a[84:87], a[176:179], a[196:199], a[84:87]
 buffer_load_dwordx4 v24, s[44:47], s60 offen lds
 mf a[88:91], a[176:179], a[200:203], a[88:91]
 mf a[92:95], a[176:179], a[204:207], a[92:95]
 s_waitcnt lgkmcnt(4)
 ds_read_b64_tr_b16 a[176:177], v12 offset:256
 ds_read_b64_tr_b16 a[178:179], v12 offset:1536
 mf a[96:99], a[180:183], a[192:195], a[96:99]
 mf a[100:103], a[180:183], a[196:199], a[100:103]
 s_add_u32 m0, s78, 0xb400
 mf a[104:107], a[180:183], a[200:203], a[104:107]
 buffer_load_dwordx4 v25, s[44:47], s60 offen lds
 mf a[108:111], a[180:183], a[204:207], a[108:111]
 s_waitcnt lgkmcnt(4)
 ds_read_b64_tr_b16 a[180:181], v12 offset:20736
 ds_read_b64_tr_b16 a[182:183], v12 offset:22016
 mf a[112:115], a[184:187], a[192:195], a[112:115]
 mf a[116:119], a[184:187], a[196:199], a[116:119]
 mf a[120:123], a[184:187], a[200:203], a[120:123]
 s_add_u32 m0, s78, 0xb800
 mf a[124:127], a[184:187], a[204:207], a[124:127]
 s_waitcnt lgkmcnt(4)
 ds_read_b64_tr_b16 a[184:185], v12 offset:10240
 ds_read_b64_tr_b16 a[186:187], v12 offset:11520
 mf a[128:131], a[188:191], a[192:195], a[128:131]
 buffer_load_dwordx4 v26, s[44:47], s60 offen lds
 mf a[132:135], a[188:191], a[196:199], a[132:135]
 mf a[136:139], a[188:191], a[200:203], a[136:139]
 mf a[140:143], a[188:191], a[204:207], a[140:143]
 s_waitcnt lgkmcnt(4)
 s_add_u32 m0, s78, 0xbc00
 ds_read_b64_tr_b16 a[188:189], v12 offset:30720
 ds_read_b64_tr_b16 a[190:191], v12 offset:32000
 mf a[144:147], a[176:179], a[192:195], a[144:147]
 buffer_load_dwordx4 v27, s[44:47], s60 offen lds
 mf a[148:151], a[176:179], a[196:199], a[148:151]
 mf a[152:155], a[176:179], a[200:203], a[152:155]
 mf a[156:159], a[176:179], a[204:207], a[156:159]
 s_waitcnt lgkmcnt(4)
 ds_read_b64_tr_b16 a[176:177], v13 offset:10240
 ds_read_b64_tr_b16 a[178:179], v13 offset:11520
 mf a[160:163], a[180:183], a[192:195], a[160:163]
 s_add_u32 m0, s78, 0xc000
 mf a[164:167], a[180:183], a[196:199], a[164:167]
 buffer_load_dwordx4 v28, s[44:47], s60 offen lds
 mf a[168:171], a[180:183], a[200:203], a[168:171]
 mf a[172:175], a[180:183], a[204:207], a[172:175]
 s_waitcnt vmcnt(35) lgkmcnt(4)
 ds_read_b64_tr_b16 a[180:181], v13 offset:30720
 ds_read_b64_tr_b16 a[182:183], v13 offset:32000
 mf v[36:39], a[184:187], a[208:211], v[36:39]
 s_waitcnt vmcnt(34)
 mf v[44:47], a[184:187], a[212:215], v[44:47]
 s_waitcnt vmcnt(33)
 s_add_u32 m0, s78, 0xc400
 mf v[52:55], a[184:187], a[216:219], v[52:55]
 s_waitcnt vmcnt(32)
 buffer_load_dwordx4 v29, s[44:47], s60 offen lds
 mf v[60:63], a[184:187], a[220:223], v[60:63]
 s_waitcnt lgkmcnt(4)
 ds_read_b64_tr_b16 a[184:185], v12 offset:10304
 ds_read_b64_tr_b16 a[186:187], v12 offset:11584
 mf v[68:71], a[188:191], a[208:211], v[68:71]
 mf v[76:79], a[188:191], a[212:215], v[76:79]
 mf v[84:87], a[188:191], a[216:219], v[84:87]
 mf v[92:95], a[188:191], a[220:223], v[92:95]
 s_waitcnt lgkmcnt(4)
 ds_read_b64_tr_b16 a[188:189], v12 offset:30784
 ds_read_b64_tr_b16 a[190:191], v12 offset:32064
 mf v[100:103], a[176:179], a[208:211], v[100:103]
 mf v[108:111], a[176:179], a[212:215], v[108:111]
 mf v[116:119], a[176:179], a[216:219], v[116:119]
 mf v[124:127], a[176:179], a[220:223], v[124:127]
 s_waitcnt lgkmcnt(4)
 ds_read_b64_tr_b16 a[176:177], v13 offset:10304
 ds_read_b64_tr_b16 a[178:179], v13 offset:11584
 mf v[132:135], a[180:183], a[208:211], v[132:135]
 mf v[140:143], a[180:183], a[212:215], v[140:143]
 mf v[148:151], a[180:183], a[216:219], v[148:151]
 mf v[156:159], a[180:183], a[220:223], v[156:159]
 s_waitcnt lgkmcnt(4)
 ds_read_b64_tr_b16 a[180:181], v13 offset:30784
 ds_read_b64_tr_b16 a[182:183], v13 offset:32064
 mf v[164:167], a[184:187], a[208:211], v[164:167]
 mf v[172:175], a[184:187], a[212:215], v[172:175]
 mf v[180:183], a[184:187], a[216:219], v[180:183]
 mf v[188:191], a[184:187], a[220:223], v[188:191]
 s_waitcnt lgkmcnt(4)
 ds_read_b64_tr_b16 a[184:185], v12 offset:10368
 ds_read_b64_tr_b16 a[186:187], v12 offset:11648
 mf v[196:199], a[188:191], a[208:211], v[196:199]
 mf v[204:207], a[188:191], a[212:215], v[204:207]
 mf v[212:215], a[188:191], a[216:219], v[212:215]
 mf v[220:223], a[188:191], a[220:223], v[220:223]
 s_waitcnt lgkmcnt(4)
 ds_read_b64_tr_b16 a[188:189], v12 offset:30848
 ds_read_b64_tr_b16 a[190:191], v12 offset:32128
 mf v[228:231], a[176:179], a[208:211], v[228:231]
 s_add_u32 s62, s73, 0x1000
 buffer_store_dwordx4 v[72:75], v4, s[40:43], s62 offen offset:1024 sc1
 mf v[236:239], a[176:179], a[212:215], v[236:239]
 mf v[244:247], a[176:179], a[216:219], v[244:247]
 mf v[252:255], a[176:179], a[220:223], v[252:255]
 s_waitcnt lgkmcnt(4)
 ds_read_b64_tr_b16 a[176:177], v13 offset:10368
 ds_read_b64_tr_b16 a[178:179], v13 offset:11648
 mf a[0:3], a[180:183], a[208:211], a[0:3]
 mf a[4:7], a[180:183], a[212:215], a[4:7]
 mf a[8:11], a[180:183], a[216:219], a[8:11]
 mf a[12:15], a[180:183], a[220:223], a[12:15]
 s_waitcnt lgkmcnt(4)
 ds_read_b64_tr_b16 a[180:181], v13 offset:30848
 ds_read_b64_tr_b16 a[182:183], v13 offset:32128
 mf a[16:19], a[184:187], a[208:211], a[16:19]
 mf a[20:23], a[184:187], a[212:215], a[20:23]
 mf a[24:27], a[184:187], a[216:219], a[24:27]
 mf a[28:31], a[184:187], a[220:223], a[28:31]
 s_waitcnt lgkmcnt(4)
 ds_read_b64_tr_b16 a[184:185], v12 offset:10432
 ds_read_b64_tr_b16 a[186:187], v12 offset:11712
 mf a[32:35], a[188:191], a[208:211], a[32:35]
 s_add_u32 s62, s73, 0x1000
 buffer_store_dwordx4 v[80:83], v4, s[40:43], s62 offen offset:2048 sc1
 mf a[36:39], a[188:191], a[212:215], a[36:39]
 mf a[40:43], a[188:191], a[216:219], a[40:43]
 mf a[44:47], a[188:191], a[220:223], a[44:47]
 s_waitcnt lgkmcnt(4)
 ds_read_b64_tr_b16 a[188:189], v12 offset:30912
 ds_read_b64_tr_b16 a[190:191], v12 offset:32192
 mf a[48:51], a[176:179], a[208:211], a[48:51]
 mf a[52:55], a[176:179], a[212:215], a[52:55]
 mf a[56:59], a[176:179], a[216:219], a[56:59]
 mf a[60:63], a[176:179], a[220:223], a[60:63]
 s_waitcnt lgkmcnt(4)
 ds_read_b64_tr_b16 a[176:177], v13 offset:10432
 ds_read_b64_tr_b16 a[178:179], v13 offset:11712
 mf a[64:67], a[180:183], a[208:211], a[64:67]
 mf a[68:71], a[180:183], a[212:215], a[68:71]
 mf a[72:75], a[180:183], a[216:219], a[72:75]
 mf a[76:79], a[180:183], a[220:223], a[76:79]
 s_waitcnt lgkmcnt(4)
 ds_read_b64_tr_b16 a[180:181], v13 offset:30912
 ds_read_b64_tr_b16 a[182:183], v13 offset:32192
 mf a[80:83], a[184:187], a[208:211], a[80:83]
 s_add_u32 s62, s73, 0x1000
 buffer_store_dwordx4 v[88:91], v4, s[40:43], s62 offen offset:3072 sc1
 mf a[84:87], a[184:187], a[212:215], a[84:87]
 mf a[88:91], a[184:187], a[216:219], a[88:91]
 mf a[92:95], a[184:187], a[220:223], a[92:95]
 s_waitcnt lgkmcnt(4)
 ds_read_b64_tr_b16 a[184:185], v12 offset:10496
 ds_read_b64_tr_b16 a[186:187], v12 offset:11776
 mf a[96:99], a[188:191], a[208:211], a[96:99]
 mf a[100:103], a[188:191], a[212:215], a[100:103]
 mf a[104:107], a[188:191], a[216:219], a[104:107]
 mf a[108:111], a[188:191], a[220:223], a[108:111]
 s_waitcnt lgkmcnt(4)
 ds_read_b64_tr_b16 a[188:189], v12 offset:30976
 ds_read_b64_tr_b16 a[190:191], v12 offset:32256
 mf a[112:115], a[176:179], a[208:211], a[112:115]
 mf a[116:119], a[176:179], a[212:215], a[116:119]
 mf a[120:123], a[176:179], a[216:219], a[120:123]
 mf a[124:127], a[176:179], a[220:223], a[124:127]
 s_waitcnt lgkmcnt(4)
 mf a[128:131], a[180:183], a[208:211], a[128:131]
 mf a[132:135], a[180:183], a[212:215], a[132:135]
 s_waitcnt vmcnt(25)
 s_waitcnt lgkmcnt(0)
 s_barrier
 mf a[136:139], a[180:183], a[216:219], a[136:139]
 ds_read_b64_tr_b16 a[176:177], v8
 ds_read_b64_tr_b16 a[178:179], v8 offset:1280
 mf a[140:143], a[180:183], a[220:223], a[140:143]
 ds_read_b64_tr_b16 a[180:181], v8 offset:20480
 ds_read_b64_tr_b16 a[182:183], v8 offset:21760
 mf a[144:147], a[184:187], a[208:211], a[144:147]
 mf a[148:151], a[184:187], a[212:215], a[148:151]
 mf a[152:155], a[184:187], a[216:219], a[152:155]
 mf a[156:159], a[184:187], a[220:223], a[156:159]
 ds_read_b64_tr_b16 a[184:185], v9
 ds_read_b64_tr_b16 a[186:187], v9 offset:1280
 mf a[160:163], a[188:191], a[208:211], a[160:163]
 mf a[164:167], a[188:191], a[212:215], a[164:167]
 mf a[168:171], a[188:191], a[216:219], a[168:171]
 mf a[172:175], a[188:191], a[220:223], a[172:175]
 s_waitcnt vmcnt(21) lgkmcnt(4)
 ds_read_b64_tr_b16 a[188:189], v9 offset:20480
 ds_read_b64_tr_b16 a[190:191], v9 offset:21760
 mf v[36:39], a[176:179], a[224:227], v[36:39]
 s_waitcnt vmcnt(20)
 s_add_u32 s61, s81, 0x2000
 buffer_load_dwordx4 a[192:195], v4, s[48:51], s61 offen
 mf v[44:47], a[176:179], a[228:231], v[44:47]
 s_waitcnt vmcnt(20)
 mf v[52:55], a[176:179], a[232:235], v[52:55]
 s_waitcnt vmcnt(19)
 s_add_u32 s61, s81, s16
 mf v[60:63], a[176:179], a[236:239], v[60:63]
 s_waitcnt lgkmcnt(4)
 s_add_u32 s61, s61, 0x2000
 ds_read_b64_tr_b16 a[176:177], v8 offset:64
 ds_read_b64_tr_b16 a[178:179], v8 offset:1344
 mf v[68:71], a[180:183], a[224:227], v[68:71]
 buffer_load_dwordx4 a[196:199], v4, s[48:51], s61 offen
 mf v[76:79], a[180:183], a[228:231], v[76:79]
 mf v[84:87], a[180:183], a[232:235], v[84:87]
 s_add_u32 s61, s82, 0x2000
 buffer_load_dwordx4 a[200:203], v4, s[48:51], s61 offen
 mf v[92:95], a[180:183], a[236:239], v[92:95]
 s_waitcnt lgkmcnt(4)
 ds_read_b64_tr_b16 a[180:181], v8 offset:20544
 ds_read_b64_tr_b16 a[182:183], v8 offset:21824
 mf v[100:103], a[184:187], a[224:227], v[100:103]
 s_add_u32 s61, s82, s16
 mf v[108:111], a[184:187], a[228:231], v[108:111]
 s_add_u32 s61, s61, 0x2000
 buffer_load_dwordx4 a[204:207], v4, s[48:51], s61 offen
 mf v[116:119], a[184:187], a[232:235], v[116:119]
 mf v[124:127], a[184:187], a[236:239], v[124:127]
 s_waitcnt lgkmcnt(4)
 s_add_u32 s61, s81, 0x2000
 ds_read_b64_tr_b16 a[184:185], v9 offset:64
 ds_read_b64_tr_b16 a[186:187], v9 offset:1344
 mf v[132:135], a[188:191], a[224:227], v[132:135]
 buffer_load_dwordx4 a[208:211], v4, s[48:51], s61 offen offset:1024
 mf v[140:143], a[188:191], a[228:231], v[140:143]
 mf v[148:151], a[188:191], a[232:235], v[148:151]
 s_add_u32 s61, s81, s16
 mf v[156:159], a[188:191], a[236:239], v[156:159]
 s_waitcnt lgkmcnt(4)
 s_add_u32 s61, s61, 0x2000
 ds_read_b64_tr_b16 a[188:189], v9 offset:20544
 ds_read_b64_tr_b16 a[190:191], v9 offset:21824
 mf v[164:167], a[176:179], a[224:227], v[164:167]
 buffer_load_dwordx4 a[212:215], v4, s[48:51], s61 offen offset:1024
 mf v[172:175], a[176:179], a[228:231], v[172:175]
 mf v[180:183], a[176:179], a[232:235], v[180:183]
 s_add_u32 s61, s82, 0x2000
 buffer_load_dwordx4 a[216:219], v4, s[48:51], s61 offen offset:1024
 mf v[188:191], a[176:179], a[236:239], v[188:191]
 s_waitcnt lgkmcnt(4)
 ds_read_b64_tr_b16 a[176:177], v8 offset:128
 ds_read_b64_tr_b16 a[178:179], v8 offset:1408
 mf v[196:199], a[180:183], a[224:227], v[196:199]
 s_add_u32 s61, s82, s16
 mf v[204:207], a[180:183], a[228:231], v[204:207]
 s_add_u32 s61, s61, 0x2000
 buffer_load_dwordx4 a[220:223], v4, s[48:51], s61 offen offset:1024
 mf v[212:215], a[180:183], a[232:235], v[212:215]
 s_mov_b32 s56, s8
 mf v[220:223], a[180:183], a[236:239], v[220:223]
 s_waitcnt lgkmcnt(4)
 s_mov_b32 s57, s9
 ds_read_b64_tr_b16 a[180:181], v8 offset:20608
 ds_read_b64_tr_b16 a[182:183], v8 offset:21888
 mf v[228:231], a[184:187], a[224:227], v[228:231]
 s_mov_b32 s58, 0x480000
 mf v[236:239], a[184:187], a[228:231], v[236:239]
 s_mov_b32 s59, 0x20000
 v_add_u32 v17, 0x200000, v7
 mf v[244:247], a[184:187], a[232:235], v[244:247]
 buffer_load_dword v16, v17, s[56:59], 0 offen
 mf v[252:255], a[184:187], a[236:239], v[252:255]
 s_waitcnt lgkmcnt(4)
 ds_read_b64_tr_b16 a[184:185], v9 offset:128
 ds_read_b64_tr_b16 a[186:187], v9 offset:1408
 mf a[0:3], a[188:191], a[224:227], a[0:3]
 s_mov_b32 s60, 0x2d0000
 mf a[4:7], a[188:191], a[228:231], a[4:7]
 s_add_u32 m0, s78, 0x14000
 mf a[8:11], a[188:191], a[232:235], a[8:11]
 buffer_load_dwordx4 v20, s[44:47], s60 offen lds
 mf a[12:15], a[188:191], a[236:239], a[12:15]
 s_waitcnt lgkmcnt(4)
 ds_read_b64_tr_b16 a[188:189], v9 offset:20608
 ds_read_b64_tr_b16 a[190:191], v9 offset:21888
 mf a[16:19], a[176:179], a[224:227], a[16:19]
 mf a[20:23], a[176:179], a[228:231], a[20:23]
 s_add_u32 m0, s78, 0x14400
 mf a[24:27], a[176:179], a[232:235], a[24:27]
 buffer_load_dwordx4 v21, s[44:47], s60 offen lds
 mf a[28:31], a[176:179], a[236:239], a[28:31]
 s_waitcnt lgkmcnt(4)
 ds_read_b64_tr_b16 a[176:177], v8 offset:192
 ds_read_b64_tr_b16 a[178:179], v8 offset:1472
 mf a[32:35], a[180:183], a[224:227], a[32:35]
 mf a[36:39], a[180:183], a[228:231], a[36:39]
 mf a[40:43], a[180:183], a[232:235], a[40:43]
 s_add_u32 m0, s78, 0x14800
 mf a[44:47], a[180:183], a[236:239], a[44:47]
 s_waitcnt lgkmcnt(4)
 ds_read_b64_tr_b16 a[180:181], v8 offset:20672
 ds_read_b64_tr_b16 a[182:183], v8 offset:21952
 mf a[48:51], a[184:187], a[224:227], a[48:51]
 buffer_load_dwordx4 v22, s[44:47], s60 offen lds
 mf a[52:55], a[184:187], a[228:231], a[52:55]
 mf a[56:59], a[184:187], a[232:235], a[56:59]
 mf a[60:63], a[184:187], a[236:239], a[60:63]
 s_waitcnt lgkmcnt(4)
 s_add_u32 m0, s78, 0x14c00
 ds_read_b64_tr_b16 a[184:185], v9 offset:192
 ds_read_b64_tr_b16 a[186:187], v9 offset:1472
 mf a[64:67], a[188:191], a[224:227], a[64:67]
 buffer_load_dwordx4 v23, s[44:47], s60 offen lds
 mf a[68:71], a[188:191], a[228:231], a[68:71]
 mf a[72:75], a[188:191], a[232:235], a[72:75]
 mf a[76:79], a[188:191], a[236:239], a[76:79]
 s_waitcnt lgkmcnt(4)
 ds_read_b64_tr_b16 a[188:189], v9 offset:20672
 ds_read_b64_tr_b16 a[190:191], v9 offset:21952
 mf a[80:83], a[176:179], a[224:227], a[80:83]
 s_add_u32 m0, s78, 0x15000
 mf a[84:87], a[176:179], a[228:231], a[84:87]
 buffer_load_dwordx4 v24, s[44:47], s60 offen lds
 mf a[88:91], a[176:179], a[232:235], a[88:91]
 mf a[92:95], a[176:179], a[236:239], a[92:95]
 s_waitcnt lgkmcnt(4)
 ds_read_b64_tr_b16 a[176:177], v8 offset:256
 ds_read_b64_tr_b16 a[178:179], v8 offset:1536
 mf a[96:99], a[180:183], a[224:227], a[96:99]
 mf a[100:103], a[180:183], a[228:231], a[100:103]
 s_add_u32 m0, s78, 0x15400
 mf a[104:107], a[180:183], a[232:235], a[104:107]
 buffer_load_dwordx4 v25, s[44:47], s60 offen lds
 mf a[108:111], a[180:183], a[236:239], a[108:111]
 s_waitcnt lgkmcnt(4)
 ds_read_b64_tr_b16 a[180:181], v8 offset:20736
 ds_read_b64_tr_b16 a[182:183], v8 offset:22016
 mf a[112:115], a[184:187], a[224:227], a[112:115]
 mf a[116:119], a[184:187], a[228:231], a[116:119]
 mf a[120:123], a[184:187], a[232:235], a[120:123]
 s_add_u32 m0, s78, 0x15800
 mf a[124:127], a[184:187], a[236:239], a[124:127]
 s_waitcnt lgkmcnt(4)
 ds_read_b64_tr_b16 a[184:185], v8 offset:10240
 ds_read_b64_tr_b16 a[186:187], v8 offset:11520
 mf a[128:131], a[188:191], a[224:227], a[128:131]
 buffer_load_dwordx4 v26, s[44:47], s60 offen lds
 mf a[132:135], a[188:191], a[228:231], a[132:135]
 mf a[136:139], a[188:191], a[232:235], a[136:139]
 mf a[140:143], a[188:191], a[236:239], a[140:143]
 s_waitcnt lgkmcnt(4)
 s_add_u32 m0, s78, 0x15c00
 ds_read_b64_tr_b16 a[188:189], v8 offset:30720
 ds_read_b64_tr_b16 a[190:191], v8 offset:32000
 mf a[144:147], a[176:179], a[224:227], a[144:147]
 buffer_load_dwordx4 v27, s[44:47], s60 offen lds
 mf a[148:151], a[176:179], a[228:231], a[148:151]
 mf a[152:155], a[176:179], a[232:235], a[152:155]
 mf a[156:159], a[176:179], a[236:239], a[156:159]
 s_waitcnt lgkmcnt(4)
 ds_read_b64_tr_b16 a[176:177], v9 offset:10240
 ds_read_b64_tr_b16 a[178:179], v9 offset:11520
 mf a[160:163], a[180:183], a[224:227], a[160:163]
 s_add_u32 m0, s78, 0x16000
 mf a[164:167], a[180:183], a[228:231], a[164:167]
 buffer_load_dwordx4 v28, s[44:47], s60 offen lds
 mf a[168:171], a[180:183], a[232:235], a[168:171]
 mf a[172:175], a[180:183], a[236:239], a[172:175]
 s_waitcnt vmcnt(35) lgkmcnt(4)
 ds_read_b64_tr_b16 a[180:181], v9 offset:30720
 ds_read_b64_tr_b16 a[182:183], v9 offset:32000
 mf v[36:39], a[184:187], a[240:243], v[36:39]
 s_waitcnt vmcnt(34)
 mf v[44:47], a[184:187], a[244:247], v[44:47]
 s_waitcnt vmcnt(33)
 s_add_u32 m0, s78, 0x16400
 mf v[52:55], a[184:187], a[248:251], v[52:55]
 s_waitcnt vmcnt(32)
 buffer_load_dwordx4 v29, s[44:47], s60 offen lds
 mf v[60:63], a[184:187], a[252:255], v[60:63]
 s_waitcnt lgkmcnt(4)
 ds_read_b64_tr_b16 a[184:185], v8 offset:10304
 ds_read_b64_tr_b16 a[186:187], v8 offset:11584
 mf v[68:71], a[188:191], a[240:243], v[68:71]
 mf v[76:79], a[188:191], a[244:247], v[76:79]
 mf v[84:87], a[188:191], a[248:251], v[84:87]
 mf v[92:95], a[188:191], a[252:255], v[92:95]
 s_waitcnt lgkmcnt(4)
 ds_read_b64_tr_b16 a[188:189], v8 offset:30784
 ds_read_b64_tr_b16 a[190:191], v8 offset:32064
 mf v[100:103], a[176:179], a[240:243], v[100:103]
 mf v[108:111], a[176:179], a[244:247], v[108:111]
 mf v[116:119], a[176:179], a[248:251], v[116:119]
 mf v[124:127], a[176:179], a[252:255], v[124:127]
 s_waitcnt lgkmcnt(4)
 ds_read_b64_tr_b16 a[176:177], v9 offset:10304
 ds_read_b64_tr_b16 a[178:179], v9 offset:11584
 mf v[132:135], a[180:183], a[240:243], v[132:135]
 mf v[140:143], a[180:183], a[244:247], v[140:143]
 mf v[148:151], a[180:183], a[248:251], v[148:151]
 mf v[156:159], a[180:183], a[252:255], v[156:159]
 s_waitcnt lgkmcnt(4)
 ds_read_b64_tr_b16 a[180:181], v9 offset:30784
 ds_read_b64_tr_b16 a[182:183], v9 offset:32064
 mf v[164:167], a[184:187], a[240:243], v[164:167]
 mf v[172:175], a[184:187], a[244:247], v[172:175]
 mf v[180:183], a[184:187], a[248:251], v[180:183]
 mf v[188:191], a[184:187], a[252:255], v[188:191]
 s_waitcnt lgkmcnt(4)
 ds_read_b64_tr_b16 a[184:185], v8 offset:10368
 ds_read_b64_tr_b16 a[186:187], v8 offset:11648
 mf v[196:199], a[188:191], a[240:243], v[196:199]
 mf v[204:207], a[188:191], a[244:247], v[204:207]
 mf v[212:215], a[188:191], a[248:251], v[212:215]
 mf v[220:223], a[188:191], a[252:255], v[220:223]
 s_waitcnt lgkmcnt(4)
 ds_read_b64_tr_b16 a[188:189], v8 offset:30848
 ds_read_b64_tr_b16 a[190:191], v8 offset:32128
 mf v[228:231], a[176:179], a[240:243], v[228:231]
 s_add_u32 s62, s73, 0x2000
 buffer_store_dwordx4 v[96:99], v4, s[40:43], s62 offen sc1
 mf v[236:239], a[176:179], a[244:247], v[236:239]
 mf v[244:247], a[176:179], a[248:251], v[244:247]
 mf v[252:255], a[176:179], a[252:255], v[252:255]
 s_waitcnt lgkmcnt(4)
 ds_read_b64_tr_b16 a[176:177], v9 offset:10368
 ds_read_b64_tr_b16 a[178:179], v9 offset:11648
 mf a[0:3], a[180:183], a[240:243], a[0:3]
 mf a[4:7], a[180:183], a[244:247], a[4:7]
 mf a[8:11], a[180:183], a[248:251], a[8:11]
 mf a[12:15], a[180:183], a[252:255], a[12:15]
 s_waitcnt lgkmcnt(4)
 ds_read_b64_tr_b16 a[180:181], v9 offset:30848
 ds_read_b64_tr_b16 a[182:183], v9 offset:32128
 mf a[16:19], a[184:187], a[240:243], a[16:19]
 mf a[20:23], a[184:187], a[244:247], a[20:23]
 mf a[24:27], a[184:187], a[248:251], a[24:27]
 mf a[28:31], a[184:187], a[252:255], a[28:31]
 s_waitcnt lgkmcnt(4)
 ds_read_b64_tr_b16 a[184:185], v8 offset:10432
 ds_read_b64_tr_b16 a[186:187], v8 offset:11712
 mf a[32:35], a[188:191], a[240:243], a[32:35]
 s_add_u32 s62, s73, 0x2000
 buffer_store_dwordx4 v[104:107], v4, s[40:43], s62 offen offset:1024 sc1
 mf a[36:39], a[188:191], a[244:247], a[36:39]
 mf a[40:43], a[188:191], a[248:251], a[40:43]
 mf a[44:47], a[188:191], a[252:255], a[44:47]
 s_waitcnt lgkmcnt(4)
 ds_read_b64_tr_b16 a[188:189], v8 offset:30912
 ds_read_b64_tr_b16 a[190:191], v8 offset:32192
 mf a[48:51], a[176:179], a[240:243], a[48:51]
 mf a[52:55], a[176:179], a[244:247], a[52:55]
 mf a[56:59], a[176:179], a[248:251], a[56:59]
 mf a[60:63], a[176:179], a[252:255], a[60:63]
 s_waitcnt lgkmcnt(4)
 ds_read_b64_tr_b16 a[176:177], v9 offset:10432
 ds_read_b64_tr_b16 a[178:179], v9 offset:11712
 mf a[64:67], a[180:183], a[240:243], a[64:67]
 mf a[68:71], a[180:183], a[244:247], a[68:71]
 mf a[72:75], a[180:183], a[248:251], a[72:75]
 mf a[76:79], a[180:183], a[252:255], a[76:79]
 s_waitcnt lgkmcnt(4)
 ds_read_b64_tr_b16 a[180:181], v9 offset:30912
 ds_read_b64_tr_b16 a[182:183], v9 offset:32192
 mf a[80:83], a[184:187], a[240:243], a[80:83]
 s_add_u32 s62, s73, 0x2000
 buffer_store_dwordx4 v[112:115], v4, s[40:43], s62 offen offset:2048 sc1
 mf a[84:87], a[184:187], a[244:247], a[84:87]
 mf a[88:91], a[184:187], a[248:251], a[88:91]
 mf a[92:95], a[184:187], a[252:255], a[92:95]
 s_waitcnt lgkmcnt(4)
 ds_read_b64_tr_b16 a[184:185], v8 offset:10496
 ds_read_b64_tr_b16 a[186:187], v8 offset:11776
 mf a[96:99], a[188:191], a[240:243], a[96:99]
 mf a[100:103], a[188:191], a[244:247], a[100:103]
 mf a[104:107], a[188:191], a[248:251], a[104:107]
 mf a[108:111], a[188:191], a[252:255], a[108:111]
 s_waitcnt lgkmcnt(4)
 ds_read_b64_tr_b16 a[188:189], v8 offset:30976
 ds_read_b64_tr_b16 a[190:191], v8 offset:32256
 mf a[112:115], a[176:179], a[240:243], a[112:115]
 mf a[116:119], a[176:179], a[244:247], a[116:119]
 mf a[120:123], a[176:179], a[248:251], a[120:123]
 mf a[124:127], a[176:179], a[252:255], a[124:127]
 s_waitcnt lgkmcnt(4)
 mf a[128:131], a[180:183], a[240:243], a[128:131]
 mf a[132:135], a[180:183], a[244:247], a[132:135]
 s_waitcnt vmcnt(25)
 s_waitcnt lgkmcnt(0)
 s_barrier
 mf a[136:139], a[180:183], a[248:251], a[136:139]
 ds_read_b64_tr_b16 a[176:177], v10
 ds_read_b64_tr_b16 a[178:179], v10 offset:1280
 mf a[140:143], a[180:183], a[252:255], a[140:143]
 ds_read_b64_tr_b16 a[180:181], v10 offset:20480
 ds_read_b64_tr_b16 a[182:183], v10 offset:21760
 mf a[144:147], a[184:187], a[240:243], a[144:147]
 mf a[148:151], a[184:187], a[244:247], a[148:151]
 mf a[152:155], a[184:187], a[248:251], a[152:155]
 mf a[156:159], a[184:187], a[252:255], a[156:159]
 ds_read_b64_tr_b16 a[184:185], v11
 ds_read_b64_tr_b16 a[186:187], v11 offset:1280
 mf a[160:163], a[188:191], a[240:243], a[160:163]
 mf a[164:167], a[188:191], a[244:247], a[164:167]
 mf a[168:171], a[188:191], a[248:251], a[168:171]
 mf a[172:175], a[188:191], a[252:255], a[172:175]
 s_waitcnt vmcnt(21) lgkmcnt(4)
 ds_read_b64_tr_b16 a[188:189], v11 offset:20480
 ds_read_b64_tr_b16 a[190:191], v11 offset:21760
 mf v[36:39], a[176:179], a[192:195], v[36:39]
 s_waitcnt vmcnt(20)
 s_add_u32 s61, s81, 0x2800
 buffer_load_dwordx4 a[224:227], v4, s[48:51], s61 offen
 mf v[44:47], a[176:179], a[196:199], v[44:47]
 s_waitcnt vmcnt(20)
 mf v[52:55], a[176:179], a[200:203], v[52:55]
 s_waitcnt vmcnt(19)
 s_add_u32 s61, s81, s16
 mf v[60:63], a[176:179], a[204:207], v[60:63]
 s_waitcnt lgkmcnt(4)
 s_add_u32 s61, s61, 0x2800
 ds_read_b64_tr_b16 a[176:177], v10 offset:64
 ds_read_b64_tr_b16 a[178:179], v10 offset:1344
 mf v[68:71], a[180:183], a[192:195], v[68:71]
 buffer_load_dwordx4 a[228:231], v4, s[48:51], s61 offen
 mf v[76:79], a[180:183], a[196:199], v[76:79]
 mf v[84:87], a[180:183], a[200:203], v[84:87]
 s_add_u32 s61, s82, 0x2800
 buffer_load_dwordx4 a[232:235], v4, s[48:51], s61 offen
 mf v[92:95], a[180:183], a[204:207], v[92:95]
 s_waitcnt lgkmcnt(4)
 ds_read_b64_tr_b16 a[180:181], v10 offset:20544
 ds_read_b64_tr_b16 a[182:183], v10 offset:21824
 mf v[100:103], a[184:187], a[192:195], v[100:103]
 s_add_u32 s61, s82, s16
 mf v[108:111], a[184:187], a[196:199], v[108:111]
 s_add_u32 s61, s61, 0x2800
 buffer_load_dwordx4 a[236:239], v4, s[48:51], s61 offen
 mf v[116:119], a[184:187], a[200:203], v[116:119]
 mf v[124:127], a[184:187], a[204:207], v[124:127]
 s_waitcnt lgkmcnt(4)
 s_add_u32 s61, s81, 0x2800
 ds_read_b64_tr_b16 a[184:185], v11 offset:64
 ds_read_b64_tr_b16 a[186:187], v11 offset:1344
 mf v[132:135], a[188:191], a[192:195], v[132:135]
 buffer_load_dwordx4 a[240:243], v4, s[48:51], s61 offen offset:1024
 mf v[140:143], a[188:191], a[196:199], v[140:143]
 mf v[148:151], a[188:191], a[200:203], v[148:151]
 s_add_u32 s61, s81, s16
 mf v[156:159], a[188:191], a[204:207], v[156:159]
 s_waitcnt lgkmcnt(4)
 s_add_u32 s61, s61, 0x2800
 ds_read_b64_tr_b16 a[188:189], v11 offset:20544
 ds_read_b64_tr_b16 a[190:191], v11 offset:21824
 mf v[164:167], a[176:179], a[192:195], v[164:167]
 buffer_load_dwordx4 a[244:247], v4, s[48:51], s61 offen offset:1024
 mf v[172:175], a[176:179], a[196:199], v[172:175]
 mf v[180:183], a[176:179], a[200:203], v[180:183]
 s_add_u32 s61, s82, 0x2800
 buffer_load_dwordx4 a[248:251], v4, s[48:51], s61 offen offset:1024
 mf v[188:191], a[176:179], a[204:207], v[188:191]
 s_waitcnt lgkmcnt(4)
 ds_read_b64_tr_b16 a[176:177], v10 offset:128
 ds_read_b64_tr_b16 a[178:179], v10 offset:1408
 mf v[196:199], a[180:183], a[192:195], v[196:199]
 s_add_u32 s61, s82, s16
 mf v[204:207], a[180:183], a[196:199], v[204:207]
 s_add_u32 s61, s61, 0x2800
 buffer_load_dwordx4 a[252:255], v4, s[48:51], s61 offen offset:1024
 mf v[212:215], a[180:183], a[200:203], v[212:215]
 s_mov_b32 s56, s8
 mf v[220:223], a[180:183], a[204:207], v[220:223]
 s_waitcnt lgkmcnt(4)
 s_mov_b32 s57, s9
 ds_read_b64_tr_b16 a[180:181], v10 offset:20608
 ds_read_b64_tr_b16 a[182:183], v10 offset:21888
 mf v[228:231], a[184:187], a[192:195], v[228:231]
 s_mov_b32 s58, 0x480000
 mf v[236:239], a[184:187], a[196:199], v[236:239]
 s_mov_b32 s59, 0x20000
 v_add_u32 v17, 0x300000, v7
 mf v[244:247], a[184:187], a[200:203], v[244:247]
 buffer_load_dword v16, v17, s[56:59], 0 offen
 mf v[252:255], a[184:187], a[204:207], v[252:255]
 s_waitcnt lgkmcnt(4)
 ds_read_b64_tr_b16 a[184:185], v11 offset:128
 ds_read_b64_tr_b16 a[186:187], v11 offset:1408
 mf a[0:3], a[188:191], a[192:195], a[0:3]
 s_mov_b32 s60, 0x360000
 mf a[4:7], a[188:191], a[196:199], a[4:7]
 s_add_u32 m0, s78, 0
 mf a[8:11], a[188:191], a[200:203], a[8:11]
 buffer_load_dwordx4 v20, s[44:47], s60 offen lds
 mf a[12:15], a[188:191], a[204:207], a[12:15]
 s_waitcnt lgkmcnt(4)
 ds_read_b64_tr_b16 a[188:189], v11 offset:20608
 ds_read_b64_tr_b16 a[190:191], v11 offset:21888
 mf a[16:19], a[176:179], a[192:195], a[16:19]
 mf a[20:23], a[176:179], a[196:199], a[20:23]
 s_add_u32 m0, s78, 0x400
 mf a[24:27], a[176:179], a[200:203], a[24:27]
 buffer_load_dwordx4 v21, s[44:47], s60 offen lds
 mf a[28:31], a[176:179], a[204:207], a[28:31]
 s_waitcnt lgkmcnt(4)
 ds_read_b64_tr_b16 a[176:177], v10 offset:192
 ds_read_b64_tr_b16 a[178:179], v10 offset:1472
 mf a[32:35], a[180:183], a[192:195], a[32:35]
 mf a[36:39], a[180:183], a[196:199], a[36:39]
 mf a[40:43], a[180:183], a[200:203], a[40:43]
 s_add_u32 m0, s78, 0x800
 mf a[44:47], a[180:183], a[204:207], a[44:47]
 s_waitcnt lgkmcnt(4)
 ds_read_b64_tr_b16 a[180:181], v10 offset:20672
 ds_read_b64_tr_b16 a[182:183], v10 offset:21952
 mf a[48:51], a[184:187], a[192:195], a[48:51]
 buffer_load_dwordx4 v22, s[44:47], s60 offen lds
 mf a[52:55], a[184:187], a[196:199], a[52:55]
 mf a[56:59], a[184:187], a[200:203], a[56:59]
 mf a[60:63], a[184:187], a[204:207], a[60:63]
 s_waitcnt lgkmcnt(4)
 s_add_u32 m0, s78, 0xc00
 ds_read_b64_tr_b16 a[184:185], v11 offset:192
 ds_read_b64_tr_b16 a[186:187], v11 offset:1472
 mf a[64:67], a[188:191], a[192:195], a[64:67]
 buffer_load_dwordx4 v23, s[44:47], s60 offen lds
 mf a[68:71], a[188:191], a[196:199], a[68:71]
 mf a[72:75], a[188:191], a[200:203], a[72:75]
 mf a[76:79], a[188:191], a[204:207], a[76:79]
 s_waitcnt lgkmcnt(4)
 ds_read_b64_tr_b16 a[188:189], v11 offset:20672
 ds_read_b64_tr_b16 a[190:191], v11 offset:21952
 mf a[80:83], a[176:179], a[192:195], a[80:83]
 s_add_u32 m0, s78, 0x1000
 mf a[84:87], a[176:179], a[196:199], a[84:87]
 buffer_load_dwordx4 v24, s[44:47], s60 offen lds
 mf a[88:91], a[176:179], a[200:203], a[88:91]
 mf a[92:95], a[176:179], a[204:207], a[92:95]
 s_waitcnt lgkmcnt(4)
 ds_read_b64_tr_b16 a[176:177], v10 offset:256
 ds_read_b64_tr_b16 a[178:179], v10 offset:1536
 mf a[96:99], a[180:183], a[192:195], a[96:99]
 mf a[100:103], a[180:183], a[196:199], a[100:103]
 s_add_u32 m0, s78, 0x1400
 mf a[104:107], a[180:183], a[200:203], a[104:107]
 buffer_load_dwordx4 v25, s[44:47], s60 offen lds
 mf a[108:111], a[180:183], a[204:207], a[108:111]
 s_waitcnt lgkmcnt(4)
 ds_read_b64_tr_b16 a[180:181], v10 offset:20736
 ds_read_b64_tr_b16 a[182:183], v10 offset:22016
 mf a[112:115], a[184:187], a[192:195], a[112:115]
 mf a[116:119], a[184:187], a[196:199], a[116:119]
 mf a[120:123], a[184:187], a[200:203], a[120:123]
 s_add_u32 m0, s78, 0x1800
 mf a[124:127], a[184:187], a[204:207], a[124:127]
 s_waitcnt lgkmcnt(4)
 ds_read_b64_tr_b16 a[184:185], v10 offset:10240
 ds_read_b64_tr_b16 a[186:187], v10 offset:11520
 mf a[128:131], a[188:191], a[192:195], a[128:131]
 buffer_load_dwordx4 v26, s[44:47], s60 offen lds
 mf a[132:135], a[188:191], a[196:199], a[132:135]
 mf a[136:139], a[188:191], a[200:203], a[136:139]
 mf a[140:143], a[188:191], a[204:207], a[140:143]
 s_waitcnt lgkmcnt(4)
 s_add_u32 m0, s78, 0x1c00
 ds_read_b64_tr_b16 a[188:189], v10 offset:30720
 ds_read_b64_tr_b16 a[190:191], v10 offset:32000
 mf a[144:147], a[176:179], a[192:195], a[144:147]
 buffer_load_dwordx4 v27, s[44:47], s60 offen lds
 mf a[148:151], a[176:179], a[196:199], a[148:151]
 mf a[152:155], a[176:179], a[200:203], a[152:155]
 mf a[156:159], a[176:179], a[204:207], a[156:159]
 s_waitcnt lgkmcnt(4)
 ds_read_b64_tr_b16 a[176:177], v11 offset:10240
 ds_read_b64_tr_b16 a[178:179], v11 offset:11520
 mf a[160:163], a[180:183], a[192:195], a[160:163]
 s_add_u32 m0, s78, 0x2000
 mf a[164:167], a[180:183], a[196:199], a[164:167]
 buffer_load_dwordx4 v28, s[44:47], s60 offen lds
 mf a[168:171], a[180:183], a[200:203], a[168:171]
 mf a[172:175], a[180:183], a[204:207], a[172:175]
 s_waitcnt vmcnt(35) lgkmcnt(4)
 ds_read_b64_tr_b16 a[180:181], v11 offset:30720
 ds_read_b64_tr_b16 a[182:183], v11 offset:32000
 mf v[36:39], a[184:187], a[208:211], v[36:39]
 s_waitcnt vmcnt(34)
 mf v[44:47], a[184:187], a[212:215], v[44:47]
 s_waitcnt vmcnt(33)
 s_add_u32 m0, s78, 0x2400
 mf v[52:55], a[184:187], a[216:219], v[52:55]
 s_waitcnt vmcnt(32)
 buffer_load_dwordx4 v29, s[44:47], s60 offen lds
 mf v[60:63], a[184:187], a[220:223], v[60:63]
 s_waitcnt lgkmcnt(4)
 ds_read_b64_tr_b16 a[184:185], v10 offset:10304
 ds_read_b64_tr_b16 a[186:187], v10 offset:11584
 mf v[68:71], a[188:191], a[208:211], v[68:71]
 mf v[76:79], a[188:191], a[212:215], v[76:79]
 mf v[84:87], a[188:191], a[216:219], v[84:87]
 mf v[92:95], a[188:191], a[220:223], v[92:95]
 s_waitcnt lgkmcnt(4)
 ds_read_b64_tr_b16 a[188:189], v10 offset:30784
 ds_read_b64_tr_b16 a[190:191], v10 offset:32064
 mf v[100:103], a[176:179], a[208:211], v[100:103]
 mf v[108:111], a[176:179], a[212:215], v[108:111]
 mf v[116:119], a[176:179], a[216:219], v[116:119]
 mf v[124:127], a[176:179], a[220:223], v[124:127]
 s_waitcnt lgkmcnt(4)
 ds_read_b64_tr_b16 a[176:177], v11 offset:10304
 ds_read_b64_tr_b16 a[178:179], v11 offset:11584
 mf v[132:135], a[180:183], a[208:211], v[132:135]
 mf v[140:143], a[180:183], a[212:215], v[140:143]
 mf v[148:151], a[180:183], a[216:219], v[148:151]
 mf v[156:159], a[180:183], a[220:223], v[156:159]
 s_waitcnt lgkmcnt(4)
 ds_read_b64_tr_b16 a[180:181], v11 offset:30784
 ds_read_b64_tr_b16 a[182:183], v11 offset:32064
 mf v[164:167], a[184:187], a[208:211], v[164:167]
 mf v[172:175], a[184:187], a[212:215], v[172:175]
 mf v[180:183], a[184:187], a[216:219], v[180:183]
 mf v[188:191], a[184:187], a[220:223], v[188:191]
 s_waitcnt lgkmcnt(4)
 ds_read_b64_tr_b16 a[184:185], v10 offset:10368
 ds_read_b64_tr_b16 a[186:187], v10 offset:11648
 mf v[196:199], a[188:191], a[208:211], v[196:199]
 mf v[204:207], a[188:191], a[212:215], v[204:207]
 mf v[212:215], a[188:191], a[216:219], v[212:215]
 mf v[220:223], a[188:191], a[220:223], v[220:223]
 s_waitcnt lgkmcnt(4)
 ds_read_b64_tr_b16 a[188:189], v10 offset:30848
 ds_read_b64_tr_b16 a[190:191], v10 offset:32128
 mf v[228:231], a[176:179], a[208:211], v[228:231]
 s_add_u32 s62, s73, 0x2000
 buffer_store_dwordx4 v[120:123], v4, s[40:43], s62 offen offset:3072 sc1
 mf v[236:239], a[176:179], a[212:215], v[236:239]
 mf v[244:247], a[176:179], a[216:219], v[244:247]
 mf v[252:255], a[176:179], a[220:223], v[252:255]
 s_waitcnt lgkmcnt(4)
 ds_read_b64_tr_b16 a[176:177], v11 offset:10368
 ds_read_b64_tr_b16 a[178:179], v11 offset:11648
 mf a[0:3], a[180:183], a[208:211], a[0:3]
 mf a[4:7], a[180:183], a[212:215], a[4:7]
 mf a[8:11], a[180:183], a[216:219], a[8:11]
 mf a[12:15], a[180:183], a[220:223], a[12:15]
 s_waitcnt lgkmcnt(4)
 ds_read_b64_tr_b16 a[180:181], v11 offset:30848
 ds_read_b64_tr_b16 a[182:183], v11 offset:32128
 mf a[16:19], a[184:187], a[208:211], a[16:19]
 mf a[20:23], a[184:187], a[212:215], a[20:23]
 mf a[24:27], a[184:187], a[216:219], a[24:27]
 mf a[28:31], a[184:187], a[220:223], a[28:31]
 s_waitcnt lgkmcnt(4)
 ds_read_b64_tr_b16 a[184:185], v10 offset:10432
 ds_read_b64_tr_b16 a[186:187], v10 offset:11712
 mf a[32:35], a[188:191], a[208:211], a[32:35]
 s_add_u32 s62, s73, 0x3000
 buffer_store_dwordx4 v[128:131], v4, s[40:43], s62 offen sc1
 mf a[36:39], a[188:191], a[212:215], a[36:39]
 mf a[40:43], a[188:191], a[216:219], a[40:43]
 mf a[44:47], a[188:191], a[220:223], a[44:47]
 s_waitcnt lgkmcnt(4)
 ds_read_b64_tr_b16 a[188:189], v10 offset:30912
 ds_read_b64_tr_b16 a[190:191], v10 offset:32192
 mf a[48:51], a[176:179], a[208:211], a[48:51]
 mf a[52:55], a[176:179], a[212:215], a[52:55]
 mf a[56:59], a[176:179], a[216:219], a[56:59]
 mf a[60:63], a[176:179], a[220:223], a[60:63]
 s_waitcnt lgkmcnt(4)
 ds_read_b64_tr_b16 a[176:177], v11 offset:10432
 ds_read_b64_tr_b16 a[178:179], v11 offset:11712
 mf a[64:67], a[180:183], a[208:211], a[64:67]
 mf a[68:71], a[180:183], a[212:215], a[68:71]
 mf a[72:75], a[180:183], a[216:219], a[72:75]
 mf a[76:79], a[180:183], a[220:223], a[76:79]
 s_waitcnt lgkmcnt(4)
 ds_read_b64_tr_b16 a[180:181], v11 offset:30912
 ds_read_b64_tr_b16 a[182:183], v11 offset:32192
 mf a[80:83], a[184:187], a[208:211], a[80:83]
 s_add_u32 s62, s73, 0x3000
 buffer_store_dwordx4 v[136:139], v4, s[40:43], s62 offen offset:1024 sc1
 mf a[84:87], a[184:187], a[212:215], a[84:87]
 mf a[88:91], a[184:187], a[216:219], a[88:91]
 mf a[92:95], a[184:187], a[220:223], a[92:95]
 s_waitcnt lgkmcnt(4)
 ds_read_b64_tr_b16 a[184:185], v10 offset:10496
 ds_read_b64_tr_b16 a[186:187], v10 offset:11776
 mf a[96:99], a[188:191], a[208:211], a[96:99]
 mf a[100:103], a[188:191], a[212:215], a[100:103]
 mf a[104:107], a[188:191], a[216:219], a[104:107]
 mf a[108:111], a[188:191], a[220:223], a[108:111]
 s_waitcnt lgkmcnt(4)
 ds_read_b64_tr_b16 a[188:189], v10 offset:30976
 ds_read_b64_tr_b16 a[190:191], v10 offset:32256
 mf a[112:115], a[176:179], a[208:211], a[112:115]
 mf a[116:119], a[176:179], a[212:215], a[116:119]
 mf a[120:123], a[176:179], a[216:219], a[120:123]
 mf a[124:127], a[176:179], a[220:223], a[124:127]
 s_waitcnt lgkmcnt(4)
 mf a[128:131], a[180:183], a[208:211], a[128:131]
 mf a[132:135], a[180:183], a[212:215], a[132:135]
 s_waitcnt vmcnt(25)
 s_waitcnt lgkmcnt(0)
 s_barrier
 mf a[136:139], a[180:183], a[216:219], a[136:139]
 ds_read_b64_tr_b16 a[176:177], v12
 ds_read_b64_tr_b16 a[178:179], v12 offset:1280
 mf a[140:143], a[180:183], a[220:223], a[140:143]
 ds_read_b64_tr_b16 a[180:181], v12 offset:20480
 ds_read_b64_tr_b16 a[182:183], v12 offset:21760
 mf a[144:147], a[184:187], a[208:211], a[144:147]
 mf a[148:151], a[184:187], a[212:215], a[148:151]
 mf a[152:155], a[184:187], a[216:219], a[152:155]
 mf a[156:159], a[184:187], a[220:223], a[156:159]
 ds_read_b64_tr_b16 a[184:185], v13
 ds_read_b64_tr_b16 a[186:187], v13 offset:1280
 mf a[160:163], a[188:191], a[208:211], a[160:163]
 mf a[164:167], a[188:191], a[212:215], a[164:167]
 mf a[168:171], a[188:191], a[216:219], a[168:171]
 mf a[172:175], a[188:191], a[220:223], a[172:175]
 s_waitcnt vmcnt(21) lgkmcnt(4)
 ds_read_b64_tr_b16 a[188:189], v13 offset:20480
 ds_read_b64_tr_b16 a[190:191], v13 offset:21760
 mf v[36:39], a[176:179], a[224:227], v[36:39]
 s_waitcnt vmcnt(20)
 s_add_u32 s61, s81, 0x3000
 buffer_load_dwordx4 a[192:195], v4, s[48:51], s61 offen
 mf v[44:47], a[176:179], a[228:231], v[44:47]
 s_waitcnt vmcnt(20)
 mf v[52:55], a[176:179], a[232:235], v[52:55]
 s_waitcnt vmcnt(19)
 s_add_u32 s61, s81, s16
 mf v[60:63], a[176:179], a[236:239], v[60:63]
 s_waitcnt lgkmcnt(4)
 s_add_u32 s61, s61, 0x3000
 ds_read_b64_tr_b16 a[176:177], v12 offset:64
 ds_read_b64_tr_b16 a[178:179], v12 offset:1344
 mf v[68:71], a[180:183], a[224:227], v[68:71]
 buffer_load_dwordx4 a[196:199], v4, s[48:51], s61 offen
 mf v[76:79], a[180:183], a[228:231], v[76:79]
 mf v[84:87], a[180:183], a[232:235], v[84:87]
 s_add_u32 s61, s82, 0x3000
 buffer_load_dwordx4 a[200:203], v4, s[48:51], s61 offen
 mf v[92:95], a[180:183], a[236:239], v[92:95]
 s_waitcnt lgkmcnt(4)
 ds_read_b64_tr_b16 a[180:181], v12 offset:20544
 ds_read_b64_tr_b16 a[182:183], v12 offset:21824
 mf v[100:103], a[184:187], a[224:227], v[100:103]
 s_add_u32 s61, s82, s16
 mf v[108:111], a[184:187], a[228:231], v[108:111]
 s_add_u32 s61, s61, 0x3000
 buffer_load_dwordx4 a[204:207], v4, s[48:51], s61 offen
 mf v[116:119], a[184:187], a[232:235], v[116:119]
 v_and_b32 v18, 1, v1
 v_lshlrev_b32 v18, 7, v18
 mf v[124:127], a[184:187], a[236:239], v[124:127]
 s_waitcnt lgkmcnt(4)
 s_add_u32 s61, s81, 0x3000
 ds_read_b64_tr_b16 a[184:185], v13 offset:64
 ds_read_b64_tr_b16 a[186:187], v13 offset:1344
 mf v[132:135], a[188:191], a[224:227], v[132:135]
 buffer_load_dwordx4 a[208:211], v4, s[48:51], s61 offen offset:1024
 mf v[140:143], a[188:191], a[228:231], v[140:143]
 v_add_u32 v18, s100, v18
 v_add_u32 v18, f_qp-parallel_sum__compressed_kv_cla__geglu_ffn__prompt_kernel, v18
 mf v[148:151], a[188:191], a[232:235], v[148:151]
 s_add_u32 s61, s81, s16
 v_min_u32 v18, f_done-parallel_sum__compressed_kv_cla__geglu_ffn__prompt_kernel, v18
 v_add_co_u32 v18, vcc, s98, v18
 mf v[156:159], a[188:191], a[236:239], v[156:159]
 s_waitcnt lgkmcnt(4)
 s_add_u32 s61, s61, 0x3000
 ds_read_b64_tr_b16 a[188:189], v13 offset:20544
 ds_read_b64_tr_b16 a[190:191], v13 offset:21824
 mf v[164:167], a[176:179], a[224:227], v[164:167]
 buffer_load_dwordx4 a[212:215], v4, s[48:51], s61 offen offset:1024
 mf v[172:175], a[176:179], a[228:231], v[172:175]
 v_mov_b32 v19, s99
 v_addc_co_u32 v19, vcc, 0, v19, vcc
 mf v[180:183], a[176:179], a[232:235], v[180:183]
 s_add_u32 s61, s82, 0x3000
 buffer_load_dwordx4 a[216:219], v4, s[48:51], s61 offen offset:1024
 mf v[188:191], a[176:179], a[236:239], v[188:191]
 s_waitcnt lgkmcnt(4)
 ds_read_b64_tr_b16 a[176:177], v12 offset:128
 ds_read_b64_tr_b16 a[178:179], v12 offset:1408
 mf v[196:199], a[180:183], a[224:227], v[196:199]
 s_add_u32 s61, s82, s16
 global_load_dword v16, v[18:19], off
 mf v[204:207], a[180:183], a[228:231], v[204:207]
 s_add_u32 s61, s61, 0x3000
 buffer_load_dwordx4 a[220:223], v4, s[48:51], s61 offen offset:1024
 mf v[212:215], a[180:183], a[232:235], v[212:215]
 s_mov_b32 s56, s8
 mf v[220:223], a[180:183], a[236:239], v[220:223]
 s_waitcnt lgkmcnt(4)
 s_mov_b32 s57, s9
 ds_read_b64_tr_b16 a[180:181], v12 offset:20608
 ds_read_b64_tr_b16 a[182:183], v12 offset:21888
 mf v[228:231], a[184:187], a[224:227], v[228:231]
 s_mov_b32 s58, 0x480000
 mf v[236:239], a[184:187], a[228:231], v[236:239]
 s_mov_b32 s59, 0x20000
 v_add_u32 v17, 0x400000, v7
 mf v[244:247], a[184:187], a[232:235], v[244:247]
 buffer_load_dword v16, v17, s[56:59], 0 offen
 mf v[252:255], a[184:187], a[236:239], v[252:255]
 s_waitcnt lgkmcnt(4)
 ds_read_b64_tr_b16 a[184:185], v13 offset:128
 ds_read_b64_tr_b16 a[186:187], v13 offset:1408
 mf a[0:3], a[188:191], a[224:227], a[0:3]
 s_mov_b32 s60, 0x3f0000
 mf a[4:7], a[188:191], a[228:231], a[4:7]
 s_add_u32 m0, s78, 0xa000
 mf a[8:11], a[188:191], a[232:235], a[8:11]
 buffer_load_dwordx4 v20, s[44:47], s60 offen lds
 mf a[12:15], a[188:191], a[236:239], a[12:15]
 s_waitcnt lgkmcnt(4)
 ds_read_b64_tr_b16 a[188:189], v13 offset:20608
 ds_read_b64_tr_b16 a[190:191], v13 offset:21888
 mf a[16:19], a[176:179], a[224:227], a[16:19]
 mf a[20:23], a[176:179], a[228:231], a[20:23]
 s_add_u32 m0, s78, 0xa400
 mf a[24:27], a[176:179], a[232:235], a[24:27]
 buffer_load_dwordx4 v21, s[44:47], s60 offen lds
 mf a[28:31], a[176:179], a[236:239], a[28:31]
 s_waitcnt lgkmcnt(4)
 ds_read_b64_tr_b16 a[176:177], v12 offset:192
 ds_read_b64_tr_b16 a[178:179], v12 offset:1472
 mf a[32:35], a[180:183], a[224:227], a[32:35]
 mf a[36:39], a[180:183], a[228:231], a[36:39]
 mf a[40:43], a[180:183], a[232:235], a[40:43]
 s_add_u32 m0, s78, 0xa800
 mf a[44:47], a[180:183], a[236:239], a[44:47]
 s_waitcnt lgkmcnt(4)
 ds_read_b64_tr_b16 a[180:181], v12 offset:20672
 ds_read_b64_tr_b16 a[182:183], v12 offset:21952
 mf a[48:51], a[184:187], a[224:227], a[48:51]
 buffer_load_dwordx4 v22, s[44:47], s60 offen lds
 mf a[52:55], a[184:187], a[228:231], a[52:55]
 mf a[56:59], a[184:187], a[232:235], a[56:59]
 mf a[60:63], a[184:187], a[236:239], a[60:63]
 s_waitcnt lgkmcnt(4)
 s_add_u32 m0, s78, 0xac00
 ds_read_b64_tr_b16 a[184:185], v13 offset:192
 ds_read_b64_tr_b16 a[186:187], v13 offset:1472
 mf a[64:67], a[188:191], a[224:227], a[64:67]
 buffer_load_dwordx4 v23, s[44:47], s60 offen lds
 mf a[68:71], a[188:191], a[228:231], a[68:71]
 mf a[72:75], a[188:191], a[232:235], a[72:75]
 mf a[76:79], a[188:191], a[236:239], a[76:79]
 s_waitcnt lgkmcnt(4)
 ds_read_b64_tr_b16 a[188:189], v13 offset:20672
 ds_read_b64_tr_b16 a[190:191], v13 offset:21952
 mf a[80:83], a[176:179], a[224:227], a[80:83]
 s_add_u32 m0, s78, 0xb000
 mf a[84:87], a[176:179], a[228:231], a[84:87]
 buffer_load_dwordx4 v24, s[44:47], s60 offen lds
 mf a[88:91], a[176:179], a[232:235], a[88:91]
 mf a[92:95], a[176:179], a[236:239], a[92:95]
 s_waitcnt lgkmcnt(4)
 ds_read_b64_tr_b16 a[176:177], v12 offset:256
 ds_read_b64_tr_b16 a[178:179], v12 offset:1536
 mf a[96:99], a[180:183], a[224:227], a[96:99]
 mf a[100:103], a[180:183], a[228:231], a[100:103]
 s_add_u32 m0, s78, 0xb400
 mf a[104:107], a[180:183], a[232:235], a[104:107]
 buffer_load_dwordx4 v25, s[44:47], s60 offen lds
 mf a[108:111], a[180:183], a[236:239], a[108:111]
 s_waitcnt lgkmcnt(4)
 ds_read_b64_tr_b16 a[180:181], v12 offset:20736
 ds_read_b64_tr_b16 a[182:183], v12 offset:22016
 mf a[112:115], a[184:187], a[224:227], a[112:115]
 mf a[116:119], a[184:187], a[228:231], a[116:119]
 mf a[120:123], a[184:187], a[232:235], a[120:123]
 s_add_u32 m0, s78, 0xb800
 mf a[124:127], a[184:187], a[236:239], a[124:127]
 s_waitcnt lgkmcnt(4)
 ds_read_b64_tr_b16 a[184:185], v12 offset:10240
 ds_read_b64_tr_b16 a[186:187], v12 offset:11520
 mf a[128:131], a[188:191], a[224:227], a[128:131]
 buffer_load_dwordx4 v26, s[44:47], s60 offen lds
 mf a[132:135], a[188:191], a[228:231], a[132:135]
 mf a[136:139], a[188:191], a[232:235], a[136:139]
 mf a[140:143], a[188:191], a[236:239], a[140:143]
 s_waitcnt lgkmcnt(4)
 s_add_u32 m0, s78, 0xbc00
 ds_read_b64_tr_b16 a[188:189], v12 offset:30720
 ds_read_b64_tr_b16 a[190:191], v12 offset:32000
 mf a[144:147], a[176:179], a[224:227], a[144:147]
 buffer_load_dwordx4 v27, s[44:47], s60 offen lds
 mf a[148:151], a[176:179], a[228:231], a[148:151]
 mf a[152:155], a[176:179], a[232:235], a[152:155]
 mf a[156:159], a[176:179], a[236:239], a[156:159]
 s_waitcnt lgkmcnt(4)
 ds_read_b64_tr_b16 a[176:177], v13 offset:10240
 ds_read_b64_tr_b16 a[178:179], v13 offset:11520
 mf a[160:163], a[180:183], a[224:227], a[160:163]
 s_add_u32 m0, s78, 0xc000
 mf a[164:167], a[180:183], a[228:231], a[164:167]
 buffer_load_dwordx4 v28, s[44:47], s60 offen lds
 mf a[168:171], a[180:183], a[232:235], a[168:171]
 mf a[172:175], a[180:183], a[236:239], a[172:175]
 s_waitcnt vmcnt(36) lgkmcnt(4)
 ds_read_b64_tr_b16 a[180:181], v13 offset:30720
 ds_read_b64_tr_b16 a[182:183], v13 offset:32000
 mf v[36:39], a[184:187], a[240:243], v[36:39]
 s_waitcnt vmcnt(35)
 mf v[44:47], a[184:187], a[244:247], v[44:47]
 s_waitcnt vmcnt(34)
 s_add_u32 m0, s78, 0xc400
 mf v[52:55], a[184:187], a[248:251], v[52:55]
 s_waitcnt vmcnt(33)
 buffer_load_dwordx4 v29, s[44:47], s60 offen lds
 mf v[60:63], a[184:187], a[252:255], v[60:63]
 s_waitcnt lgkmcnt(4)
 ds_read_b64_tr_b16 a[184:185], v12 offset:10304
 ds_read_b64_tr_b16 a[186:187], v12 offset:11584
 mf v[68:71], a[188:191], a[240:243], v[68:71]
 mf v[76:79], a[188:191], a[244:247], v[76:79]
 mf v[84:87], a[188:191], a[248:251], v[84:87]
 mf v[92:95], a[188:191], a[252:255], v[92:95]
 s_waitcnt lgkmcnt(4)
 ds_read_b64_tr_b16 a[188:189], v12 offset:30784
 ds_read_b64_tr_b16 a[190:191], v12 offset:32064
 mf v[100:103], a[176:179], a[240:243], v[100:103]
 mf v[108:111], a[176:179], a[244:247], v[108:111]
 mf v[116:119], a[176:179], a[248:251], v[116:119]
 mf v[124:127], a[176:179], a[252:255], v[124:127]
 s_waitcnt lgkmcnt(4)
 ds_read_b64_tr_b16 a[176:177], v13 offset:10304
 ds_read_b64_tr_b16 a[178:179], v13 offset:11584
 mf v[132:135], a[180:183], a[240:243], v[132:135]
 mf v[140:143], a[180:183], a[244:247], v[140:143]
 mf v[148:151], a[180:183], a[248:251], v[148:151]
 mf v[156:159], a[180:183], a[252:255], v[156:159]
 s_waitcnt lgkmcnt(4)
 ds_read_b64_tr_b16 a[180:181], v13 offset:30784
 ds_read_b64_tr_b16 a[182:183], v13 offset:32064
 mf v[164:167], a[184:187], a[240:243], v[164:167]
 mf v[172:175], a[184:187], a[244:247], v[172:175]
 mf v[180:183], a[184:187], a[248:251], v[180:183]
 mf v[188:191], a[184:187], a[252:255], v[188:191]
 s_waitcnt lgkmcnt(4)
 ds_read_b64_tr_b16 a[184:185], v12 offset:10368
 ds_read_b64_tr_b16 a[186:187], v12 offset:11648
 mf v[196:199], a[188:191], a[240:243], v[196:199]
 mf v[204:207], a[188:191], a[244:247], v[204:207]
 mf v[212:215], a[188:191], a[248:251], v[212:215]
 mf v[220:223], a[188:191], a[252:255], v[220:223]
 s_waitcnt lgkmcnt(4)
 ds_read_b64_tr_b16 a[188:189], v12 offset:30848
 ds_read_b64_tr_b16 a[190:191], v12 offset:32128
 mf v[228:231], a[176:179], a[240:243], v[228:231]
 s_add_u32 s62, s73, 0x3000
 buffer_store_dwordx4 v[144:147], v4, s[40:43], s62 offen offset:2048 sc1
 mf v[236:239], a[176:179], a[244:247], v[236:239]
 mf v[244:247], a[176:179], a[248:251], v[244:247]
 mf v[252:255], a[176:179], a[252:255], v[252:255]
 s_waitcnt lgkmcnt(4)
 ds_read_b64_tr_b16 a[176:177], v13 offset:10368
 ds_read_b64_tr_b16 a[178:179], v13 offset:11648
 mf a[0:3], a[180:183], a[240:243], a[0:3]
 mf a[4:7], a[180:183], a[244:247], a[4:7]
 mf a[8:11], a[180:183], a[248:251], a[8:11]
 mf a[12:15], a[180:183], a[252:255], a[12:15]
 s_waitcnt lgkmcnt(4)
 ds_read_b64_tr_b16 a[180:181], v13 offset:30848
 ds_read_b64_tr_b16 a[182:183], v13 offset:32128
 mf a[16:19], a[184:187], a[240:243], a[16:19]
 mf a[20:23], a[184:187], a[244:247], a[20:23]
 mf a[24:27], a[184:187], a[248:251], a[24:27]
 mf a[28:31], a[184:187], a[252:255], a[28:31]
 s_waitcnt lgkmcnt(4)
 ds_read_b64_tr_b16 a[184:185], v12 offset:10432
 ds_read_b64_tr_b16 a[186:187], v12 offset:11712
 mf a[32:35], a[188:191], a[240:243], a[32:35]
 s_add_u32 s62, s73, 0x3000
 buffer_store_dwordx4 v[152:155], v4, s[40:43], s62 offen offset:3072 sc1
 mf a[36:39], a[188:191], a[244:247], a[36:39]
 mf a[40:43], a[188:191], a[248:251], a[40:43]
 mf a[44:47], a[188:191], a[252:255], a[44:47]
 s_waitcnt lgkmcnt(4)
 ds_read_b64_tr_b16 a[188:189], v12 offset:30912
 ds_read_b64_tr_b16 a[190:191], v12 offset:32192
 mf a[48:51], a[176:179], a[240:243], a[48:51]
 mf a[52:55], a[176:179], a[244:247], a[52:55]
 mf a[56:59], a[176:179], a[248:251], a[56:59]
 mf a[60:63], a[176:179], a[252:255], a[60:63]
 s_waitcnt lgkmcnt(4)
 ds_read_b64_tr_b16 a[176:177], v13 offset:10432
 ds_read_b64_tr_b16 a[178:179], v13 offset:11712
 mf a[64:67], a[180:183], a[240:243], a[64:67]
 mf a[68:71], a[180:183], a[244:247], a[68:71]
 mf a[72:75], a[180:183], a[248:251], a[72:75]
 mf a[76:79], a[180:183], a[252:255], a[76:79]
 s_waitcnt lgkmcnt(4)
 ds_read_b64_tr_b16 a[180:181], v13 offset:30912
 ds_read_b64_tr_b16 a[182:183], v13 offset:32192
 mf a[80:83], a[184:187], a[240:243], a[80:83]
 s_add_u32 s62, s73, 0x8000
 buffer_store_dwordx4 v[160:163], v4, s[40:43], s62 offen sc1
 mf a[84:87], a[184:187], a[244:247], a[84:87]
 mf a[88:91], a[184:187], a[248:251], a[88:91]
 mf a[92:95], a[184:187], a[252:255], a[92:95]
 s_waitcnt lgkmcnt(4)
 ds_read_b64_tr_b16 a[184:185], v12 offset:10496
 ds_read_b64_tr_b16 a[186:187], v12 offset:11776
 mf a[96:99], a[188:191], a[240:243], a[96:99]
 mf a[100:103], a[188:191], a[244:247], a[100:103]
 mf a[104:107], a[188:191], a[248:251], a[104:107]
 mf a[108:111], a[188:191], a[252:255], a[108:111]
 s_waitcnt lgkmcnt(4)
 ds_read_b64_tr_b16 a[188:189], v12 offset:30976
 ds_read_b64_tr_b16 a[190:191], v12 offset:32256
 mf a[112:115], a[176:179], a[240:243], a[112:115]
 mf a[116:119], a[176:179], a[244:247], a[116:119]
 mf a[120:123], a[176:179], a[248:251], a[120:123]
 mf a[124:127], a[176:179], a[252:255], a[124:127]
 s_waitcnt lgkmcnt(4)
 mf a[128:131], a[180:183], a[240:243], a[128:131]
 mf a[132:135], a[180:183], a[244:247], a[132:135]
 s_waitcnt vmcnt(26)
 s_waitcnt lgkmcnt(0)
 s_barrier
 mf a[136:139], a[180:183], a[248:251], a[136:139]
 ds_read_b64_tr_b16 a[176:177], v8
 ds_read_b64_tr_b16 a[178:179], v8 offset:1280
 mf a[140:143], a[180:183], a[252:255], a[140:143]
 ds_read_b64_tr_b16 a[180:181], v8 offset:20480
 ds_read_b64_tr_b16 a[182:183], v8 offset:21760
 mf a[144:147], a[184:187], a[240:243], a[144:147]
 mf a[148:151], a[184:187], a[244:247], a[148:151]
 mf a[152:155], a[184:187], a[248:251], a[152:155]
 mf a[156:159], a[184:187], a[252:255], a[156:159]
 ds_read_b64_tr_b16 a[184:185], v9
 ds_read_b64_tr_b16 a[186:187], v9 offset:1280
 mf a[160:163], a[188:191], a[240:243], a[160:163]
 mf a[164:167], a[188:191], a[244:247], a[164:167]
 mf a[168:171], a[188:191], a[248:251], a[168:171]
 mf a[172:175], a[188:191], a[252:255], a[172:175]
 s_waitcnt vmcnt(22) lgkmcnt(4)
 ds_read_b64_tr_b16 a[188:189], v9 offset:20480
 ds_read_b64_tr_b16 a[190:191], v9 offset:21760
 mf v[36:39], a[176:179], a[192:195], v[36:39]
 s_waitcnt vmcnt(21)
 s_add_u32 s61, s81, 0x3800
 buffer_load_dwordx4 a[224:227], v4, s[48:51], s61 offen
 mf v[44:47], a[176:179], a[196:199], v[44:47]
 s_waitcnt vmcnt(21)
 mf v[52:55], a[176:179], a[200:203], v[52:55]
 s_waitcnt vmcnt(20)
 s_add_u32 s61, s81, s16
 mf v[60:63], a[176:179], a[204:207], v[60:63]
 s_waitcnt lgkmcnt(4)
 s_add_u32 s61, s61, 0x3800
 ds_read_b64_tr_b16 a[176:177], v8 offset:64
 ds_read_b64_tr_b16 a[178:179], v8 offset:1344
 mf v[68:71], a[180:183], a[192:195], v[68:71]
 buffer_load_dwordx4 a[228:231], v4, s[48:51], s61 offen
 mf v[76:79], a[180:183], a[196:199], v[76:79]
 mf v[84:87], a[180:183], a[200:203], v[84:87]
 s_add_u32 s61, s82, 0x3800
 buffer_load_dwordx4 a[232:235], v4, s[48:51], s61 offen
 mf v[92:95], a[180:183], a[204:207], v[92:95]
 s_waitcnt lgkmcnt(4)
 ds_read_b64_tr_b16 a[180:181], v8 offset:20544
 ds_read_b64_tr_b16 a[182:183], v8 offset:21824
 mf v[100:103], a[184:187], a[192:195], v[100:103]
 s_add_u32 s61, s82, s16
 mf v[108:111], a[184:187], a[196:199], v[108:111]
 s_add_u32 s61, s61, 0x3800
 buffer_load_dwordx4 a[236:239], v4, s[48:51], s61 offen
 mf v[116:119], a[184:187], a[200:203], v[116:119]
 mf v[124:127], a[184:187], a[204:207], v[124:127]
 s_waitcnt lgkmcnt(4)
 s_add_u32 s61, s81, 0x3800
 ds_read_b64_tr_b16 a[184:185], v9 offset:64
 ds_read_b64_tr_b16 a[186:187], v9 offset:1344
 mf v[132:135], a[188:191], a[192:195], v[132:135]
 buffer_load_dwordx4 a[240:243], v4, s[48:51], s61 offen offset:1024
 mf v[140:143], a[188:191], a[196:199], v[140:143]
 mf v[148:151], a[188:191], a[200:203], v[148:151]
 s_add_u32 s61, s81, s16
 mf v[156:159], a[188:191], a[204:207], v[156:159]
 s_waitcnt lgkmcnt(4)
 s_add_u32 s61, s61, 0x3800
 ds_read_b64_tr_b16 a[188:189], v9 offset:20544
 ds_read_b64_tr_b16 a[190:191], v9 offset:21824
 mf v[164:167], a[176:179], a[192:195], v[164:167]
 buffer_load_dwordx4 a[244:247], v4, s[48:51], s61 offen offset:1024
 mf v[172:175], a[176:179], a[196:199], v[172:175]
 mf v[180:183], a[176:179], a[200:203], v[180:183]
 s_add_u32 s61, s82, 0x3800
 buffer_load_dwordx4 a[248:251], v4, s[48:51], s61 offen offset:1024
 mf v[188:191], a[176:179], a[204:207], v[188:191]
 s_waitcnt lgkmcnt(4)
 ds_read_b64_tr_b16 a[176:177], v8 offset:128
 ds_read_b64_tr_b16 a[178:179], v8 offset:1408
 mf v[196:199], a[180:183], a[192:195], v[196:199]
 s_add_u32 s61, s82, s16
 mf v[204:207], a[180:183], a[196:199], v[204:207]
 s_add_u32 s61, s61, 0x3800
 buffer_load_dwordx4 a[252:255], v4, s[48:51], s61 offen offset:1024
 mf v[212:215], a[180:183], a[200:203], v[212:215]
 mf v[220:223], a[180:183], a[204:207], v[220:223]
 s_waitcnt lgkmcnt(4)
 ds_read_b64_tr_b16 a[180:181], v8 offset:20608
 ds_read_b64_tr_b16 a[182:183], v8 offset:21888
 mf v[228:231], a[184:187], a[192:195], v[228:231]
 mf v[236:239], a[184:187], a[196:199], v[236:239]
 mf v[244:247], a[184:187], a[200:203], v[244:247]
 mf v[252:255], a[184:187], a[204:207], v[252:255]
 s_waitcnt lgkmcnt(4)
 ds_read_b64_tr_b16 a[184:185], v9 offset:128
 ds_read_b64_tr_b16 a[186:187], v9 offset:1408
 mf a[0:3], a[188:191], a[192:195], a[0:3]
 s_mov_b32 s60, 0x480000
 mf a[4:7], a[188:191], a[196:199], a[4:7]
 s_add_u32 m0, s78, 0x14000
 mf a[8:11], a[188:191], a[200:203], a[8:11]
 buffer_load_dwordx4 v20, s[44:47], s60 offen lds
 mf a[12:15], a[188:191], a[204:207], a[12:15]
 s_waitcnt lgkmcnt(4)
 ds_read_b64_tr_b16 a[188:189], v9 offset:20608
 ds_read_b64_tr_b16 a[190:191], v9 offset:21888
 mf a[16:19], a[176:179], a[192:195], a[16:19]
 mf a[20:23], a[176:179], a[196:199], a[20:23]
 s_add_u32 m0, s78, 0x14400
 mf a[24:27], a[176:179], a[200:203], a[24:27]
 buffer_load_dwordx4 v21, s[44:47], s60 offen lds
 mf a[28:31], a[176:179], a[204:207], a[28:31]
 s_waitcnt lgkmcnt(4)
 ds_read_b64_tr_b16 a[176:177], v8 offset:192
 ds_read_b64_tr_b16 a[178:179], v8 offset:1472
 mf a[32:35], a[180:183], a[192:195], a[32:35]
 mf a[36:39], a[180:183], a[196:199], a[36:39]
 mf a[40:43], a[180:183], a[200:203], a[40:43]
 s_add_u32 m0, s78, 0x14800
 mf a[44:47], a[180:183], a[204:207], a[44:47]
 s_waitcnt lgkmcnt(4)
 ds_read_b64_tr_b16 a[180:181], v8 offset:20672
 ds_read_b64_tr_b16 a[182:183], v8 offset:21952
 mf a[48:51], a[184:187], a[192:195], a[48:51]
 buffer_load_dwordx4 v22, s[44:47], s60 offen lds
 mf a[52:55], a[184:187], a[196:199], a[52:55]
 mf a[56:59], a[184:187], a[200:203], a[56:59]
 mf a[60:63], a[184:187], a[204:207], a[60:63]
 s_waitcnt lgkmcnt(4)
 s_add_u32 m0, s78, 0x14c00
 ds_read_b64_tr_b16 a[184:185], v9 offset:192
 ds_read_b64_tr_b16 a[186:187], v9 offset:1472
 mf a[64:67], a[188:191], a[192:195], a[64:67]
 buffer_load_dwordx4 v23, s[44:47], s60 offen lds
 mf a[68:71], a[188:191], a[196:199], a[68:71]
 mf a[72:75], a[188:191], a[200:203], a[72:75]
 mf a[76:79], a[188:191], a[204:207], a[76:79]
 s_waitcnt lgkmcnt(4)
 ds_read_b64_tr_b16 a[188:189], v9 offset:20672
 ds_read_b64_tr_b16 a[190:191], v9 offset:21952
 mf a[80:83], a[176:179], a[192:195], a[80:83]
 s_add_u32 m0, s78, 0x15000
 mf a[84:87], a[176:179], a[196:199], a[84:87]
 buffer_load_dwordx4 v24, s[44:47], s60 offen lds
 mf a[88:91], a[176:179], a[200:203], a[88:91]
 mf a[92:95], a[176:179], a[204:207], a[92:95]
 s_waitcnt lgkmcnt(4)
 ds_read_b64_tr_b16 a[176:177], v8 offset:256
 ds_read_b64_tr_b16 a[178:179], v8 offset:1536
 mf a[96:99], a[180:183], a[192:195], a[96:99]
 mf a[100:103], a[180:183], a[196:199], a[100:103]
 s_add_u32 m0, s78, 0x15400
 mf a[104:107], a[180:183], a[200:203], a[104:107]
 buffer_load_dwordx4 v25, s[44:47], s60 offen lds
 mf a[108:111], a[180:183], a[204:207], a[108:111]
 s_waitcnt lgkmcnt(4)
 ds_read_b64_tr_b16 a[180:181], v8 offset:20736
 ds_read_b64_tr_b16 a[182:183], v8 offset:22016
 mf a[112:115], a[184:187], a[192:195], a[112:115]
 mf a[116:119], a[184:187], a[196:199], a[116:119]
 mf a[120:123], a[184:187], a[200:203], a[120:123]
 s_add_u32 m0, s78, 0x15800
 mf a[124:127], a[184:187], a[204:207], a[124:127]
 s_waitcnt lgkmcnt(4)
 ds_read_b64_tr_b16 a[184:185], v8 offset:10240
 ds_read_b64_tr_b16 a[186:187], v8 offset:11520
 mf a[128:131], a[188:191], a[192:195], a[128:131]
 buffer_load_dwordx4 v26, s[44:47], s60 offen lds
 mf a[132:135], a[188:191], a[196:199], a[132:135]
 mf a[136:139], a[188:191], a[200:203], a[136:139]
 mf a[140:143], a[188:191], a[204:207], a[140:143]
 s_waitcnt lgkmcnt(4)
 s_add_u32 m0, s78, 0x15c00
 ds_read_b64_tr_b16 a[188:189], v8 offset:30720
 ds_read_b64_tr_b16 a[190:191], v8 offset:32000
 mf a[144:147], a[176:179], a[192:195], a[144:147]
 buffer_load_dwordx4 v27, s[44:47], s60 offen lds
 mf a[148:151], a[176:179], a[196:199], a[148:151]
 mf a[152:155], a[176:179], a[200:203], a[152:155]
 mf a[156:159], a[176:179], a[204:207], a[156:159]
 s_waitcnt lgkmcnt(4)
 ds_read_b64_tr_b16 a[176:177], v9 offset:10240
 ds_read_b64_tr_b16 a[178:179], v9 offset:11520
 mf a[160:163], a[180:183], a[192:195], a[160:163]
 s_add_u32 m0, s78, 0x16000
 mf a[164:167], a[180:183], a[196:199], a[164:167]
 buffer_load_dwordx4 v28, s[44:47], s60 offen lds
 mf a[168:171], a[180:183], a[200:203], a[168:171]
 mf a[172:175], a[180:183], a[204:207], a[172:175]
 s_waitcnt vmcnt(35) lgkmcnt(4)
 ds_read_b64_tr_b16 a[180:181], v9 offset:30720
 ds_read_b64_tr_b16 a[182:183], v9 offset:32000
 mf v[36:39], a[184:187], a[208:211], v[36:39]
 s_waitcnt vmcnt(34)
 mf v[44:47], a[184:187], a[212:215], v[44:47]
 s_waitcnt vmcnt(33)
 s_add_u32 m0, s78, 0x16400
 mf v[52:55], a[184:187], a[216:219], v[52:55]
 s_waitcnt vmcnt(31)
 buffer_load_dwordx4 v29, s[44:47], s60 offen lds
 mf v[60:63], a[184:187], a[220:223], v[60:63]
 s_waitcnt lgkmcnt(4)
 ds_read_b64_tr_b16 a[184:185], v8 offset:10304
 ds_read_b64_tr_b16 a[186:187], v8 offset:11584
 mf v[68:71], a[188:191], a[208:211], v[68:71]
 mf v[76:79], a[188:191], a[212:215], v[76:79]
 mf v[84:87], a[188:191], a[216:219], v[84:87]
 mf v[92:95], a[188:191], a[220:223], v[92:95]
 s_waitcnt lgkmcnt(4)
 ds_read_b64_tr_b16 a[188:189], v8 offset:30784
 ds_read_b64_tr_b16 a[190:191], v8 offset:32064
 mf v[100:103], a[176:179], a[208:211], v[100:103]
 mf v[108:111], a[176:179], a[212:215], v[108:111]
 mf v[116:119], a[176:179], a[216:219], v[116:119]
 mf v[124:127], a[176:179], a[220:223], v[124:127]
 s_waitcnt lgkmcnt(4)
 ds_read_b64_tr_b16 a[176:177], v9 offset:10304
 ds_read_b64_tr_b16 a[178:179], v9 offset:11584
 mf v[132:135], a[180:183], a[208:211], v[132:135]
 mf v[140:143], a[180:183], a[212:215], v[140:143]
 mf v[148:151], a[180:183], a[216:219], v[148:151]
 mf v[156:159], a[180:183], a[220:223], v[156:159]
 s_waitcnt lgkmcnt(4)
 ds_read_b64_tr_b16 a[180:181], v9 offset:30784
 ds_read_b64_tr_b16 a[182:183], v9 offset:32064
 mf v[164:167], a[184:187], a[208:211], v[164:167]
 mf v[172:175], a[184:187], a[212:215], v[172:175]
 mf v[180:183], a[184:187], a[216:219], v[180:183]
 mf v[188:191], a[184:187], a[220:223], v[188:191]
 s_waitcnt lgkmcnt(4)
 ds_read_b64_tr_b16 a[184:185], v8 offset:10368
 ds_read_b64_tr_b16 a[186:187], v8 offset:11648
 mf v[196:199], a[188:191], a[208:211], v[196:199]
 mf v[204:207], a[188:191], a[212:215], v[204:207]
 mf v[212:215], a[188:191], a[216:219], v[212:215]
 mf v[220:223], a[188:191], a[220:223], v[220:223]
 s_waitcnt lgkmcnt(4)
 ds_read_b64_tr_b16 a[188:189], v8 offset:30848
 ds_read_b64_tr_b16 a[190:191], v8 offset:32128
 mf v[228:231], a[176:179], a[208:211], v[228:231]
 s_add_u32 s62, s73, 0x8000
 buffer_store_dwordx4 v[168:171], v4, s[40:43], s62 offen offset:1024 sc1
 mf v[236:239], a[176:179], a[212:215], v[236:239]
 mf v[244:247], a[176:179], a[216:219], v[244:247]
 mf v[252:255], a[176:179], a[220:223], v[252:255]
 s_waitcnt lgkmcnt(4)
 ds_read_b64_tr_b16 a[176:177], v9 offset:10368
 ds_read_b64_tr_b16 a[178:179], v9 offset:11648
 mf a[0:3], a[180:183], a[208:211], a[0:3]
 s_add_u32 m0, s86, 0x20000
 mf a[4:7], a[180:183], a[212:215], a[4:7]
 s_mov_b32 s31, 0x400000
 mf a[8:11], a[180:183], a[216:219], a[8:11]
 buffer_load_dwordx4 v15, s[32:35], s31 offen lds
 mf a[12:15], a[180:183], a[220:223], a[12:15]
 s_waitcnt lgkmcnt(4)
 ds_read_b64_tr_b16 a[180:181], v9 offset:30848
 ds_read_b64_tr_b16 a[182:183], v9 offset:32128
 mf a[16:19], a[184:187], a[208:211], a[16:19]
 s_add_u32 m0, s86, 0x21000
 mf a[20:23], a[184:187], a[212:215], a[20:23]
 s_mov_b32 s31, 0x420000
 mf a[24:27], a[184:187], a[216:219], a[24:27]
 buffer_load_dwordx4 v15, s[32:35], s31 offen lds
 mf a[28:31], a[184:187], a[220:223], a[28:31]
 s_waitcnt lgkmcnt(4)
 ds_read_b64_tr_b16 a[184:185], v8 offset:10432
 ds_read_b64_tr_b16 a[186:187], v8 offset:11712
 mf a[32:35], a[188:191], a[208:211], a[32:35]
 s_add_u32 s62, s73, 0x8000
 buffer_store_dwordx4 v[176:179], v4, s[40:43], s62 offen offset:2048 sc1
 mf a[36:39], a[188:191], a[212:215], a[36:39]
 s_add_u32 m0, s86, 0x22000
 mf a[40:43], a[188:191], a[216:219], a[40:43]
 s_mov_b32 s31, 0x440000
 mf a[44:47], a[188:191], a[220:223], a[44:47]
 s_waitcnt lgkmcnt(4)
 ds_read_b64_tr_b16 a[188:189], v8 offset:30912
 ds_read_b64_tr_b16 a[190:191], v8 offset:32192
 mf a[48:51], a[176:179], a[208:211], a[48:51]
 buffer_load_dwordx4 v15, s[32:35], s31 offen lds
 mf a[52:55], a[176:179], a[212:215], a[52:55]
 mf a[56:59], a[176:179], a[216:219], a[56:59]
 s_add_u32 m0, s86, 0x23000
 mf a[60:63], a[176:179], a[220:223], a[60:63]
 s_waitcnt lgkmcnt(4)
 s_mov_b32 s31, 0x460000
 ds_read_b64_tr_b16 a[176:177], v9 offset:10432
 ds_read_b64_tr_b16 a[178:179], v9 offset:11712
 mf a[64:67], a[180:183], a[208:211], a[64:67]
 buffer_load_dwordx4 v15, s[32:35], s31 offen lds
 mf a[68:71], a[180:183], a[212:215], a[68:71]
 mf a[72:75], a[180:183], a[216:219], a[72:75]
 mf a[76:79], a[180:183], a[220:223], a[76:79]
 s_waitcnt lgkmcnt(4)
 ds_read_b64_tr_b16 a[180:181], v9 offset:30912
 ds_read_b64_tr_b16 a[182:183], v9 offset:32192
 mf a[80:83], a[184:187], a[208:211], a[80:83]
 s_add_u32 s62, s73, 0x8000
 buffer_store_dwordx4 v[184:187], v4, s[40:43], s62 offen offset:3072 sc1
 mf a[84:87], a[184:187], a[212:215], a[84:87]
 mf a[88:91], a[184:187], a[216:219], a[88:91]
 mf a[92:95], a[184:187], a[220:223], a[92:95]
 s_waitcnt lgkmcnt(4)
 ds_read_b64_tr_b16 a[184:185], v8 offset:10496
 ds_read_b64_tr_b16 a[186:187], v8 offset:11776
 mf a[96:99], a[188:191], a[208:211], a[96:99]
 mf a[100:103], a[188:191], a[212:215], a[100:103]
 mf a[104:107], a[188:191], a[216:219], a[104:107]
 mf a[108:111], a[188:191], a[220:223], a[108:111]
 s_waitcnt lgkmcnt(4)
 ds_read_b64_tr_b16 a[188:189], v8 offset:30976
 ds_read_b64_tr_b16 a[190:191], v8 offset:32256
 mf a[112:115], a[176:179], a[208:211], a[112:115]
 mf a[116:119], a[176:179], a[212:215], a[116:119]
 mf a[120:123], a[176:179], a[216:219], a[120:123]
 mf a[124:127], a[176:179], a[220:223], a[124:127]
 s_waitcnt lgkmcnt(4)
 mf a[128:131], a[180:183], a[208:211], a[128:131]
 mf a[132:135], a[180:183], a[212:215], a[132:135]
 s_waitcnt vmcnt(28)
 s_waitcnt lgkmcnt(0)
 s_barrier
 mf a[136:139], a[180:183], a[216:219], a[136:139]
 ds_read_b64_tr_b16 a[176:177], v10
 ds_read_b64_tr_b16 a[178:179], v10 offset:1280
 mf a[140:143], a[180:183], a[220:223], a[140:143]
 ds_read_b64_tr_b16 a[180:181], v10 offset:20480
 ds_read_b64_tr_b16 a[182:183], v10 offset:21760
 mf a[144:147], a[184:187], a[208:211], a[144:147]
 mf a[148:151], a[184:187], a[212:215], a[148:151]
 mf a[152:155], a[184:187], a[216:219], a[152:155]
 mf a[156:159], a[184:187], a[220:223], a[156:159]
 ds_read_b64_tr_b16 a[184:185], v11
 ds_read_b64_tr_b16 a[186:187], v11 offset:1280
 mf a[160:163], a[188:191], a[208:211], a[160:163]
 mf a[164:167], a[188:191], a[212:215], a[164:167]
 mf a[168:171], a[188:191], a[216:219], a[168:171]
 mf a[172:175], a[188:191], a[220:223], a[172:175]
 s_waitcnt vmcnt(24) lgkmcnt(4)
 ds_read_b64_tr_b16 a[188:189], v11 offset:20480
 ds_read_b64_tr_b16 a[190:191], v11 offset:21760
 mf v[36:39], a[176:179], a[224:227], v[36:39]
 s_waitcnt vmcnt(23)
 s_add_u32 s61, s81, 0x4000
 buffer_load_dwordx4 a[192:195], v4, s[48:51], s61 offen
 mf v[44:47], a[176:179], a[228:231], v[44:47]
 s_waitcnt vmcnt(23)
 mf v[52:55], a[176:179], a[232:235], v[52:55]
 s_waitcnt vmcnt(22)
 s_add_u32 s61, s81, s16
 mf v[60:63], a[176:179], a[236:239], v[60:63]
 s_waitcnt lgkmcnt(4)
 s_add_u32 s61, s61, 0x4000
 ds_read_b64_tr_b16 a[176:177], v10 offset:64
 ds_read_b64_tr_b16 a[178:179], v10 offset:1344
 mf v[68:71], a[180:183], a[224:227], v[68:71]
 buffer_load_dwordx4 a[196:199], v4, s[48:51], s61 offen
 mf v[76:79], a[180:183], a[228:231], v[76:79]
 mf v[84:87], a[180:183], a[232:235], v[84:87]
 s_add_u32 s61, s82, 0x4000
 buffer_load_dwordx4 a[200:203], v4, s[48:51], s61 offen
 mf v[92:95], a[180:183], a[236:239], v[92:95]
 s_waitcnt lgkmcnt(4)
 ds_read_b64_tr_b16 a[180:181], v10 offset:20544
 ds_read_b64_tr_b16 a[182:183], v10 offset:21824
 mf v[100:103], a[184:187], a[224:227], v[100:103]
 s_add_u32 s61, s82, s16
 mf v[108:111], a[184:187], a[228:231], v[108:111]
 s_add_u32 s61, s61, 0x4000
 buffer_load_dwordx4 a[204:207], v4, s[48:51], s61 offen
 mf v[116:119], a[184:187], a[232:235], v[116:119]
 mf v[124:127], a[184:187], a[236:239], v[124:127]
 s_waitcnt lgkmcnt(4)
 s_add_u32 s61, s81, 0x4000
 ds_read_b64_tr_b16 a[184:185], v11 offset:64
 ds_read_b64_tr_b16 a[186:187], v11 offset:1344
 mf v[132:135], a[188:191], a[224:227], v[132:135]
 buffer_load_dwordx4 a[208:211], v4, s[48:51], s61 offen offset:1024
 mf v[140:143], a[188:191], a[228:231], v[140:143]
 mf v[148:151], a[188:191], a[232:235], v[148:151]
 s_add_u32 s61, s81, s16
 mf v[156:159], a[188:191], a[236:239], v[156:159]
 s_waitcnt lgkmcnt(4)
 s_add_u32 s61, s61, 0x4000
 ds_read_b64_tr_b16 a[188:189], v11 offset:20544
 ds_read_b64_tr_b16 a[190:191], v11 offset:21824
 mf v[164:167], a[176:179], a[224:227], v[164:167]
 buffer_load_dwordx4 a[212:215], v4, s[48:51], s61 offen offset:1024
 mf v[172:175], a[176:179], a[228:231], v[172:175]
 mf v[180:183], a[176:179], a[232:235], v[180:183]
 s_add_u32 s61, s82, 0x4000
 buffer_load_dwordx4 a[216:219], v4, s[48:51], s61 offen offset:1024
 mf v[188:191], a[176:179], a[236:239], v[188:191]
 s_waitcnt lgkmcnt(4)
 ds_read_b64_tr_b16 a[176:177], v10 offset:128
 ds_read_b64_tr_b16 a[178:179], v10 offset:1408
 mf v[196:199], a[180:183], a[224:227], v[196:199]
 s_add_u32 s61, s82, s16
 mf v[204:207], a[180:183], a[228:231], v[204:207]
 s_add_u32 s61, s61, 0x4000
 buffer_load_dwordx4 a[220:223], v4, s[48:51], s61 offen offset:1024
 mf v[212:215], a[180:183], a[232:235], v[212:215]
 mf v[220:223], a[180:183], a[236:239], v[220:223]
 s_waitcnt lgkmcnt(4)
 ds_read_b64_tr_b16 a[180:181], v10 offset:20608
 ds_read_b64_tr_b16 a[182:183], v10 offset:21888
 mf v[228:231], a[184:187], a[224:227], v[228:231]
 mf v[236:239], a[184:187], a[228:231], v[236:239]
 mf v[244:247], a[184:187], a[232:235], v[244:247]
 mf v[252:255], a[184:187], a[236:239], v[252:255]
 s_waitcnt lgkmcnt(4)
 ds_read_b64_tr_b16 a[184:185], v11 offset:128
 ds_read_b64_tr_b16 a[186:187], v11 offset:1408
 mf a[0:3], a[188:191], a[224:227], a[0:3]
 mf a[4:7], a[188:191], a[228:231], a[4:7]
 mf a[8:11], a[188:191], a[232:235], a[8:11]
 mf a[12:15], a[188:191], a[236:239], a[12:15]
 s_waitcnt lgkmcnt(4)
 ds_read_b64_tr_b16 a[188:189], v11 offset:20608
 ds_read_b64_tr_b16 a[190:191], v11 offset:21888
 mf a[16:19], a[176:179], a[224:227], a[16:19]
 mf a[20:23], a[176:179], a[228:231], a[20:23]
 s_add_u32 m0, s86, 0
 mf a[24:27], a[176:179], a[232:235], a[24:27]
 s_mov_b32 s31, 0
 mf a[28:31], a[176:179], a[236:239], a[28:31]
 s_waitcnt lgkmcnt(4)
 ds_read_b64_tr_b16 a[176:177], v10 offset:192
 ds_read_b64_tr_b16 a[178:179], v10 offset:1472
 mf a[32:35], a[180:183], a[224:227], a[32:35]
 buffer_load_dwordx4 v15, s[32:35], s31 offen lds
 mf a[36:39], a[180:183], a[228:231], a[36:39]
 mf a[40:43], a[180:183], a[232:235], a[40:43]
 s_add_u32 m0, s86, 0x1000
 mf a[44:47], a[180:183], a[236:239], a[44:47]
 s_waitcnt lgkmcnt(4)
 s_mov_b32 s31, 0x20000
 ds_read_b64_tr_b16 a[180:181], v10 offset:20672
 ds_read_b64_tr_b16 a[182:183], v10 offset:21952
 mf a[48:51], a[184:187], a[224:227], a[48:51]
 buffer_load_dwordx4 v15, s[32:35], s31 offen lds
 mf a[52:55], a[184:187], a[228:231], a[52:55]
 mf a[56:59], a[184:187], a[232:235], a[56:59]
 s_add_u32 m0, s86, 0x2000
 mf a[60:63], a[184:187], a[236:239], a[60:63]
 s_waitcnt lgkmcnt(4)
 s_mov_b32 s31, 0x40000
 ds_read_b64_tr_b16 a[184:185], v11 offset:192
 ds_read_b64_tr_b16 a[186:187], v11 offset:1472
 mf a[64:67], a[188:191], a[224:227], a[64:67]
 buffer_load_dwordx4 v15, s[32:35], s31 offen lds
 mf a[68:71], a[188:191], a[228:231], a[68:71]
 mf a[72:75], a[188:191], a[232:235], a[72:75]
 s_add_u32 m0, s86, 0x3000
 mf a[76:79], a[188:191], a[236:239], a[76:79]
 s_waitcnt lgkmcnt(4)
 s_mov_b32 s31, 0x60000
 ds_read_b64_tr_b16 a[188:189], v11 offset:20672
 ds_read_b64_tr_b16 a[190:191], v11 offset:21952
 mf a[80:83], a[176:179], a[224:227], a[80:83]
 buffer_load_dwordx4 v15, s[32:35], s31 offen lds
 mf a[84:87], a[176:179], a[228:231], a[84:87]
 mf a[88:91], a[176:179], a[232:235], a[88:91]
 mf a[92:95], a[176:179], a[236:239], a[92:95]
 s_waitcnt lgkmcnt(4)
 ds_read_b64_tr_b16 a[176:177], v10 offset:256
 ds_read_b64_tr_b16 a[178:179], v10 offset:1536
 mf a[96:99], a[180:183], a[224:227], a[96:99]
 mf a[100:103], a[180:183], a[228:231], a[100:103]
 s_add_u32 m0, s86, 0x4000
 mf a[104:107], a[180:183], a[232:235], a[104:107]
 s_mov_b32 s31, 0x80000
 mf a[108:111], a[180:183], a[236:239], a[108:111]
 s_waitcnt lgkmcnt(4)
 ds_read_b64_tr_b16 a[180:181], v10 offset:20736
 ds_read_b64_tr_b16 a[182:183], v10 offset:22016
 mf a[112:115], a[184:187], a[224:227], a[112:115]
 buffer_load_dwordx4 v15, s[32:35], s31 offen lds
 mf a[116:119], a[184:187], a[228:231], a[116:119]
 mf a[120:123], a[184:187], a[232:235], a[120:123]
 s_add_u32 m0, s86, 0x5000
 mf a[124:127], a[184:187], a[236:239], a[124:127]
 s_waitcnt lgkmcnt(4)
 s_mov_b32 s31, 0xa0000
 ds_read_b64_tr_b16 a[184:185], v10 offset:10240
 ds_read_b64_tr_b16 a[186:187], v10 offset:11520
 mf a[128:131], a[188:191], a[224:227], a[128:131]
 buffer_load_dwordx4 v15, s[32:35], s31 offen lds
 mf a[132:135], a[188:191], a[228:231], a[132:135]
 mf a[136:139], a[188:191], a[232:235], a[136:139]
 s_add_u32 m0, s86, 0x6000
 mf a[140:143], a[188:191], a[236:239], a[140:143]
 s_waitcnt lgkmcnt(4)
 s_mov_b32 s31, 0xc0000
 ds_read_b64_tr_b16 a[188:189], v10 offset:30720
 ds_read_b64_tr_b16 a[190:191], v10 offset:32000
 mf a[144:147], a[176:179], a[224:227], a[144:147]
 buffer_load_dwordx4 v15, s[32:35], s31 offen lds
 mf a[148:151], a[176:179], a[228:231], a[148:151]
 mf a[152:155], a[176:179], a[232:235], a[152:155]
 s_add_u32 m0, s86, 0x7000
 mf a[156:159], a[176:179], a[236:239], a[156:159]
 s_waitcnt lgkmcnt(4)
 s_mov_b32 s31, 0xe0000
 ds_read_b64_tr_b16 a[176:177], v11 offset:10240
 ds_read_b64_tr_b16 a[178:179], v11 offset:11520
 mf a[160:163], a[180:183], a[224:227], a[160:163]
 buffer_load_dwordx4 v15, s[32:35], s31 offen lds
 mf a[164:167], a[180:183], a[228:231], a[164:167]
 mf a[168:171], a[180:183], a[232:235], a[168:171]
 mf a[172:175], a[180:183], a[236:239], a[172:175]
 s_waitcnt vmcnt(36) lgkmcnt(4)
 ds_read_b64_tr_b16 a[180:181], v11 offset:30720
 ds_read_b64_tr_b16 a[182:183], v11 offset:32000
 mf v[36:39], a[184:187], a[240:243], v[36:39]
 s_waitcnt vmcnt(35)
 mf v[44:47], a[184:187], a[244:247], v[44:47]
 s_waitcnt vmcnt(34)
 mf v[52:55], a[184:187], a[248:251], v[52:55]
 s_waitcnt vmcnt(33)
 mf v[60:63], a[184:187], a[252:255], v[60:63]
 s_waitcnt lgkmcnt(4)
 ds_read_b64_tr_b16 a[184:185], v10 offset:10304
 ds_read_b64_tr_b16 a[186:187], v10 offset:11584
 mf v[68:71], a[188:191], a[240:243], v[68:71]
 mf v[76:79], a[188:191], a[244:247], v[76:79]
 mf v[84:87], a[188:191], a[248:251], v[84:87]
 mf v[92:95], a[188:191], a[252:255], v[92:95]
 s_waitcnt lgkmcnt(4)
 ds_read_b64_tr_b16 a[188:189], v10 offset:30784
 ds_read_b64_tr_b16 a[190:191], v10 offset:32064
 mf v[100:103], a[176:179], a[240:243], v[100:103]
 mf v[108:111], a[176:179], a[244:247], v[108:111]
 mf v[116:119], a[176:179], a[248:251], v[116:119]
 mf v[124:127], a[176:179], a[252:255], v[124:127]
 s_waitcnt lgkmcnt(4)
 ds_read_b64_tr_b16 a[176:177], v11 offset:10304
 ds_read_b64_tr_b16 a[178:179], v11 offset:11584
 mf v[132:135], a[180:183], a[240:243], v[132:135]
 mf v[140:143], a[180:183], a[244:247], v[140:143]
 mf v[148:151], a[180:183], a[248:251], v[148:151]
 mf v[156:159], a[180:183], a[252:255], v[156:159]
 s_waitcnt lgkmcnt(4)
 ds_read_b64_tr_b16 a[180:181], v11 offset:30784
 ds_read_b64_tr_b16 a[182:183], v11 offset:32064
 mf v[164:167], a[184:187], a[240:243], v[164:167]
 mf v[172:175], a[184:187], a[244:247], v[172:175]
 mf v[180:183], a[184:187], a[248:251], v[180:183]
 mf v[188:191], a[184:187], a[252:255], v[188:191]
 s_waitcnt lgkmcnt(4)
 ds_read_b64_tr_b16 a[184:185], v10 offset:10368
 ds_read_b64_tr_b16 a[186:187], v10 offset:11648
 mf v[196:199], a[188:191], a[240:243], v[196:199]
 mf v[204:207], a[188:191], a[244:247], v[204:207]
 mf v[212:215], a[188:191], a[248:251], v[212:215]
 mf v[220:223], a[188:191], a[252:255], v[220:223]
 s_waitcnt lgkmcnt(4)
 ds_read_b64_tr_b16 a[188:189], v10 offset:30848
 ds_read_b64_tr_b16 a[190:191], v10 offset:32128
 mf v[228:231], a[176:179], a[240:243], v[228:231]
 s_add_u32 s62, s73, 0x9000
 buffer_store_dwordx4 v[192:195], v4, s[40:43], s62 offen sc1
 mf v[236:239], a[176:179], a[244:247], v[236:239]
 mf v[244:247], a[176:179], a[248:251], v[244:247]
 mf v[252:255], a[176:179], a[252:255], v[252:255]
 s_waitcnt lgkmcnt(4)
 ds_read_b64_tr_b16 a[176:177], v11 offset:10368
 ds_read_b64_tr_b16 a[178:179], v11 offset:11648
 mf a[0:3], a[180:183], a[240:243], a[0:3]
 mf a[4:7], a[180:183], a[244:247], a[4:7]
 mf a[8:11], a[180:183], a[248:251], a[8:11]
 mf a[12:15], a[180:183], a[252:255], a[12:15]
 s_waitcnt lgkmcnt(4)
 ds_read_b64_tr_b16 a[180:181], v11 offset:30848
 ds_read_b64_tr_b16 a[182:183], v11 offset:32128
 mf a[16:19], a[184:187], a[240:243], a[16:19]
 mf a[20:23], a[184:187], a[244:247], a[20:23]
 s_add_u32 s62, s73, 0x9000
 buffer_store_dwordx4 v[200:203], v4, s[40:43], s62 offen offset:1024 sc1
 mf a[24:27], a[184:187], a[248:251], a[24:27]
 mf a[28:31], a[184:187], a[252:255], a[28:31]
 s_waitcnt lgkmcnt(4)
 ds_read_b64_tr_b16 a[184:185], v10 offset:10432
 ds_read_b64_tr_b16 a[186:187], v10 offset:11712
 mf a[32:35], a[188:191], a[240:243], a[32:35]
 mf a[36:39], a[188:191], a[244:247], a[36:39]
 mf a[40:43], a[188:191], a[248:251], a[40:43]
 mf a[44:47], a[188:191], a[252:255], a[44:47]
 s_waitcnt lgkmcnt(4)
 ds_read_b64_tr_b16 a[188:189], v10 offset:30912
 ds_read_b64_tr_b16 a[190:191], v10 offset:32192
 mf a[48:51], a[176:179], a[240:243], a[48:51]
 mf a[52:55], a[176:179], a[244:247], a[52:55]
 mf a[56:59], a[176:179], a[248:251], a[56:59]
 s_add_u32 s62, s73, 0x9000
 buffer_store_dwordx4 v[208:211], v4, s[40:43], s62 offen offset:2048 sc1
 mf a[60:63], a[176:179], a[252:255], a[60:63]
 s_waitcnt lgkmcnt(4)
 ds_read_b64_tr_b16 a[176:177], v11 offset:10432
 ds_read_b64_tr_b16 a[178:179], v11 offset:11712
 mf a[64:67], a[180:183], a[240:243], a[64:67]
 mf a[68:71], a[180:183], a[244:247], a[68:71]
 mf a[72:75], a[180:183], a[248:251], a[72:75]
 mf a[76:79], a[180:183], a[252:255], a[76:79]
 s_waitcnt lgkmcnt(4)
 ds_read_b64_tr_b16 a[180:181], v11 offset:30912
 ds_read_b64_tr_b16 a[182:183], v11 offset:32192
 mf a[80:83], a[184:187], a[240:243], a[80:83]
 mf a[84:87], a[184:187], a[244:247], a[84:87]
 mf a[88:91], a[184:187], a[248:251], a[88:91]
 mf a[92:95], a[184:187], a[252:255], a[92:95]
 s_waitcnt lgkmcnt(4)
 s_add_u32 s62, s73, 0x9000
 ds_read_b64_tr_b16 a[184:185], v10 offset:10496
 ds_read_b64_tr_b16 a[186:187], v10 offset:11776
 mf a[96:99], a[188:191], a[240:243], a[96:99]
 buffer_store_dwordx4 v[216:219], v4, s[40:43], s62 offen offset:3072 sc1
 mf a[100:103], a[188:191], a[244:247], a[100:103]
 mf a[104:107], a[188:191], a[248:251], a[104:107]
 mf a[108:111], a[188:191], a[252:255], a[108:111]
 s_waitcnt lgkmcnt(4)
 ds_read_b64_tr_b16 a[188:189], v10 offset:30976
 ds_read_b64_tr_b16 a[190:191], v10 offset:32256
 mf a[112:115], a[176:179], a[240:243], a[112:115]
 mf a[116:119], a[176:179], a[244:247], a[116:119]
 mf a[120:123], a[176:179], a[248:251], a[120:123]
 mf a[124:127], a[176:179], a[252:255], a[124:127]
 s_waitcnt lgkmcnt(4)
 mf a[128:131], a[180:183], a[240:243], a[128:131]
 mf a[132:135], a[180:183], a[244:247], a[132:135]
 s_waitcnt vmcnt(27)
 s_waitcnt lgkmcnt(0)
 s_barrier
 mf a[136:139], a[180:183], a[248:251], a[136:139]
 ds_read_b64_tr_b16 a[176:177], v12
 ds_read_b64_tr_b16 a[178:179], v12 offset:1280
 mf a[140:143], a[180:183], a[252:255], a[140:143]
 ds_read_b64_tr_b16 a[180:181], v12 offset:20480
 ds_read_b64_tr_b16 a[182:183], v12 offset:21760
 mf a[144:147], a[184:187], a[240:243], a[144:147]
 mf a[148:151], a[184:187], a[244:247], a[148:151]
 mf a[152:155], a[184:187], a[248:251], a[152:155]
 mf a[156:159], a[184:187], a[252:255], a[156:159]
 ds_read_b64_tr_b16 a[184:185], v13
 ds_read_b64_tr_b16 a[186:187], v13 offset:1280
 mf a[160:163], a[188:191], a[240:243], a[160:163]
 mf a[164:167], a[188:191], a[244:247], a[164:167]
 mf a[168:171], a[188:191], a[248:251], a[168:171]
 mf a[172:175], a[188:191], a[252:255], a[172:175]
 s_waitcnt vmcnt(19) lgkmcnt(4)
 ds_read_b64_tr_b16 a[188:189], v13 offset:20480
 ds_read_b64_tr_b16 a[190:191], v13 offset:21760
 mf v[36:39], a[176:179], a[192:195], v[36:39]
 s_waitcnt vmcnt(18)
 mf v[44:47], a[176:179], a[196:199], v[44:47]
 s_waitcnt vmcnt(17)
 mf v[52:55], a[176:179], a[200:203], v[52:55]
 s_waitcnt vmcnt(16)
 mf v[60:63], a[176:179], a[204:207], v[60:63]
 s_waitcnt lgkmcnt(4)
 s_add_u32 m0, s86, 0x8000
 ds_read_b64_tr_b16 a[176:177], v12 offset:64
 ds_read_b64_tr_b16 a[178:179], v12 offset:1344
 mf v[68:71], a[180:183], a[192:195], v[68:71]
 s_mov_b32 s31, 0x100000
 mf v[76:79], a[180:183], a[196:199], v[76:79]
 buffer_load_dwordx4 v15, s[32:35], s31 offen lds
 mf v[84:87], a[180:183], a[200:203], v[84:87]
 mf v[92:95], a[180:183], a[204:207], v[92:95]
 s_waitcnt lgkmcnt(4)
 s_add_u32 m0, s86, 0x9000
 ds_read_b64_tr_b16 a[180:181], v12 offset:20544
 ds_read_b64_tr_b16 a[182:183], v12 offset:21824
 mf v[100:103], a[184:187], a[192:195], v[100:103]
 s_mov_b32 s31, 0x120000
 mf v[108:111], a[184:187], a[196:199], v[108:111]
 s_lshl_b32 s63, s77, 4
 buffer_load_dwordx4 v15, s[32:35], s31 offen lds
 mf v[116:119], a[184:187], a[200:203], v[116:119]
 s_lshl_b32 s30, s76, 3
 mf v[124:127], a[184:187], a[204:207], v[124:127]
 s_waitcnt lgkmcnt(4)
 s_add_u32 m0, s86, 0xa000
 ds_read_b64_tr_b16 a[184:185], v13 offset:64
 ds_read_b64_tr_b16 a[186:187], v13 offset:1344
 mf v[132:135], a[188:191], a[192:195], v[132:135]
 s_mov_b32 s31, 0x140000
 mf v[140:143], a[188:191], a[196:199], v[140:143]
 s_add_u32 s63, s63, s30
 buffer_load_dwordx4 v15, s[32:35], s31 offen lds
 mf v[148:151], a[188:191], a[200:203], v[148:151]
 s_add_u32 s63, s63, s66
 mf v[156:159], a[188:191], a[204:207], v[156:159]
 s_waitcnt lgkmcnt(4)
 s_add_u32 m0, s86, 0xb000
 ds_read_b64_tr_b16 a[188:189], v13 offset:20544
 ds_read_b64_tr_b16 a[190:191], v13 offset:21824
 mf v[164:167], a[176:179], a[192:195], v[164:167]
 s_mov_b32 s31, 0x160000
 mf v[172:175], a[176:179], a[196:199], v[172:175]
 s_lshl_b32 s63, s63, 7
 buffer_load_dwordx4 v15, s[32:35], s31 offen lds
 mf v[180:183], a[176:179], a[200:203], v[180:183]
 s_add_u32 s63, s63, 0x8000
 mf v[188:191], a[176:179], a[204:207], v[188:191]
 s_waitcnt lgkmcnt(4)
 ds_read_b64_tr_b16 a[176:177], v12 offset:128
 ds_read_b64_tr_b16 a[178:179], v12 offset:1408
 mf v[196:199], a[180:183], a[192:195], v[196:199]
 mf v[204:207], a[180:183], a[196:199], v[204:207]
 mf v[212:215], a[180:183], a[200:203], v[212:215]
 mf v[220:223], a[180:183], a[204:207], v[220:223]
 s_waitcnt lgkmcnt(4)
 s_add_u32 m0, s86, 0xc000
 ds_read_b64_tr_b16 a[180:181], v12 offset:20608
 ds_read_b64_tr_b16 a[182:183], v12 offset:21888
 mf v[228:231], a[184:187], a[192:195], v[228:231]
 s_mov_b32 s31, 0x180000
 mf v[236:239], a[184:187], a[196:199], v[236:239]
 buffer_load_dwordx4 v15, s[32:35], s31 offen lds
 mf v[244:247], a[184:187], a[200:203], v[244:247]
 mf v[252:255], a[184:187], a[204:207], v[252:255]
 s_waitcnt lgkmcnt(4)
 s_add_u32 m0, s86, 0xd000
 ds_read_b64_tr_b16 a[184:185], v13 offset:128
 ds_read_b64_tr_b16 a[186:187], v13 offset:1408
 mf a[0:3], a[188:191], a[192:195], a[0:3]
 s_mov_b32 s31, 0x1a0000
 mf a[4:7], a[188:191], a[196:199], a[4:7]
 buffer_load_dwordx4 v15, s[32:35], s31 offen lds
 mf a[8:11], a[188:191], a[200:203], a[8:11]
 mf a[12:15], a[188:191], a[204:207], a[12:15]
 s_waitcnt lgkmcnt(4)
 s_add_u32 m0, s86, 0xe000
 ds_read_b64_tr_b16 a[188:189], v13 offset:20608
 ds_read_b64_tr_b16 a[190:191], v13 offset:21888
 mf a[16:19], a[176:179], a[192:195], a[16:19]
 s_mov_b32 s31, 0x1c0000
 mf a[20:23], a[176:179], a[196:199], a[20:23]
 buffer_load_dwordx4 v15, s[32:35], s31 offen lds
 mf a[24:27], a[176:179], a[200:203], a[24:27]
 mf a[28:31], a[176:179], a[204:207], a[28:31]
 s_waitcnt lgkmcnt(4)
 s_add_u32 m0, s86, 0xf000
 ds_read_b64_tr_b16 a[176:177], v12 offset:192
 ds_read_b64_tr_b16 a[178:179], v12 offset:1472
 mf a[32:35], a[180:183], a[192:195], a[32:35]
 s_mov_b32 s31, 0x1e0000
 mf a[36:39], a[180:183], a[196:199], a[36:39]
 buffer_load_dwordx4 v15, s[32:35], s31 offen lds
 mf a[40:43], a[180:183], a[200:203], a[40:43]
 mf a[44:47], a[180:183], a[204:207], a[44:47]
 s_waitcnt lgkmcnt(4)
 ds_read_b64_tr_b16 a[180:181], v12 offset:20672
 ds_read_b64_tr_b16 a[182:183], v12 offset:21952
 mf a[48:51], a[184:187], a[192:195], a[48:51]
 mf a[52:55], a[184:187], a[196:199], a[52:55]
 mf a[56:59], a[184:187], a[200:203], a[56:59]
 mf a[60:63], a[184:187], a[204:207], a[60:63]
 s_waitcnt lgkmcnt(4)
 s_add_u32 m0, s86, 0x10000
 ds_read_b64_tr_b16 a[184:185], v13 offset:192
 ds_read_b64_tr_b16 a[186:187], v13 offset:1472
 mf a[64:67], a[188:191], a[192:195], a[64:67]
 s_mov_b32 s31, 0x200000
 mf a[68:71], a[188:191], a[196:199], a[68:71]
 buffer_load_dwordx4 v15, s[32:35], s31 offen lds
 mf a[72:75], a[188:191], a[200:203], a[72:75]
 mf a[76:79], a[188:191], a[204:207], a[76:79]
 s_waitcnt lgkmcnt(4)
 s_add_u32 m0, s86, 0x11000
 ds_read_b64_tr_b16 a[188:189], v13 offset:20672
 ds_read_b64_tr_b16 a[190:191], v13 offset:21952
 mf a[80:83], a[176:179], a[192:195], a[80:83]
 s_mov_b32 s31, 0x220000
 mf a[84:87], a[176:179], a[196:199], a[84:87]
 buffer_load_dwordx4 v15, s[32:35], s31 offen lds
 mf a[88:91], a[176:179], a[200:203], a[88:91]
 mf a[92:95], a[176:179], a[204:207], a[92:95]
 s_waitcnt lgkmcnt(4)
 s_add_u32 m0, s86, 0x12000
 ds_read_b64_tr_b16 a[176:177], v12 offset:256
 ds_read_b64_tr_b16 a[178:179], v12 offset:1536
 mf a[96:99], a[180:183], a[192:195], a[96:99]
 s_mov_b32 s31, 0x240000
 mf a[100:103], a[180:183], a[196:199], a[100:103]
 buffer_load_dwordx4 v15, s[32:35], s31 offen lds
 mf a[104:107], a[180:183], a[200:203], a[104:107]
 mf a[108:111], a[180:183], a[204:207], a[108:111]
 s_waitcnt lgkmcnt(4)
 s_add_u32 m0, s86, 0x13000
 ds_read_b64_tr_b16 a[180:181], v12 offset:20736
 ds_read_b64_tr_b16 a[182:183], v12 offset:22016
 mf a[112:115], a[184:187], a[192:195], a[112:115]
 s_mov_b32 s31, 0x260000
 mf a[116:119], a[184:187], a[196:199], a[116:119]
 buffer_load_dwordx4 v15, s[32:35], s31 offen lds
 mf a[120:123], a[184:187], a[200:203], a[120:123]
 mf a[124:127], a[184:187], a[204:207], a[124:127]
 s_waitcnt lgkmcnt(4)
 ds_read_b64_tr_b16 a[184:185], v12 offset:10240
 ds_read_b64_tr_b16 a[186:187], v12 offset:11520
 mf a[128:131], a[188:191], a[192:195], a[128:131]
 mf a[132:135], a[188:191], a[196:199], a[132:135]
 mf a[136:139], a[188:191], a[200:203], a[136:139]
 mf a[140:143], a[188:191], a[204:207], a[140:143]
 s_waitcnt lgkmcnt(4)
 ds_read_b64_tr_b16 a[188:189], v12 offset:30720
 ds_read_b64_tr_b16 a[190:191], v12 offset:32000
 mf a[144:147], a[176:179], a[192:195], a[144:147]
 mf a[148:151], a[176:179], a[196:199], a[148:151]
 mf a[152:155], a[176:179], a[200:203], a[152:155]
 mf a[156:159], a[176:179], a[204:207], a[156:159]
 s_waitcnt lgkmcnt(4)
 ds_read_b64_tr_b16 a[176:177], v13 offset:10240
 ds_read_b64_tr_b16 a[178:179], v13 offset:11520
 mf a[160:163], a[180:183], a[192:195], a[160:163]
 mf a[164:167], a[180:183], a[196:199], a[164:167]
 mf a[168:171], a[180:183], a[200:203], a[168:171]
 mf a[172:175], a[180:183], a[204:207], a[172:175]
 s_waitcnt vmcnt(27) lgkmcnt(4)
 ds_read_b64_tr_b16 a[180:181], v13 offset:30720
 ds_read_b64_tr_b16 a[182:183], v13 offset:32000
 mf v[36:39], a[184:187], a[208:211], v[36:39]
 s_waitcnt vmcnt(26)
 mf v[44:47], a[184:187], a[212:215], v[44:47]
 s_waitcnt vmcnt(25)
 mf v[52:55], a[184:187], a[216:219], v[52:55]
 s_waitcnt vmcnt(24)
 mf v[60:63], a[184:187], a[220:223], v[60:63]
 s_waitcnt lgkmcnt(4)
 ds_read_b64_tr_b16 a[184:185], v12 offset:10304
 ds_read_b64_tr_b16 a[186:187], v12 offset:11584
 mf v[68:71], a[188:191], a[208:211], v[68:71]
 mf v[76:79], a[188:191], a[212:215], v[76:79]
 mf v[84:87], a[188:191], a[216:219], v[84:87]
 mf v[92:95], a[188:191], a[220:223], v[92:95]
 s_waitcnt lgkmcnt(4)
 ds_read_b64_tr_b16 a[188:189], v12 offset:30784
 ds_read_b64_tr_b16 a[190:191], v12 offset:32064
 mf v[100:103], a[176:179], a[208:211], v[100:103]
 mf v[108:111], a[176:179], a[212:215], v[108:111]
 mf v[116:119], a[176:179], a[216:219], v[116:119]
 mf v[124:127], a[176:179], a[220:223], v[124:127]
 s_waitcnt lgkmcnt(4)
 ds_read_b64_tr_b16 a[176:177], v13 offset:10304
 ds_read_b64_tr_b16 a[178:179], v13 offset:11584
 mf v[132:135], a[180:183], a[208:211], v[132:135]
 mf v[140:143], a[180:183], a[212:215], v[140:143]
 mf v[148:151], a[180:183], a[216:219], v[148:151]
 mf v[156:159], a[180:183], a[220:223], v[156:159]
 s_waitcnt lgkmcnt(4)
 ds_read_b64_tr_b16 a[180:181], v13 offset:30784
 ds_read_b64_tr_b16 a[182:183], v13 offset:32064
 mf v[164:167], a[184:187], a[208:211], v[164:167]
 mf v[172:175], a[184:187], a[212:215], v[172:175]
 mf v[180:183], a[184:187], a[216:219], v[180:183]
 mf v[188:191], a[184:187], a[220:223], v[188:191]
 s_waitcnt lgkmcnt(4)
 ds_read_b64_tr_b16 a[184:185], v12 offset:10368
 ds_read_b64_tr_b16 a[186:187], v12 offset:11648
 mf v[196:199], a[188:191], a[208:211], v[196:199]
 mf v[204:207], a[188:191], a[212:215], v[204:207]
 mf v[212:215], a[188:191], a[216:219], v[212:215]
 mf v[220:223], a[188:191], a[220:223], v[220:223]
 s_waitcnt lgkmcnt(4)
 ds_read_b64_tr_b16 a[188:189], v12 offset:30848
 ds_read_b64_tr_b16 a[190:191], v12 offset:32128
 mf v[228:231], a[176:179], a[208:211], v[228:231]
 s_add_u32 s62, s73, 0xa000
 buffer_store_dwordx4 v[224:227], v4, s[40:43], s62 offen sc1
 mf v[236:239], a[176:179], a[212:215], v[236:239]
 mf v[244:247], a[176:179], a[216:219], v[244:247]
 mf v[252:255], a[176:179], a[220:223], v[252:255]
 s_waitcnt lgkmcnt(4)
 ds_read_b64_tr_b16 a[176:177], v13 offset:10368
 ds_read_b64_tr_b16 a[178:179], v13 offset:11648
 mf a[0:3], a[180:183], a[208:211], a[0:3]
 mf a[4:7], a[180:183], a[212:215], a[4:7]
 mf a[8:11], a[180:183], a[216:219], a[8:11]
 mf a[12:15], a[180:183], a[220:223], a[12:15]
 s_waitcnt lgkmcnt(4)
 ds_read_b64_tr_b16 a[180:181], v13 offset:30848
 ds_read_b64_tr_b16 a[182:183], v13 offset:32128
 mf a[16:19], a[184:187], a[208:211], a[16:19]
 mf a[20:23], a[184:187], a[212:215], a[20:23]
 s_add_u32 s62, s73, 0xa000
 buffer_store_dwordx4 v[232:235], v4, s[40:43], s62 offen offset:1024 sc1
 mf a[24:27], a[184:187], a[216:219], a[24:27]
 mf a[28:31], a[184:187], a[220:223], a[28:31]
 s_waitcnt lgkmcnt(4)
 ds_read_b64_tr_b16 a[184:185], v12 offset:10432
 ds_read_b64_tr_b16 a[186:187], v12 offset:11712
 mf a[32:35], a[188:191], a[208:211], a[32:35]
 mf a[36:39], a[188:191], a[212:215], a[36:39]
 mf a[40:43], a[188:191], a[216:219], a[40:43]
 mf a[44:47], a[188:191], a[220:223], a[44:47]
 s_waitcnt lgkmcnt(4)
 ds_read_b64_tr_b16 a[188:189], v12 offset:30912
 ds_read_b64_tr_b16 a[190:191], v12 offset:32192
 mf a[48:51], a[176:179], a[208:211], a[48:51]
 mf a[52:55], a[176:179], a[212:215], a[52:55]
 mf a[56:59], a[176:179], a[216:219], a[56:59]
 s_add_u32 s62, s73, 0xa000
 buffer_store_dwordx4 v[240:243], v4, s[40:43], s62 offen offset:2048 sc1
 mf a[60:63], a[176:179], a[220:223], a[60:63]
 s_waitcnt lgkmcnt(4)
 ds_read_b64_tr_b16 a[176:177], v13 offset:10432
 ds_read_b64_tr_b16 a[178:179], v13 offset:11712
 mf a[64:67], a[180:183], a[208:211], a[64:67]
 mf a[68:71], a[180:183], a[212:215], a[68:71]
 mf a[72:75], a[180:183], a[216:219], a[72:75]
 mf a[76:79], a[180:183], a[220:223], a[76:79]
 s_waitcnt lgkmcnt(4)
 ds_read_b64_tr_b16 a[180:181], v13 offset:30912
 ds_read_b64_tr_b16 a[182:183], v13 offset:32192
 mf a[80:83], a[184:187], a[208:211], a[80:83]
 mf a[84:87], a[184:187], a[212:215], a[84:87]
 mf a[88:91], a[184:187], a[216:219], a[88:91]
 mf a[92:95], a[184:187], a[220:223], a[92:95]
 s_waitcnt lgkmcnt(4)
 s_add_u32 s62, s73, 0xa000
 ds_read_b64_tr_b16 a[184:185], v12 offset:10496
 ds_read_b64_tr_b16 a[186:187], v12 offset:11776
 mf a[96:99], a[188:191], a[208:211], a[96:99]
 buffer_store_dwordx4 v[248:251], v4, s[40:43], s62 offen offset:3072 sc1
 mf a[100:103], a[188:191], a[212:215], a[100:103]
 mf a[104:107], a[188:191], a[216:219], a[104:107]
 mf a[108:111], a[188:191], a[220:223], a[108:111]
 s_waitcnt lgkmcnt(4)
 ds_read_b64_tr_b16 a[188:189], v12 offset:30976
 ds_read_b64_tr_b16 a[190:191], v12 offset:32256
 mf a[112:115], a[176:179], a[208:211], a[112:115]
 mf a[116:119], a[176:179], a[212:215], a[116:119]
 mf a[120:123], a[176:179], a[216:219], a[120:123]
 mf a[124:127], a[176:179], a[220:223], a[124:127]
 s_waitcnt lgkmcnt(4)
 mf a[128:131], a[180:183], a[208:211], a[128:131]
 mf a[132:135], a[180:183], a[212:215], a[132:135]
 mf a[136:139], a[180:183], a[216:219], a[136:139]
 mf a[140:143], a[180:183], a[220:223], a[140:143]
 s_waitcnt lgkmcnt(2)
 mf a[144:147], a[184:187], a[208:211], a[144:147]
 mf a[148:151], a[184:187], a[212:215], a[148:151]
 mf a[152:155], a[184:187], a[216:219], a[152:155]
 mf a[156:159], a[184:187], a[220:223], a[156:159]
 s_waitcnt lgkmcnt(0)
 mf a[160:163], a[188:191], a[208:211], a[160:163]
 mf a[164:167], a[188:191], a[212:215], a[164:167]
 mf a[168:171], a[188:191], a[216:219], a[168:171]
 mf a[172:175], a[188:191], a[220:223], a[172:175]
 s_waitcnt vmcnt(0)
 s_barrier
 buffer_store_dword v6, v5, s[52:55], s63 offen sc1
 s_add_u32 s36, s28, 0x2800000
 s_addc_u32 s37, s29, 0
 s_mov_b32 s38, 0x2200000
 s_mov_b32 s39, 0x20000
 s_cmp_eq_u32 s79, 0
 s_cselect_b32 s30, 0, 0x7ff00000
 s_cselect_b32 s31, 0x7ff00000, 0
 v_add_u32 v27, s30, v4
 v_add_u32 v28, s31, v4
 v_lshlrev_b32 v29, 3, v1
 v_add_u32 v80, s31, v29
 v_add_u32 v29, s30, v29
 v_mov_b32 v32, 0xc0135761
 v_mov_b32 v33, 0xc0135761
 v_mov_b32 v34, 0xbdd2d3e8
 v_mov_b32 v35, 0xbdd2d3e8
 v_mov_b32 v40, 1.0
 v_mov_b32 v41, 1.0
 s_add_u32 m0, s86, 0x14000
 s_mov_b32 s31, 0x280000
 s_nop 0
 buffer_load_dwordx4 v15, s[32:35], s31 offen lds
 s_add_u32 m0, s86, 0x15000
 s_mov_b32 s31, 0x2a0000
 s_nop 0
 buffer_load_dwordx4 v15, s[32:35], s31 offen lds
 s_add_u32 m0, s86, 0x16000
 s_mov_b32 s31, 0x2c0000
 s_nop 0
 buffer_load_dwordx4 v15, s[32:35], s31 offen lds
 s_add_u32 m0, s86, 0x17000
 s_mov_b32 s31, 0x2e0000
 s_nop 0
 buffer_load_dwordx4 v15, s[32:35], s31 offen lds
 s_add_u32 m0, s86, 0x18000
 s_mov_b32 s31, 0x300000
 s_nop 0
 buffer_load_dwordx4 v15, s[32:35], s31 offen lds
 s_add_u32 m0, s86, 0x19000
 s_mov_b32 s31, 0x320000
 s_nop 0
 buffer_load_dwordx4 v15, s[32:35], s31 offen lds
 s_add_u32 m0, s86, 0x1a000
 s_mov_b32 s31, 0x340000
 s_nop 0
 buffer_load_dwordx4 v15, s[32:35], s31 offen lds
 s_add_u32 m0, s86, 0x1b000
 s_mov_b32 s31, 0x360000
 s_nop 0
 buffer_load_dwordx4 v15, s[32:35], s31 offen lds
 s_add_u32 m0, s86, 0x1c000
 s_mov_b32 s31, 0x380000
 s_nop 0
 buffer_load_dwordx4 v15, s[32:35], s31 offen lds
 s_add_u32 m0, s86, 0x1d000
 s_mov_b32 s31, 0x3a0000
 s_nop 0
 buffer_load_dwordx4 v15, s[32:35], s31 offen lds
 s_add_u32 m0, s86, 0x1e000
 s_mov_b32 s31, 0x3c0000
 s_nop 0
 buffer_load_dwordx4 v15, s[32:35], s31 offen lds
 s_add_u32 m0, s86, 0x1f000
 s_mov_b32 s31, 0x3e0000
 s_nop 0
 buffer_load_dwordx4 v15, s[32:35], s31 offen lds
 s_add_u32 s62, s84, 0
 s_add_u32 s63, s62, 0x1000
 v_pk_mul_f32 v[64:65], v[36:37], v[36:37]
 v_pk_mul_f32 v[66:67], v[38:39], v[38:39]
 v_pk_mul_f32 v[68:69], v[36:37], v[68:69]
 v_pk_mul_f32 v[70:71], v[38:39], v[70:71]
 v_pk_fma_f32 v[64:65], v[64:65], v[34:35], v[32:33]
 v_pk_fma_f32 v[66:67], v[66:67], v[34:35], v[32:33]
 v_pk_mul_f32 v[64:65], v[64:65], v[36:37]
 v_pk_mul_f32 v[66:67], v[66:67], v[38:39]
 v_exp_f32 v64, v64
 v_exp_f32 v65, v65
 v_exp_f32 v66, v66
 v_exp_f32 v67, v67
 v_pk_add_f32 v[64:65], v[64:65], v[40:41]
 v_pk_add_f32 v[66:67], v[66:67], v[40:41]
 v_rcp_f32 v64, v64
 v_rcp_f32 v65, v65
 v_rcp_f32 v66, v66
 v_rcp_f32 v67, v67
 v_pk_mul_f32 v[68:69], v[68:69], v[64:65]
 v_pk_mul_f32 v[70:71], v[70:71], v[66:67]
 v_cvt_pk_bf16_f32 v8, v68, v69
 v_cvt_pk_bf16_f32 v9, v70, v71
 buffer_store_dwordx2 v[8:9], v80, s[36:39], s62 offen offset:512 sc1
 v_pk_mul_f32 v[64:65], v[100:101], v[100:101]
 v_pk_mul_f32 v[66:67], v[102:103], v[102:103]
 v_pk_mul_f32 v[132:133], v[100:101], v[132:133]
 v_pk_mul_f32 v[134:135], v[102:103], v[134:135]
 v_pk_fma_f32 v[64:65], v[64:65], v[34:35], v[32:33]
 v_pk_fma_f32 v[66:67], v[66:67], v[34:35], v[32:33]
 v_pk_mul_f32 v[64:65], v[64:65], v[100:101]
 v_pk_mul_f32 v[66:67], v[66:67], v[102:103]
 v_exp_f32 v64, v64
 v_exp_f32 v65, v65
 v_exp_f32 v66, v66
 v_exp_f32 v67, v67
 v_pk_add_f32 v[64:65], v[64:65], v[40:41]
 v_pk_add_f32 v[66:67], v[66:67], v[40:41]
 v_rcp_f32 v64, v64
 v_rcp_f32 v65, v65
 v_rcp_f32 v66, v66
 v_rcp_f32 v67, v67
 v_pk_mul_f32 v[132:133], v[132:133], v[64:65]
 v_pk_mul_f32 v[134:135], v[134:135], v[66:67]
 v_cvt_pk_bf16_f32 v10, v132, v133
 v_cvt_pk_bf16_f32 v11, v134, v135
 buffer_store_dwordx4 v[8:11], v27, s[36:39], s62 offen sc1
 v_pk_mul_f32 v[64:65], v[164:165], v[164:165]
 v_pk_mul_f32 v[66:67], v[166:167], v[166:167]
 v_pk_mul_f32 v[196:197], v[164:165], v[196:197]
 v_pk_mul_f32 v[198:199], v[166:167], v[198:199]
 v_pk_fma_f32 v[64:65], v[64:65], v[34:35], v[32:33]
 v_pk_fma_f32 v[66:67], v[66:67], v[34:35], v[32:33]
 v_pk_mul_f32 v[64:65], v[64:65], v[164:165]
 v_pk_mul_f32 v[66:67], v[66:67], v[166:167]
 v_exp_f32 v64, v64
 v_exp_f32 v65, v65
 v_exp_f32 v66, v66
 v_exp_f32 v67, v67
 v_pk_add_f32 v[64:65], v[64:65], v[40:41]
 v_pk_add_f32 v[66:67], v[66:67], v[40:41]
 v_rcp_f32 v64, v64
 v_rcp_f32 v65, v65
 v_rcp_f32 v66, v66
 v_rcp_f32 v67, v67
 v_pk_mul_f32 v[196:197], v[196:197], v[64:65]
 v_pk_mul_f32 v[198:199], v[198:199], v[66:67]
 v_cvt_pk_bf16_f32 v12, v196, v197
 v_cvt_pk_bf16_f32 v13, v198, v199
 buffer_store_dwordx4 v[10:13], v28, s[36:39], s62 offen offset:1024 sc1
 s_add_u32 s61, s81, 0
 buffer_load_dwordx4 a[192:195], v4, s[48:51], s61 offen
 v_accvgpr_read_b32 v56, a0
 v_accvgpr_read_b32 v57, a1
 v_accvgpr_read_b32 v58, a2
 v_accvgpr_read_b32 v59, a3
 v_pk_mul_f32 v[64:65], v[228:229], v[228:229]
 v_pk_mul_f32 v[66:67], v[230:231], v[230:231]
 v_pk_mul_f32 v[56:57], v[228:229], v[56:57]
 v_pk_mul_f32 v[58:59], v[230:231], v[58:59]
 v_pk_fma_f32 v[64:65], v[64:65], v[34:35], v[32:33]
 v_pk_fma_f32 v[66:67], v[66:67], v[34:35], v[32:33]
 v_pk_mul_f32 v[64:65], v[64:65], v[228:229]
 v_pk_mul_f32 v[66:67], v[66:67], v[230:231]
 v_exp_f32 v64, v64
 v_exp_f32 v65, v65
 v_exp_f32 v66, v66
 v_exp_f32 v67, v67
 v_pk_add_f32 v[64:65], v[64:65], v[40:41]
 v_pk_add_f32 v[66:67], v[66:67], v[40:41]
 v_rcp_f32 v64, v64
 v_rcp_f32 v65, v65
 v_rcp_f32 v66, v66
 v_rcp_f32 v67, v67
 v_pk_mul_f32 v[56:57], v[56:57], v[64:65]
 v_pk_mul_f32 v[58:59], v[58:59], v[66:67]
 v_cvt_pk_bf16_f32 v14, v56, v57
 v_cvt_pk_bf16_f32 v15, v58, v59
 buffer_store_dwordx4 v[12:15], v27, s[36:39], s62 offen offset:1024 sc1
 v_accvgpr_read_b32 v48, a16
 v_accvgpr_read_b32 v49, a17
 v_accvgpr_read_b32 v50, a18
 v_accvgpr_read_b32 v51, a19
 v_accvgpr_read_b32 v56, a32
 v_accvgpr_read_b32 v57, a33
 v_accvgpr_read_b32 v58, a34
 v_accvgpr_read_b32 v59, a35
 v_pk_mul_f32 v[64:65], v[48:49], v[48:49]
 v_pk_mul_f32 v[66:67], v[50:51], v[50:51]
 v_pk_mul_f32 v[56:57], v[48:49], v[56:57]
 v_pk_mul_f32 v[58:59], v[50:51], v[58:59]
 v_pk_fma_f32 v[64:65], v[64:65], v[34:35], v[32:33]
 v_pk_fma_f32 v[66:67], v[66:67], v[34:35], v[32:33]
 v_pk_mul_f32 v[64:65], v[64:65], v[48:49]
 v_pk_mul_f32 v[66:67], v[66:67], v[50:51]
 v_exp_f32 v64, v64
 v_exp_f32 v65, v65
 v_exp_f32 v66, v66
 v_exp_f32 v67, v67
 v_pk_add_f32 v[64:65], v[64:65], v[40:41]
 v_pk_add_f32 v[66:67], v[66:67], v[40:41]
 v_rcp_f32 v64, v64
 v_rcp_f32 v65, v65
 v_rcp_f32 v66, v66
 v_rcp_f32 v67, v67
 v_pk_mul_f32 v[56:57], v[56:57], v[64:65]
 v_pk_mul_f32 v[58:59], v[58:59], v[66:67]
 v_cvt_pk_bf16_f32 v16, v56, v57
 v_cvt_pk_bf16_f32 v17, v58, v59
 buffer_store_dwordx4 v[14:17], v28, s[36:39], s62 offen offset:2048 sc1
 s_add_u32 s61, s81, s16
 s_add_u32 s61, s61, 0
 buffer_load_dwordx4 a[196:199], v4, s[48:51], s61 offen
 v_accvgpr_read_b32 v48, a48
 v_accvgpr_read_b32 v49, a49
 v_accvgpr_read_b32 v50, a50
 v_accvgpr_read_b32 v51, a51
 v_accvgpr_read_b32 v56, a64
 v_accvgpr_read_b32 v57, a65
 v_accvgpr_read_b32 v58, a66
 v_accvgpr_read_b32 v59, a67
 v_pk_mul_f32 v[64:65], v[48:49], v[48:49]
 v_pk_mul_f32 v[66:67], v[50:51], v[50:51]
 v_pk_mul_f32 v[56:57], v[48:49], v[56:57]
 v_pk_mul_f32 v[58:59], v[50:51], v[58:59]
 v_pk_fma_f32 v[64:65], v[64:65], v[34:35], v[32:33]
 v_pk_fma_f32 v[66:67], v[66:67], v[34:35], v[32:33]
 v_pk_mul_f32 v[64:65], v[64:65], v[48:49]
 v_pk_mul_f32 v[66:67], v[66:67], v[50:51]
 v_exp_f32 v64, v64
 v_exp_f32 v65, v65
 v_exp_f32 v66, v66
 v_exp_f32 v67, v67
 v_pk_add_f32 v[64:65], v[64:65], v[40:41]
 v_pk_add_f32 v[66:67], v[66:67], v[40:41]
 v_rcp_f32 v64, v64
 v_rcp_f32 v65, v65
 v_rcp_f32 v66, v66
 v_rcp_f32 v67, v67
 v_pk_mul_f32 v[56:57], v[56:57], v[64:65]
 v_pk_mul_f32 v[58:59], v[58:59], v[66:67]
 v_cvt_pk_bf16_f32 v18, v56, v57
 v_cvt_pk_bf16_f32 v19, v58, v59
 buffer_store_dwordx4 v[16:19], v27, s[36:39], s62 offen offset:2048 sc1
 v_accvgpr_read_b32 v48, a80
 v_accvgpr_read_b32 v49, a81
 v_accvgpr_read_b32 v50, a82
 v_accvgpr_read_b32 v51, a83
 v_accvgpr_read_b32 v56, a96
 v_accvgpr_read_b32 v57, a97
 v_accvgpr_read_b32 v58, a98
 v_accvgpr_read_b32 v59, a99
 v_pk_mul_f32 v[64:65], v[48:49], v[48:49]
 v_pk_mul_f32 v[66:67], v[50:51], v[50:51]
 v_pk_mul_f32 v[56:57], v[48:49], v[56:57]
 v_pk_mul_f32 v[58:59], v[50:51], v[58:59]
 v_pk_fma_f32 v[64:65], v[64:65], v[34:35], v[32:33]
 v_pk_fma_f32 v[66:67], v[66:67], v[34:35], v[32:33]
 v_pk_mul_f32 v[64:65], v[64:65], v[48:49]
 v_pk_mul_f32 v[66:67], v[66:67], v[50:51]
 v_exp_f32 v64, v64
 v_exp_f32 v65, v65
 v_exp_f32 v66, v66
 v_exp_f32 v67, v67
 v_pk_add_f32 v[64:65], v[64:65], v[40:41]
 v_pk_add_f32 v[66:67], v[66:67], v[40:41]
 v_rcp_f32 v64, v64
 v_rcp_f32 v65, v65
 v_rcp_f32 v66, v66
 v_rcp_f32 v67, v67
 v_pk_mul_f32 v[56:57], v[56:57], v[64:65]
 v_pk_mul_f32 v[58:59], v[58:59], v[66:67]
 v_cvt_pk_bf16_f32 v20, v56, v57
 v_cvt_pk_bf16_f32 v21, v58, v59
 buffer_store_dwordx4 v[18:21], v28, s[36:39], s62 offen offset:3072 sc1
 s_add_u32 s61, s82, 0
 buffer_load_dwordx4 a[200:203], v4, s[48:51], s61 offen
 v_accvgpr_read_b32 v48, a112
 v_accvgpr_read_b32 v49, a113
 v_accvgpr_read_b32 v50, a114
 v_accvgpr_read_b32 v51, a115
 v_accvgpr_read_b32 v56, a128
 v_accvgpr_read_b32 v57, a129
 v_accvgpr_read_b32 v58, a130
 v_accvgpr_read_b32 v59, a131
 v_pk_mul_f32 v[64:65], v[48:49], v[48:49]
 v_pk_mul_f32 v[66:67], v[50:51], v[50:51]
 v_pk_mul_f32 v[56:57], v[48:49], v[56:57]
 v_pk_mul_f32 v[58:59], v[50:51], v[58:59]
 v_pk_fma_f32 v[64:65], v[64:65], v[34:35], v[32:33]
 v_pk_fma_f32 v[66:67], v[66:67], v[34:35], v[32:33]
 v_pk_mul_f32 v[64:65], v[64:65], v[48:49]
 v_pk_mul_f32 v[66:67], v[66:67], v[50:51]
 v_exp_f32 v64, v64
 v_exp_f32 v65, v65
 v_exp_f32 v66, v66
 v_exp_f32 v67, v67
 v_pk_add_f32 v[64:65], v[64:65], v[40:41]
 v_pk_add_f32 v[66:67], v[66:67], v[40:41]
 v_rcp_f32 v64, v64
 v_rcp_f32 v65, v65
 v_rcp_f32 v66, v66
 v_rcp_f32 v67, v67
 v_pk_mul_f32 v[56:57], v[56:57], v[64:65]
 v_pk_mul_f32 v[58:59], v[58:59], v[66:67]
 v_cvt_pk_bf16_f32 v22, v56, v57
 v_cvt_pk_bf16_f32 v23, v58, v59
 buffer_store_dwordx4 v[20:23], v27, s[36:39], s62 offen offset:3072 sc1
 v_accvgpr_read_b32 v48, a144
 v_accvgpr_read_b32 v49, a145
 v_accvgpr_read_b32 v50, a146
 v_accvgpr_read_b32 v51, a147
 v_accvgpr_read_b32 v56, a160
 v_accvgpr_read_b32 v57, a161
 v_accvgpr_read_b32 v58, a162
 v_accvgpr_read_b32 v59, a163
 v_pk_mul_f32 v[64:65], v[48:49], v[48:49]
 v_pk_mul_f32 v[66:67], v[50:51], v[50:51]
 v_pk_mul_f32 v[56:57], v[48:49], v[56:57]
 v_pk_mul_f32 v[58:59], v[50:51], v[58:59]
 v_pk_fma_f32 v[64:65], v[64:65], v[34:35], v[32:33]
 v_pk_fma_f32 v[66:67], v[66:67], v[34:35], v[32:33]
 v_pk_mul_f32 v[64:65], v[64:65], v[48:49]
 v_pk_mul_f32 v[66:67], v[66:67], v[50:51]
 v_exp_f32 v64, v64
 v_exp_f32 v65, v65
 v_exp_f32 v66, v66
 v_exp_f32 v67, v67
 v_pk_add_f32 v[64:65], v[64:65], v[40:41]
 v_pk_add_f32 v[66:67], v[66:67], v[40:41]
 v_rcp_f32 v64, v64
 v_rcp_f32 v65, v65
 v_rcp_f32 v66, v66
 v_rcp_f32 v67, v67
 v_pk_mul_f32 v[56:57], v[56:57], v[64:65]
 v_pk_mul_f32 v[58:59], v[58:59], v[66:67]
 v_cvt_pk_bf16_f32 v24, v56, v57
 v_cvt_pk_bf16_f32 v25, v58, v59
 buffer_store_dwordx4 v[22:25], v28, s[36:39], s63 offen sc1
 buffer_store_dwordx2 v[24:25], v29, s[36:39], s63 offen sc1
 s_add_u32 s61, s82, s16
 s_add_u32 s61, s61, 0
 buffer_load_dwordx4 a[204:207], v4, s[48:51], s61 offen
 s_add_u32 s62, s84, s17
 s_add_u32 s63, s62, 0x1000
 v_pk_mul_f32 v[64:65], v[44:45], v[44:45]
 v_pk_mul_f32 v[66:67], v[46:47], v[46:47]
 v_pk_mul_f32 v[76:77], v[44:45], v[76:77]
 v_pk_mul_f32 v[78:79], v[46:47], v[78:79]
 v_pk_fma_f32 v[64:65], v[64:65], v[34:35], v[32:33]
 v_pk_fma_f32 v[66:67], v[66:67], v[34:35], v[32:33]
 v_pk_mul_f32 v[64:65], v[64:65], v[44:45]
 v_pk_mul_f32 v[66:67], v[66:67], v[46:47]
 v_exp_f32 v64, v64
 v_exp_f32 v65, v65
 v_exp_f32 v66, v66
 v_exp_f32 v67, v67
 v_pk_add_f32 v[64:65], v[64:65], v[40:41]
 v_pk_add_f32 v[66:67], v[66:67], v[40:41]
 v_rcp_f32 v64, v64
 v_rcp_f32 v65, v65
 v_rcp_f32 v66, v66
 v_rcp_f32 v67, v67
 v_pk_mul_f32 v[76:77], v[76:77], v[64:65]
 v_pk_mul_f32 v[78:79], v[78:79], v[66:67]
 v_cvt_pk_bf16_f32 v8, v76, v77
 v_cvt_pk_bf16_f32 v9, v78, v79
 buffer_store_dwordx2 v[8:9], v80, s[36:39], s62 offen offset:512 sc1
 v_pk_mul_f32 v[64:65], v[108:109], v[108:109]
 v_pk_mul_f32 v[66:67], v[110:111], v[110:111]
 v_pk_mul_f32 v[140:141], v[108:109], v[140:141]
 v_pk_mul_f32 v[142:143], v[110:111], v[142:143]
 v_pk_fma_f32 v[64:65], v[64:65], v[34:35], v[32:33]
 v_pk_fma_f32 v[66:67], v[66:67], v[34:35], v[32:33]
 v_pk_mul_f32 v[64:65], v[64:65], v[108:109]
 v_pk_mul_f32 v[66:67], v[66:67], v[110:111]
 v_exp_f32 v64, v64
 v_exp_f32 v65, v65
 v_exp_f32 v66, v66
 v_exp_f32 v67, v67
 v_pk_add_f32 v[64:65], v[64:65], v[40:41]
 v_pk_add_f32 v[66:67], v[66:67], v[40:41]
 v_rcp_f32 v64, v64
 v_rcp_f32 v65, v65
 v_rcp_f32 v66, v66
 v_rcp_f32 v67, v67
 v_pk_mul_f32 v[140:141], v[140:141], v[64:65]
 v_pk_mul_f32 v[142:143], v[142:143], v[66:67]
 v_cvt_pk_bf16_f32 v10, v140, v141
 v_cvt_pk_bf16_f32 v11, v142, v143
 buffer_store_dwordx4 v[8:11], v27, s[36:39], s62 offen sc1
 v_pk_mul_f32 v[64:65], v[172:173], v[172:173]
 v_pk_mul_f32 v[66:67], v[174:175], v[174:175]
 v_pk_mul_f32 v[204:205], v[172:173], v[204:205]
 v_pk_mul_f32 v[206:207], v[174:175], v[206:207]
 v_pk_fma_f32 v[64:65], v[64:65], v[34:35], v[32:33]
 v_pk_fma_f32 v[66:67], v[66:67], v[34:35], v[32:33]
 v_pk_mul_f32 v[64:65], v[64:65], v[172:173]
 v_pk_mul_f32 v[66:67], v[66:67], v[174:175]
 v_exp_f32 v64, v64
 v_exp_f32 v65, v65
 v_exp_f32 v66, v66
 v_exp_f32 v67, v67
 v_pk_add_f32 v[64:65], v[64:65], v[40:41]
 v_pk_add_f32 v[66:67], v[66:67], v[40:41]
 v_rcp_f32 v64, v64
 v_rcp_f32 v65, v65
 v_rcp_f32 v66, v66
 v_rcp_f32 v67, v67
 v_pk_mul_f32 v[204:205], v[204:205], v[64:65]
 v_pk_mul_f32 v[206:207], v[206:207], v[66:67]
 v_cvt_pk_bf16_f32 v12, v204, v205
 v_cvt_pk_bf16_f32 v13, v206, v207
 buffer_store_dwordx4 v[10:13], v28, s[36:39], s62 offen offset:1024 sc1
 s_add_u32 s61, s81, 0
 buffer_load_dwordx4 a[208:211], v4, s[48:51], s61 offen offset:1024
 v_accvgpr_read_b32 v56, a4
 v_accvgpr_read_b32 v57, a5
 v_accvgpr_read_b32 v58, a6
 v_accvgpr_read_b32 v59, a7
 v_pk_mul_f32 v[64:65], v[236:237], v[236:237]
 v_pk_mul_f32 v[66:67], v[238:239], v[238:239]
 v_pk_mul_f32 v[56:57], v[236:237], v[56:57]
 v_pk_mul_f32 v[58:59], v[238:239], v[58:59]
 v_pk_fma_f32 v[64:65], v[64:65], v[34:35], v[32:33]
 v_pk_fma_f32 v[66:67], v[66:67], v[34:35], v[32:33]
 v_pk_mul_f32 v[64:65], v[64:65], v[236:237]
 v_pk_mul_f32 v[66:67], v[66:67], v[238:239]
 v_exp_f32 v64, v64
 v_exp_f32 v65, v65
 v_exp_f32 v66, v66
 v_exp_f32 v67, v67
 v_pk_add_f32 v[64:65], v[64:65], v[40:41]
 v_pk_add_f32 v[66:67], v[66:67], v[40:41]
 v_rcp_f32 v64, v64
 v_rcp_f32 v65, v65
 v_rcp_f32 v66, v66
 v_rcp_f32 v67, v67
 v_pk_mul_f32 v[56:57], v[56:57], v[64:65]
 v_pk_mul_f32 v[58:59], v[58:59], v[66:67]
 v_cvt_pk_bf16_f32 v14, v56, v57
 v_cvt_pk_bf16_f32 v15, v58, v59
 buffer_store_dwordx4 v[12:15], v27, s[36:39], s62 offen offset:1024 sc1
 v_accvgpr_read_b32 v48, a20
 v_accvgpr_read_b32 v49, a21
 v_accvgpr_read_b32 v50, a22
 v_accvgpr_read_b32 v51, a23
 v_accvgpr_read_b32 v56, a36
 v_accvgpr_read_b32 v57, a37
 v_accvgpr_read_b32 v58, a38
 v_accvgpr_read_b32 v59, a39
 v_pk_mul_f32 v[64:65], v[48:49], v[48:49]
 v_pk_mul_f32 v[66:67], v[50:51], v[50:51]
 v_pk_mul_f32 v[56:57], v[48:49], v[56:57]
 v_pk_mul_f32 v[58:59], v[50:51], v[58:59]
 v_pk_fma_f32 v[64:65], v[64:65], v[34:35], v[32:33]
 v_pk_fma_f32 v[66:67], v[66:67], v[34:35], v[32:33]
 v_pk_mul_f32 v[64:65], v[64:65], v[48:49]
 v_pk_mul_f32 v[66:67], v[66:67], v[50:51]
 v_exp_f32 v64, v64
 v_exp_f32 v65, v65
 v_exp_f32 v66, v66
 v_exp_f32 v67, v67
 v_pk_add_f32 v[64:65], v[64:65], v[40:41]
 v_pk_add_f32 v[66:67], v[66:67], v[40:41]
 v_rcp_f32 v64, v64
 v_rcp_f32 v65, v65
 v_rcp_f32 v66, v66
 v_rcp_f32 v67, v67
 v_pk_mul_f32 v[56:57], v[56:57], v[64:65]
 v_pk_mul_f32 v[58:59], v[58:59], v[66:67]
 v_cvt_pk_bf16_f32 v16, v56, v57
 v_cvt_pk_bf16_f32 v17, v58, v59
 buffer_store_dwordx4 v[14:17], v28, s[36:39], s62 offen offset:2048 sc1
 s_add_u32 s61, s81, s16
 s_add_u32 s61, s61, 0
 buffer_load_dwordx4 a[212:215], v4, s[48:51], s61 offen offset:1024
 v_accvgpr_read_b32 v48, a52
 v_accvgpr_read_b32 v49, a53
 v_accvgpr_read_b32 v50, a54
 v_accvgpr_read_b32 v51, a55
 v_accvgpr_read_b32 v56, a68
 v_accvgpr_read_b32 v57, a69
 v_accvgpr_read_b32 v58, a70
 v_accvgpr_read_b32 v59, a71
 v_pk_mul_f32 v[64:65], v[48:49], v[48:49]
 v_pk_mul_f32 v[66:67], v[50:51], v[50:51]
 v_pk_mul_f32 v[56:57], v[48:49], v[56:57]
 v_pk_mul_f32 v[58:59], v[50:51], v[58:59]
 v_pk_fma_f32 v[64:65], v[64:65], v[34:35], v[32:33]
 v_pk_fma_f32 v[66:67], v[66:67], v[34:35], v[32:33]
 v_pk_mul_f32 v[64:65], v[64:65], v[48:49]
 v_pk_mul_f32 v[66:67], v[66:67], v[50:51]
 v_exp_f32 v64, v64
 v_exp_f32 v65, v65
 v_exp_f32 v66, v66
 v_exp_f32 v67, v67
 v_pk_add_f32 v[64:65], v[64:65], v[40:41]
 v_pk_add_f32 v[66:67], v[66:67], v[40:41]
 v_rcp_f32 v64, v64
 v_rcp_f32 v65, v65
 v_rcp_f32 v66, v66
 v_rcp_f32 v67, v67
 v_pk_mul_f32 v[56:57], v[56:57], v[64:65]
 v_pk_mul_f32 v[58:59], v[58:59], v[66:67]
 v_cvt_pk_bf16_f32 v18, v56, v57
 v_cvt_pk_bf16_f32 v19, v58, v59
 buffer_store_dwordx4 v[16:19], v27, s[36:39], s62 offen offset:2048 sc1
 v_accvgpr_read_b32 v48, a84
 v_accvgpr_read_b32 v49, a85
 v_accvgpr_read_b32 v50, a86
 v_accvgpr_read_b32 v51, a87
 v_accvgpr_read_b32 v56, a100
 v_accvgpr_read_b32 v57, a101
 v_accvgpr_read_b32 v58, a102
 v_accvgpr_read_b32 v59, a103
 v_pk_mul_f32 v[64:65], v[48:49], v[48:49]
 v_pk_mul_f32 v[66:67], v[50:51], v[50:51]
 v_pk_mul_f32 v[56:57], v[48:49], v[56:57]
 v_pk_mul_f32 v[58:59], v[50:51], v[58:59]
 v_pk_fma_f32 v[64:65], v[64:65], v[34:35], v[32:33]
 v_pk_fma_f32 v[66:67], v[66:67], v[34:35], v[32:33]
 v_pk_mul_f32 v[64:65], v[64:65], v[48:49]
 v_pk_mul_f32 v[66:67], v[66:67], v[50:51]
 v_exp_f32 v64, v64
 v_exp_f32 v65, v65
 v_exp_f32 v66, v66
 v_exp_f32 v67, v67
 v_pk_add_f32 v[64:65], v[64:65], v[40:41]
 v_pk_add_f32 v[66:67], v[66:67], v[40:41]
 v_rcp_f32 v64, v64
 v_rcp_f32 v65, v65
 v_rcp_f32 v66, v66
 v_rcp_f32 v67, v67
 v_pk_mul_f32 v[56:57], v[56:57], v[64:65]
 v_pk_mul_f32 v[58:59], v[58:59], v[66:67]
 v_cvt_pk_bf16_f32 v20, v56, v57
 v_cvt_pk_bf16_f32 v21, v58, v59
 buffer_store_dwordx4 v[18:21], v28, s[36:39], s62 offen offset:3072 sc1
 s_add_u32 s61, s82, 0
 buffer_load_dwordx4 a[216:219], v4, s[48:51], s61 offen offset:1024
 v_accvgpr_read_b32 v48, a116
 v_accvgpr_read_b32 v49, a117
 v_accvgpr_read_b32 v50, a118
 v_accvgpr_read_b32 v51, a119
 v_accvgpr_read_b32 v56, a132
 v_accvgpr_read_b32 v57, a133
 v_accvgpr_read_b32 v58, a134
 v_accvgpr_read_b32 v59, a135
 v_pk_mul_f32 v[64:65], v[48:49], v[48:49]
 v_pk_mul_f32 v[66:67], v[50:51], v[50:51]
 v_pk_mul_f32 v[56:57], v[48:49], v[56:57]
 v_pk_mul_f32 v[58:59], v[50:51], v[58:59]
 v_pk_fma_f32 v[64:65], v[64:65], v[34:35], v[32:33]
 v_pk_fma_f32 v[66:67], v[66:67], v[34:35], v[32:33]
 v_pk_mul_f32 v[64:65], v[64:65], v[48:49]
 v_pk_mul_f32 v[66:67], v[66:67], v[50:51]
 v_exp_f32 v64, v64
 v_exp_f32 v65, v65
 v_exp_f32 v66, v66
 v_exp_f32 v67, v67
 v_pk_add_f32 v[64:65], v[64:65], v[40:41]
 v_pk_add_f32 v[66:67], v[66:67], v[40:41]
 v_rcp_f32 v64, v64
 v_rcp_f32 v65, v65
 v_rcp_f32 v66, v66
 v_rcp_f32 v67, v67
 v_pk_mul_f32 v[56:57], v[56:57], v[64:65]
 v_pk_mul_f32 v[58:59], v[58:59], v[66:67]
 v_cvt_pk_bf16_f32 v22, v56, v57
 v_cvt_pk_bf16_f32 v23, v58, v59
 buffer_store_dwordx4 v[20:23], v27, s[36:39], s62 offen offset:3072 sc1
 v_accvgpr_read_b32 v48, a148
 v_accvgpr_read_b32 v49, a149
 v_accvgpr_read_b32 v50, a150
 v_accvgpr_read_b32 v51, a151
 v_accvgpr_read_b32 v56, a164
 v_accvgpr_read_b32 v57, a165
 v_accvgpr_read_b32 v58, a166
 v_accvgpr_read_b32 v59, a167
 v_pk_mul_f32 v[64:65], v[48:49], v[48:49]
 v_pk_mul_f32 v[66:67], v[50:51], v[50:51]
 v_pk_mul_f32 v[56:57], v[48:49], v[56:57]
 v_pk_mul_f32 v[58:59], v[50:51], v[58:59]
 v_pk_fma_f32 v[64:65], v[64:65], v[34:35], v[32:33]
 v_pk_fma_f32 v[66:67], v[66:67], v[34:35], v[32:33]
 v_pk_mul_f32 v[64:65], v[64:65], v[48:49]
 v_pk_mul_f32 v[66:67], v[66:67], v[50:51]
 v_exp_f32 v64, v64
 v_exp_f32 v65, v65
 v_exp_f32 v66, v66
 v_exp_f32 v67, v67
 v_pk_add_f32 v[64:65], v[64:65], v[40:41]
 v_pk_add_f32 v[66:67], v[66:67], v[40:41]
 v_rcp_f32 v64, v64
 v_rcp_f32 v65, v65
 v_rcp_f32 v66, v66
 v_rcp_f32 v67, v67
 v_pk_mul_f32 v[56:57], v[56:57], v[64:65]
 v_pk_mul_f32 v[58:59], v[58:59], v[66:67]
 v_cvt_pk_bf16_f32 v24, v56, v57
 v_cvt_pk_bf16_f32 v25, v58, v59
 buffer_store_dwordx4 v[22:25], v28, s[36:39], s63 offen sc1
 buffer_store_dwordx2 v[24:25], v29, s[36:39], s63 offen sc1
 s_add_u32 s61, s82, s16
 s_add_u32 s61, s61, 0
 buffer_load_dwordx4 a[220:223], v4, s[48:51], s61 offen offset:1024
 s_add_u32 s62, s85, 0
 s_add_u32 s63, s62, 0x1000
 v_pk_mul_f32 v[64:65], v[52:53], v[52:53]
 v_pk_mul_f32 v[66:67], v[54:55], v[54:55]
 v_pk_mul_f32 v[84:85], v[52:53], v[84:85]
 v_pk_mul_f32 v[86:87], v[54:55], v[86:87]
 v_pk_fma_f32 v[64:65], v[64:65], v[34:35], v[32:33]
 v_pk_fma_f32 v[66:67], v[66:67], v[34:35], v[32:33]
 v_pk_mul_f32 v[64:65], v[64:65], v[52:53]
 v_pk_mul_f32 v[66:67], v[66:67], v[54:55]
 v_exp_f32 v64, v64
 v_exp_f32 v65, v65
 v_exp_f32 v66, v66
 v_exp_f32 v67, v67
 v_pk_add_f32 v[64:65], v[64:65], v[40:41]
 v_pk_add_f32 v[66:67], v[66:67], v[40:41]
 v_rcp_f32 v64, v64
 v_rcp_f32 v65, v65
 v_rcp_f32 v66, v66
 v_rcp_f32 v67, v67
 v_pk_mul_f32 v[84:85], v[84:85], v[64:65]
 v_pk_mul_f32 v[86:87], v[86:87], v[66:67]
 v_cvt_pk_bf16_f32 v8, v84, v85
 v_cvt_pk_bf16_f32 v9, v86, v87
 buffer_store_dwordx2 v[8:9], v80, s[36:39], s62 offen offset:512 sc1
 v_pk_mul_f32 v[64:65], v[116:117], v[116:117]
 v_pk_mul_f32 v[66:67], v[118:119], v[118:119]
 v_pk_mul_f32 v[148:149], v[116:117], v[148:149]
 v_pk_mul_f32 v[150:151], v[118:119], v[150:151]
 v_pk_fma_f32 v[64:65], v[64:65], v[34:35], v[32:33]
 v_pk_fma_f32 v[66:67], v[66:67], v[34:35], v[32:33]
 v_pk_mul_f32 v[64:65], v[64:65], v[116:117]
 v_pk_mul_f32 v[66:67], v[66:67], v[118:119]
 v_exp_f32 v64, v64
 v_exp_f32 v65, v65
 v_exp_f32 v66, v66
 v_exp_f32 v67, v67
 v_pk_add_f32 v[64:65], v[64:65], v[40:41]
 v_pk_add_f32 v[66:67], v[66:67], v[40:41]
 v_rcp_f32 v64, v64
 v_rcp_f32 v65, v65
 v_rcp_f32 v66, v66
 v_rcp_f32 v67, v67
 v_pk_mul_f32 v[148:149], v[148:149], v[64:65]
 v_pk_mul_f32 v[150:151], v[150:151], v[66:67]
 v_cvt_pk_bf16_f32 v10, v148, v149
 v_cvt_pk_bf16_f32 v11, v150, v151
 buffer_store_dwordx4 v[8:11], v27, s[36:39], s62 offen sc1
 v_pk_mul_f32 v[64:65], v[180:181], v[180:181]
 v_pk_mul_f32 v[66:67], v[182:183], v[182:183]
 v_pk_mul_f32 v[212:213], v[180:181], v[212:213]
 v_pk_mul_f32 v[214:215], v[182:183], v[214:215]
 v_pk_fma_f32 v[64:65], v[64:65], v[34:35], v[32:33]
 v_pk_fma_f32 v[66:67], v[66:67], v[34:35], v[32:33]
 v_pk_mul_f32 v[64:65], v[64:65], v[180:181]
 v_pk_mul_f32 v[66:67], v[66:67], v[182:183]
 v_exp_f32 v64, v64
 v_exp_f32 v65, v65
 v_exp_f32 v66, v66
 v_exp_f32 v67, v67
 v_pk_add_f32 v[64:65], v[64:65], v[40:41]
 v_pk_add_f32 v[66:67], v[66:67], v[40:41]
 v_rcp_f32 v64, v64
 v_rcp_f32 v65, v65
 v_rcp_f32 v66, v66
 v_rcp_f32 v67, v67
 v_pk_mul_f32 v[212:213], v[212:213], v[64:65]
 v_pk_mul_f32 v[214:215], v[214:215], v[66:67]
 v_cvt_pk_bf16_f32 v12, v212, v213
 v_cvt_pk_bf16_f32 v13, v214, v215
 buffer_store_dwordx4 v[10:13], v28, s[36:39], s62 offen offset:1024 sc1
 s_add_u32 s61, s81, 0x800
 buffer_load_dwordx4 a[224:227], v4, s[48:51], s61 offen
 v_accvgpr_read_b32 v56, a8
 v_accvgpr_read_b32 v57, a9
 v_accvgpr_read_b32 v58, a10
 v_accvgpr_read_b32 v59, a11
 v_pk_mul_f32 v[64:65], v[244:245], v[244:245]
 v_pk_mul_f32 v[66:67], v[246:247], v[246:247]
 v_pk_mul_f32 v[56:57], v[244:245], v[56:57]
 v_pk_mul_f32 v[58:59], v[246:247], v[58:59]
 v_pk_fma_f32 v[64:65], v[64:65], v[34:35], v[32:33]
 v_pk_fma_f32 v[66:67], v[66:67], v[34:35], v[32:33]
 v_pk_mul_f32 v[64:65], v[64:65], v[244:245]
 v_pk_mul_f32 v[66:67], v[66:67], v[246:247]
 v_exp_f32 v64, v64
 v_exp_f32 v65, v65
 v_exp_f32 v66, v66
 v_exp_f32 v67, v67
 v_pk_add_f32 v[64:65], v[64:65], v[40:41]
 v_pk_add_f32 v[66:67], v[66:67], v[40:41]
 v_rcp_f32 v64, v64
 v_rcp_f32 v65, v65
 v_rcp_f32 v66, v66
 v_rcp_f32 v67, v67
 v_pk_mul_f32 v[56:57], v[56:57], v[64:65]
 v_pk_mul_f32 v[58:59], v[58:59], v[66:67]
 v_cvt_pk_bf16_f32 v14, v56, v57
 v_cvt_pk_bf16_f32 v15, v58, v59
 buffer_store_dwordx4 v[12:15], v27, s[36:39], s62 offen offset:1024 sc1
 v_accvgpr_read_b32 v48, a24
 v_accvgpr_read_b32 v49, a25
 v_accvgpr_read_b32 v50, a26
 v_accvgpr_read_b32 v51, a27
 v_accvgpr_read_b32 v56, a40
 v_accvgpr_read_b32 v57, a41
 v_accvgpr_read_b32 v58, a42
 v_accvgpr_read_b32 v59, a43
 v_pk_mul_f32 v[64:65], v[48:49], v[48:49]
 v_pk_mul_f32 v[66:67], v[50:51], v[50:51]
 v_pk_mul_f32 v[56:57], v[48:49], v[56:57]
 v_pk_mul_f32 v[58:59], v[50:51], v[58:59]
 v_pk_fma_f32 v[64:65], v[64:65], v[34:35], v[32:33]
 v_pk_fma_f32 v[66:67], v[66:67], v[34:35], v[32:33]
 v_pk_mul_f32 v[64:65], v[64:65], v[48:49]
 v_pk_mul_f32 v[66:67], v[66:67], v[50:51]
 v_exp_f32 v64, v64
 v_exp_f32 v65, v65
 v_exp_f32 v66, v66
 v_exp_f32 v67, v67
 v_pk_add_f32 v[64:65], v[64:65], v[40:41]
 v_pk_add_f32 v[66:67], v[66:67], v[40:41]
 v_rcp_f32 v64, v64
 v_rcp_f32 v65, v65
 v_rcp_f32 v66, v66
 v_rcp_f32 v67, v67
 v_pk_mul_f32 v[56:57], v[56:57], v[64:65]
 v_pk_mul_f32 v[58:59], v[58:59], v[66:67]
 v_cvt_pk_bf16_f32 v16, v56, v57
 v_cvt_pk_bf16_f32 v17, v58, v59
 buffer_store_dwordx4 v[14:17], v28, s[36:39], s62 offen offset:2048 sc1
 s_add_u32 s61, s81, s16
 s_add_u32 s61, s61, 0x800
 buffer_load_dwordx4 a[228:231], v4, s[48:51], s61 offen
 v_accvgpr_read_b32 v48, a56
 v_accvgpr_read_b32 v49, a57
 v_accvgpr_read_b32 v50, a58
 v_accvgpr_read_b32 v51, a59
 v_accvgpr_read_b32 v56, a72
 v_accvgpr_read_b32 v57, a73
 v_accvgpr_read_b32 v58, a74
 v_accvgpr_read_b32 v59, a75
 v_pk_mul_f32 v[64:65], v[48:49], v[48:49]
 v_pk_mul_f32 v[66:67], v[50:51], v[50:51]
 v_pk_mul_f32 v[56:57], v[48:49], v[56:57]
 v_pk_mul_f32 v[58:59], v[50:51], v[58:59]
 v_pk_fma_f32 v[64:65], v[64:65], v[34:35], v[32:33]
 v_pk_fma_f32 v[66:67], v[66:67], v[34:35], v[32:33]
 v_pk_mul_f32 v[64:65], v[64:65], v[48:49]
 v_pk_mul_f32 v[66:67], v[66:67], v[50:51]
 v_exp_f32 v64, v64
 v_exp_f32 v65, v65
 v_exp_f32 v66, v66
 v_exp_f32 v67, v67
 v_pk_add_f32 v[64:65], v[64:65], v[40:41]
 v_pk_add_f32 v[66:67], v[66:67], v[40:41]
 v_rcp_f32 v64, v64
 v_rcp_f32 v65, v65
 v_rcp_f32 v66, v66
 v_rcp_f32 v67, v67
 v_pk_mul_f32 v[56:57], v[56:57], v[64:65]
 v_pk_mul_f32 v[58:59], v[58:59], v[66:67]
 v_cvt_pk_bf16_f32 v18, v56, v57
 v_cvt_pk_bf16_f32 v19, v58, v59
 buffer_store_dwordx4 v[16:19], v27, s[36:39], s62 offen offset:2048 sc1
 v_and_b32 v31, 15, v1
 v_lshlrev_b32 v31, 7, v31
 s_lshr_b32 s31, s67, 1
 s_lshl_b32 s31, s31, 11
 s_add_u32 s31, s31, 0x8000
 buffer_load_dword v30, v31, s[52:55], s31 offen sc1
 v_accvgpr_read_b32 v48, a88
 v_accvgpr_read_b32 v49, a89
 v_accvgpr_read_b32 v50, a90
 v_accvgpr_read_b32 v51, a91
 v_accvgpr_read_b32 v56, a104
 v_accvgpr_read_b32 v57, a105
 v_accvgpr_read_b32 v58, a106
 v_accvgpr_read_b32 v59, a107
 v_pk_mul_f32 v[64:65], v[48:49], v[48:49]
 v_pk_mul_f32 v[66:67], v[50:51], v[50:51]
 v_pk_mul_f32 v[56:57], v[48:49], v[56:57]
 v_pk_mul_f32 v[58:59], v[50:51], v[58:59]
 v_pk_fma_f32 v[64:65], v[64:65], v[34:35], v[32:33]
 v_pk_fma_f32 v[66:67], v[66:67], v[34:35], v[32:33]
 v_pk_mul_f32 v[64:65], v[64:65], v[48:49]
 v_pk_mul_f32 v[66:67], v[66:67], v[50:51]
 v_exp_f32 v64, v64
 v_exp_f32 v65, v65
 v_exp_f32 v66, v66
 v_exp_f32 v67, v67
 v_pk_add_f32 v[64:65], v[64:65], v[40:41]
 v_pk_add_f32 v[66:67], v[66:67], v[40:41]
 v_rcp_f32 v64, v64
 v_rcp_f32 v65, v65
 v_rcp_f32 v66, v66
 v_rcp_f32 v67, v67
 v_pk_mul_f32 v[56:57], v[56:57], v[64:65]
 v_pk_mul_f32 v[58:59], v[58:59], v[66:67]
 v_cvt_pk_bf16_f32 v20, v56, v57
 v_cvt_pk_bf16_f32 v21, v58, v59
 buffer_store_dwordx4 v[18:21], v28, s[36:39], s62 offen offset:3072 sc1
 s_add_u32 s61, s82, 0x800
 buffer_load_dwordx4 a[232:235], v4, s[48:51], s61 offen
 v_accvgpr_read_b32 v48, a120
 v_accvgpr_read_b32 v49, a121
 v_accvgpr_read_b32 v50, a122
 v_accvgpr_read_b32 v51, a123
 v_accvgpr_read_b32 v56, a136
 v_accvgpr_read_b32 v57, a137
 v_accvgpr_read_b32 v58, a138
 v_accvgpr_read_b32 v59, a139
 v_pk_mul_f32 v[64:65], v[48:49], v[48:49]
 v_pk_mul_f32 v[66:67], v[50:51], v[50:51]
 v_pk_mul_f32 v[56:57], v[48:49], v[56:57]
 v_pk_mul_f32 v[58:59], v[50:51], v[58:59]
 v_pk_fma_f32 v[64:65], v[64:65], v[34:35], v[32:33]
 v_pk_fma_f32 v[66:67], v[66:67], v[34:35], v[32:33]
 v_pk_mul_f32 v[64:65], v[64:65], v[48:49]
 v_pk_mul_f32 v[66:67], v[66:67], v[50:51]
 v_exp_f32 v64, v64
 v_exp_f32 v65, v65
 v_exp_f32 v66, v66
 v_exp_f32 v67, v67
 v_pk_add_f32 v[64:65], v[64:65], v[40:41]
 v_pk_add_f32 v[66:67], v[66:67], v[40:41]
 v_rcp_f32 v64, v64
 v_rcp_f32 v65, v65
 v_rcp_f32 v66, v66
 v_rcp_f32 v67, v67
 v_pk_mul_f32 v[56:57], v[56:57], v[64:65]
 v_pk_mul_f32 v[58:59], v[58:59], v[66:67]
 v_cvt_pk_bf16_f32 v22, v56, v57
 v_cvt_pk_bf16_f32 v23, v58, v59
 buffer_store_dwordx4 v[20:23], v27, s[36:39], s62 offen offset:3072 sc1
 v_accvgpr_read_b32 v48, a152
 v_accvgpr_read_b32 v49, a153
 v_accvgpr_read_b32 v50, a154
 v_accvgpr_read_b32 v51, a155
 v_accvgpr_read_b32 v56, a168
 v_accvgpr_read_b32 v57, a169
 v_accvgpr_read_b32 v58, a170
 v_accvgpr_read_b32 v59, a171
 v_pk_mul_f32 v[64:65], v[48:49], v[48:49]
 v_pk_mul_f32 v[66:67], v[50:51], v[50:51]
 v_pk_mul_f32 v[56:57], v[48:49], v[56:57]
 v_pk_mul_f32 v[58:59], v[50:51], v[58:59]
 v_pk_fma_f32 v[64:65], v[64:65], v[34:35], v[32:33]
 v_pk_fma_f32 v[66:67], v[66:67], v[34:35], v[32:33]
 v_pk_mul_f32 v[64:65], v[64:65], v[48:49]
 v_pk_mul_f32 v[66:67], v[66:67], v[50:51]
 v_exp_f32 v64, v64
 v_exp_f32 v65, v65
 v_exp_f32 v66, v66
 v_exp_f32 v67, v67
 v_pk_add_f32 v[64:65], v[64:65], v[40:41]
 v_pk_add_f32 v[66:67], v[66:67], v[40:41]
 v_rcp_f32 v64, v64
 v_rcp_f32 v65, v65
 v_rcp_f32 v66, v66
 v_rcp_f32 v67, v67
 v_pk_mul_f32 v[56:57], v[56:57], v[64:65]
 v_pk_mul_f32 v[58:59], v[58:59], v[66:67]
 v_cvt_pk_bf16_f32 v24, v56, v57
 v_cvt_pk_bf16_f32 v25, v58, v59
 buffer_store_dwordx4 v[22:25], v28, s[36:39], s63 offen sc1
 buffer_store_dwordx2 v[24:25], v29, s[36:39], s63 offen sc1
 s_add_u32 s61, s82, s16
 s_add_u32 s61, s61, 0x800
 buffer_load_dwordx4 a[236:239], v4, s[48:51], s61 offen
 s_add_u32 s62, s85, s17
 s_add_u32 s63, s62, 0x1000
 v_pk_mul_f32 v[64:65], v[60:61], v[60:61]
 v_pk_mul_f32 v[66:67], v[62:63], v[62:63]
 v_pk_mul_f32 v[92:93], v[60:61], v[92:93]
 v_pk_mul_f32 v[94:95], v[62:63], v[94:95]
 v_pk_fma_f32 v[64:65], v[64:65], v[34:35], v[32:33]
 v_pk_fma_f32 v[66:67], v[66:67], v[34:35], v[32:33]
 v_pk_mul_f32 v[64:65], v[64:65], v[60:61]
 v_pk_mul_f32 v[66:67], v[66:67], v[62:63]
 v_exp_f32 v64, v64
 v_exp_f32 v65, v65
 v_exp_f32 v66, v66
 v_exp_f32 v67, v67
 v_pk_add_f32 v[64:65], v[64:65], v[40:41]
 v_pk_add_f32 v[66:67], v[66:67], v[40:41]
 v_rcp_f32 v64, v64
 v_rcp_f32 v65, v65
 v_rcp_f32 v66, v66
 v_rcp_f32 v67, v67
 v_pk_mul_f32 v[92:93], v[92:93], v[64:65]
 v_pk_mul_f32 v[94:95], v[94:95], v[66:67]
 v_cvt_pk_bf16_f32 v8, v92, v93
 v_cvt_pk_bf16_f32 v9, v94, v95
 buffer_store_dwordx2 v[8:9], v80, s[36:39], s62 offen offset:512 sc1
 v_pk_mul_f32 v[64:65], v[124:125], v[124:125]
 v_pk_mul_f32 v[66:67], v[126:127], v[126:127]
 v_pk_mul_f32 v[156:157], v[124:125], v[156:157]
 v_pk_mul_f32 v[158:159], v[126:127], v[158:159]
 v_pk_fma_f32 v[64:65], v[64:65], v[34:35], v[32:33]
 v_pk_fma_f32 v[66:67], v[66:67], v[34:35], v[32:33]
 v_pk_mul_f32 v[64:65], v[64:65], v[124:125]
 v_pk_mul_f32 v[66:67], v[66:67], v[126:127]
 v_exp_f32 v64, v64
 v_exp_f32 v65, v65
 v_exp_f32 v66, v66
 v_exp_f32 v67, v67
 v_pk_add_f32 v[64:65], v[64:65], v[40:41]
 v_pk_add_f32 v[66:67], v[66:67], v[40:41]
 v_rcp_f32 v64, v64
 v_rcp_f32 v65, v65
 v_rcp_f32 v66, v66
 v_rcp_f32 v67, v67
 v_pk_mul_f32 v[156:157], v[156:157], v[64:65]
 v_pk_mul_f32 v[158:159], v[158:159], v[66:67]
 v_cvt_pk_bf16_f32 v10, v156, v157
 v_cvt_pk_bf16_f32 v11, v158, v159
 buffer_store_dwordx4 v[8:11], v27, s[36:39], s62 offen sc1
 v_pk_mul_f32 v[64:65], v[188:189], v[188:189]
 v_pk_mul_f32 v[66:67], v[190:191], v[190:191]
 v_pk_mul_f32 v[220:221], v[188:189], v[220:221]
 v_pk_mul_f32 v[222:223], v[190:191], v[222:223]
 v_pk_fma_f32 v[64:65], v[64:65], v[34:35], v[32:33]
 v_pk_fma_f32 v[66:67], v[66:67], v[34:35], v[32:33]
 v_pk_mul_f32 v[64:65], v[64:65], v[188:189]
 v_pk_mul_f32 v[66:67], v[66:67], v[190:191]
 v_exp_f32 v64, v64
 v_exp_f32 v65, v65
 v_exp_f32 v66, v66
 v_exp_f32 v67, v67
 v_pk_add_f32 v[64:65], v[64:65], v[40:41]
 v_pk_add_f32 v[66:67], v[66:67], v[40:41]
 v_rcp_f32 v64, v64
 v_rcp_f32 v65, v65
 v_rcp_f32 v66, v66
 v_rcp_f32 v67, v67
 v_pk_mul_f32 v[220:221], v[220:221], v[64:65]
 v_pk_mul_f32 v[222:223], v[222:223], v[66:67]
 v_cvt_pk_bf16_f32 v12, v220, v221
 v_cvt_pk_bf16_f32 v13, v222, v223
 buffer_store_dwordx4 v[10:13], v28, s[36:39], s62 offen offset:1024 sc1
 s_add_u32 s61, s81, 0x800
 buffer_load_dwordx4 a[240:243], v4, s[48:51], s61 offen offset:1024
 v_accvgpr_read_b32 v56, a12
 v_accvgpr_read_b32 v57, a13
 v_accvgpr_read_b32 v58, a14
 v_accvgpr_read_b32 v59, a15
 v_pk_mul_f32 v[64:65], v[252:253], v[252:253]
 v_pk_mul_f32 v[66:67], v[254:255], v[254:255]
 v_pk_mul_f32 v[56:57], v[252:253], v[56:57]
 v_pk_mul_f32 v[58:59], v[254:255], v[58:59]
 v_pk_fma_f32 v[64:65], v[64:65], v[34:35], v[32:33]
 v_pk_fma_f32 v[66:67], v[66:67], v[34:35], v[32:33]
 v_pk_mul_f32 v[64:65], v[64:65], v[252:253]
 v_pk_mul_f32 v[66:67], v[66:67], v[254:255]
 v_exp_f32 v64, v64
 v_exp_f32 v65, v65
 v_exp_f32 v66, v66
 v_exp_f32 v67, v67
 v_pk_add_f32 v[64:65], v[64:65], v[40:41]
 v_pk_add_f32 v[66:67], v[66:67], v[40:41]
 v_rcp_f32 v64, v64
 v_rcp_f32 v65, v65
 v_rcp_f32 v66, v66
 v_rcp_f32 v67, v67
 v_pk_mul_f32 v[56:57], v[56:57], v[64:65]
 v_pk_mul_f32 v[58:59], v[58:59], v[66:67]
 v_cvt_pk_bf16_f32 v14, v56, v57
 v_cvt_pk_bf16_f32 v15, v58, v59
 buffer_store_dwordx4 v[12:15], v27, s[36:39], s62 offen offset:1024 sc1
 v_accvgpr_read_b32 v48, a28
 v_accvgpr_read_b32 v49, a29
 v_accvgpr_read_b32 v50, a30
 v_accvgpr_read_b32 v51, a31
 v_accvgpr_read_b32 v56, a44
 v_accvgpr_read_b32 v57, a45
 v_accvgpr_read_b32 v58, a46
 v_accvgpr_read_b32 v59, a47
 v_pk_mul_f32 v[64:65], v[48:49], v[48:49]
 v_pk_mul_f32 v[66:67], v[50:51], v[50:51]
 v_pk_mul_f32 v[56:57], v[48:49], v[56:57]
 v_pk_mul_f32 v[58:59], v[50:51], v[58:59]
 v_pk_fma_f32 v[64:65], v[64:65], v[34:35], v[32:33]
 v_pk_fma_f32 v[66:67], v[66:67], v[34:35], v[32:33]
 v_pk_mul_f32 v[64:65], v[64:65], v[48:49]
 v_pk_mul_f32 v[66:67], v[66:67], v[50:51]
 v_exp_f32 v64, v64
 v_exp_f32 v65, v65
 v_exp_f32 v66, v66
 v_exp_f32 v67, v67
 v_pk_add_f32 v[64:65], v[64:65], v[40:41]
 v_pk_add_f32 v[66:67], v[66:67], v[40:41]
 v_rcp_f32 v64, v64
 v_rcp_f32 v65, v65
 v_rcp_f32 v66, v66
 v_rcp_f32 v67, v67
 v_pk_mul_f32 v[56:57], v[56:57], v[64:65]
 v_pk_mul_f32 v[58:59], v[58:59], v[66:67]
 v_cvt_pk_bf16_f32 v16, v56, v57
 v_cvt_pk_bf16_f32 v17, v58, v59
 buffer_store_dwordx4 v[14:17], v28, s[36:39], s62 offen offset:2048 sc1
 s_add_u32 s61, s81, s16
 s_add_u32 s61, s61, 0x800
 buffer_load_dwordx4 a[244:247], v4, s[48:51], s61 offen offset:1024
 v_accvgpr_read_b32 v48, a60
 v_accvgpr_read_b32 v49, a61
 v_accvgpr_read_b32 v50, a62
 v_accvgpr_read_b32 v51, a63
 v_accvgpr_read_b32 v56, a76
 v_accvgpr_read_b32 v57, a77
 v_accvgpr_read_b32 v58, a78
 v_accvgpr_read_b32 v59, a79
 v_pk_mul_f32 v[64:65], v[48:49], v[48:49]
 v_pk_mul_f32 v[66:67], v[50:51], v[50:51]
 v_pk_mul_f32 v[56:57], v[48:49], v[56:57]
 v_pk_mul_f32 v[58:59], v[50:51], v[58:59]
 v_pk_fma_f32 v[64:65], v[64:65], v[34:35], v[32:33]
 v_pk_fma_f32 v[66:67], v[66:67], v[34:35], v[32:33]
 v_pk_mul_f32 v[64:65], v[64:65], v[48:49]
 v_pk_mul_f32 v[66:67], v[66:67], v[50:51]
 v_exp_f32 v64, v64
 v_exp_f32 v65, v65
 v_exp_f32 v66, v66
 v_exp_f32 v67, v67
 v_pk_add_f32 v[64:65], v[64:65], v[40:41]
 v_pk_add_f32 v[66:67], v[66:67], v[40:41]
 v_rcp_f32 v64, v64
 v_rcp_f32 v65, v65
 v_rcp_f32 v66, v66
 v_rcp_f32 v67, v67
 v_pk_mul_f32 v[56:57], v[56:57], v[64:65]
 v_pk_mul_f32 v[58:59], v[58:59], v[66:67]
 v_cvt_pk_bf16_f32 v18, v56, v57
 v_cvt_pk_bf16_f32 v19, v58, v59
 s_waitcnt vmcnt(62)
 buffer_store_dwordx4 v[16:19], v27, s[36:39], s62 offen offset:2048 sc1
 v_accvgpr_read_b32 v48, a92
 v_accvgpr_read_b32 v49, a93
 v_accvgpr_read_b32 v50, a94
 v_accvgpr_read_b32 v51, a95
 v_accvgpr_read_b32 v56, a108
 v_accvgpr_read_b32 v57, a109
 v_accvgpr_read_b32 v58, a110
 v_accvgpr_read_b32 v59, a111
 v_pk_mul_f32 v[64:65], v[48:49], v[48:49]
 v_pk_mul_f32 v[66:67], v[50:51], v[50:51]
 v_pk_mul_f32 v[56:57], v[48:49], v[56:57]
 v_pk_mul_f32 v[58:59], v[50:51], v[58:59]
 v_pk_fma_f32 v[64:65], v[64:65], v[34:35], v[32:33]
 v_pk_fma_f32 v[66:67], v[66:67], v[34:35], v[32:33]
 v_pk_mul_f32 v[64:65], v[64:65], v[48:49]
 v_pk_mul_f32 v[66:67], v[66:67], v[50:51]
 v_exp_f32 v64, v64
 v_exp_f32 v65, v65
 v_exp_f32 v66, v66
 v_exp_f32 v67, v67
 v_pk_add_f32 v[64:65], v[64:65], v[40:41]
 v_pk_add_f32 v[66:67], v[66:67], v[40:41]
 v_rcp_f32 v64, v64
 v_rcp_f32 v65, v65
 v_rcp_f32 v66, v66
 v_rcp_f32 v67, v67
 v_pk_mul_f32 v[56:57], v[56:57], v[64:65]
 v_pk_mul_f32 v[58:59], v[58:59], v[66:67]
 v_cvt_pk_bf16_f32 v20, v56, v57
 v_cvt_pk_bf16_f32 v21, v58, v59
 s_waitcnt vmcnt(62)
 buffer_store_dwordx4 v[18:21], v28, s[36:39], s62 offen offset:3072 sc1
 s_add_u32 s61, s82, 0x800
 s_waitcnt vmcnt(62)
 buffer_load_dwordx4 a[248:251], v4, s[48:51], s61 offen offset:1024
 v_accvgpr_read_b32 v48, a124
 v_accvgpr_read_b32 v49, a125
 v_accvgpr_read_b32 v50, a126
 v_accvgpr_read_b32 v51, a127
 v_accvgpr_read_b32 v56, a140
 v_accvgpr_read_b32 v57, a141
 v_accvgpr_read_b32 v58, a142
 v_accvgpr_read_b32 v59, a143
 v_pk_mul_f32 v[64:65], v[48:49], v[48:49]
 v_pk_mul_f32 v[66:67], v[50:51], v[50:51]
 v_pk_mul_f32 v[56:57], v[48:49], v[56:57]
 v_pk_mul_f32 v[58:59], v[50:51], v[58:59]
 v_pk_fma_f32 v[64:65], v[64:65], v[34:35], v[32:33]
 v_pk_fma_f32 v[66:67], v[66:67], v[34:35], v[32:33]
 v_pk_mul_f32 v[64:65], v[64:65], v[48:49]
 v_pk_mul_f32 v[66:67], v[66:67], v[50:51]
 v_exp_f32 v64, v64
 v_exp_f32 v65, v65
 v_exp_f32 v66, v66
 v_exp_f32 v67, v67
 v_pk_add_f32 v[64:65], v[64:65], v[40:41]
 v_pk_add_f32 v[66:67], v[66:67], v[40:41]
 v_rcp_f32 v64, v64
 v_rcp_f32 v65, v65
 v_rcp_f32 v66, v66
 v_rcp_f32 v67, v67
 v_pk_mul_f32 v[56:57], v[56:57], v[64:65]
 v_pk_mul_f32 v[58:59], v[58:59], v[66:67]
 v_cvt_pk_bf16_f32 v22, v56, v57
 v_cvt_pk_bf16_f32 v23, v58, v59
 s_waitcnt vmcnt(62)
 buffer_store_dwordx4 v[20:23], v27, s[36:39], s62 offen offset:3072 sc1
 v_accvgpr_read_b32 v48, a156
 v_accvgpr_read_b32 v49, a157
 v_accvgpr_read_b32 v50, a158
 v_accvgpr_read_b32 v51, a159
 v_accvgpr_read_b32 v56, a172
 v_accvgpr_read_b32 v57, a173
 v_accvgpr_read_b32 v58, a174
 v_accvgpr_read_b32 v59, a175
 v_pk_mul_f32 v[64:65], v[48:49], v[48:49]
 v_pk_mul_f32 v[66:67], v[50:51], v[50:51]
 v_pk_mul_f32 v[56:57], v[48:49], v[56:57]
 v_pk_mul_f32 v[58:59], v[50:51], v[58:59]
 v_pk_fma_f32 v[64:65], v[64:65], v[34:35], v[32:33]
 v_pk_fma_f32 v[66:67], v[66:67], v[34:35], v[32:33]
 v_pk_mul_f32 v[64:65], v[64:65], v[48:49]
 v_pk_mul_f32 v[66:67], v[66:67], v[50:51]
 v_exp_f32 v64, v64
 v_exp_f32 v65, v65
 v_exp_f32 v66, v66
 v_exp_f32 v67, v67
 v_pk_add_f32 v[64:65], v[64:65], v[40:41]
 v_pk_add_f32 v[66:67], v[66:67], v[40:41]
 v_rcp_f32 v64, v64
 v_rcp_f32 v65, v65
 v_rcp_f32 v66, v66
 v_rcp_f32 v67, v67
 v_pk_mul_f32 v[56:57], v[56:57], v[64:65]
 v_pk_mul_f32 v[58:59], v[58:59], v[66:67]
 v_cvt_pk_bf16_f32 v24, v56, v57
 v_cvt_pk_bf16_f32 v25, v58, v59
 s_waitcnt vmcnt(62)
 buffer_store_dwordx4 v[22:25], v28, s[36:39], s63 offen sc1
 s_waitcnt vmcnt(62)
 buffer_store_dwordx2 v[24:25], v29, s[36:39], s63 offen sc1
 s_add_u32 s61, s82, s16
 s_add_u32 s61, s61, 0x800
 s_waitcnt vmcnt(62)
 buffer_load_dwordx4 a[252:255], v4, s[48:51], s61 offen offset:1024
f_qp:
 s_waitcnt vmcnt(20)
 v_cmp_eq_u32 vcc, v6, v30
 s_nop 3
 s_cmp_eq_u64 vcc, -1
 s_cbranch_scc0 f_kv_spin
f_kv_ok:
 v_lshrrev_b32 v28, 2, v3
 v_and_b32 v29, 1, v2
 v_lshl_or_b32 v29, v29, 2, v28
 v_lshl_add_u32 v28, v2, 3, v28
 v_lshlrev_b32 v28, 8, v28
 v_and_b32 v30, 3, v3
 v_lshl_add_u32 v28, v30, 3, v28
 v_xor_b32 v30, 0, v29
 v_lshl_add_u32 v8, v30, 5, v28
 v_xor_b32 v30, 1, v29
 v_lshl_add_u32 v9, v30, 5, v28
 v_xor_b32 v30, 2, v29
 v_lshl_add_u32 v10, v30, 5, v28
 v_xor_b32 v30, 3, v29
 v_lshl_add_u32 v11, v30, 5, v28
 v_xor_b32 v30, 4, v29
 v_lshl_add_u32 v12, v30, 5, v28
 v_xor_b32 v30, 5, v29
 v_lshl_add_u32 v13, v30, 5, v28
 v_xor_b32 v30, 6, v29
 v_lshl_add_u32 v14, v30, 5, v28
 v_xor_b32 v30, 7, v29
 v_lshl_add_u32 v15, v30, 5, v28
 s_add_u32 s44, s28, 0x400000
 s_addc_u32 s45, s29, 0
 s_mov_b32 s46, 0x2000000
 s_mov_b32 s47, 0x20000
 s_add_u32 s36, s28, 0x400000
 s_addc_u32 s37, s29, 0
 s_mov_b32 s38, 0x2000000
 s_mov_b32 s39, 0x20000
 s_add_u32 s40, s28, 0x2800000
 s_addc_u32 s41, s29, 0
 s_mov_b32 s42, 0x2200000
 s_mov_b32 s43, 0x20000
 s_sub_u32 s70, 15, s66
 s_add_u32 s72, s70, 1
 s_lshl_b32 s74, s67, 20
 s_lshl_b32 s30, s3, 12
 s_add_u32 s74, s74, s30
 s_mov_b32 s75, s30
 s_mov_b32 s71, 0
 s_add_u32 s77, s74, 0x10000
 s_barrier
 ds_read_b64_tr_b16 a[176:177], v8
 ds_read_b64_tr_b16 a[178:179], v8 offset:1024
 ds_read_b64_tr_b16 a[180:181], v9
 ds_read_b64_tr_b16 a[182:183], v9 offset:1024
 ds_read_b64_tr_b16 a[184:185], v10
 ds_read_b64_tr_b16 a[186:187], v10 offset:1024
 ds_read_b64_tr_b16 a[188:189], v11
 ds_read_b64_tr_b16 a[190:191], v11 offset:1024
 s_waitcnt lgkmcnt(6)
 mf v[128:131], a[176:179], a[192:195], 0
 mf v[160:163], a[176:179], a[196:199], 0
 mf v[192:195], a[176:179], a[200:203], 0
 mf v[224:227], a[176:179], a[204:207], 0
 s_waitcnt lgkmcnt(4)
 ds_read_b64_tr_b16 a[176:177], v12
 ds_read_b64_tr_b16 a[178:179], v12 offset:1024
 mf v[132:135], a[180:183], a[192:195], 0
 mf v[164:167], a[180:183], a[196:199], 0
 mf v[196:199], a[180:183], a[200:203], 0
 mf v[228:231], a[180:183], a[204:207], 0
 s_waitcnt lgkmcnt(4)
 ds_read_b64_tr_b16 a[180:181], v13
 ds_read_b64_tr_b16 a[182:183], v13 offset:1024
 mf v[136:139], a[184:187], a[192:195], 0
 v_mov_b32 v112, v4
 v_xor_b32 v113, 0x8000, v4
 mf v[168:171], a[184:187], a[196:199], 0
 v_add_u32 v114, 0x10000, v4
 v_xor_b32 v115, 0x8000, v114
 mf v[200:203], a[184:187], a[200:203], 0
 v_lshlrev_b32 v116, 2, v2
 v_sub_u32 v116, v116, v3
 mf v[232:235], a[184:187], a[204:207], 0
 s_waitcnt lgkmcnt(4)
 ds_read_b64_tr_b16 a[184:185], v14
 ds_read_b64_tr_b16 a[186:187], v14 offset:1024
 mf v[140:143], a[188:191], a[192:195], 0
 s_lshl_b32 s31, s3, 4
 v_mov_b32 v117, 0x7f800000
 v_mov_b32 v118, 0xff800000
 mf v[172:175], a[188:191], a[196:199], 0
 s_add_i32 s30, s31, 0
 mf v[204:207], a[188:191], a[200:203], 0
 v_cmp_ge_i32 vcc, s30, v116
 mf v[236:239], a[188:191], a[204:207], 0
 s_waitcnt lgkmcnt(4)
 ds_read_b64_tr_b16 a[188:189], v15
 ds_read_b64_tr_b16 a[190:191], v15 offset:1024
 mf v[144:147], a[176:179], a[192:195], 0
 s_add_i32 s30, s31, -1
 v_cndmask_b32 v32, v118, v117, vcc
 mf v[176:179], a[176:179], a[196:199], 0
 v_cmp_ge_i32 vcc, s30, v116
 mf v[208:211], a[176:179], a[200:203], 0
 mf v[240:243], a[176:179], a[204:207], 0
 s_waitcnt lgkmcnt(4)
 ds_read_b64_tr_b16 a[176:177], v8 offset:8192
 ds_read_b64_tr_b16 a[178:179], v8 offset:9216
 mf v[148:151], a[180:183], a[192:195], 0
 s_add_i32 s30, s31, -2
 v_cndmask_b32 v33, v118, v117, vcc
 mf v[180:183], a[180:183], a[196:199], 0
 v_cmp_ge_i32 vcc, s30, v116
 mf v[212:215], a[180:183], a[200:203], 0
 mf v[244:247], a[180:183], a[204:207], 0
 s_waitcnt lgkmcnt(4)
 ds_read_b64_tr_b16 a[180:181], v9 offset:8192
 ds_read_b64_tr_b16 a[182:183], v9 offset:9216
 mf v[152:155], a[184:187], a[192:195], 0
 s_add_i32 s30, s31, -3
 v_cndmask_b32 v34, v118, v117, vcc
 mf v[184:187], a[184:187], a[196:199], 0
 v_cmp_ge_i32 vcc, s30, v116
 mf v[216:219], a[184:187], a[200:203], 0
 mf v[248:251], a[184:187], a[204:207], 0
 s_waitcnt lgkmcnt(4)
 ds_read_b64_tr_b16 a[184:185], v10 offset:8192
 ds_read_b64_tr_b16 a[186:187], v10 offset:9216
 mf v[156:159], a[188:191], a[192:195], 0
 s_add_i32 s30, s31, -16
 v_cndmask_b32 v35, v118, v117, vcc
 mf v[188:191], a[188:191], a[196:199], 0
 v_cmp_ge_i32 vcc, s30, v116
 mf v[220:223], a[188:191], a[200:203], 0
 mf v[252:255], a[188:191], a[204:207], 0
 s_waitcnt lgkmcnt(4)
 ds_read_b64_tr_b16 a[188:189], v11 offset:8192
 ds_read_b64_tr_b16 a[190:191], v11 offset:9216
 mf v[128:131], a[176:179], a[208:211], v[128:131]
 s_add_i32 s30, s31, 0xffffffef
 v_cndmask_b32 v40, v118, v117, vcc
 mf v[160:163], a[176:179], a[212:215], v[160:163]
 v_cmp_ge_i32 vcc, s30, v116
 mf v[192:195], a[176:179], a[216:219], v[192:195]
 mf v[224:227], a[176:179], a[220:223], v[224:227]
 s_waitcnt lgkmcnt(4)
 ds_read_b64_tr_b16 a[176:177], v12 offset:8192
 ds_read_b64_tr_b16 a[178:179], v12 offset:9216
 mf v[132:135], a[180:183], a[208:211], v[132:135]
 s_add_i32 s30, s31, 0xffffffee
 v_cndmask_b32 v41, v118, v117, vcc
 mf v[164:167], a[180:183], a[212:215], v[164:167]
 v_cmp_ge_i32 vcc, s30, v116
 mf v[196:199], a[180:183], a[216:219], v[196:199]
 mf v[228:231], a[180:183], a[220:223], v[228:231]
 s_waitcnt lgkmcnt(4)
 ds_read_b64_tr_b16 a[180:181], v13 offset:8192
 ds_read_b64_tr_b16 a[182:183], v13 offset:9216
 mf v[136:139], a[184:187], a[208:211], v[136:139]
 s_add_i32 s30, s31, 0xffffffed
 v_cndmask_b32 v42, v118, v117, vcc
 mf v[168:171], a[184:187], a[212:215], v[168:171]
 v_cmp_ge_i32 vcc, s30, v116
 mf v[200:203], a[184:187], a[216:219], v[200:203]
 mf v[232:235], a[184:187], a[220:223], v[232:235]
 s_waitcnt lgkmcnt(4)
 ds_read_b64_tr_b16 a[184:185], v14 offset:8192
 ds_read_b64_tr_b16 a[186:187], v14 offset:9216
 mf v[140:143], a[188:191], a[208:211], v[140:143]
 s_add_i32 s30, s31, 0xffffffe0
 v_cndmask_b32 v43, v118, v117, vcc
 mf v[172:175], a[188:191], a[212:215], v[172:175]
 v_cmp_ge_i32 vcc, s30, v116
 mf v[204:207], a[188:191], a[216:219], v[204:207]
 mf v[236:239], a[188:191], a[220:223], v[236:239]
 s_waitcnt lgkmcnt(4)
 ds_read_b64_tr_b16 a[188:189], v15 offset:8192
 ds_read_b64_tr_b16 a[190:191], v15 offset:9216
 mf v[144:147], a[176:179], a[208:211], v[144:147]
 s_add_i32 s30, s31, 0xffffffdf
 v_cndmask_b32 v48, v118, v117, vcc
 mf v[176:179], a[176:179], a[212:215], v[176:179]
 v_cmp_ge_i32 vcc, s30, v116
 mf v[208:211], a[176:179], a[216:219], v[208:211]
 mf v[240:243], a[176:179], a[220:223], v[240:243]
 s_waitcnt lgkmcnt(4)
 s_add_i32 s30, s31, 0xffffffde
 v_cndmask_b32 v49, v118, v117, vcc
 mf v[148:151], a[180:183], a[208:211], v[148:151]
 v_cmp_ge_i32 vcc, s30, v116
 mf v[180:183], a[180:183], a[212:215], v[180:183]
 s_waitcnt lgkmcnt(0)
 s_barrier
 mf v[212:215], a[180:183], a[216:219], v[212:215]
 ds_read_b64_tr_b16 a[176:177], v8 offset:16384
 ds_read_b64_tr_b16 a[178:179], v8 offset:17408
 mf v[244:247], a[180:183], a[220:223], v[244:247]
 ds_read_b64_tr_b16 a[180:181], v9 offset:16384
 ds_read_b64_tr_b16 a[182:183], v9 offset:17408
 mf v[152:155], a[184:187], a[208:211], v[152:155]
 s_add_i32 s30, s31, 0xffffffdd
 v_cndmask_b32 v50, v118, v117, vcc
 mf v[184:187], a[184:187], a[212:215], v[184:187]
 v_cmp_ge_i32 vcc, s30, v116
 mf v[216:219], a[184:187], a[216:219], v[216:219]
 mf v[248:251], a[184:187], a[220:223], v[248:251]
 ds_read_b64_tr_b16 a[184:185], v10 offset:16384
 ds_read_b64_tr_b16 a[186:187], v10 offset:17408
 mf v[156:159], a[188:191], a[208:211], v[156:159]
 s_add_i32 s30, s31, 0xffffffd0
 v_cndmask_b32 v51, v118, v117, vcc
 mf v[188:191], a[188:191], a[212:215], v[188:191]
 v_cmp_ge_i32 vcc, s30, v116
 mf v[220:223], a[188:191], a[216:219], v[220:223]
 mf v[252:255], a[188:191], a[220:223], v[252:255]
 s_waitcnt lgkmcnt(4)
 ds_read_b64_tr_b16 a[188:189], v11 offset:16384
 ds_read_b64_tr_b16 a[190:191], v11 offset:17408
 mf v[128:131], a[176:179], a[224:227], v[128:131]
 s_add_u32 s61, s81, 0x1000
 buffer_load_dwordx4 a[192:195], v4, s[48:51], s61 offen
 mf v[160:163], a[176:179], a[228:231], v[160:163]
 s_waitcnt vmcnt(19)
 s_add_i32 s30, s31, 0xffffffcf
 v_cndmask_b32 v56, v118, v117, vcc
 mf v[192:195], a[176:179], a[232:235], v[192:195]
 s_waitcnt vmcnt(15)
 v_cmp_ge_i32 vcc, s30, v116
 mf v[224:227], a[176:179], a[236:239], v[224:227]
 s_waitcnt lgkmcnt(4)
 ds_read_b64_tr_b16 a[176:177], v12 offset:16384
 ds_read_b64_tr_b16 a[178:179], v12 offset:17408
 mf v[132:135], a[180:183], a[224:227], v[132:135]
 s_add_i32 s30, s31, 0xffffffce
 v_cndmask_b32 v57, v118, v117, vcc
 mf v[164:167], a[180:183], a[228:231], v[164:167]
 s_add_u32 s61, s81, s16
 v_cmp_ge_i32 vcc, s30, v116
 mf v[196:199], a[180:183], a[232:235], v[196:199]
 s_add_u32 s61, s61, 0x1000
 buffer_load_dwordx4 a[196:199], v4, s[48:51], s61 offen
 mf v[228:231], a[180:183], a[236:239], v[228:231]
 s_waitcnt lgkmcnt(4)
 ds_read_b64_tr_b16 a[180:181], v13 offset:16384
 ds_read_b64_tr_b16 a[182:183], v13 offset:17408
 mf v[136:139], a[184:187], a[224:227], v[136:139]
 s_add_i32 s30, s31, 0xffffffcd
 v_cndmask_b32 v58, v118, v117, vcc
 mf v[168:171], a[184:187], a[228:231], v[168:171]
 v_cmp_ge_i32 vcc, s30, v116
 mf v[200:203], a[184:187], a[232:235], v[200:203]
 mf v[232:235], a[184:187], a[236:239], v[232:235]
 s_waitcnt lgkmcnt(4)
 s_add_u32 s61, s82, 0x1000
 ds_read_b64_tr_b16 a[184:185], v14 offset:16384
 ds_read_b64_tr_b16 a[186:187], v14 offset:17408
 mf v[140:143], a[188:191], a[224:227], v[140:143]
 buffer_load_dwordx4 a[200:203], v4, s[48:51], s61 offen
 mf v[172:175], a[188:191], a[228:231], v[172:175]
 s_lshl_b32 s31, s3, 4
 v_cndmask_b32 v59, v118, v117, vcc
 mf v[204:207], a[188:191], a[232:235], v[204:207]
 s_sub_u32 s31, 0x70, s31
 mf v[236:239], a[188:191], a[236:239], v[236:239]
 s_waitcnt lgkmcnt(4)
 s_add_i32 s30, s31, 0
 ds_read_b64_tr_b16 a[188:189], v15 offset:16384
 ds_read_b64_tr_b16 a[190:191], v15 offset:17408
 mf v[144:147], a[176:179], a[224:227], v[144:147]
 v_cmp_ge_i32 vcc, s30, v116
 mf v[176:179], a[176:179], a[228:231], v[176:179]
 s_add_u32 s61, s82, s16
 mf v[208:211], a[176:179], a[232:235], v[208:211]
 s_add_u32 s61, s61, 0x1000
 buffer_load_dwordx4 a[204:207], v4, s[48:51], s61 offen
 mf v[240:243], a[176:179], a[236:239], v[240:243]
 s_waitcnt lgkmcnt(4)
 ds_read_b64_tr_b16 a[176:177], v8 offset:24576
 ds_read_b64_tr_b16 a[178:179], v8 offset:25600
 mf v[148:151], a[180:183], a[224:227], v[148:151]
 s_add_i32 s30, s31, -1
 v_cndmask_b32 v36, v118, v117, vcc
 mf v[180:183], a[180:183], a[228:231], v[180:183]
 v_cmp_ge_i32 vcc, s30, v116
 mf v[212:215], a[180:183], a[232:235], v[212:215]
 mf v[244:247], a[180:183], a[236:239], v[244:247]
 s_waitcnt lgkmcnt(4)
 s_add_u32 s61, s81, 0x1000
 ds_read_b64_tr_b16 a[180:181], v9 offset:24576
 ds_read_b64_tr_b16 a[182:183], v9 offset:25600
 mf v[152:155], a[184:187], a[224:227], v[152:155]
 buffer_load_dwordx4 a[208:211], v4, s[48:51], s61 offen offset:1024
 mf v[184:187], a[184:187], a[228:231], v[184:187]
 s_add_i32 s30, s31, -2
 v_cndmask_b32 v37, v118, v117, vcc
 mf v[216:219], a[184:187], a[232:235], v[216:219]
 v_cmp_ge_i32 vcc, s30, v116
 mf v[248:251], a[184:187], a[236:239], v[248:251]
 s_waitcnt lgkmcnt(4)
 ds_read_b64_tr_b16 a[184:185], v10 offset:24576
 ds_read_b64_tr_b16 a[186:187], v10 offset:25600
 mf v[156:159], a[188:191], a[224:227], v[156:159]
 s_add_i32 s30, s31, -3
 v_cndmask_b32 v38, v118, v117, vcc
 mf v[188:191], a[188:191], a[228:231], v[188:191]
 s_add_u32 s61, s81, s16
 v_cmp_ge_i32 vcc, s30, v116
 mf v[220:223], a[188:191], a[232:235], v[220:223]
 s_add_u32 s61, s61, 0x1000
 buffer_load_dwordx4 a[212:215], v4, s[48:51], s61 offen offset:1024
 mf v[252:255], a[188:191], a[236:239], v[252:255]
 s_waitcnt vmcnt(16) lgkmcnt(4)
 ds_read_b64_tr_b16 a[188:189], v11 offset:24576
 ds_read_b64_tr_b16 a[190:191], v11 offset:25600
 mf v[128:131], a[176:179], a[240:243], v[128:131]
 s_waitcnt vmcnt(13)
 s_add_i32 s30, s31, -16
 v_cndmask_b32 v39, v118, v117, vcc
 mf v[160:163], a[176:179], a[244:247], v[160:163]
 s_waitcnt vmcnt(10)
 v_cmp_ge_i32 vcc, s30, v116
 mf v[192:195], a[176:179], a[248:251], v[192:195]
 s_waitcnt vmcnt(6)
 mf v[224:227], a[176:179], a[252:255], v[224:227]
 s_waitcnt lgkmcnt(4)
 s_add_u32 s61, s82, 0x1000
 ds_read_b64_tr_b16 a[176:177], v12 offset:24576
 ds_read_b64_tr_b16 a[178:179], v12 offset:25600
 mf v[132:135], a[180:183], a[240:243], v[132:135]
 buffer_load_dwordx4 a[216:219], v4, s[48:51], s61 offen offset:1024
 mf v[164:167], a[180:183], a[244:247], v[164:167]
 s_add_i32 s30, s31, 0xffffffef
 v_cndmask_b32 v44, v118, v117, vcc
 mf v[196:199], a[180:183], a[248:251], v[196:199]
 v_cmp_ge_i32 vcc, s30, v116
 mf v[228:231], a[180:183], a[252:255], v[228:231]
 s_waitcnt lgkmcnt(4)
 ds_read_b64_tr_b16 a[180:181], v13 offset:24576
 ds_read_b64_tr_b16 a[182:183], v13 offset:25600
 mf v[136:139], a[184:187], a[240:243], v[136:139]
 s_add_i32 s30, s31, 0xffffffee
 v_cndmask_b32 v45, v118, v117, vcc
 mf v[168:171], a[184:187], a[244:247], v[168:171]
 s_add_u32 s61, s82, s16
 v_cmp_ge_i32 vcc, s30, v116
 mf v[200:203], a[184:187], a[248:251], v[200:203]
 s_add_u32 s61, s61, 0x1000
 buffer_load_dwordx4 a[220:223], v4, s[48:51], s61 offen offset:1024
 mf v[232:235], a[184:187], a[252:255], v[232:235]
 s_waitcnt lgkmcnt(4)
 ds_read_b64_tr_b16 a[184:185], v14 offset:24576
 ds_read_b64_tr_b16 a[186:187], v14 offset:25600
 mf v[140:143], a[188:191], a[240:243], v[140:143]
 s_add_i32 s30, s31, 0xffffffed
 v_cndmask_b32 v46, v118, v117, vcc
 mf v[172:175], a[188:191], a[244:247], v[172:175]
 v_cmp_ge_i32 vcc, s30, v116
 mf v[204:207], a[188:191], a[248:251], v[204:207]
 mf v[236:239], a[188:191], a[252:255], v[236:239]
 s_waitcnt lgkmcnt(4)
 ds_read_b64_tr_b16 a[188:189], v15 offset:24576
 ds_read_b64_tr_b16 a[190:191], v15 offset:25600
 mf v[144:147], a[176:179], a[240:243], v[144:147]
 s_add_i32 s30, s31, 0xffffffe0
 v_cndmask_b32 v47, v118, v117, vcc
 mf v[176:179], a[176:179], a[244:247], v[176:179]
 v_cmp_ge_i32 vcc, s30, v116
 mf v[208:211], a[176:179], a[248:251], v[208:211]
 mf v[240:243], a[176:179], a[252:255], v[240:243]
 s_waitcnt lgkmcnt(4)
 s_add_i32 s30, s31, 0xffffffdf
 v_cndmask_b32 v52, v118, v117, vcc
 mf v[148:151], a[180:183], a[240:243], v[148:151]
 v_cmp_ge_i32 vcc, s30, v116
 mf v[180:183], a[180:183], a[244:247], v[180:183]
 s_waitcnt lgkmcnt(0)
 s_barrier
 mf v[212:215], a[180:183], a[248:251], v[212:215]
 s_add_u32 m0, s75, 0
 ds_read_b64_tr_b16 a[176:177], v8 offset:32768
 ds_read_b64_tr_b16 a[178:179], v8 offset:33792
 mf v[244:247], a[180:183], a[252:255], v[244:247]
 s_add_u32 s60, s74, 0
 ds_read_b64_tr_b16 a[180:181], v9 offset:32768
 ds_read_b64_tr_b16 a[182:183], v9 offset:33792
 mf v[152:155], a[184:187], a[240:243], v[152:155]
 buffer_load_dwordx4 v4, s[36:39], s60 offen lds
 mf v[184:187], a[184:187], a[244:247], v[184:187]
 s_add_i32 s30, s31, 0xffffffde
 v_cndmask_b32 v53, v118, v117, vcc
 mf v[216:219], a[184:187], a[248:251], v[216:219]
 v_cmp_ge_i32 vcc, s30, v116
 mf v[248:251], a[184:187], a[252:255], v[248:251]
 ds_read_b64_tr_b16 a[184:185], v10 offset:32768
 ds_read_b64_tr_b16 a[186:187], v10 offset:33792
 mf v[156:159], a[188:191], a[240:243], v[156:159]
 buffer_load_dwordx4 v4, s[36:39], s60 offen offset:1024 lds
 mf v[188:191], a[188:191], a[244:247], v[188:191]
 s_add_i32 s30, s31, 0xffffffdd
 v_cndmask_b32 v54, v118, v117, vcc
 mf v[220:223], a[188:191], a[248:251], v[220:223]
 v_cmp_ge_i32 vcc, s30, v116
 mf v[252:255], a[188:191], a[252:255], v[252:255]
 s_waitcnt vmcnt(9) lgkmcnt(4)
 ds_read_b64_tr_b16 a[188:189], v11 offset:32768
 ds_read_b64_tr_b16 a[190:191], v11 offset:33792
 mf v[128:131], a[176:179], a[192:195], v[128:131]
 s_waitcnt vmcnt(8)
 s_add_u32 s61, s81, 0x1800
 buffer_load_dwordx4 a[224:227], v4, s[48:51], s61 offen
 mf v[160:163], a[176:179], a[196:199], v[160:163]
 s_waitcnt vmcnt(8)
 buffer_load_dwordx4 v4, s[36:39], s60 offen offset:2048 lds
 mf v[192:195], a[176:179], a[200:203], v[192:195]
 s_waitcnt vmcnt(8)
 s_add_i32 s30, s31, 0xffffffd0
 v_cndmask_b32 v55, v118, v117, vcc
 mf v[224:227], a[176:179], a[204:207], v[224:227]
 s_waitcnt lgkmcnt(4)
 ds_read_b64_tr_b16 a[176:177], v12 offset:32768
 ds_read_b64_tr_b16 a[178:179], v12 offset:33792
 mf v[132:135], a[180:183], a[192:195], v[132:135]
 buffer_load_dwordx4 v4, s[36:39], s60 offen offset:3072 lds
 mf v[164:167], a[180:183], a[196:199], v[164:167]
 s_add_u32 s61, s81, s16
 v_cmp_ge_i32 vcc, s30, v116
 mf v[196:199], a[180:183], a[200:203], v[196:199]
 s_add_u32 s61, s61, 0x1800
 buffer_load_dwordx4 a[228:231], v4, s[48:51], s61 offen
 mf v[228:231], a[180:183], a[204:207], v[228:231]
 s_waitcnt lgkmcnt(4)
 s_add_u32 m0, s75, 0x4000
 ds_read_b64_tr_b16 a[180:181], v13 offset:32768
 ds_read_b64_tr_b16 a[182:183], v13 offset:33792
 mf v[136:139], a[184:187], a[192:195], v[136:139]
 s_add_u32 s60, s74, 0x8000
 v_cndmask_b32 v60, v118, v117, vcc
 mf v[168:171], a[184:187], a[196:199], v[168:171]
 s_add_i32 s30, s31, 0xffffffcf
 buffer_load_dwordx4 v4, s[36:39], s60 offen lds
 mf v[200:203], a[184:187], a[200:203], v[200:203]
 v_cmp_ge_i32 vcc, s30, v116
 mf v[232:235], a[184:187], a[204:207], v[232:235]
 s_waitcnt lgkmcnt(4)
 s_add_u32 s61, s82, 0x1800
 ds_read_b64_tr_b16 a[184:185], v14 offset:32768
 ds_read_b64_tr_b16 a[186:187], v14 offset:33792
 mf v[140:143], a[188:191], a[192:195], v[140:143]
 buffer_load_dwordx4 a[232:235], v4, s[48:51], s61 offen
 mf v[172:175], a[188:191], a[196:199], v[172:175]
 buffer_load_dwordx4 v4, s[36:39], s60 offen offset:1024 lds
 mf v[204:207], a[188:191], a[200:203], v[204:207]
 s_add_i32 s30, s31, 0xffffffce
 v_cndmask_b32 v61, v118, v117, vcc
 mf v[236:239], a[188:191], a[204:207], v[236:239]
 s_waitcnt lgkmcnt(4)
 ds_read_b64_tr_b16 a[188:189], v15 offset:32768
 ds_read_b64_tr_b16 a[190:191], v15 offset:33792
 mf v[144:147], a[176:179], a[192:195], v[144:147]
 buffer_load_dwordx4 v4, s[36:39], s60 offen offset:2048 lds
 mf v[176:179], a[176:179], a[196:199], v[176:179]
 s_add_u32 s61, s82, s16
 v_cmp_ge_i32 vcc, s30, v116
 mf v[208:211], a[176:179], a[200:203], v[208:211]
 s_add_u32 s61, s61, 0x1800
 buffer_load_dwordx4 a[236:239], v4, s[48:51], s61 offen
 mf v[240:243], a[176:179], a[204:207], v[240:243]
 s_waitcnt lgkmcnt(4)
 ds_read_b64_tr_b16 a[176:177], v8 offset:40960
 ds_read_b64_tr_b16 a[178:179], v8 offset:41984
 mf v[148:151], a[180:183], a[192:195], v[148:151]
 buffer_load_dwordx4 v4, s[36:39], s60 offen offset:3072 lds
 mf v[180:183], a[180:183], a[196:199], v[180:183]
 s_add_i32 s30, s31, 0xffffffcd
 v_cndmask_b32 v62, v118, v117, vcc
 mf v[212:215], a[180:183], a[200:203], v[212:215]
 v_cmp_ge_i32 vcc, s30, v116
 mf v[244:247], a[180:183], a[204:207], v[244:247]
 s_waitcnt lgkmcnt(4)
 s_add_u32 s61, s81, 0x1800
 ds_read_b64_tr_b16 a[180:181], v9 offset:40960
 ds_read_b64_tr_b16 a[182:183], v9 offset:41984
 mf v[152:155], a[184:187], a[192:195], v[152:155]
 buffer_load_dwordx4 a[240:243], v4, s[48:51], s61 offen offset:1024
 mf v[184:187], a[184:187], a[196:199], v[184:187]
 s_add_i32 s30, s31, 0xffffffc0
 v_cndmask_b32 v63, v118, v117, vcc
 mf v[216:219], a[184:187], a[200:203], v[216:219]
 v_cmp_ge_i32 vcc, s30, v116
 mf v[248:251], a[184:187], a[204:207], v[248:251]
 s_waitcnt lgkmcnt(4)
 ds_read_b64_tr_b16 a[184:185], v10 offset:40960
 ds_read_b64_tr_b16 a[186:187], v10 offset:41984
 mf v[156:159], a[188:191], a[192:195], v[156:159]
 s_add_i32 s30, s31, 0xffffffbf
 v_cndmask_b32 v64, v118, v117, vcc
 mf v[188:191], a[188:191], a[196:199], v[188:191]
 s_add_u32 s61, s81, s16
 v_cmp_ge_i32 vcc, s30, v116
 mf v[220:223], a[188:191], a[200:203], v[220:223]
 s_add_u32 s61, s61, 0x1800
 buffer_load_dwordx4 a[244:247], v4, s[48:51], s61 offen offset:1024
 mf v[252:255], a[188:191], a[204:207], v[252:255]
 s_waitcnt vmcnt(17) lgkmcnt(4)
 ds_read_b64_tr_b16 a[188:189], v11 offset:40960
 ds_read_b64_tr_b16 a[190:191], v11 offset:41984
 mf v[128:131], a[176:179], a[208:211], v[128:131]
 s_waitcnt vmcnt(16)
 s_add_i32 s30, s31, 0xffffffbe
 v_cndmask_b32 v65, v118, v117, vcc
 mf v[160:163], a[176:179], a[212:215], v[160:163]
 s_waitcnt vmcnt(15)
 v_cmp_ge_i32 vcc, s30, v116
 mf v[192:195], a[176:179], a[216:219], v[192:195]
 s_waitcnt vmcnt(14)
 mf v[224:227], a[176:179], a[220:223], v[224:227]
 s_waitcnt lgkmcnt(4)
 s_add_u32 s61, s82, 0x1800
 ds_read_b64_tr_b16 a[176:177], v12 offset:40960
 ds_read_b64_tr_b16 a[178:179], v12 offset:41984
 mf v[132:135], a[180:183], a[208:211], v[132:135]
 buffer_load_dwordx4 a[248:251], v4, s[48:51], s61 offen offset:1024
 mf v[164:167], a[180:183], a[212:215], v[164:167]
 s_add_i32 s30, s31, 0xffffffbd
 v_cndmask_b32 v66, v118, v117, vcc
 mf v[196:199], a[180:183], a[216:219], v[196:199]
 v_cmp_ge_i32 vcc, s30, v116
 mf v[228:231], a[180:183], a[220:223], v[228:231]
 s_waitcnt lgkmcnt(4)
 ds_read_b64_tr_b16 a[180:181], v13 offset:40960
 ds_read_b64_tr_b16 a[182:183], v13 offset:41984
 mf v[136:139], a[184:187], a[208:211], v[136:139]
 s_add_i32 s30, s31, 0xffffffb0
 v_cndmask_b32 v67, v118, v117, vcc
 mf v[168:171], a[184:187], a[212:215], v[168:171]
 s_add_u32 s61, s82, s16
 v_cmp_ge_i32 vcc, s30, v116
 mf v[200:203], a[184:187], a[216:219], v[200:203]
 s_add_u32 s61, s61, 0x1800
 buffer_load_dwordx4 a[252:255], v4, s[48:51], s61 offen offset:1024
 mf v[232:235], a[184:187], a[220:223], v[232:235]
 s_waitcnt lgkmcnt(4)
 ds_read_b64_tr_b16 a[184:185], v14 offset:40960
 ds_read_b64_tr_b16 a[186:187], v14 offset:41984
 mf v[140:143], a[188:191], a[208:211], v[140:143]
 s_add_i32 s30, s31, 0xffffffaf
 v_cndmask_b32 v68, v118, v117, vcc
 mf v[172:175], a[188:191], a[212:215], v[172:175]
 v_cmp_ge_i32 vcc, s30, v116
 mf v[204:207], a[188:191], a[216:219], v[204:207]
 mf v[236:239], a[188:191], a[220:223], v[236:239]
 s_waitcnt lgkmcnt(4)
 ds_read_b64_tr_b16 a[188:189], v15 offset:40960
 ds_read_b64_tr_b16 a[190:191], v15 offset:41984
 mf v[144:147], a[176:179], a[208:211], v[144:147]
 s_add_i32 s30, s31, 0xffffffae
 v_cndmask_b32 v69, v118, v117, vcc
 mf v[176:179], a[176:179], a[212:215], v[176:179]
 v_cmp_ge_i32 vcc, s30, v116
 mf v[208:211], a[176:179], a[216:219], v[208:211]
 mf v[240:243], a[176:179], a[220:223], v[240:243]
 s_waitcnt lgkmcnt(4)
 s_add_i32 s30, s31, 0xffffffad
 v_cndmask_b32 v70, v118, v117, vcc
 mf v[148:151], a[180:183], a[208:211], v[148:151]
 v_cmp_ge_i32 vcc, s30, v116
 mf v[180:183], a[180:183], a[212:215], v[180:183]
 s_waitcnt lgkmcnt(0)
 s_barrier
 mf v[212:215], a[180:183], a[216:219], v[212:215]
 ds_read_b64_tr_b16 a[176:177], v8 offset:49152
 ds_read_b64_tr_b16 a[178:179], v8 offset:50176
 mf v[244:247], a[180:183], a[220:223], v[244:247]
 ds_read_b64_tr_b16 a[180:181], v9 offset:49152
 ds_read_b64_tr_b16 a[182:183], v9 offset:50176
 mf v[152:155], a[184:187], a[208:211], v[152:155]
 s_add_i32 s30, s31, 0xffffffa0
 v_cndmask_b32 v71, v118, v117, vcc
 mf v[184:187], a[184:187], a[212:215], v[184:187]
 v_cmp_ge_i32 vcc, s30, v116
 mf v[216:219], a[184:187], a[216:219], v[216:219]
 mf v[248:251], a[184:187], a[220:223], v[248:251]
 ds_read_b64_tr_b16 a[184:185], v10 offset:49152
 ds_read_b64_tr_b16 a[186:187], v10 offset:50176
 mf v[156:159], a[188:191], a[208:211], v[156:159]
 s_add_i32 s30, s31, 0xffffff9f
 v_cndmask_b32 v72, v118, v117, vcc
 mf v[188:191], a[188:191], a[212:215], v[188:191]
 v_cmp_ge_i32 vcc, s30, v116
 mf v[220:223], a[188:191], a[216:219], v[220:223]
 mf v[252:255], a[188:191], a[220:223], v[252:255]
 s_waitcnt vmcnt(13) lgkmcnt(4)
 ds_read_b64_tr_b16 a[188:189], v11 offset:49152
 ds_read_b64_tr_b16 a[190:191], v11 offset:50176
 mf v[128:131], a[176:179], a[224:227], v[128:131]
 s_waitcnt vmcnt(10)
 s_add_u32 s61, s81, 0x2000
 buffer_load_dwordx4 a[192:195], v4, s[48:51], s61 offen
 mf v[160:163], a[176:179], a[228:231], v[160:163]
 s_waitcnt vmcnt(9)
 s_add_i32 s30, s31, 0xffffff9e
 v_cndmask_b32 v73, v118, v117, vcc
 mf v[192:195], a[176:179], a[232:235], v[192:195]
 s_waitcnt vmcnt(6)
 v_cmp_ge_i32 vcc, s30, v116
 mf v[224:227], a[176:179], a[236:239], v[224:227]
 s_waitcnt lgkmcnt(4)
 ds_read_b64_tr_b16 a[176:177], v12 offset:49152
 ds_read_b64_tr_b16 a[178:179], v12 offset:50176
 mf v[132:135], a[180:183], a[224:227], v[132:135]
 s_add_i32 s30, s31, 0xffffff9d
 v_cndmask_b32 v74, v118, v117, vcc
 mf v[164:167], a[180:183], a[228:231], v[164:167]
 s_add_u32 s61, s81, s16
 v_cmp_ge_i32 vcc, s30, v116
 mf v[196:199], a[180:183], a[232:235], v[196:199]
 s_add_u32 s61, s61, 0x2000
 buffer_load_dwordx4 a[196:199], v4, s[48:51], s61 offen
 mf v[228:231], a[180:183], a[236:239], v[228:231]
 s_waitcnt lgkmcnt(4)
 ds_read_b64_tr_b16 a[180:181], v13 offset:49152
 ds_read_b64_tr_b16 a[182:183], v13 offset:50176
 mf v[136:139], a[184:187], a[224:227], v[136:139]
 s_add_i32 s30, s31, 0xffffff90
 v_cndmask_b32 v75, v118, v117, vcc
 mf v[168:171], a[184:187], a[228:231], v[168:171]
 v_cmp_ge_i32 vcc, s30, v116
 mf v[200:203], a[184:187], a[232:235], v[200:203]
 mf v[232:235], a[184:187], a[236:239], v[232:235]
 s_waitcnt lgkmcnt(4)
 s_add_u32 s61, s82, 0x2000
 ds_read_b64_tr_b16 a[184:185], v14 offset:49152
 ds_read_b64_tr_b16 a[186:187], v14 offset:50176
 mf v[140:143], a[188:191], a[224:227], v[140:143]
 buffer_load_dwordx4 a[200:203], v4, s[48:51], s61 offen
 mf v[172:175], a[188:191], a[228:231], v[172:175]
 s_add_i32 s30, s31, 0xffffff8f
 v_cndmask_b32 v76, v118, v117, vcc
 mf v[204:207], a[188:191], a[232:235], v[204:207]
 v_cmp_ge_i32 vcc, s30, v116
 mf v[236:239], a[188:191], a[236:239], v[236:239]
 s_waitcnt lgkmcnt(4)
 ds_read_b64_tr_b16 a[188:189], v15 offset:49152
 ds_read_b64_tr_b16 a[190:191], v15 offset:50176
 mf v[144:147], a[176:179], a[224:227], v[144:147]
 s_add_i32 s30, s31, 0xffffff8e
 v_cndmask_b32 v77, v118, v117, vcc
 mf v[176:179], a[176:179], a[228:231], v[176:179]
 s_add_u32 s61, s82, s16
 v_cmp_ge_i32 vcc, s30, v116
 mf v[208:211], a[176:179], a[232:235], v[208:211]
 s_add_u32 s61, s61, 0x2000
 buffer_load_dwordx4 a[204:207], v4, s[48:51], s61 offen
 mf v[240:243], a[176:179], a[236:239], v[240:243]
 s_waitcnt lgkmcnt(4)
 ds_read_b64_tr_b16 a[176:177], v8 offset:57344
 ds_read_b64_tr_b16 a[178:179], v8 offset:58368
 mf v[148:151], a[180:183], a[224:227], v[148:151]
 s_add_i32 s30, s31, 0xffffff8d
 v_cndmask_b32 v78, v118, v117, vcc
 mf v[180:183], a[180:183], a[228:231], v[180:183]
 v_cmp_ge_i32 vcc, s30, v116
 mf v[212:215], a[180:183], a[232:235], v[212:215]
 mf v[244:247], a[180:183], a[236:239], v[244:247]
 s_waitcnt lgkmcnt(4)
 s_add_u32 s61, s81, 0x2000
 ds_read_b64_tr_b16 a[180:181], v9 offset:57344
 ds_read_b64_tr_b16 a[182:183], v9 offset:58368
 mf v[152:155], a[184:187], a[224:227], v[152:155]
 buffer_load_dwordx4 a[208:211], v4, s[48:51], s61 offen offset:1024
 mf v[184:187], a[184:187], a[228:231], v[184:187]
 s_lshl_b32 s30, s2, 2
 v_cndmask_b32 v79, v118, v117, vcc
 mf v[216:219], a[184:187], a[232:235], v[216:219]
 s_add_u32 s30, s30, s3
 mf v[248:251], a[184:187], a[236:239], v[248:251]
 s_waitcnt lgkmcnt(4)
 s_lshl_b32 s30, s30, 10
 ds_read_b64_tr_b16 a[184:185], v10 offset:57344
 ds_read_b64_tr_b16 a[186:187], v10 offset:58368
 mf v[156:159], a[188:191], a[224:227], v[156:159]
 v_lshlrev_b32 v7, 7, v1
 v_add_u32 v7, s30, v7
 mf v[188:191], a[188:191], a[228:231], v[188:191]
 s_add_u32 s61, s81, s16
 v_cmp_gt_u32 vcc, 8, v1
 v_mov_b32 v119, 0x7ff00000
 mf v[220:223], a[188:191], a[232:235], v[220:223]
 s_add_u32 s61, s61, 0x2000
 buffer_load_dwordx4 a[212:215], v4, s[48:51], s61 offen offset:1024
 mf v[252:255], a[188:191], a[236:239], v[252:255]
 s_waitcnt vmcnt(9) lgkmcnt(4)
 ds_read_b64_tr_b16 a[188:189], v11 offset:57344
 ds_read_b64_tr_b16 a[190:191], v11 offset:58368
 mf v[128:131], a[176:179], a[240:243], v[128:131]
 s_waitcnt vmcnt(8)
 s_mov_b32 s59, 0x20000
 v_cndmask_b32 v7, v119, v7, vcc
 mf v[160:163], a[176:179], a[244:247], v[160:163]
 s_waitcnt vmcnt(7)
 s_mov_b32 s79, 0
 mf v[192:195], a[176:179], a[248:251], v[192:195]
 s_waitcnt vmcnt(6)
 s_mov_b32 s32, s22
 mf v[224:227], a[176:179], a[252:255], v[224:227]
 s_waitcnt lgkmcnt(4)
 s_add_u32 s61, s82, 0x2000
 ds_read_b64_tr_b16 a[176:177], v12 offset:57344
 ds_read_b64_tr_b16 a[178:179], v12 offset:58368
 mf v[132:135], a[180:183], a[240:243], v[132:135]
 s_mov_b32 s33, s23
 buffer_load_dwordx4 a[216:219], v4, s[48:51], s61 offen offset:1024
 mf v[164:167], a[180:183], a[244:247], v[164:167]
 s_mov_b32 s34, 0x510000
 mf v[196:199], a[180:183], a[248:251], v[196:199]
 s_mov_b32 s35, 0x20000
 mf v[228:231], a[180:183], a[252:255], v[228:231]
 s_waitcnt lgkmcnt(4)
 s_mul_i32 s83, s3, 0x1400
 ds_read_b64_tr_b16 a[180:181], v13 offset:57344
 ds_read_b64_tr_b16 a[182:183], v13 offset:58368
 mf v[136:139], a[184:187], a[240:243], v[136:139]
 s_mul_i32 s94, s3, 0x140
 mf v[168:171], a[184:187], a[244:247], v[168:171]
 s_add_u32 s61, s82, s16
 mf v[200:203], a[184:187], a[248:251], v[200:203]
 s_add_u32 s61, s61, 0x2000
 buffer_load_dwordx4 a[220:223], v4, s[48:51], s61 offen offset:1024
 mf v[232:235], a[184:187], a[252:255], v[232:235]
 s_waitcnt lgkmcnt(4)
 s_and_b32 s90, s65, 1
 ds_read_b64_tr_b16 a[184:185], v14 offset:57344
 ds_read_b64_tr_b16 a[186:187], v14 offset:58368
 mf v[140:143], a[188:191], a[240:243], v[140:143]
 s_mul_i32 s93, s65, 0x120
 mf v[172:175], a[188:191], a[244:247], v[172:175]
 s_lshl_b32 s30, s90, 5
 mf v[204:207], a[188:191], a[248:251], v[204:207]
 s_sub_u32 s93, s93, s30
 mf v[236:239], a[188:191], a[252:255], v[236:239]
 s_waitcnt lgkmcnt(4)
 s_mul_i32 s91, s64, 0xa2000
 ds_read_b64_tr_b16 a[188:189], v15 offset:57344
 ds_read_b64_tr_b16 a[190:191], v15 offset:58368
 mf v[144:147], a[176:179], a[240:243], v[144:147]
 s_mul_i32 s92, s64, 0x90000
 mf v[176:179], a[176:179], a[244:247], v[176:179]
 v_add_u32 v28, s94, v1
 v_mul_u32_u24 v29, 0xccd, v28
 mf v[208:211], a[176:179], a[248:251], v[208:211]
 v_lshrrev_b32 v29, 16, v29
 v_mul_u32_u24 v30, 20, v29
 mf v[240:243], a[176:179], a[252:255], v[240:243]
 s_waitcnt lgkmcnt(4)
 v_sub_u32 v30, v28, v30
 v_bfe_u32 v31, v29, 2, 1
 mf v[148:151], a[180:183], a[240:243], v[148:151]
 s_movk_i32 s30, 0x480
 v_lshlrev_b32 v31, 1, v31
 v_xor_b32 v30, v30, v31
 mf v[180:183], a[180:183], a[244:247], v[180:183]
 s_waitcnt lgkmcnt(0)
 s_barrier
 v_add_u32 v8, 0x10000, v8
 v_add_u32 v9, 0x10000, v9
 v_add_u32 v10, 0x10000, v10
 v_add_u32 v11, 0x10000, v11
 v_add_u32 v12, 0x10000, v12
 v_add_u32 v13, 0x10000, v13
 v_add_u32 v14, 0x10000, v14
 v_add_u32 v15, 0x10000, v15
 mf v[212:215], a[180:183], a[248:251], v[212:215]
 s_add_u32 m0, s75, 0x8000
 ds_read_b64_tr_b16 a[176:177], v8
 ds_read_b64_tr_b16 a[178:179], v8 offset:1024
 mf v[244:247], a[180:183], a[252:255], v[244:247]
 s_add_u32 s60, s74, 0x10000
 ds_read_b64_tr_b16 a[180:181], v9
 ds_read_b64_tr_b16 a[182:183], v9 offset:1024
 mf v[152:155], a[184:187], a[240:243], v[152:155]
 buffer_load_dwordx4 v4, s[36:39], s60 offen lds
 mf v[184:187], a[184:187], a[244:247], v[184:187]
 v_mul_lo_u32 v29, v29, s30
 v_lshl_add_u32 v29, v30, 4, v29
 mf v[216:219], a[184:187], a[248:251], v[216:219]
 v_add_u32 v22, s93, v29
 v_add_u32 v28, s94, v1
 mf v[248:251], a[184:187], a[252:255], v[248:251]
 ds_read_b64_tr_b16 a[184:185], v10
 ds_read_b64_tr_b16 a[186:187], v10 offset:1024
 mf v[156:159], a[188:191], a[240:243], v[156:159]
 buffer_load_dwordx4 v4, s[36:39], s60 offen offset:1024 lds
 mf v[188:191], a[188:191], a[244:247], v[188:191]
 v_add_u32 v28, 64, v28
 v_mul_u32_u24 v29, 0xccd, v28
 mf v[220:223], a[188:191], a[248:251], v[220:223]
 v_lshrrev_b32 v29, 16, v29
 v_mul_u32_u24 v30, 20, v29
 mf v[252:255], a[188:191], a[252:255], v[252:255]
 s_waitcnt vmcnt(9) lgkmcnt(4)
 ds_read_b64_tr_b16 a[188:189], v11
 ds_read_b64_tr_b16 a[190:191], v11 offset:1024
 mf v[128:131], a[176:179], a[192:195], v[128:131]
 s_waitcnt vmcnt(8)
 s_add_u32 s61, s81, 0x2800
 buffer_load_dwordx4 a[224:227], v4, s[48:51], s61 offen
 mf v[160:163], a[176:179], a[196:199], v[160:163]
 s_waitcnt vmcnt(8)
 buffer_load_dwordx4 v4, s[36:39], s60 offen offset:2048 lds
 mf v[192:195], a[176:179], a[200:203], v[192:195]
 s_waitcnt vmcnt(8)
 v_sub_u32 v30, v28, v30
 v_bfe_u32 v31, v29, 2, 1
 mf v[224:227], a[176:179], a[204:207], v[224:227]
 s_waitcnt lgkmcnt(4)
 ds_read_b64_tr_b16 a[176:177], v12
 ds_read_b64_tr_b16 a[178:179], v12 offset:1024
 mf v[132:135], a[180:183], a[192:195], v[132:135]
 buffer_load_dwordx4 v4, s[36:39], s60 offen offset:3072 lds
 mf v[164:167], a[180:183], a[196:199], v[164:167]
 s_add_u32 s61, s81, s16
 v_lshlrev_b32 v31, 1, v31
 v_xor_b32 v30, v30, v31
 mf v[196:199], a[180:183], a[200:203], v[196:199]
 s_add_u32 s61, s61, 0x2800
 buffer_load_dwordx4 a[228:231], v4, s[48:51], s61 offen
 mf v[228:231], a[180:183], a[204:207], v[228:231]
 s_waitcnt lgkmcnt(4)
 s_add_u32 m0, s75, 0xc000
 ds_read_b64_tr_b16 a[180:181], v13
 ds_read_b64_tr_b16 a[182:183], v13 offset:1024
 mf v[136:139], a[184:187], a[192:195], v[136:139]
 s_add_u32 s60, s74, 0x18000
 mf v[168:171], a[184:187], a[196:199], v[168:171]
 s_movk_i32 s30, 0x480
 buffer_load_dwordx4 v4, s[36:39], s60 offen lds
 mf v[200:203], a[184:187], a[200:203], v[200:203]
 v_mul_lo_u32 v29, v29, s30
 v_lshl_add_u32 v29, v30, 4, v29
 mf v[232:235], a[184:187], a[204:207], v[232:235]
 s_waitcnt lgkmcnt(4)
 s_add_u32 s61, s82, 0x2800
 ds_read_b64_tr_b16 a[184:185], v14
 ds_read_b64_tr_b16 a[186:187], v14 offset:1024
 mf v[140:143], a[188:191], a[192:195], v[140:143]
 buffer_load_dwordx4 a[232:235], v4, s[48:51], s61 offen
 mf v[172:175], a[188:191], a[196:199], v[172:175]
 buffer_load_dwordx4 v4, s[36:39], s60 offen offset:1024 lds
 mf v[204:207], a[188:191], a[200:203], v[204:207]
 v_add_u32 v23, s93, v29
 v_add_u32 v28, s94, v1
 mf v[236:239], a[188:191], a[204:207], v[236:239]
 s_waitcnt lgkmcnt(4)
 ds_read_b64_tr_b16 a[188:189], v15
 ds_read_b64_tr_b16 a[190:191], v15 offset:1024
 mf v[144:147], a[176:179], a[192:195], v[144:147]
 buffer_load_dwordx4 v4, s[36:39], s60 offen offset:2048 lds
 mf v[176:179], a[176:179], a[196:199], v[176:179]
 s_add_u32 s61, s82, s16
 v_add_u32 v28, 0x80, v28
 v_mul_u32_u24 v29, 0xccd, v28
 mf v[208:211], a[176:179], a[200:203], v[208:211]
 s_add_u32 s61, s61, 0x2800
 buffer_load_dwordx4 a[236:239], v4, s[48:51], s61 offen
 mf v[240:243], a[176:179], a[204:207], v[240:243]
 s_waitcnt lgkmcnt(4)
 ds_read_b64_tr_b16 a[176:177], v8 offset:8192
 ds_read_b64_tr_b16 a[178:179], v8 offset:9216
 mf v[148:151], a[180:183], a[192:195], v[148:151]
 buffer_load_dwordx4 v4, s[36:39], s60 offen offset:3072 lds
 mf v[180:183], a[180:183], a[196:199], v[180:183]
 v_lshrrev_b32 v29, 16, v29
 v_mul_u32_u24 v30, 20, v29
 mf v[212:215], a[180:183], a[200:203], v[212:215]
 v_sub_u32 v30, v28, v30
 v_bfe_u32 v31, v29, 2, 1
 mf v[244:247], a[180:183], a[204:207], v[244:247]
 s_waitcnt lgkmcnt(4)
 s_add_u32 s61, s81, 0x2800
 ds_read_b64_tr_b16 a[180:181], v9 offset:8192
 ds_read_b64_tr_b16 a[182:183], v9 offset:9216
 mf v[152:155], a[184:187], a[192:195], v[152:155]
 buffer_load_dwordx4 a[240:243], v4, s[48:51], s61 offen offset:1024
 mf v[184:187], a[184:187], a[196:199], v[184:187]
 s_movk_i32 s30, 0x480
 v_lshlrev_b32 v31, 1, v31
 v_xor_b32 v30, v30, v31
 mf v[216:219], a[184:187], a[200:203], v[216:219]
 v_mul_lo_u32 v29, v29, s30
 v_lshl_add_u32 v29, v30, 4, v29
 mf v[248:251], a[184:187], a[204:207], v[248:251]
 s_waitcnt lgkmcnt(4)
 ds_read_b64_tr_b16 a[184:185], v10 offset:8192
 ds_read_b64_tr_b16 a[186:187], v10 offset:9216
 mf v[156:159], a[188:191], a[192:195], v[156:159]
 v_add_u32 v24, s93, v29
 v_add_u32 v28, s94, v1
 mf v[188:191], a[188:191], a[196:199], v[188:191]
 s_add_u32 s61, s81, s16
 v_add_u32 v28, 0xc0, v28
 v_mul_u32_u24 v29, 0xccd, v28
 mf v[220:223], a[188:191], a[200:203], v[220:223]
 s_add_u32 s61, s61, 0x2800
 buffer_load_dwordx4 a[244:247], v4, s[48:51], s61 offen offset:1024
 mf v[252:255], a[188:191], a[204:207], v[252:255]
 s_waitcnt vmcnt(17) lgkmcnt(4)
 ds_read_b64_tr_b16 a[188:189], v11 offset:8192
 ds_read_b64_tr_b16 a[190:191], v11 offset:9216
 mf v[128:131], a[176:179], a[208:211], v[128:131]
 s_waitcnt vmcnt(16)
 v_lshrrev_b32 v29, 16, v29
 v_mul_u32_u24 v30, 20, v29
 mf v[160:163], a[176:179], a[212:215], v[160:163]
 s_waitcnt vmcnt(15)
 v_sub_u32 v30, v28, v30
 v_bfe_u32 v31, v29, 2, 1
 mf v[192:195], a[176:179], a[216:219], v[192:195]
 s_waitcnt vmcnt(14)
 s_movk_i32 s30, 0x480
 v_lshlrev_b32 v31, 1, v31
 v_xor_b32 v30, v30, v31
 mf v[224:227], a[176:179], a[220:223], v[224:227]
 s_waitcnt lgkmcnt(4)
 s_add_u32 s61, s82, 0x2800
 ds_read_b64_tr_b16 a[176:177], v12 offset:8192
 ds_read_b64_tr_b16 a[178:179], v12 offset:9216
 mf v[132:135], a[180:183], a[208:211], v[132:135]
 buffer_load_dwordx4 a[248:251], v4, s[48:51], s61 offen offset:1024
 mf v[164:167], a[180:183], a[212:215], v[164:167]
 v_mul_lo_u32 v29, v29, s30
 v_lshl_add_u32 v29, v30, 4, v29
 mf v[196:199], a[180:183], a[216:219], v[196:199]
 v_add_u32 v25, s93, v29
 v_add_u32 v28, s94, v1
 mf v[228:231], a[180:183], a[220:223], v[228:231]
 s_waitcnt lgkmcnt(4)
 ds_read_b64_tr_b16 a[180:181], v13 offset:8192
 ds_read_b64_tr_b16 a[182:183], v13 offset:9216
 mf v[136:139], a[184:187], a[208:211], v[136:139]
 v_add_u32 v28, 0x100, v28
 v_mul_u32_u24 v29, 0xccd, v28
 mf v[168:171], a[184:187], a[212:215], v[168:171]
 s_add_u32 s61, s82, s16
 v_lshrrev_b32 v29, 16, v29
 v_mul_u32_u24 v30, 20, v29
 mf v[200:203], a[184:187], a[216:219], v[200:203]
 s_add_u32 s61, s61, 0x2800
 buffer_load_dwordx4 a[252:255], v4, s[48:51], s61 offen offset:1024
 mf v[232:235], a[184:187], a[220:223], v[232:235]
 s_waitcnt lgkmcnt(4)
 ds_read_b64_tr_b16 a[184:185], v14 offset:8192
 ds_read_b64_tr_b16 a[186:187], v14 offset:9216
 mf v[140:143], a[188:191], a[208:211], v[140:143]
 v_sub_u32 v30, v28, v30
 v_bfe_u32 v31, v29, 2, 1
 mf v[172:175], a[188:191], a[212:215], v[172:175]
 s_movk_i32 s30, 0x480
 v_lshlrev_b32 v31, 1, v31
 v_xor_b32 v30, v30, v31
 mf v[204:207], a[188:191], a[216:219], v[204:207]
 v_mul_lo_u32 v29, v29, s30
 v_lshl_add_u32 v29, v30, 4, v29
 mf v[236:239], a[188:191], a[220:223], v[236:239]
 s_waitcnt lgkmcnt(4)
 ds_read_b64_tr_b16 a[188:189], v15 offset:8192
 ds_read_b64_tr_b16 a[190:191], v15 offset:9216
 mf v[144:147], a[176:179], a[208:211], v[144:147]
 s_mul_i32 s86, s68, 0x44000
 v_add_u32 v26, s93, v29
 mf v[176:179], a[176:179], a[212:215], v[176:179]
 s_mul_i32 s31, s64, 0x4800
 mf v[208:211], a[176:179], a[216:219], v[208:211]
 s_add_u32 s84, s86, s31
 mf v[240:243], a[176:179], a[220:223], v[240:243]
 s_waitcnt lgkmcnt(4)
 s_add_u32 s84, s84, 0x20000
 mf v[148:151], a[180:183], a[208:211], v[148:151]
 s_lshl_b32 s31, s64, 14
 mf v[180:183], a[180:183], a[212:215], v[180:183]
 s_waitcnt lgkmcnt(0)
 s_barrier
 mf v[212:215], a[180:183], a[216:219], v[212:215]
 s_add_u32 s86, s86, s31
 ds_read_b64_tr_b16 a[176:177], v8 offset:16384
 ds_read_b64_tr_b16 a[178:179], v8 offset:17408
 mf v[244:247], a[180:183], a[220:223], v[244:247]
 s_sub_u32 s30, s68, s3
 ds_read_b64_tr_b16 a[180:181], v9 offset:16384
 ds_read_b64_tr_b16 a[182:183], v9 offset:17408
 mf v[152:155], a[184:187], a[208:211], v[152:155]
 s_lshr_b32 s30, s30, 1
 mf v[184:187], a[184:187], a[212:215], v[184:187]
 s_add_u32 s30, s30, s3
 mf v[216:219], a[184:187], a[216:219], v[216:219]
 s_lshl_b32 s31, s64, 6
 mf v[248:251], a[184:187], a[220:223], v[248:251]
 s_add_u32 s30, s30, s31
 ds_read_b64_tr_b16 a[184:185], v10 offset:16384
 ds_read_b64_tr_b16 a[186:187], v10 offset:17408
 mf v[156:159], a[188:191], a[208:211], v[156:159]
 s_mul_i32 s30, s30, 36
 mf v[188:191], a[188:191], a[212:215], v[188:191]
 s_mul_i32 s31, s65, 9
 mf v[220:223], a[188:191], a[216:219], v[220:223]
 s_add_u32 s30, s30, s31
 mf v[252:255], a[188:191], a[220:223], v[252:255]
 s_waitcnt vmcnt(13) lgkmcnt(4)
 s_lshl_b32 s88, s30, 10
 ds_read_b64_tr_b16 a[188:189], v11 offset:16384
 ds_read_b64_tr_b16 a[190:191], v11 offset:17408
 mf v[128:131], a[176:179], a[224:227], v[128:131]
 s_waitcnt vmcnt(10)
 s_add_u32 s61, s81, 0x3000
 buffer_load_dwordx4 a[192:195], v4, s[48:51], s61 offen
 mf v[160:163], a[176:179], a[228:231], v[160:163]
 s_waitcnt vmcnt(9)
 s_mul_i32 s87, s69, 0x44000
 mf v[192:195], a[176:179], a[232:235], v[192:195]
 s_waitcnt vmcnt(6)
 s_mul_i32 s31, s64, 0x4800
 mf v[224:227], a[176:179], a[236:239], v[224:227]
 s_waitcnt lgkmcnt(4)
 s_add_u32 s85, s87, s31
 ds_read_b64_tr_b16 a[176:177], v12 offset:16384
 ds_read_b64_tr_b16 a[178:179], v12 offset:17408
 mf v[132:135], a[180:183], a[224:227], v[132:135]
 s_add_u32 s85, s85, 0x20000
 mf v[164:167], a[180:183], a[228:231], v[164:167]
 s_add_u32 s61, s81, s16
 mf v[196:199], a[180:183], a[232:235], v[196:199]
 s_add_u32 s61, s61, 0x3000
 buffer_load_dwordx4 a[196:199], v4, s[48:51], s61 offen
 mf v[228:231], a[180:183], a[236:239], v[228:231]
 s_waitcnt lgkmcnt(4)
 s_lshl_b32 s31, s64, 14
 ds_read_b64_tr_b16 a[180:181], v13 offset:16384
 ds_read_b64_tr_b16 a[182:183], v13 offset:17408
 mf v[136:139], a[184:187], a[224:227], v[136:139]
 s_add_u32 s87, s87, s31
 mf v[168:171], a[184:187], a[228:231], v[168:171]
 s_sub_u32 s30, s69, s3
 mf v[200:203], a[184:187], a[232:235], v[200:203]
 s_lshr_b32 s30, s30, 1
 mf v[232:235], a[184:187], a[236:239], v[232:235]
 s_waitcnt lgkmcnt(4)
 s_add_u32 s61, s82, 0x3000
 ds_read_b64_tr_b16 a[184:185], v14 offset:16384
 ds_read_b64_tr_b16 a[186:187], v14 offset:17408
 mf v[140:143], a[188:191], a[224:227], v[140:143]
 s_add_u32 s30, s30, s3
 buffer_load_dwordx4 a[200:203], v4, s[48:51], s61 offen
 mf v[172:175], a[188:191], a[228:231], v[172:175]
 s_lshl_b32 s31, s64, 6
 mf v[204:207], a[188:191], a[232:235], v[204:207]
 s_add_u32 s30, s30, s31
 mf v[236:239], a[188:191], a[236:239], v[236:239]
 s_waitcnt lgkmcnt(4)
 s_mul_i32 s30, s30, 36
 ds_read_b64_tr_b16 a[188:189], v15 offset:16384
 ds_read_b64_tr_b16 a[190:191], v15 offset:17408
 mf v[144:147], a[176:179], a[224:227], v[144:147]
 s_mul_i32 s31, s65, 9
 mf v[176:179], a[176:179], a[228:231], v[176:179]
 s_add_u32 s61, s82, s16
 mf v[208:211], a[176:179], a[232:235], v[208:211]
 s_add_u32 s61, s61, 0x3000
 buffer_load_dwordx4 a[204:207], v4, s[48:51], s61 offen
 mf v[240:243], a[176:179], a[236:239], v[240:243]
 s_waitcnt lgkmcnt(4)
 s_add_u32 s30, s30, s31
 ds_read_b64_tr_b16 a[176:177], v8 offset:24576
 ds_read_b64_tr_b16 a[178:179], v8 offset:25600
 mf v[148:151], a[180:183], a[224:227], v[148:151]
 s_lshl_b32 s89, s30, 10
 mf v[180:183], a[180:183], a[228:231], v[180:183]
 v_accvgpr_write_b32 a0, 0
 v_accvgpr_write_b32 a1, 0
 mf v[212:215], a[180:183], a[232:235], v[212:215]
 v_accvgpr_write_b32 a2, 0
 v_accvgpr_write_b32 a3, 0
 mf v[244:247], a[180:183], a[236:239], v[244:247]
 s_waitcnt lgkmcnt(4)
 s_add_u32 s61, s81, 0x3000
 ds_read_b64_tr_b16 a[180:181], v9 offset:24576
 ds_read_b64_tr_b16 a[182:183], v9 offset:25600
 mf v[152:155], a[184:187], a[224:227], v[152:155]
 buffer_load_dwordx4 a[208:211], v4, s[48:51], s61 offen offset:1024
 mf v[184:187], a[184:187], a[228:231], v[184:187]
 v_accvgpr_write_b32 a4, 0
 v_accvgpr_write_b32 a5, 0
 mf v[216:219], a[184:187], a[232:235], v[216:219]
 v_accvgpr_write_b32 a6, 0
 v_accvgpr_write_b32 a7, 0
 mf v[248:251], a[184:187], a[236:239], v[248:251]
 s_waitcnt lgkmcnt(4)
 ds_read_b64_tr_b16 a[184:185], v10 offset:24576
 ds_read_b64_tr_b16 a[186:187], v10 offset:25600
 mf v[156:159], a[188:191], a[224:227], v[156:159]
 v_accvgpr_write_b32 a8, 0
 v_accvgpr_write_b32 a9, 0
 mf v[188:191], a[188:191], a[228:231], v[188:191]
 s_add_u32 s61, s81, s16
 v_accvgpr_write_b32 a10, 0
 v_accvgpr_write_b32 a11, 0
 mf v[220:223], a[188:191], a[232:235], v[220:223]
 s_add_u32 s61, s61, 0x3000
 buffer_load_dwordx4 a[212:215], v4, s[48:51], s61 offen offset:1024
 mf v[252:255], a[188:191], a[236:239], v[252:255]
 s_waitcnt vmcnt(9) lgkmcnt(4)
 ds_read_b64_tr_b16 a[188:189], v11 offset:24576
 ds_read_b64_tr_b16 a[190:191], v11 offset:25600
 mf v[128:131], a[176:179], a[240:243], v[128:131]
 s_waitcnt vmcnt(8)
 v_accvgpr_write_b32 a12, 0
 v_accvgpr_write_b32 a13, 0
 mf v[160:163], a[176:179], a[244:247], v[160:163]
 s_waitcnt vmcnt(7)
 v_accvgpr_write_b32 a14, 0
 v_accvgpr_write_b32 a15, 0
 mf v[192:195], a[176:179], a[248:251], v[192:195]
 s_waitcnt vmcnt(6)
 v_accvgpr_write_b32 a16, 0
 v_accvgpr_write_b32 a17, 0
 mf v[224:227], a[176:179], a[252:255], v[224:227]
 s_waitcnt lgkmcnt(4)
 s_add_u32 s61, s82, 0x3000
 ds_read_b64_tr_b16 a[176:177], v12 offset:24576
 ds_read_b64_tr_b16 a[178:179], v12 offset:25600
 mf v[132:135], a[180:183], a[240:243], v[132:135]
 buffer_load_dwordx4 a[216:219], v4, s[48:51], s61 offen offset:1024
 mf v[164:167], a[180:183], a[244:247], v[164:167]
 v_accvgpr_write_b32 a18, 0
 v_accvgpr_write_b32 a19, 0
 mf v[196:199], a[180:183], a[248:251], v[196:199]
 v_accvgpr_write_b32 a20, 0
 v_accvgpr_write_b32 a21, 0
 mf v[228:231], a[180:183], a[252:255], v[228:231]
 s_waitcnt lgkmcnt(4)
 ds_read_b64_tr_b16 a[180:181], v13 offset:24576
 ds_read_b64_tr_b16 a[182:183], v13 offset:25600
 mf v[136:139], a[184:187], a[240:243], v[136:139]
 v_accvgpr_write_b32 a22, 0
 v_accvgpr_write_b32 a23, 0
 mf v[168:171], a[184:187], a[244:247], v[168:171]
 s_add_u32 s61, s82, s16
 v_accvgpr_write_b32 a24, 0
 v_accvgpr_write_b32 a25, 0
 mf v[200:203], a[184:187], a[248:251], v[200:203]
 s_add_u32 s61, s61, 0x3000
 buffer_load_dwordx4 a[220:223], v4, s[48:51], s61 offen offset:1024
 mf v[232:235], a[184:187], a[252:255], v[232:235]
 s_waitcnt lgkmcnt(4)
 ds_read_b64_tr_b16 a[184:185], v14 offset:24576
 ds_read_b64_tr_b16 a[186:187], v14 offset:25600
 mf v[140:143], a[188:191], a[240:243], v[140:143]
 v_accvgpr_write_b32 a26, 0
 v_accvgpr_write_b32 a27, 0
 mf v[172:175], a[188:191], a[244:247], v[172:175]
 v_accvgpr_write_b32 a28, 0
 v_accvgpr_write_b32 a29, 0
 mf v[204:207], a[188:191], a[248:251], v[204:207]
 v_accvgpr_write_b32 a30, 0
 v_accvgpr_write_b32 a31, 0
 mf v[236:239], a[188:191], a[252:255], v[236:239]
 s_waitcnt lgkmcnt(4)
 ds_read_b64_tr_b16 a[188:189], v15 offset:24576
 ds_read_b64_tr_b16 a[190:191], v15 offset:25600
 mf v[144:147], a[176:179], a[240:243], v[144:147]
 v_accvgpr_write_b32 a32, 0
 v_accvgpr_write_b32 a33, 0
 mf v[176:179], a[176:179], a[244:247], v[176:179]
 v_accvgpr_write_b32 a34, 0
 v_accvgpr_write_b32 a35, 0
 mf v[208:211], a[176:179], a[248:251], v[208:211]
 v_accvgpr_write_b32 a36, 0
 v_accvgpr_write_b32 a37, 0
 mf v[240:243], a[176:179], a[252:255], v[240:243]
 s_waitcnt lgkmcnt(4)
 v_accvgpr_write_b32 a38, 0
 v_accvgpr_write_b32 a39, 0
 mf v[148:151], a[180:183], a[240:243], v[148:151]
 v_accvgpr_write_b32 a40, 0
 v_accvgpr_write_b32 a41, 0
 mf v[180:183], a[180:183], a[244:247], v[180:183]
 s_waitcnt lgkmcnt(0)
 s_barrier
 mf v[212:215], a[180:183], a[248:251], v[212:215]
 s_add_u32 m0, s75, 0x10000
 ds_read_b64_tr_b16 a[176:177], v8 offset:32768
 ds_read_b64_tr_b16 a[178:179], v8 offset:33792
 mf v[244:247], a[180:183], a[252:255], v[244:247]
 s_add_u32 s60, s74, 0x4000
 ds_read_b64_tr_b16 a[180:181], v9 offset:32768
 ds_read_b64_tr_b16 a[182:183], v9 offset:33792
 mf v[152:155], a[184:187], a[240:243], v[152:155]
 buffer_load_dwordx4 v4, s[36:39], s60 offen lds
 mf v[184:187], a[184:187], a[244:247], v[184:187]
 v_accvgpr_write_b32 a42, 0
 v_accvgpr_write_b32 a43, 0
 mf v[216:219], a[184:187], a[248:251], v[216:219]
 v_accvgpr_write_b32 a44, 0
 v_accvgpr_write_b32 a45, 0
 mf v[248:251], a[184:187], a[252:255], v[248:251]
 ds_read_b64_tr_b16 a[184:185], v10 offset:32768
 ds_read_b64_tr_b16 a[186:187], v10 offset:33792
 mf v[156:159], a[188:191], a[240:243], v[156:159]
 buffer_load_dwordx4 v4, s[36:39], s60 offen offset:1024 lds
 mf v[188:191], a[188:191], a[244:247], v[188:191]
 v_accvgpr_write_b32 a46, 0
 v_accvgpr_write_b32 a47, 0
 mf v[220:223], a[188:191], a[248:251], v[220:223]
 v_accvgpr_write_b32 a48, 0
 v_accvgpr_write_b32 a49, 0
 mf v[252:255], a[188:191], a[252:255], v[252:255]
 s_waitcnt vmcnt(9) lgkmcnt(4)
 ds_read_b64_tr_b16 a[188:189], v11 offset:32768
 ds_read_b64_tr_b16 a[190:191], v11 offset:33792
 mf v[128:131], a[176:179], a[192:195], v[128:131]
 s_waitcnt vmcnt(8)
 s_add_u32 s61, s81, 0x3800
 buffer_load_dwordx4 a[224:227], v4, s[48:51], s61 offen
 mf v[160:163], a[176:179], a[196:199], v[160:163]
 s_waitcnt vmcnt(8)
 buffer_load_dwordx4 v4, s[36:39], s60 offen offset:2048 lds
 mf v[192:195], a[176:179], a[200:203], v[192:195]
 s_waitcnt vmcnt(8)
 v_accvgpr_write_b32 a50, 0
 v_accvgpr_write_b32 a51, 0
 mf v[224:227], a[176:179], a[204:207], v[224:227]
 s_waitcnt lgkmcnt(4)
 ds_read_b64_tr_b16 a[176:177], v12 offset:32768
 ds_read_b64_tr_b16 a[178:179], v12 offset:33792
 mf v[132:135], a[180:183], a[192:195], v[132:135]
 buffer_load_dwordx4 v4, s[36:39], s60 offen offset:3072 lds
 mf v[164:167], a[180:183], a[196:199], v[164:167]
 s_add_u32 s61, s81, s16
 v_accvgpr_write_b32 a52, 0
 v_accvgpr_write_b32 a53, 0
 mf v[196:199], a[180:183], a[200:203], v[196:199]
 s_add_u32 s61, s61, 0x3800
 buffer_load_dwordx4 a[228:231], v4, s[48:51], s61 offen
 mf v[228:231], a[180:183], a[204:207], v[228:231]
 s_waitcnt lgkmcnt(4)
 s_add_u32 m0, s75, 0x14000
 ds_read_b64_tr_b16 a[180:181], v13 offset:32768
 ds_read_b64_tr_b16 a[182:183], v13 offset:33792
 mf v[136:139], a[184:187], a[192:195], v[136:139]
 s_add_u32 s60, s74, 0x4000
 v_accvgpr_write_b32 a54, 0
 v_accvgpr_write_b32 a55, 0
 mf v[168:171], a[184:187], a[196:199], v[168:171]
 buffer_load_dwordx4 v4, s[36:39], s60 offen lds
 mf v[200:203], a[184:187], a[200:203], v[200:203]
 v_accvgpr_write_b32 a56, 0
 v_accvgpr_write_b32 a57, 0
 mf v[232:235], a[184:187], a[204:207], v[232:235]
 s_waitcnt lgkmcnt(4)
 s_add_u32 s61, s82, 0x3800
 ds_read_b64_tr_b16 a[184:185], v14 offset:32768
 ds_read_b64_tr_b16 a[186:187], v14 offset:33792
 mf v[140:143], a[188:191], a[192:195], v[140:143]
 buffer_load_dwordx4 a[232:235], v4, s[48:51], s61 offen
 mf v[172:175], a[188:191], a[196:199], v[172:175]
 buffer_load_dwordx4 v4, s[36:39], s60 offen offset:1024 lds
 mf v[204:207], a[188:191], a[200:203], v[204:207]
 v_accvgpr_write_b32 a58, 0
 v_accvgpr_write_b32 a59, 0
 mf v[236:239], a[188:191], a[204:207], v[236:239]
 s_waitcnt lgkmcnt(4)
 ds_read_b64_tr_b16 a[188:189], v15 offset:32768
 ds_read_b64_tr_b16 a[190:191], v15 offset:33792
 mf v[144:147], a[176:179], a[192:195], v[144:147]
 buffer_load_dwordx4 v4, s[36:39], s60 offen offset:2048 lds
 mf v[176:179], a[176:179], a[196:199], v[176:179]
 s_add_u32 s61, s82, s16
 v_accvgpr_write_b32 a60, 0
 v_accvgpr_write_b32 a61, 0
 mf v[208:211], a[176:179], a[200:203], v[208:211]
 s_add_u32 s61, s61, 0x3800
 buffer_load_dwordx4 a[236:239], v4, s[48:51], s61 offen
 mf v[240:243], a[176:179], a[204:207], v[240:243]
 s_waitcnt lgkmcnt(4)
 ds_read_b64_tr_b16 a[176:177], v8 offset:40960
 ds_read_b64_tr_b16 a[178:179], v8 offset:41984
 mf v[148:151], a[180:183], a[192:195], v[148:151]
 buffer_load_dwordx4 v4, s[36:39], s60 offen offset:3072 lds
 mf v[180:183], a[180:183], a[196:199], v[180:183]
 v_accvgpr_write_b32 a62, 0
 v_accvgpr_write_b32 a63, 0
 mf v[212:215], a[180:183], a[200:203], v[212:215]
 v_accvgpr_write_b32 a64, 0
 v_accvgpr_write_b32 a65, 0
 mf v[244:247], a[180:183], a[204:207], v[244:247]
 s_waitcnt lgkmcnt(4)
 s_add_u32 s61, s81, 0x3800
 ds_read_b64_tr_b16 a[180:181], v9 offset:40960
 ds_read_b64_tr_b16 a[182:183], v9 offset:41984
 mf v[152:155], a[184:187], a[192:195], v[152:155]
 buffer_load_dwordx4 a[240:243], v4, s[48:51], s61 offen offset:1024
 mf v[184:187], a[184:187], a[196:199], v[184:187]
 v_accvgpr_write_b32 a66, 0
 v_accvgpr_write_b32 a67, 0
 mf v[216:219], a[184:187], a[200:203], v[216:219]
 v_accvgpr_write_b32 a68, 0
 v_accvgpr_write_b32 a69, 0
 mf v[248:251], a[184:187], a[204:207], v[248:251]
 s_waitcnt lgkmcnt(4)
 ds_read_b64_tr_b16 a[184:185], v10 offset:40960
 ds_read_b64_tr_b16 a[186:187], v10 offset:41984
 mf v[156:159], a[188:191], a[192:195], v[156:159]
 v_accvgpr_write_b32 a70, 0
 v_accvgpr_write_b32 a71, 0
 mf v[188:191], a[188:191], a[196:199], v[188:191]
 s_add_u32 s61, s81, s16
 mf v[220:223], a[188:191], a[200:203], v[220:223]
 s_add_u32 s61, s61, 0x3800
 buffer_load_dwordx4 a[244:247], v4, s[48:51], s61 offen offset:1024
 mf v[252:255], a[188:191], a[204:207], v[252:255]
 s_waitcnt vmcnt(17) lgkmcnt(4)
 ds_read_b64_tr_b16 a[188:189], v11 offset:40960
 ds_read_b64_tr_b16 a[190:191], v11 offset:41984
 mf v[128:131], a[176:179], a[208:211], v[128:131]
 s_waitcnt vmcnt(16)
 mf v[160:163], a[176:179], a[212:215], v[160:163]
 s_waitcnt vmcnt(15)
 mf v[192:195], a[176:179], a[216:219], v[192:195]
 s_waitcnt vmcnt(14)
 mf v[224:227], a[176:179], a[220:223], v[224:227]
 s_waitcnt lgkmcnt(4)
 s_add_u32 s61, s82, 0x3800
 ds_read_b64_tr_b16 a[176:177], v12 offset:40960
 ds_read_b64_tr_b16 a[178:179], v12 offset:41984
 mf v[132:135], a[180:183], a[208:211], v[132:135]
 buffer_load_dwordx4 a[248:251], v4, s[48:51], s61 offen offset:1024
 mf v[164:167], a[180:183], a[212:215], v[164:167]
 mf v[196:199], a[180:183], a[216:219], v[196:199]
 mf v[228:231], a[180:183], a[220:223], v[228:231]
 s_waitcnt lgkmcnt(4)
 ds_read_b64_tr_b16 a[180:181], v13 offset:40960
 ds_read_b64_tr_b16 a[182:183], v13 offset:41984
 mf v[136:139], a[184:187], a[208:211], v[136:139]
 mf v[168:171], a[184:187], a[212:215], v[168:171]
 s_add_u32 s61, s82, s16
 mf v[200:203], a[184:187], a[216:219], v[200:203]
 s_add_u32 s61, s61, 0x3800
 buffer_load_dwordx4 a[252:255], v4, s[48:51], s61 offen offset:1024
 mf v[232:235], a[184:187], a[220:223], v[232:235]
 s_waitcnt lgkmcnt(4)
 ds_read_b64_tr_b16 a[184:185], v14 offset:40960
 ds_read_b64_tr_b16 a[186:187], v14 offset:41984
 mf v[140:143], a[188:191], a[208:211], v[140:143]
 mf v[172:175], a[188:191], a[212:215], v[172:175]
 mf v[204:207], a[188:191], a[216:219], v[204:207]
 mf v[236:239], a[188:191], a[220:223], v[236:239]
 s_waitcnt lgkmcnt(4)
 ds_read_b64_tr_b16 a[188:189], v15 offset:40960
 ds_read_b64_tr_b16 a[190:191], v15 offset:41984
 mf v[144:147], a[176:179], a[208:211], v[144:147]
 mf v[176:179], a[176:179], a[212:215], v[176:179]
 mf v[208:211], a[176:179], a[216:219], v[208:211]
 mf v[240:243], a[176:179], a[220:223], v[240:243]
 s_waitcnt lgkmcnt(4)
 mf v[148:151], a[180:183], a[208:211], v[148:151]
 mf v[180:183], a[180:183], a[212:215], v[180:183]
 s_waitcnt lgkmcnt(0)
 s_barrier
 mf v[212:215], a[180:183], a[216:219], v[212:215]
 ds_read_b64_tr_b16 a[176:177], v8 offset:49152
 ds_read_b64_tr_b16 a[178:179], v8 offset:50176
 mf v[244:247], a[180:183], a[220:223], v[244:247]
 ds_read_b64_tr_b16 a[180:181], v9 offset:49152
 ds_read_b64_tr_b16 a[182:183], v9 offset:50176
 mf v[152:155], a[184:187], a[208:211], v[152:155]
 mf v[184:187], a[184:187], a[212:215], v[184:187]
 mf v[216:219], a[184:187], a[216:219], v[216:219]
 mf v[248:251], a[184:187], a[220:223], v[248:251]
 ds_read_b64_tr_b16 a[184:185], v10 offset:49152
 ds_read_b64_tr_b16 a[186:187], v10 offset:50176
 mf v[156:159], a[188:191], a[208:211], v[156:159]
 mf v[188:191], a[188:191], a[212:215], v[188:191]
 mf v[220:223], a[188:191], a[216:219], v[220:223]
 mf v[252:255], a[188:191], a[220:223], v[252:255]
 s_waitcnt vmcnt(13) lgkmcnt(4)
 ds_read_b64_tr_b16 a[188:189], v11 offset:49152
 ds_read_b64_tr_b16 a[190:191], v11 offset:50176
 mf v[128:131], a[176:179], a[224:227], v[128:131]
 s_waitcnt vmcnt(10)
 s_add_u32 s61, s81, 0x4000
 buffer_load_dwordx4 a[192:195], v4, s[48:51], s61 offen
 mf v[160:163], a[176:179], a[228:231], v[160:163]
 s_waitcnt vmcnt(9)
 mf v[192:195], a[176:179], a[232:235], v[192:195]
 s_waitcnt vmcnt(6)
 mf v[224:227], a[176:179], a[236:239], v[224:227]
 s_waitcnt lgkmcnt(4)
 ds_read_b64_tr_b16 a[176:177], v12 offset:49152
 ds_read_b64_tr_b16 a[178:179], v12 offset:50176
 mf v[132:135], a[180:183], a[224:227], v[132:135]
 mf v[164:167], a[180:183], a[228:231], v[164:167]
 s_add_u32 s61, s81, s16
 mf v[196:199], a[180:183], a[232:235], v[196:199]
 s_add_u32 s61, s61, 0x4000
 buffer_load_dwordx4 a[196:199], v4, s[48:51], s61 offen
 mf v[228:231], a[180:183], a[236:239], v[228:231]
 s_waitcnt lgkmcnt(4)
 ds_read_b64_tr_b16 a[180:181], v13 offset:49152
 ds_read_b64_tr_b16 a[182:183], v13 offset:50176
 mf v[136:139], a[184:187], a[224:227], v[136:139]
 mf v[168:171], a[184:187], a[228:231], v[168:171]
 mf v[200:203], a[184:187], a[232:235], v[200:203]
 mf v[232:235], a[184:187], a[236:239], v[232:235]
 s_waitcnt lgkmcnt(4)
 s_add_u32 s61, s82, 0x4000
 ds_read_b64_tr_b16 a[184:185], v14 offset:49152
 ds_read_b64_tr_b16 a[186:187], v14 offset:50176
 mf v[140:143], a[188:191], a[224:227], v[140:143]
 buffer_load_dwordx4 a[200:203], v4, s[48:51], s61 offen
 mf v[172:175], a[188:191], a[228:231], v[172:175]
 mf v[204:207], a[188:191], a[232:235], v[204:207]
 mf v[236:239], a[188:191], a[236:239], v[236:239]
 s_waitcnt lgkmcnt(4)
 ds_read_b64_tr_b16 a[188:189], v15 offset:49152
 ds_read_b64_tr_b16 a[190:191], v15 offset:50176
 mf v[144:147], a[176:179], a[224:227], v[144:147]
 mf v[176:179], a[176:179], a[228:231], v[176:179]
 s_add_u32 s61, s82, s16
 mf v[208:211], a[176:179], a[232:235], v[208:211]
 s_add_u32 s61, s61, 0x4000
 buffer_load_dwordx4 a[204:207], v4, s[48:51], s61 offen
 mf v[240:243], a[176:179], a[236:239], v[240:243]
 s_waitcnt lgkmcnt(4)
 ds_read_b64_tr_b16 a[176:177], v8 offset:57344
 ds_read_b64_tr_b16 a[178:179], v8 offset:58368
 mf v[148:151], a[180:183], a[224:227], v[148:151]
 mf v[180:183], a[180:183], a[228:231], v[180:183]
 mf v[212:215], a[180:183], a[232:235], v[212:215]
 mf v[244:247], a[180:183], a[236:239], v[244:247]
 s_waitcnt lgkmcnt(4)
 s_add_u32 s61, s81, 0x4000
 ds_read_b64_tr_b16 a[180:181], v9 offset:57344
 ds_read_b64_tr_b16 a[182:183], v9 offset:58368
 mf v[152:155], a[184:187], a[224:227], v[152:155]
 buffer_load_dwordx4 a[208:211], v4, s[48:51], s61 offen offset:1024
 mf v[184:187], a[184:187], a[228:231], v[184:187]
 mf v[216:219], a[184:187], a[232:235], v[216:219]
 mf v[248:251], a[184:187], a[236:239], v[248:251]
 s_waitcnt lgkmcnt(4)
 ds_read_b64_tr_b16 a[184:185], v10 offset:57344
 ds_read_b64_tr_b16 a[186:187], v10 offset:58368
 mf v[156:159], a[188:191], a[224:227], v[156:159]
 mf v[188:191], a[188:191], a[228:231], v[188:191]
 s_add_u32 s61, s81, s16
 mf v[220:223], a[188:191], a[232:235], v[220:223]
 s_add_u32 s61, s61, 0x4000
 buffer_load_dwordx4 a[212:215], v4, s[48:51], s61 offen offset:1024
 mf v[252:255], a[188:191], a[236:239], v[252:255]
 s_waitcnt vmcnt(9) lgkmcnt(4)
 ds_read_b64_tr_b16 a[188:189], v11 offset:57344
 ds_read_b64_tr_b16 a[190:191], v11 offset:58368
 mf v[128:131], a[176:179], a[240:243], v[128:131]
 s_waitcnt vmcnt(8)
 mf v[160:163], a[176:179], a[244:247], v[160:163]
 s_waitcnt vmcnt(7)
 mf v[192:195], a[176:179], a[248:251], v[192:195]
 s_waitcnt vmcnt(6)
 mf v[224:227], a[176:179], a[252:255], v[224:227]
 s_waitcnt lgkmcnt(4)
 s_add_u32 s61, s82, 0x4000
 ds_read_b64_tr_b16 a[176:177], v12 offset:57344
 ds_read_b64_tr_b16 a[178:179], v12 offset:58368
 mf v[132:135], a[180:183], a[240:243], v[132:135]
 buffer_load_dwordx4 a[216:219], v4, s[48:51], s61 offen offset:1024
 mf v[164:167], a[180:183], a[244:247], v[164:167]
 mf v[196:199], a[180:183], a[248:251], v[196:199]
 mf v[228:231], a[180:183], a[252:255], v[228:231]
 s_waitcnt lgkmcnt(4)
 ds_read_b64_tr_b16 a[180:181], v13 offset:57344
 ds_read_b64_tr_b16 a[182:183], v13 offset:58368
 mf v[136:139], a[184:187], a[240:243], v[136:139]
 mf v[168:171], a[184:187], a[244:247], v[168:171]
 s_add_u32 s61, s82, s16
 mf v[200:203], a[184:187], a[248:251], v[200:203]
 s_add_u32 s61, s61, 0x4000
 buffer_load_dwordx4 a[220:223], v4, s[48:51], s61 offen offset:1024
 mf v[232:235], a[184:187], a[252:255], v[232:235]
 s_waitcnt lgkmcnt(4)
 ds_read_b64_tr_b16 a[184:185], v14 offset:57344
 ds_read_b64_tr_b16 a[186:187], v14 offset:58368
 mf v[140:143], a[188:191], a[240:243], v[140:143]
 mf v[172:175], a[188:191], a[244:247], v[172:175]
 mf v[204:207], a[188:191], a[248:251], v[204:207]
 mf v[236:239], a[188:191], a[252:255], v[236:239]
 s_waitcnt lgkmcnt(4)
 ds_read_b64_tr_b16 a[188:189], v15 offset:57344
 ds_read_b64_tr_b16 a[190:191], v15 offset:58368
 mf v[144:147], a[176:179], a[240:243], v[144:147]
 mf v[176:179], a[176:179], a[244:247], v[176:179]
 mf v[208:211], a[176:179], a[248:251], v[208:211]
 mf v[240:243], a[176:179], a[252:255], v[240:243]
 s_waitcnt lgkmcnt(4)
 mf v[148:151], a[180:183], a[240:243], v[148:151]
 mf v[180:183], a[180:183], a[244:247], v[180:183]
 s_waitcnt lgkmcnt(0)
 s_barrier
 v_add_u32 v8, 0x10000, v8
 v_add_u32 v9, 0x10000, v9
 v_add_u32 v10, 0x10000, v10
 v_add_u32 v11, 0x10000, v11
 v_add_u32 v12, 0x10000, v12
 v_add_u32 v13, 0x10000, v13
 v_add_u32 v14, 0x10000, v14
 v_add_u32 v15, 0x10000, v15
 mf v[212:215], a[180:183], a[248:251], v[212:215]
 s_add_u32 m0, s75, 0x18000
 ds_read_b64_tr_b16 a[176:177], v8
 ds_read_b64_tr_b16 a[178:179], v8 offset:1024
 mf v[244:247], a[180:183], a[252:255], v[244:247]
 s_add_u32 s60, s74, 0xc000
 ds_read_b64_tr_b16 a[180:181], v9
 ds_read_b64_tr_b16 a[182:183], v9 offset:1024
 mf v[152:155], a[184:187], a[240:243], v[152:155]
 buffer_load_dwordx4 v4, s[36:39], s60 offen lds
 mf v[184:187], a[184:187], a[244:247], v[184:187]
 mf v[216:219], a[184:187], a[248:251], v[216:219]
 mf v[248:251], a[184:187], a[252:255], v[248:251]
 ds_read_b64_tr_b16 a[184:185], v10
 ds_read_b64_tr_b16 a[186:187], v10 offset:1024
 mf v[156:159], a[188:191], a[240:243], v[156:159]
 buffer_load_dwordx4 v4, s[36:39], s60 offen offset:1024 lds
 mf v[188:191], a[188:191], a[244:247], v[188:191]
 mf v[220:223], a[188:191], a[248:251], v[220:223]
 mf v[252:255], a[188:191], a[252:255], v[252:255]
 s_waitcnt vmcnt(9) lgkmcnt(4)
 ds_read_b64_tr_b16 a[188:189], v11
 ds_read_b64_tr_b16 a[190:191], v11 offset:1024
 mf v[128:131], a[176:179], a[192:195], v[128:131]
 s_waitcnt vmcnt(8)
 buffer_load_dwordx4 v4, s[36:39], s60 offen offset:2048 lds
 mf v[160:163], a[176:179], a[196:199], v[160:163]
 s_waitcnt vmcnt(8)
 mf v[192:195], a[176:179], a[200:203], v[192:195]
 s_waitcnt vmcnt(7)
 mf v[224:227], a[176:179], a[204:207], v[224:227]
 s_waitcnt lgkmcnt(4)
 ds_read_b64_tr_b16 a[176:177], v12
 ds_read_b64_tr_b16 a[178:179], v12 offset:1024
 mf v[132:135], a[180:183], a[192:195], v[132:135]
 buffer_load_dwordx4 v4, s[36:39], s60 offen offset:3072 lds
 mf v[164:167], a[180:183], a[196:199], v[164:167]
 mf v[196:199], a[180:183], a[200:203], v[196:199]
 s_add_u32 m0, s75, 0x1c000
 mf v[228:231], a[180:183], a[204:207], v[228:231]
 s_waitcnt lgkmcnt(4)
 s_add_u32 s60, s74, 0x14000
 ds_read_b64_tr_b16 a[180:181], v13
 ds_read_b64_tr_b16 a[182:183], v13 offset:1024
 mf v[136:139], a[184:187], a[192:195], v[136:139]
 buffer_load_dwordx4 v4, s[36:39], s60 offen lds
 mf v[168:171], a[184:187], a[196:199], v[168:171]
 mf v[200:203], a[184:187], a[200:203], v[200:203]
 mf v[232:235], a[184:187], a[204:207], v[232:235]
 s_waitcnt lgkmcnt(4)
 ds_read_b64_tr_b16 a[184:185], v14
 ds_read_b64_tr_b16 a[186:187], v14 offset:1024
 mf v[140:143], a[188:191], a[192:195], v[140:143]
 buffer_load_dwordx4 v4, s[36:39], s60 offen offset:1024 lds
 mf v[172:175], a[188:191], a[196:199], v[172:175]
 mf v[204:207], a[188:191], a[200:203], v[204:207]
 mf v[236:239], a[188:191], a[204:207], v[236:239]
 s_waitcnt lgkmcnt(4)
 ds_read_b64_tr_b16 a[188:189], v15
 ds_read_b64_tr_b16 a[190:191], v15 offset:1024
 mf v[144:147], a[176:179], a[192:195], v[144:147]
 buffer_load_dwordx4 v4, s[36:39], s60 offen offset:2048 lds
 mf v[176:179], a[176:179], a[196:199], v[176:179]
 mf v[208:211], a[176:179], a[200:203], v[208:211]
 mf v[240:243], a[176:179], a[204:207], v[240:243]
 s_waitcnt lgkmcnt(4)
 ds_read_b64_tr_b16 a[176:177], v8 offset:8192
 ds_read_b64_tr_b16 a[178:179], v8 offset:9216
 mf v[148:151], a[180:183], a[192:195], v[148:151]
 buffer_load_dwordx4 v4, s[36:39], s60 offen offset:3072 lds
 mf v[180:183], a[180:183], a[196:199], v[180:183]
 mf v[212:215], a[180:183], a[200:203], v[212:215]
 mf v[244:247], a[180:183], a[204:207], v[244:247]
 s_waitcnt lgkmcnt(4)
 ds_read_b64_tr_b16 a[180:181], v9 offset:8192
 ds_read_b64_tr_b16 a[182:183], v9 offset:9216
 mf v[152:155], a[184:187], a[192:195], v[152:155]
 mf v[184:187], a[184:187], a[196:199], v[184:187]
 mf v[216:219], a[184:187], a[200:203], v[216:219]
 mf v[248:251], a[184:187], a[204:207], v[248:251]
 s_waitcnt lgkmcnt(4)
 ds_read_b64_tr_b16 a[184:185], v10 offset:8192
 ds_read_b64_tr_b16 a[186:187], v10 offset:9216
 mf v[156:159], a[188:191], a[192:195], v[156:159]
 mf v[188:191], a[188:191], a[196:199], v[188:191]
 mf v[220:223], a[188:191], a[200:203], v[220:223]
 mf v[252:255], a[188:191], a[204:207], v[252:255]
 s_waitcnt vmcnt(11) lgkmcnt(4)
 ds_read_b64_tr_b16 a[188:189], v11 offset:8192
 ds_read_b64_tr_b16 a[190:191], v11 offset:9216
 mf v[128:131], a[176:179], a[208:211], v[128:131]
 s_waitcnt vmcnt(10)
 mf v[160:163], a[176:179], a[212:215], v[160:163]
 s_waitcnt vmcnt(9)
 mf v[192:195], a[176:179], a[216:219], v[192:195]
 s_waitcnt vmcnt(8)
 mf v[224:227], a[176:179], a[220:223], v[224:227]
 s_waitcnt lgkmcnt(4)
 ds_read_b64_tr_b16 a[176:177], v12 offset:8192
 ds_read_b64_tr_b16 a[178:179], v12 offset:9216
 mf v[132:135], a[180:183], a[208:211], v[132:135]
 mf v[164:167], a[180:183], a[212:215], v[164:167]
 mf v[196:199], a[180:183], a[216:219], v[196:199]
 mf v[228:231], a[180:183], a[220:223], v[228:231]
 s_waitcnt lgkmcnt(4)
 ds_read_b64_tr_b16 a[180:181], v13 offset:8192
 ds_read_b64_tr_b16 a[182:183], v13 offset:9216
 mf v[136:139], a[184:187], a[208:211], v[136:139]
 mf v[168:171], a[184:187], a[212:215], v[168:171]
 mf v[200:203], a[184:187], a[216:219], v[200:203]
 mf v[232:235], a[184:187], a[220:223], v[232:235]
 s_waitcnt lgkmcnt(4)
 ds_read_b64_tr_b16 a[184:185], v14 offset:8192
 ds_read_b64_tr_b16 a[186:187], v14 offset:9216
 mf v[140:143], a[188:191], a[208:211], v[140:143]
 mf v[172:175], a[188:191], a[212:215], v[172:175]
 mf v[204:207], a[188:191], a[216:219], v[204:207]
 mf v[236:239], a[188:191], a[220:223], v[236:239]
 s_waitcnt lgkmcnt(4)
 ds_read_b64_tr_b16 a[188:189], v15 offset:8192
 ds_read_b64_tr_b16 a[190:191], v15 offset:9216
 mf v[144:147], a[176:179], a[208:211], v[144:147]
 mf v[176:179], a[176:179], a[212:215], v[176:179]
 mf v[208:211], a[176:179], a[216:219], v[208:211]
 mf v[240:243], a[176:179], a[220:223], v[240:243]
 s_waitcnt lgkmcnt(4)
 mf v[148:151], a[180:183], a[208:211], v[148:151]
 mf v[180:183], a[180:183], a[212:215], v[180:183]
 mf v[212:215], a[180:183], a[216:219], v[212:215]
 mf v[244:247], a[180:183], a[220:223], v[244:247]
 s_waitcnt lgkmcnt(2)
 mf v[152:155], a[184:187], a[208:211], v[152:155]
 mf v[184:187], a[184:187], a[212:215], v[184:187]
 mf v[216:219], a[184:187], a[216:219], v[216:219]
 mf v[248:251], a[184:187], a[220:223], v[248:251]
 s_waitcnt lgkmcnt(0)
 mf v[156:159], a[188:191], a[208:211], v[156:159]
 mf v[188:191], a[188:191], a[212:215], v[188:191]
 mf v[220:223], a[188:191], a[216:219], v[220:223]
 mf v[252:255], a[188:191], a[220:223], v[252:255]
 v_mov_b32 v28, 0x3e0293ee
 v_mov_b32 v29, 0x3e0293ee
 v_pk_mul_f32 v[128:129], v[128:129], v[28:29]
 v_pk_mul_f32 v[130:131], v[130:131], v[28:29]
 v_pk_mul_f32 v[132:133], v[132:133], v[28:29]
 v_pk_mul_f32 v[134:135], v[134:135], v[28:29]
 v_cvt_pk_bf16_f32 v128, v128, v129
 v_cvt_pk_bf16_f32 v129, v130, v131
 v_cvt_pk_bf16_f32 v130, v132, v133
 v_cvt_pk_bf16_f32 v131, v134, v135
 v_pk_mul_f32 v[136:137], v[136:137], v[28:29]
 v_pk_mul_f32 v[138:139], v[138:139], v[28:29]
 v_pk_mul_f32 v[140:141], v[140:141], v[28:29]
 v_pk_mul_f32 v[142:143], v[142:143], v[28:29]
 v_cvt_pk_bf16_f32 v136, v136, v137
 v_cvt_pk_bf16_f32 v137, v138, v139
 v_cvt_pk_bf16_f32 v138, v140, v141
 v_cvt_pk_bf16_f32 v139, v142, v143
 v_pk_mul_f32 v[144:145], v[144:145], v[28:29]
 v_pk_mul_f32 v[146:147], v[146:147], v[28:29]
 v_pk_mul_f32 v[148:149], v[148:149], v[28:29]
 v_pk_mul_f32 v[150:151], v[150:151], v[28:29]
 v_cvt_pk_bf16_f32 v144, v144, v145
 v_cvt_pk_bf16_f32 v145, v146, v147
 v_cvt_pk_bf16_f32 v146, v148, v149
 v_cvt_pk_bf16_f32 v147, v150, v151
 v_pk_mul_f32 v[152:153], v[152:153], v[28:29]
 v_pk_mul_f32 v[154:155], v[154:155], v[28:29]
 v_pk_mul_f32 v[156:157], v[156:157], v[28:29]
 v_pk_mul_f32 v[158:159], v[158:159], v[28:29]
 v_cvt_pk_bf16_f32 v152, v152, v153
 v_cvt_pk_bf16_f32 v153, v154, v155
 v_cvt_pk_bf16_f32 v154, v156, v157
 v_cvt_pk_bf16_f32 v155, v158, v159
 v_pk_mul_f32 v[160:161], v[160:161], v[28:29]
 v_pk_mul_f32 v[162:163], v[162:163], v[28:29]
 v_pk_mul_f32 v[164:165], v[164:165], v[28:29]
 v_pk_mul_f32 v[166:167], v[166:167], v[28:29]
 v_cvt_pk_bf16_f32 v160, v160, v161
 v_cvt_pk_bf16_f32 v161, v162, v163
 v_cvt_pk_bf16_f32 v162, v164, v165
 v_cvt_pk_bf16_f32 v163, v166, v167
 v_pk_mul_f32 v[168:169], v[168:169], v[28:29]
 v_pk_mul_f32 v[170:171], v[170:171], v[28:29]
 v_pk_mul_f32 v[172:173], v[172:173], v[28:29]
 v_pk_mul_f32 v[174:175], v[174:175], v[28:29]
 v_cvt_pk_bf16_f32 v168, v168, v169
 v_cvt_pk_bf16_f32 v169, v170, v171
 v_cvt_pk_bf16_f32 v170, v172, v173
 v_cvt_pk_bf16_f32 v171, v174, v175
 v_pk_mul_f32 v[176:177], v[176:177], v[28:29]
 v_pk_mul_f32 v[178:179], v[178:179], v[28:29]
 v_pk_mul_f32 v[180:181], v[180:181], v[28:29]
 v_pk_mul_f32 v[182:183], v[182:183], v[28:29]
 v_cvt_pk_bf16_f32 v176, v176, v177
 v_cvt_pk_bf16_f32 v177, v178, v179
 v_cvt_pk_bf16_f32 v178, v180, v181
 v_cvt_pk_bf16_f32 v179, v182, v183
 v_pk_mul_f32 v[184:185], v[184:185], v[28:29]
 v_pk_mul_f32 v[186:187], v[186:187], v[28:29]
 v_pk_mul_f32 v[188:189], v[188:189], v[28:29]
 v_pk_mul_f32 v[190:191], v[190:191], v[28:29]
 v_cvt_pk_bf16_f32 v184, v184, v185
 v_cvt_pk_bf16_f32 v185, v186, v187
 v_cvt_pk_bf16_f32 v186, v188, v189
 v_cvt_pk_bf16_f32 v187, v190, v191
 v_pk_mul_f32 v[192:193], v[192:193], v[28:29]
 v_pk_mul_f32 v[194:195], v[194:195], v[28:29]
 v_pk_mul_f32 v[196:197], v[196:197], v[28:29]
 v_pk_mul_f32 v[198:199], v[198:199], v[28:29]
 v_cvt_pk_bf16_f32 v192, v192, v193
 v_cvt_pk_bf16_f32 v193, v194, v195
 v_cvt_pk_bf16_f32 v194, v196, v197
 v_cvt_pk_bf16_f32 v195, v198, v199
 v_pk_mul_f32 v[200:201], v[200:201], v[28:29]
 v_pk_mul_f32 v[202:203], v[202:203], v[28:29]
 v_pk_mul_f32 v[204:205], v[204:205], v[28:29]
 v_pk_mul_f32 v[206:207], v[206:207], v[28:29]
 v_cvt_pk_bf16_f32 v200, v200, v201
 v_cvt_pk_bf16_f32 v201, v202, v203
 v_cvt_pk_bf16_f32 v202, v204, v205
 v_cvt_pk_bf16_f32 v203, v206, v207
 v_pk_mul_f32 v[208:209], v[208:209], v[28:29]
 v_pk_mul_f32 v[210:211], v[210:211], v[28:29]
 v_pk_mul_f32 v[212:213], v[212:213], v[28:29]
 v_pk_mul_f32 v[214:215], v[214:215], v[28:29]
 v_cvt_pk_bf16_f32 v208, v208, v209
 v_cvt_pk_bf16_f32 v209, v210, v211
 v_cvt_pk_bf16_f32 v210, v212, v213
 v_cvt_pk_bf16_f32 v211, v214, v215
 v_pk_mul_f32 v[216:217], v[216:217], v[28:29]
 v_pk_mul_f32 v[218:219], v[218:219], v[28:29]
 v_pk_mul_f32 v[220:221], v[220:221], v[28:29]
 v_pk_mul_f32 v[222:223], v[222:223], v[28:29]
 v_cvt_pk_bf16_f32 v216, v216, v217
 v_cvt_pk_bf16_f32 v217, v218, v219
 v_cvt_pk_bf16_f32 v218, v220, v221
 v_cvt_pk_bf16_f32 v219, v222, v223
 v_pk_mul_f32 v[224:225], v[224:225], v[28:29]
 v_pk_mul_f32 v[226:227], v[226:227], v[28:29]
 v_pk_mul_f32 v[228:229], v[228:229], v[28:29]
 v_pk_mul_f32 v[230:231], v[230:231], v[28:29]
 v_cvt_pk_bf16_f32 v224, v224, v225
 v_cvt_pk_bf16_f32 v225, v226, v227
 v_cvt_pk_bf16_f32 v226, v228, v229
 v_cvt_pk_bf16_f32 v227, v230, v231
 v_pk_mul_f32 v[232:233], v[232:233], v[28:29]
 v_pk_mul_f32 v[234:235], v[234:235], v[28:29]
 v_pk_mul_f32 v[236:237], v[236:237], v[28:29]
 v_pk_mul_f32 v[238:239], v[238:239], v[28:29]
 v_cvt_pk_bf16_f32 v232, v232, v233
 v_cvt_pk_bf16_f32 v233, v234, v235
 v_cvt_pk_bf16_f32 v234, v236, v237
 v_cvt_pk_bf16_f32 v235, v238, v239
 v_pk_mul_f32 v[240:241], v[240:241], v[28:29]
 v_pk_mul_f32 v[242:243], v[242:243], v[28:29]
 v_pk_mul_f32 v[244:245], v[244:245], v[28:29]
 v_pk_mul_f32 v[246:247], v[246:247], v[28:29]
 v_cvt_pk_bf16_f32 v240, v240, v241
 v_cvt_pk_bf16_f32 v241, v242, v243
 v_cvt_pk_bf16_f32 v242, v244, v245
 v_cvt_pk_bf16_f32 v243, v246, v247
 v_pk_mul_f32 v[248:249], v[248:249], v[28:29]
 v_pk_mul_f32 v[250:251], v[250:251], v[28:29]
 v_pk_mul_f32 v[252:253], v[252:253], v[28:29]
 v_pk_mul_f32 v[254:255], v[254:255], v[28:29]
 v_cvt_pk_bf16_f32 v248, v248, v249
 v_cvt_pk_bf16_f32 v249, v250, v251
 v_cvt_pk_bf16_f32 v250, v252, v253
 v_cvt_pk_bf16_f32 v251, v254, v255
 v_mov_b32 v244, 0x3f803f80
 v_mov_b32 v245, 0x3f803f80
 v_mov_b32 v246, 0x3f803f80
 v_mov_b32 v247, 0x3f803f80
 v_lshrrev_b32 v28, 2, v3
 v_lshl_add_u32 v28, v2, 2, v28
 v_mul_u32_u24 v28, 0x140, v28
 v_and_b32 v29, 3, v3
 v_lshl_add_u32 v28, v29, 3, v28
 v_and_b32 v29, 1, v2
 s_add_u32 s30, s90, 0
 v_xor_b32 v30, s30, v29
 v_lshl_add_u32 v30, v30, 5, v28
 v_add_u32 v8, 0x20000, v30
 v_add_u32 v10, 0, v30
 v_add_u32 v12, 0x5000, v30
 v_add_u32 v14, 0xa000, v30
 s_add_u32 s30, s90, 1
 v_xor_b32 v30, s30, v29
 v_lshl_add_u32 v30, v30, 5, v28
 v_add_u32 v9, 0x20000, v30
 v_add_u32 v11, 0, v30
 v_add_u32 v13, 0x5000, v30
 v_add_u32 v15, 0xa000, v30
 v_lshlrev_b32 v16, 3, v1
 s_mov_b32 s48, s14
 s_mov_b32 s49, s15
 s_mov_b32 s50, 0x480000
 s_mov_b32 s51, 0x20000
 s_waitcnt vmcnt(8)
 s_barrier
 s_lshl_b32 s62, s66, 3
 s_add_u32 s62, s62, s64
 s_lshl_b32 s62, s62, 2
 s_add_u32 s62, s62, s65
 s_lshl_b32 s62, s62, 7
 s_add_u32 s62, s62, 0x10000
 buffer_store_dword v6, v5, s[52:55], s62 offen sc1
f_tile:
 s_lshl_b32 s30, s70, 3
 s_add_u32 s30, s30, s3
 s_mul_i32 s78, s30, 0x44000
 s_lshl_b32 s30, s67, 12
 s_add_u32 s78, s78, s30
 v_and_b32 v19, 3, v1
 v_lshlrev_b32 v19, 7, v19
 s_lshl_b32 s63, s66, 3
 s_add_u32 s63, s63, s64
 s_lshl_b32 s63, s63, 9
 s_add_u32 s63, s63, 0x10000
 buffer_load_dword v27, v19, s[52:55], s63 offen sc1
 v_and_b32 v30, 1, v1
 v_lshlrev_b32 v30, 7, v30
 v_add_u32 v30, s100, v30
 v_add_u32 v30, f_last-parallel_sum__compressed_kv_cla__geglu_ffn__prompt_kernel, v30
 v_min_u32 v30, f_done-parallel_sum__compressed_kv_cla__geglu_ffn__prompt_kernel, v30
 v_add_co_u32 v30, vcc, s98, v30
 v_mov_b32 v31, s99
 s_nop 0
 v_addc_co_u32 v31, vcc, 0, v31, vcc
 global_load_dword v20, v[30:31], off
 v_mov_b32 v212, 0
 v_mov_b32 v213, 0
 v_mov_b32 v214, 0
 v_mov_b32 v215, 0
 v_mov_b32 v220, 0
 v_mov_b32 v221, 0
 v_mov_b32 v222, 0
 v_mov_b32 v223, 0
 ds_read_b128 a[72:75], v112
 ds_read_b128 a[76:79], v112 offset:1024
 ds_read_b128 a[80:83], v112 offset:2048
 ds_read_b128 a[84:87], v112 offset:3072
 ds_read_b128 a[88:91], v112 offset:4096
 ds_read_b128 a[92:95], v112 offset:5120
 ds_read_b128 a[96:99], v112 offset:6144
 ds_read_b128 a[100:103], v112 offset:7168
 s_waitcnt lgkmcnt(7)
 mf v[132:135], a[72:75], v[128:131], 0
 mf v[140:143], a[72:75], v[160:163], 0
 s_waitcnt lgkmcnt(6)
 mf v[132:135], a[76:79], v[136:139], v[132:135]
 mf v[140:143], a[76:79], v[168:171], v[140:143]
 s_waitcnt lgkmcnt(5)
 mf v[132:135], a[80:83], v[144:147], v[132:135]
 mf v[140:143], a[80:83], v[176:179], v[140:143]
 s_waitcnt lgkmcnt(4)
 mf v[132:135], a[84:87], v[152:155], v[132:135]
 mf v[140:143], a[84:87], v[184:187], v[140:143]
 s_waitcnt lgkmcnt(3)
 mf v[148:151], a[88:91], v[128:131], 0
 mf v[156:159], a[88:91], v[160:163], 0
 s_waitcnt lgkmcnt(2)
 mf v[148:151], a[92:95], v[136:139], v[148:151]
 mf v[156:159], a[92:95], v[168:171], v[156:159]
 s_waitcnt lgkmcnt(1)
 mf v[148:151], a[96:99], v[144:147], v[148:151]
 mf v[156:159], a[96:99], v[176:179], v[156:159]
 s_waitcnt lgkmcnt(0)
 mf v[148:151], a[100:103], v[152:155], v[148:151]
 mf v[156:159], a[100:103], v[184:187], v[156:159]
 ds_read_b128 a[72:75], v112 offset:8192
 ds_read_b128 a[76:79], v112 offset:9216
 ds_read_b128 a[80:83], v112 offset:10240
 ds_read_b128 a[84:87], v112 offset:11264
 ds_read_b128 a[88:91], v114 offset:8192
 ds_read_b128 a[92:95], v114 offset:9216
 ds_read_b128 a[96:99], v114 offset:10240
 ds_read_b128 a[100:103], v114 offset:11264
 ds_read_b128 a[104:107], v112 offset:12288
 ds_read_b128 a[108:111], v112 offset:13312
 ds_read_b128 a[112:115], v112 offset:14336
 ds_read_b128 a[116:119], v112 offset:15360
 ds_read_b128 a[120:123], v114 offset:12288
 ds_read_b128 a[124:127], v114 offset:13312
 ds_read_b128 a[128:131], v114 offset:14336
 s_waitcnt lgkmcnt(14)
 ds_read_b128 a[132:135], v114 offset:15360
 s_cmp_lg_u32 s70, 0
 s_cbranch_scc1 f_nomask
 s_nop 7
 v_min_f32 v132, v132, v32
 v_min_f32 v133, v133, v33
 v_min_f32 v134, v134, v34
 v_min_f32 v135, v135, v35
 v_min_f32 v148, v148, v40
 v_min_f32 v149, v149, v41
 v_min_f32 v150, v150, v42
 v_min_f32 v151, v151, v43
 v_min_f32 v140, v140, v36
 v_min_f32 v141, v141, v37
 v_min_f32 v142, v142, v38
 v_min_f32 v143, v143, v39
 v_min_f32 v156, v156, v44
 v_min_f32 v157, v157, v45
 v_min_f32 v158, v158, v46
 v_min_f32 v159, v159, v47
f_nomask:
 s_nop 7
 v_max3_f32 v28, v132, v133, v134
 v_max3_f32 v28, v28, v135, v148
 v_max3_f32 v28, v28, v149, v150
 v_max_f32 v28, v28, v151
 v_mov_b32 v29, v28
 s_nop 1
 v_permlane16_swap_b32 v28, v29
 v_max_f32 v28, v28, v29
 v_mov_b32 v29, v28
 s_nop 1
 v_permlane32_swap_b32 v28, v29
 v_max_f32 v28, v28, v29
 v_sub_f32 v228, 0, v28
 v_sub_f32 v229, 0, v28
 v_sub_f32 v230, 0, v28
 v_sub_f32 v231, 0, v28
 v_sub_f32 v132, v132, v28
 v_sub_f32 v133, v133, v28
 v_sub_f32 v134, v134, v28
 v_sub_f32 v135, v135, v28
 v_sub_f32 v148, v148, v28
 v_sub_f32 v149, v149, v28
 v_sub_f32 v150, v150, v28
 v_sub_f32 v151, v151, v28
 v_max3_f32 v30, v140, v141, v142
 v_max3_f32 v30, v30, v143, v156
 v_max3_f32 v30, v30, v157, v158
 v_max_f32 v30, v30, v159
 v_mov_b32 v31, v30
 s_nop 1
 v_permlane16_swap_b32 v30, v31
 v_max_f32 v30, v30, v31
 v_mov_b32 v31, v30
 s_nop 1
 v_permlane32_swap_b32 v30, v31
 v_max_f32 v30, v30, v31
 v_sub_f32 v236, 0, v30
 v_sub_f32 v237, 0, v30
 v_sub_f32 v238, 0, v30
 v_sub_f32 v239, 0, v30
 v_sub_f32 v140, v140, v30
 v_sub_f32 v141, v141, v30
 v_sub_f32 v142, v142, v30
 v_sub_f32 v143, v143, v30
 v_sub_f32 v156, v156, v30
 v_sub_f32 v157, v157, v30
 v_sub_f32 v158, v158, v30
 v_sub_f32 v159, v159, v30
 s_waitcnt lgkmcnt(0)
 s_mov_b32 s73, s70
 s_cmp_eq_u32 s70, 0
 s_cbranch_scc1 f_last
f_loop:
 mf v[164:167], a[72:75], v[128:131], v[228:231]
 s_sub_u32 s73, s73, 1
 v_exp_f32 v132, v132
 mf v[172:175], a[72:75], v[160:163], v[236:239]
 s_waitcnt lgkmcnt(14)
 ds_read_b128 a[72:75], v112 offset:16384
 mf v[164:167], a[76:79], v[136:139], v[164:167]
 s_mov_b32 s76, s77
 v_exp_f32 v133, v133
 mf v[172:175], a[76:79], v[168:171], v[172:175]
 s_waitcnt lgkmcnt(14)
 ds_read_b128 a[76:79], v112 offset:17408
 v_cvt_pk_bf16_f32 v196, v132, v133
 mf v[164:167], a[80:83], v[144:147], v[164:167]
 s_add_u32 s30, s71, 2
 v_exp_f32 v134, v134
 mf v[172:175], a[80:83], v[176:179], v[172:175]
 s_waitcnt lgkmcnt(14)
 ds_read_b128 a[80:83], v112 offset:18432
 mf v[164:167], a[84:87], v[152:155], v[164:167]
 s_sub_u32 s31, s30, s72
 v_exp_f32 v135, v135
 mf v[172:175], a[84:87], v[184:187], v[172:175]
 s_waitcnt lgkmcnt(14)
 ds_read_b128 a[84:87], v112 offset:19456
 v_cvt_pk_bf16_f32 v197, v134, v135
 mf a[0:3], a[88:91], v[212:215], a[0:3]
 s_cmp_lt_u32 s30, s72
 v_exp_f32 v148, v148
 mf a[4:7], a[88:91], v[220:223], a[4:7]
 s_waitcnt lgkmcnt(14)
 ds_read_b128 a[88:91], v114 offset:16384
 mf a[8:11], a[92:95], v[212:215], a[8:11]
 s_cselect_b32 s31, s30, s31
 v_exp_f32 v149, v149
 mf a[12:15], a[92:95], v[220:223], a[12:15]
 s_waitcnt lgkmcnt(14)
 ds_read_b128 a[92:95], v114 offset:17408
 v_cvt_pk_bf16_f32 v198, v148, v149
 mf a[16:19], a[96:99], v[212:215], a[16:19]
 s_lshl_b32 s77, s31, 16
 v_exp_f32 v150, v150
 mf a[20:23], a[96:99], v[220:223], a[20:23]
 s_waitcnt lgkmcnt(14)
 ds_read_b128 a[96:99], v114 offset:18432
 mf a[24:27], a[100:103], v[212:215], a[24:27]
 s_add_u32 s77, s77, s74
 v_exp_f32 v151, v151
 mf a[28:31], a[100:103], v[220:223], a[28:31]
 s_waitcnt lgkmcnt(14)
 ds_read_b128 a[100:103], v114 offset:19456
 v_cvt_pk_bf16_f32 v199, v150, v151
 mf v[180:183], a[104:107], v[128:131], v[228:231]
 s_cmp_le_u32 s30, 16
 v_exp_f32 v140, v140
 mf v[188:191], a[104:107], v[160:163], v[236:239]
 s_waitcnt lgkmcnt(14)
 ds_read_b128 a[104:107], v112 offset:20480
 mf v[180:183], a[108:111], v[136:139], v[180:183]
 s_cselect_b32 s38, 0x2000000, 0
 v_exp_f32 v141, v141
 mf v[188:191], a[108:111], v[168:171], v[188:191]
 s_waitcnt lgkmcnt(14)
 ds_read_b128 a[108:111], v112 offset:21504
 v_cvt_pk_bf16_f32 v204, v140, v141
 mf v[180:183], a[112:115], v[144:147], v[180:183]
 s_cmp_le_u32 s30, 17
 v_exp_f32 v142, v142
 mf v[188:191], a[112:115], v[176:179], v[188:191]
 s_waitcnt lgkmcnt(14)
 ds_read_b128 a[112:115], v112 offset:22528
 mf v[180:183], a[116:119], v[152:155], v[180:183]
 s_cselect_b32 s46, 0x2000000, 0
 v_exp_f32 v143, v143
 mf v[188:191], a[116:119], v[184:187], v[188:191]
 s_waitcnt lgkmcnt(14)
 ds_read_b128 a[116:119], v112 offset:23552
 v_cvt_pk_bf16_f32 v205, v142, v143
 mf a[32:35], a[120:123], v[212:215], a[32:35]
 s_cmp_lt_u32 s71, 6
 v_exp_f32 v156, v156
 mf a[36:39], a[120:123], v[220:223], a[36:39]
 s_waitcnt lgkmcnt(14)
 ds_read_b128 a[120:123], v114 offset:20480
 mf a[40:43], a[124:127], v[212:215], a[40:43]
 s_cselect_b32 s56, s22, s14
 v_exp_f32 v157, v157
 mf a[44:47], a[124:127], v[220:223], a[44:47]
 s_waitcnt lgkmcnt(14)
 ds_read_b128 a[124:127], v114 offset:21504
 v_cvt_pk_bf16_f32 v206, v156, v157
 mf a[48:51], a[128:131], v[212:215], a[48:51]
 s_cselect_b32 s57, s23, s15
 v_exp_f32 v158, v158
 mf a[52:55], a[128:131], v[220:223], a[52:55]
 s_waitcnt lgkmcnt(14)
 ds_read_b128 a[128:131], v114 offset:22528
 mf a[56:59], a[132:135], v[212:215], a[56:59]
 s_mov_b32 s58, 0x480000
 v_exp_f32 v159, v159
 mf a[60:63], a[132:135], v[220:223], a[60:63]
 s_waitcnt lgkmcnt(14)
 ds_read_b128 a[132:135], v114 offset:23552
 v_cvt_pk_bf16_f32 v207, v158, v159
 mf a[64:67], v[244:247], v[212:215], a[64:67]
 s_cmov_b32 s58, 0x510000
 mf a[68:71], v[244:247], v[220:223], a[68:71]
 mf v[132:135], a[72:75], v[128:131], v[228:231]
 s_cselect_b32 s80, 0, 6
 v_exp_f32 v164, v164
 mf v[140:143], a[72:75], v[160:163], v[236:239]
 s_waitcnt lgkmcnt(14)
 ds_read_b128 a[72:75], v112 offset:24576
 mf v[132:135], a[76:79], v[136:139], v[132:135]
 s_sub_u32 s80, s71, s80
 v_exp_f32 v165, v165
 mf v[140:143], a[76:79], v[168:171], v[140:143]
 s_waitcnt lgkmcnt(14)
 ds_read_b128 a[76:79], v112 offset:25600
 v_cvt_pk_bf16_f32 v212, v164, v165
 mf v[132:135], a[80:83], v[144:147], v[132:135]
 s_lshl_b32 s80, s80, 20
 v_exp_f32 v166, v166
 mf v[140:143], a[80:83], v[176:179], v[140:143]
 s_waitcnt lgkmcnt(14)
 ds_read_b128 a[80:83], v112 offset:26624
 mf v[132:135], a[84:87], v[152:155], v[132:135]
 v_exp_f32 v167, v167
 mf v[140:143], a[84:87], v[184:187], v[140:143]
 s_waitcnt lgkmcnt(14)
 ds_read_b128 a[84:87], v112 offset:27648
 v_cvt_pk_bf16_f32 v213, v166, v167
 mf a[0:3], a[88:91], v[196:199], a[0:3]
 v_exp_f32 v180, v180
 mf a[4:7], a[88:91], v[204:207], a[4:7]
 s_waitcnt lgkmcnt(14)
 ds_read_b128 a[88:91], v114 offset:24576
 v_add_u32 v21, s80, v7
 mf a[8:11], a[92:95], v[196:199], a[8:11]
 v_exp_f32 v181, v181
 mf a[12:15], a[92:95], v[204:207], a[12:15]
 s_waitcnt lgkmcnt(14)
 ds_read_b128 a[92:95], v114 offset:25600
 v_cvt_pk_bf16_f32 v214, v180, v181
 mf a[16:19], a[96:99], v[196:199], a[16:19]
 v_exp_f32 v182, v182
 mf a[20:23], a[96:99], v[204:207], a[20:23]
 s_waitcnt lgkmcnt(14)
 ds_read_b128 a[96:99], v114 offset:26624
 mf a[24:27], a[100:103], v[196:199], a[24:27]
 v_exp_f32 v183, v183
 mf a[28:31], a[100:103], v[204:207], a[28:31]
 s_waitcnt lgkmcnt(14)
 ds_read_b128 a[100:103], v114 offset:27648
 v_cvt_pk_bf16_f32 v215, v182, v183
 mf v[148:151], a[104:107], v[128:131], v[228:231]
 v_exp_f32 v172, v172
 mf v[156:159], a[104:107], v[160:163], v[236:239]
 s_waitcnt lgkmcnt(14)
 ds_read_b128 a[104:107], v112 offset:28672
 mf v[148:151], a[108:111], v[136:139], v[148:151]
 v_exp_f32 v173, v173
 mf v[156:159], a[108:111], v[168:171], v[156:159]
 s_waitcnt lgkmcnt(14)
 ds_read_b128 a[108:111], v112 offset:29696
 v_cvt_pk_bf16_f32 v220, v172, v173
 mf v[148:151], a[112:115], v[144:147], v[148:151]
 v_exp_f32 v174, v174
 mf v[156:159], a[112:115], v[176:179], v[156:159]
 s_waitcnt lgkmcnt(14)
 ds_read_b128 a[112:115], v112 offset:30720
 mf v[148:151], a[116:119], v[152:155], v[148:151]
 v_exp_f32 v175, v175
 mf v[156:159], a[116:119], v[184:187], v[156:159]
 s_waitcnt lgkmcnt(14)
 ds_read_b128 a[116:119], v112 offset:31744
 v_cvt_pk_bf16_f32 v221, v174, v175
 mf a[32:35], a[120:123], v[196:199], a[32:35]
 v_exp_f32 v188, v188
 mf a[36:39], a[120:123], v[204:207], a[36:39]
 s_waitcnt lgkmcnt(14)
 ds_read_b128 a[120:123], v114 offset:28672
 mf a[40:43], a[124:127], v[196:199], a[40:43]
 v_exp_f32 v189, v189
 mf a[44:47], a[124:127], v[204:207], a[44:47]
 s_waitcnt lgkmcnt(14)
 ds_read_b128 a[124:127], v114 offset:29696
 v_cvt_pk_bf16_f32 v222, v188, v189
 mf a[48:51], a[128:131], v[196:199], a[48:51]
 v_exp_f32 v190, v190
 mf a[52:55], a[128:131], v[204:207], a[52:55]
 s_waitcnt lgkmcnt(14)
 ds_read_b128 a[128:131], v114 offset:30720
 mf a[56:59], a[132:135], v[196:199], a[56:59]
 v_exp_f32 v191, v191
 mf a[60:63], a[132:135], v[204:207], a[60:63]
 s_waitcnt lgkmcnt(14)
 ds_read_b128 a[132:135], v114 offset:31744
 v_cvt_pk_bf16_f32 v223, v190, v191
 mf a[64:67], v[244:247], v[196:199], a[64:67]
 mf a[68:71], v[244:247], v[204:207], a[68:71]
 mf v[164:167], a[72:75], v[128:131], v[228:231]
 v_exp_f32 v132, v132
 mf v[172:175], a[72:75], v[160:163], v[236:239]
 s_waitcnt lgkmcnt(11)
 mf v[164:167], a[76:79], v[136:139], v[164:167]
 v_exp_f32 v133, v133
 mf v[172:175], a[76:79], v[168:171], v[172:175]
 v_cvt_pk_bf16_f32 v196, v132, v133
 mf v[164:167], a[80:83], v[144:147], v[164:167]
 v_exp_f32 v134, v134
 mf v[172:175], a[80:83], v[176:179], v[172:175]
 s_waitcnt vmcnt(1)
 s_waitcnt lgkmcnt(0)
 s_barrier
 mf v[164:167], a[84:87], v[152:155], v[164:167]
 s_add_u32 m0, s75, 0
 ds_read_b128 a[72:75], v113
 ds_read_b128 a[76:79], v113 offset:1024
 mf v[172:175], a[84:87], v[184:187], v[172:175]
 s_add_u32 s60, s77, 0
 ds_read_b128 a[80:83], v113 offset:2048
 ds_read_b128 a[84:87], v113 offset:3072
 mf a[0:3], a[88:91], v[212:215], a[0:3]
 v_exp_f32 v135, v135
 buffer_load_dwordx4 v4, s[36:39], s60 offen lds
 mf a[4:7], a[88:91], v[220:223], a[4:7]
 ds_read_b128 a[88:91], v115
 v_cvt_pk_bf16_f32 v197, v134, v135
 mf a[8:11], a[92:95], v[212:215], a[8:11]
 v_exp_f32 v148, v148
 mf a[12:15], a[92:95], v[220:223], a[12:15]
 ds_read_b128 a[92:95], v115 offset:1024
 buffer_load_dwordx4 v4, s[36:39], s60 offen offset:1024 lds
 mf a[16:19], a[96:99], v[212:215], a[16:19]
 v_exp_f32 v149, v149
 mf a[20:23], a[96:99], v[220:223], a[20:23]
 ds_read_b128 a[96:99], v115 offset:2048
 v_cvt_pk_bf16_f32 v198, v148, v149
 mf a[24:27], a[100:103], v[212:215], a[24:27]
 v_exp_f32 v150, v150
 mf a[28:31], a[100:103], v[220:223], a[28:31]
 ds_read_b128 a[100:103], v115 offset:3072
 buffer_load_dwordx4 v4, s[36:39], s60 offen offset:2048 lds
 mf v[180:183], a[104:107], v[128:131], v[228:231]
 v_exp_f32 v151, v151
 mf v[188:191], a[104:107], v[160:163], v[236:239]
 ds_read_b128 a[104:107], v113 offset:4096
 v_cvt_pk_bf16_f32 v199, v150, v151
 buffer_load_dwordx4 v4, s[36:39], s60 offen offset:3072 lds
 mf v[180:183], a[108:111], v[136:139], v[180:183]
 s_add_u32 m0, s75, 0x4000
 v_exp_f32 v140, v140
 mf v[188:191], a[108:111], v[168:171], v[188:191]
 s_add_u32 s60, s77, 0x8000
 ds_read_b128 a[108:111], v113 offset:5120
 v_xor_b32 v112, 0x8000, v112
 mf v[180:183], a[112:115], v[144:147], v[180:183]
 v_exp_f32 v141, v141
 buffer_load_dwordx4 v4, s[36:39], s60 offen lds
 mf v[188:191], a[112:115], v[176:179], v[188:191]
 ds_read_b128 a[112:115], v113 offset:6144
 v_cvt_pk_bf16_f32 v204, v140, v141
 mf v[180:183], a[116:119], v[152:155], v[180:183]
 v_exp_f32 v142, v142
 mf v[188:191], a[116:119], v[184:187], v[188:191]
 ds_read_b128 a[116:119], v113 offset:7168
 buffer_load_dwordx4 v4, s[36:39], s60 offen offset:1024 lds
 mf a[32:35], a[120:123], v[212:215], a[32:35]
 v_exp_f32 v143, v143
 mf a[36:39], a[120:123], v[220:223], a[36:39]
 ds_read_b128 a[120:123], v115 offset:4096
 v_cvt_pk_bf16_f32 v205, v142, v143
 mf a[40:43], a[124:127], v[212:215], a[40:43]
 v_exp_f32 v156, v156
 mf a[44:47], a[124:127], v[220:223], a[44:47]
 ds_read_b128 a[124:127], v115 offset:5120
 buffer_load_dwordx4 v4, s[36:39], s60 offen offset:2048 lds
 mf a[48:51], a[128:131], v[212:215], a[48:51]
 v_exp_f32 v157, v157
 mf a[52:55], a[128:131], v[220:223], a[52:55]
 ds_read_b128 a[128:131], v115 offset:6144
 v_cvt_pk_bf16_f32 v206, v156, v157
 buffer_load_dwordx4 v4, s[36:39], s60 offen offset:3072 lds
 mf a[56:59], a[132:135], v[212:215], a[56:59]
 s_add_u32 m0, s75, 0x10000
 v_exp_f32 v158, v158
 mf a[60:63], a[132:135], v[220:223], a[60:63]
 s_add_u32 s60, s76, 0xc000
 s_waitcnt lgkmcnt(14)
 ds_read_b128 a[132:135], v115 offset:7168
 v_xor_b32 v114, 0x8000, v114
 mf a[64:67], v[244:247], v[212:215], a[64:67]
 v_exp_f32 v159, v159
 mf a[68:71], v[244:247], v[220:223], a[68:71]
 v_cvt_pk_bf16_f32 v207, v158, v159
 buffer_load_dwordx4 v4, s[44:47], s60 offen lds
 mf v[132:135], a[72:75], v[128:131], v[228:231]
 v_exp_f32 v164, v164
 mf v[140:143], a[72:75], v[160:163], v[236:239]
 s_waitcnt lgkmcnt(14)
 ds_read_b128 a[72:75], v113 offset:8192
 buffer_load_dwordx4 v4, s[44:47], s60 offen offset:1024 lds
 mf v[132:135], a[76:79], v[136:139], v[132:135]
 v_exp_f32 v165, v165
 mf v[140:143], a[76:79], v[168:171], v[140:143]
 s_waitcnt lgkmcnt(14)
 ds_read_b128 a[76:79], v113 offset:9216
 v_cvt_pk_bf16_f32 v212, v164, v165
 mf v[132:135], a[80:83], v[144:147], v[132:135]
 v_exp_f32 v166, v166
 mf v[140:143], a[80:83], v[176:179], v[140:143]
 s_waitcnt lgkmcnt(14)
 ds_read_b128 a[80:83], v113 offset:10240
 buffer_load_dwordx4 v4, s[44:47], s60 offen offset:2048 lds
 mf v[132:135], a[84:87], v[152:155], v[132:135]
 v_exp_f32 v167, v167
 mf v[140:143], a[84:87], v[184:187], v[140:143]
 s_waitcnt lgkmcnt(14)
 ds_read_b128 a[84:87], v113 offset:11264
 v_cvt_pk_bf16_f32 v213, v166, v167
 buffer_load_dwordx4 v4, s[44:47], s60 offen offset:3072 lds
 mf a[0:3], a[88:91], v[196:199], a[0:3]
 s_add_u32 m0, s75, 0x14000
 v_exp_f32 v180, v180
 mf a[4:7], a[88:91], v[204:207], a[4:7]
 s_add_u32 s60, s77, 0x4000
 s_waitcnt lgkmcnt(14)
 ds_read_b128 a[88:91], v115 offset:8192
 mf a[8:11], a[92:95], v[196:199], a[8:11]
 v_exp_f32 v181, v181
 buffer_load_dwordx4 v4, s[36:39], s60 offen lds
 mf a[12:15], a[92:95], v[204:207], a[12:15]
 s_waitcnt lgkmcnt(14)
 ds_read_b128 a[92:95], v115 offset:9216
 v_cvt_pk_bf16_f32 v214, v180, v181
 mf a[16:19], a[96:99], v[196:199], a[16:19]
 v_exp_f32 v182, v182
 mf a[20:23], a[96:99], v[204:207], a[20:23]
 s_waitcnt lgkmcnt(14)
 ds_read_b128 a[96:99], v115 offset:10240
 buffer_load_dwordx4 v4, s[36:39], s60 offen offset:1024 lds
 mf a[24:27], a[100:103], v[196:199], a[24:27]
 v_exp_f32 v183, v183
 mf a[28:31], a[100:103], v[204:207], a[28:31]
 s_waitcnt lgkmcnt(14)
 ds_read_b128 a[100:103], v115 offset:11264
 v_cvt_pk_bf16_f32 v215, v182, v183
 mf v[148:151], a[104:107], v[128:131], v[228:231]
 v_exp_f32 v172, v172
 mf v[156:159], a[104:107], v[160:163], v[236:239]
 s_waitcnt lgkmcnt(14)
 ds_read_b128 a[104:107], v113 offset:12288
 buffer_load_dwordx4 v4, s[36:39], s60 offen offset:2048 lds
 mf v[148:151], a[108:111], v[136:139], v[148:151]
 v_exp_f32 v173, v173
 mf v[156:159], a[108:111], v[168:171], v[156:159]
 s_waitcnt lgkmcnt(14)
 ds_read_b128 a[108:111], v113 offset:13312
 v_cvt_pk_bf16_f32 v220, v172, v173
 buffer_load_dwordx4 v4, s[36:39], s60 offen offset:3072 lds
 mf v[148:151], a[112:115], v[144:147], v[148:151]
 s_xor_b32 s75, s75, 0x8000
 v_exp_f32 v174, v174
 mf v[156:159], a[112:115], v[176:179], v[156:159]
 s_waitcnt lgkmcnt(14)
 ds_read_b128 a[112:115], v113 offset:14336
 buffer_load_dword v20, v21, s[56:59], 0 offen
 mf v[148:151], a[116:119], v[152:155], v[148:151]
 s_add_u32 s71, s71, 1
 v_exp_f32 v175, v175
 mf v[156:159], a[116:119], v[184:187], v[156:159]
 s_waitcnt lgkmcnt(14)
 ds_read_b128 a[116:119], v113 offset:15360
 v_cvt_pk_bf16_f32 v221, v174, v175
 mf a[32:35], a[120:123], v[196:199], a[32:35]
 v_exp_f32 v188, v188
 mf a[36:39], a[120:123], v[204:207], a[36:39]
 s_waitcnt lgkmcnt(14)
 ds_read_b128 a[120:123], v115 offset:12288
 mf a[40:43], a[124:127], v[196:199], a[40:43]
 v_exp_f32 v189, v189
 mf a[44:47], a[124:127], v[204:207], a[44:47]
 s_waitcnt lgkmcnt(14)
 ds_read_b128 a[124:127], v115 offset:13312
 v_cvt_pk_bf16_f32 v222, v188, v189
 mf a[48:51], a[128:131], v[196:199], a[48:51]
 v_exp_f32 v190, v190
 mf a[52:55], a[128:131], v[204:207], a[52:55]
 s_waitcnt lgkmcnt(14)
 ds_read_b128 a[128:131], v115 offset:14336
 mf a[56:59], a[132:135], v[196:199], a[56:59]
 v_exp_f32 v191, v191
 mf a[60:63], a[132:135], v[204:207], a[60:63]
 s_waitcnt lgkmcnt(14)
 ds_read_b128 a[132:135], v115 offset:15360
 v_cvt_pk_bf16_f32 v223, v190, v191
 mf a[64:67], v[244:247], v[196:199], a[64:67]
 v_xor_b32 v113, 0x8000, v113
 v_xor_b32 v115, 0x8000, v115
 mf a[68:71], v[244:247], v[204:207], a[68:71]
 s_cmp_lg_u32 s73, 0
 s_cbranch_scc1 f_loop
f_last:
 s_lshr_b32 s30, s3, 1
 s_lshl_b32 s31, s79, 1
 s_add_u32 s30, s30, s31
 s_cmp_eq_u32 s30, 1
 s_cbranch_scc1 f_last0b
 s_cmp_eq_u32 s30, 2
 s_cbranch_scc1 f_last1a
 s_cmp_eq_u32 s30, 3
 s_cbranch_scc1 f_last1b
f_last0a:
 mf v[172:175], a[72:75], v[160:163], v[236:239]
 s_waitcnt lgkmcnt(11)
 v_min_f32 v132, v132, v32
 v_exp_f32 v132, v132
 mf v[172:175], a[76:79], v[168:171], v[172:175]
 ds_read_b128 a[72:75], v112 offset:16384
 mf v[172:175], a[80:83], v[176:179], v[172:175]
 s_mov_b32 s76, s77
 ds_read_b128 a[76:79], v112 offset:17408
 mf v[172:175], a[84:87], v[184:187], v[172:175]
 ds_read_b128 a[80:83], v112 offset:18432
 mf a[0:3], a[88:91], v[212:215], a[0:3]
 s_add_u32 s30, s71, 2
 ds_read_b128 a[84:87], v112 offset:19456
 mf a[4:7], a[88:91], v[220:223], a[4:7]
 s_waitcnt lgkmcnt(14)
 ds_read_b128 a[88:91], v114 offset:16384
 mf a[8:11], a[92:95], v[212:215], a[8:11]
 s_sub_u32 s31, s30, s72
 v_min_f32 v133, v133, v33
 v_exp_f32 v133, v133
 mf a[12:15], a[92:95], v[220:223], a[12:15]
 s_waitcnt lgkmcnt(14)
 ds_read_b128 a[92:95], v114 offset:17408
 v_cvt_pk_bf16_f32 v196, v132, v133
 mf a[16:19], a[96:99], v[212:215], a[16:19]
 s_cmp_lt_u32 s30, s72
 v_min_f32 v134, v134, v34
 v_exp_f32 v134, v134
 mf a[20:23], a[96:99], v[220:223], a[20:23]
 s_waitcnt lgkmcnt(14)
 ds_read_b128 a[96:99], v114 offset:18432
 mf a[24:27], a[100:103], v[212:215], a[24:27]
 s_cselect_b32 s31, s30, s31
 v_min_f32 v135, v135, v35
 v_exp_f32 v135, v135
 mf a[28:31], a[100:103], v[220:223], a[28:31]
 s_waitcnt lgkmcnt(14)
 ds_read_b128 a[100:103], v114 offset:19456
 v_cvt_pk_bf16_f32 v197, v134, v135
 mf v[188:191], a[104:107], v[160:163], v[236:239]
 s_waitcnt lgkmcnt(11)
 s_lshl_b32 s77, s31, 16
 v_min_f32 v148, v148, v40
 v_exp_f32 v148, v148
 mf v[188:191], a[108:111], v[168:171], v[188:191]
 ds_read_b128 a[104:107], v112 offset:20480
 mf v[188:191], a[112:115], v[176:179], v[188:191]
 s_add_u32 s77, s77, s74
 ds_read_b128 a[108:111], v112 offset:21504
 mf v[188:191], a[116:119], v[184:187], v[188:191]
 ds_read_b128 a[112:115], v112 offset:22528
 mf a[32:35], a[120:123], v[212:215], a[32:35]
 s_cmp_le_u32 s30, 16
 ds_read_b128 a[116:119], v112 offset:23552
 mf a[36:39], a[120:123], v[220:223], a[36:39]
 s_waitcnt lgkmcnt(14)
 ds_read_b128 a[120:123], v114 offset:20480
 mf a[40:43], a[124:127], v[212:215], a[40:43]
 s_cselect_b32 s38, 0x2000000, 0
 v_min_f32 v149, v149, v41
 v_exp_f32 v149, v149
 mf a[44:47], a[124:127], v[220:223], a[44:47]
 s_waitcnt lgkmcnt(14)
 ds_read_b128 a[124:127], v114 offset:21504
 v_cvt_pk_bf16_f32 v198, v148, v149
 mf a[48:51], a[128:131], v[212:215], a[48:51]
 s_cmp_le_u32 s30, 17
 v_min_f32 v150, v150, v42
 v_exp_f32 v150, v150
 mf a[52:55], a[128:131], v[220:223], a[52:55]
 s_waitcnt lgkmcnt(14)
 ds_read_b128 a[128:131], v114 offset:22528
 mf a[56:59], a[132:135], v[212:215], a[56:59]
 s_cselect_b32 s46, 0x2000000, 0
 v_min_f32 v151, v151, v43
 v_exp_f32 v151, v151
 mf a[60:63], a[132:135], v[220:223], a[60:63]
 s_waitcnt lgkmcnt(14)
 ds_read_b128 a[132:135], v114 offset:23552
 v_cvt_pk_bf16_f32 v199, v150, v151
 mf a[64:67], v[244:247], v[212:215], a[64:67]
 v_min_f32 v140, v140, v36
 v_exp_f32 v140, v140
 v_min_f32 v141, v141, v37
 v_exp_f32 v141, v141
 v_min_f32 v142, v142, v38
 v_exp_f32 v142, v142
 v_min_f32 v143, v143, v39
 v_exp_f32 v143, v143
 v_min_f32 v156, v156, v44
 v_exp_f32 v156, v156
 v_min_f32 v157, v157, v45
 v_exp_f32 v157, v157
 v_min_f32 v158, v158, v46
 v_exp_f32 v158, v158
 v_min_f32 v159, v159, v47
 v_exp_f32 v159, v159
 mf a[68:71], v[244:247], v[220:223], a[68:71]
 v_cvt_pk_bf16_f32 v204, v140, v141
 v_cvt_pk_bf16_f32 v205, v142, v143
 v_cvt_pk_bf16_f32 v206, v156, v157
 v_cvt_pk_bf16_f32 v207, v158, v159
 mf v[140:143], a[72:75], v[160:163], v[236:239]
 s_waitcnt lgkmcnt(11)
 v_min_f32 v172, v172, v52
 v_exp_f32 v172, v172
 mf v[140:143], a[76:79], v[168:171], v[140:143]
 ds_read_b128 a[72:75], v112 offset:24576
 mf v[140:143], a[80:83], v[176:179], v[140:143]
 ds_read_b128 a[76:79], v112 offset:25600
 mf v[140:143], a[84:87], v[184:187], v[140:143]
 ds_read_b128 a[80:83], v112 offset:26624
 mf a[0:3], a[88:91], v[196:199], a[0:3]
 ds_read_b128 a[84:87], v112 offset:27648
 mf a[4:7], a[88:91], v[204:207], a[4:7]
 s_waitcnt lgkmcnt(14)
 ds_read_b128 a[88:91], v114 offset:24576
 mf a[8:11], a[92:95], v[196:199], a[8:11]
 v_min_f32 v173, v173, v53
 v_exp_f32 v173, v173
 mf a[12:15], a[92:95], v[204:207], a[12:15]
 s_waitcnt lgkmcnt(14)
 ds_read_b128 a[92:95], v114 offset:25600
 v_cvt_pk_bf16_f32 v220, v172, v173
 mf a[16:19], a[96:99], v[196:199], a[16:19]
 v_min_f32 v174, v174, v54
 v_exp_f32 v174, v174
 mf a[20:23], a[96:99], v[204:207], a[20:23]
 s_waitcnt lgkmcnt(14)
 ds_read_b128 a[96:99], v114 offset:26624
 mf a[24:27], a[100:103], v[196:199], a[24:27]
 v_min_f32 v175, v175, v55
 v_exp_f32 v175, v175
 mf a[28:31], a[100:103], v[204:207], a[28:31]
 s_waitcnt lgkmcnt(14)
 ds_read_b128 a[100:103], v114 offset:27648
 v_cvt_pk_bf16_f32 v221, v174, v175
 mf v[156:159], a[104:107], v[160:163], v[236:239]
 s_waitcnt lgkmcnt(11)
 v_min_f32 v188, v188, v60
 v_exp_f32 v188, v188
 mf v[156:159], a[108:111], v[168:171], v[156:159]
 ds_read_b128 a[104:107], v112 offset:28672
 mf v[156:159], a[112:115], v[176:179], v[156:159]
 ds_read_b128 a[108:111], v112 offset:29696
 mf v[156:159], a[116:119], v[184:187], v[156:159]
 ds_read_b128 a[112:115], v112 offset:30720
 mf a[32:35], a[120:123], v[196:199], a[32:35]
 ds_read_b128 a[116:119], v112 offset:31744
 mf a[36:39], a[120:123], v[204:207], a[36:39]
 s_waitcnt lgkmcnt(14)
 ds_read_b128 a[120:123], v114 offset:28672
 mf a[40:43], a[124:127], v[196:199], a[40:43]
 v_min_f32 v189, v189, v61
 v_exp_f32 v189, v189
 mf a[44:47], a[124:127], v[204:207], a[44:47]
 s_waitcnt lgkmcnt(14)
 ds_read_b128 a[124:127], v114 offset:29696
 v_cvt_pk_bf16_f32 v222, v188, v189
 mf a[48:51], a[128:131], v[196:199], a[48:51]
 v_min_f32 v190, v190, v62
 v_exp_f32 v190, v190
 mf a[52:55], a[128:131], v[204:207], a[52:55]
 s_waitcnt lgkmcnt(14)
 ds_read_b128 a[128:131], v114 offset:30720
 mf a[56:59], a[132:135], v[196:199], a[56:59]
 v_min_f32 v191, v191, v63
 v_exp_f32 v191, v191
 mf a[60:63], a[132:135], v[204:207], a[60:63]
 s_waitcnt lgkmcnt(14)
 ds_read_b128 a[132:135], v114 offset:31744
 v_cvt_pk_bf16_f32 v223, v190, v191
 mf a[64:67], v[244:247], v[196:199], a[64:67]
 mf a[68:71], v[244:247], v[204:207], a[68:71]
 mf v[172:175], a[72:75], v[160:163], v[236:239]
 s_waitcnt lgkmcnt(11)
 v_min_f32 v140, v140, v64
 v_exp_f32 v140, v140
 mf v[172:175], a[76:79], v[168:171], v[172:175]
 mf v[172:175], a[80:83], v[176:179], v[172:175]
 v_min_f32 v141, v141, v65
 v_exp_f32 v141, v141
 mf v[172:175], a[84:87], v[184:187], v[172:175]
 v_cvt_pk_bf16_f32 v204, v140, v141
 mf a[4:7], a[88:91], v[220:223], a[4:7]
 s_waitcnt lgkmcnt(7)
 v_min_f32 v142, v142, v66
 v_exp_f32 v142, v142
 mf a[12:15], a[92:95], v[220:223], a[12:15]
 s_waitcnt vmcnt(1)
 s_waitcnt lgkmcnt(0)
 s_barrier
 mf a[20:23], a[96:99], v[220:223], a[20:23]
 ds_read_b128 a[88:91], v115
 ds_read_b128 a[92:95], v115 offset:1024
 mf a[28:31], a[100:103], v[220:223], a[28:31]
 ds_read_b128 a[96:99], v115 offset:2048
 s_add_u32 m0, s75, 0
 s_add_u32 s60, s77, 0
 buffer_load_dwordx4 v4, s[36:39], s60 offen lds
 mf v[188:191], a[104:107], v[160:163], v[236:239]
 ds_read_b128 a[100:103], v115 offset:3072
 buffer_load_dwordx4 v4, s[36:39], s60 offen offset:1024 lds
 mf v[188:191], a[108:111], v[168:171], v[188:191]
 v_min_f32 v143, v143, v67
 v_exp_f32 v143, v143
 buffer_load_dwordx4 v4, s[36:39], s60 offen offset:2048 lds
 mf v[188:191], a[112:115], v[176:179], v[188:191]
 v_cvt_pk_bf16_f32 v205, v142, v143
 buffer_load_dwordx4 v4, s[36:39], s60 offen offset:3072 lds
 mf v[188:191], a[116:119], v[184:187], v[188:191]
 v_min_f32 v156, v156, v68
 v_exp_f32 v156, v156
 s_add_u32 m0, s75, 0x4000
 s_add_u32 s60, s77, 0x8000
 buffer_load_dwordx4 v4, s[36:39], s60 offen lds
 mf a[36:39], a[120:123], v[220:223], a[36:39]
 buffer_load_dwordx4 v4, s[36:39], s60 offen offset:1024 lds
 v_xor_b32 v112, 0x8000, v112
 mf a[44:47], a[124:127], v[220:223], a[44:47]
 ds_read_b128 a[120:123], v115 offset:4096
 buffer_load_dwordx4 v4, s[36:39], s60 offen offset:2048 lds
 mf a[52:55], a[128:131], v[220:223], a[52:55]
 ds_read_b128 a[124:127], v115 offset:5120
 buffer_load_dwordx4 v4, s[36:39], s60 offen offset:3072 lds
 mf a[60:63], a[132:135], v[220:223], a[60:63]
 ds_read_b128 a[128:131], v115 offset:6144
 v_min_f32 v157, v157, v69
 v_exp_f32 v157, v157
 v_min_f32 v158, v158, v70
 v_exp_f32 v158, v158
 v_min_f32 v159, v159, v71
 v_exp_f32 v159, v159
 s_add_u32 m0, s75, 0x10000
 s_add_u32 s60, s76, 0xc000
 buffer_load_dwordx4 v4, s[44:47], s60 offen lds
 mf a[68:71], v[244:247], v[220:223], a[68:71]
 s_waitcnt lgkmcnt(3)
 ds_read_b128 a[132:135], v115 offset:7168
 v_cvt_pk_bf16_f32 v206, v156, v157
 v_cvt_pk_bf16_f32 v207, v158, v159
 buffer_load_dwordx4 v4, s[44:47], s60 offen offset:1024 lds
 s_nop 0
 mf a[4:7], a[88:91], v[204:207], a[4:7]
 v_min_f32 v172, v172, v72
 v_exp_f32 v172, v172
 buffer_load_dwordx4 v4, s[44:47], s60 offen offset:2048 lds
 mf a[12:15], a[92:95], v[204:207], a[12:15]
 ds_read_b128 a[88:91], v115 offset:8192
 buffer_load_dwordx4 v4, s[44:47], s60 offen offset:3072 lds
 mf a[20:23], a[96:99], v[204:207], a[20:23]
 ds_read_b128 a[92:95], v115 offset:9216
 s_add_u32 m0, s75, 0x14000
 s_add_u32 s60, s77, 0x4000
 buffer_load_dwordx4 v4, s[36:39], s60 offen lds
 mf a[28:31], a[100:103], v[204:207], a[28:31]
 s_waitcnt lgkmcnt(5)
 ds_read_b128 a[96:99], v115 offset:10240
 buffer_load_dwordx4 v4, s[36:39], s60 offen offset:1024 lds
 mf a[36:39], a[120:123], v[204:207], a[36:39]
 s_waitcnt lgkmcnt(5)
 ds_read_b128 a[100:103], v115 offset:11264
 buffer_load_dwordx4 v4, s[36:39], s60 offen offset:2048 lds
 mf a[44:47], a[124:127], v[204:207], a[44:47]
 s_waitcnt lgkmcnt(5)
 ds_read_b128 a[120:123], v115 offset:12288
 buffer_load_dwordx4 v4, s[36:39], s60 offen offset:3072 lds
 mf a[52:55], a[128:131], v[204:207], a[52:55]
 s_waitcnt lgkmcnt(5)
 ds_read_b128 a[124:127], v115 offset:13312
 v_xor_b32 v114, 0x8000, v114
 mf a[60:63], a[132:135], v[204:207], a[60:63]
 ds_read_b128 a[128:131], v115 offset:14336
 v_min_f32 v173, v173, v73
 v_exp_f32 v173, v173
 v_min_f32 v174, v174, v74
 v_exp_f32 v174, v174
 v_min_f32 v175, v175, v75
 v_exp_f32 v175, v175
 v_min_f32 v188, v188, v76
 v_exp_f32 v188, v188
 v_min_f32 v189, v189, v77
 v_exp_f32 v189, v189
 v_min_f32 v190, v190, v78
 v_exp_f32 v190, v190
 v_min_f32 v191, v191, v79
 v_exp_f32 v191, v191
 mf a[68:71], v[244:247], v[204:207], a[68:71]
 s_waitcnt lgkmcnt(5)
 ds_read_b128 a[132:135], v115 offset:15360
 v_cvt_pk_bf16_f32 v220, v172, v173
 v_cvt_pk_bf16_f32 v221, v174, v175
 v_cvt_pk_bf16_f32 v222, v188, v189
 v_cvt_pk_bf16_f32 v223, v190, v191
 s_nop 1
 mf a[4:7], a[88:91], v[220:223], a[4:7]
 mf a[12:15], a[92:95], v[220:223], a[12:15]
 s_waitcnt lgkmcnt(5)
 mf a[20:23], a[96:99], v[220:223], a[20:23]
 s_waitcnt lgkmcnt(4)
 mf a[28:31], a[100:103], v[220:223], a[28:31]
 s_waitcnt lgkmcnt(3)
 mf a[36:39], a[120:123], v[220:223], a[36:39]
 s_waitcnt lgkmcnt(2)
 mf a[44:47], a[124:127], v[220:223], a[44:47]
 s_waitcnt lgkmcnt(1)
 mf a[52:55], a[128:131], v[220:223], a[52:55]
 s_waitcnt lgkmcnt(0)
 mf a[60:63], a[132:135], v[220:223], a[60:63]
 mf a[68:71], v[244:247], v[220:223], a[68:71]
 v_xor_b32 v113, 0x8000, v113
 v_xor_b32 v115, 0x8000, v115
 s_xor_b32 s75, s75, 0x8000
 s_add_u32 s71, s71, 1
 v_accvgpr_read_b32 v28, a64
 s_nop 2
 v_accvgpr_read_b32 v29, a68
 v_mov_b32 v30, 0x4e800000
 v_cmp_nle_f32 vcc, v28, v30
 s_nop 3
 s_mov_b64 s[30:31], vcc
 v_cmp_nle_f32 vcc, v29, v30
 s_nop 3
 s_or_b64 vcc, vcc, s[30:31]
 s_nop 4
 s_cbranch_vccnz f_last0a_x
f_last0a_ok:
 s_branch f_sig
f_last0b:
 mf v[164:167], a[72:75], v[128:131], v[228:231]
 v_min_f32 v132, v132, v32
 v_exp_f32 v132, v132
 mf v[172:175], a[72:75], v[160:163], v[236:239]
 s_waitcnt lgkmcnt(14)
 ds_read_b128 a[72:75], v112 offset:16384
 mf v[164:167], a[76:79], v[136:139], v[164:167]
 s_mov_b32 s76, s77
 v_min_f32 v133, v133, v33
 v_exp_f32 v133, v133
 mf v[172:175], a[76:79], v[168:171], v[172:175]
 s_waitcnt lgkmcnt(14)
 ds_read_b128 a[76:79], v112 offset:17408
 v_cvt_pk_bf16_f32 v196, v132, v133
 mf v[164:167], a[80:83], v[144:147], v[164:167]
 s_add_u32 s30, s71, 2
 v_min_f32 v134, v134, v34
 v_exp_f32 v134, v134
 mf v[172:175], a[80:83], v[176:179], v[172:175]
 s_waitcnt lgkmcnt(14)
 ds_read_b128 a[80:83], v112 offset:18432
 mf v[164:167], a[84:87], v[152:155], v[164:167]
 s_sub_u32 s31, s30, s72
 v_min_f32 v135, v135, v35
 v_exp_f32 v135, v135
 mf v[172:175], a[84:87], v[184:187], v[172:175]
 s_waitcnt lgkmcnt(14)
 ds_read_b128 a[84:87], v112 offset:19456
 v_cvt_pk_bf16_f32 v197, v134, v135
 mf a[0:3], a[88:91], v[212:215], a[0:3]
 s_cmp_lt_u32 s30, s72
 v_min_f32 v148, v148, v40
 v_exp_f32 v148, v148
 mf a[4:7], a[88:91], v[220:223], a[4:7]
 s_waitcnt lgkmcnt(14)
 ds_read_b128 a[88:91], v114 offset:16384
 mf a[8:11], a[92:95], v[212:215], a[8:11]
 s_cselect_b32 s31, s30, s31
 v_min_f32 v149, v149, v41
 v_exp_f32 v149, v149
 mf a[12:15], a[92:95], v[220:223], a[12:15]
 s_waitcnt lgkmcnt(14)
 ds_read_b128 a[92:95], v114 offset:17408
 v_cvt_pk_bf16_f32 v198, v148, v149
 mf a[16:19], a[96:99], v[212:215], a[16:19]
 s_lshl_b32 s77, s31, 16
 v_min_f32 v150, v150, v42
 v_exp_f32 v150, v150
 mf a[20:23], a[96:99], v[220:223], a[20:23]
 s_waitcnt lgkmcnt(14)
 ds_read_b128 a[96:99], v114 offset:18432
 mf a[24:27], a[100:103], v[212:215], a[24:27]
 s_add_u32 s77, s77, s74
 v_min_f32 v151, v151, v43
 v_exp_f32 v151, v151
 mf a[28:31], a[100:103], v[220:223], a[28:31]
 s_waitcnt lgkmcnt(14)
 ds_read_b128 a[100:103], v114 offset:19456
 v_cvt_pk_bf16_f32 v199, v150, v151
 mf v[180:183], a[104:107], v[128:131], v[228:231]
 s_cmp_le_u32 s30, 16
 v_min_f32 v140, v140, v36
 v_exp_f32 v140, v140
 mf v[188:191], a[104:107], v[160:163], v[236:239]
 s_waitcnt lgkmcnt(14)
 ds_read_b128 a[104:107], v112 offset:20480
 mf v[180:183], a[108:111], v[136:139], v[180:183]
 s_cselect_b32 s38, 0x2000000, 0
 v_min_f32 v141, v141, v37
 v_exp_f32 v141, v141
 mf v[188:191], a[108:111], v[168:171], v[188:191]
 s_waitcnt lgkmcnt(14)
 ds_read_b128 a[108:111], v112 offset:21504
 v_cvt_pk_bf16_f32 v204, v140, v141
 mf v[180:183], a[112:115], v[144:147], v[180:183]
 s_cmp_le_u32 s30, 17
 v_min_f32 v142, v142, v38
 v_exp_f32 v142, v142
 mf v[188:191], a[112:115], v[176:179], v[188:191]
 s_waitcnt lgkmcnt(14)
 ds_read_b128 a[112:115], v112 offset:22528
 mf v[180:183], a[116:119], v[152:155], v[180:183]
 s_cselect_b32 s46, 0x2000000, 0
 v_min_f32 v143, v143, v39
 v_exp_f32 v143, v143
 mf v[188:191], a[116:119], v[184:187], v[188:191]
 s_waitcnt lgkmcnt(14)
 ds_read_b128 a[116:119], v112 offset:23552
 v_cvt_pk_bf16_f32 v205, v142, v143
 mf a[32:35], a[120:123], v[212:215], a[32:35]
 v_min_f32 v156, v156, v44
 v_exp_f32 v156, v156
 mf a[36:39], a[120:123], v[220:223], a[36:39]
 s_waitcnt lgkmcnt(14)
 ds_read_b128 a[120:123], v114 offset:20480
 mf a[40:43], a[124:127], v[212:215], a[40:43]
 v_min_f32 v157, v157, v45
 v_exp_f32 v157, v157
 mf a[44:47], a[124:127], v[220:223], a[44:47]
 s_waitcnt lgkmcnt(14)
 ds_read_b128 a[124:127], v114 offset:21504
 v_cvt_pk_bf16_f32 v206, v156, v157
 mf a[48:51], a[128:131], v[212:215], a[48:51]
 v_min_f32 v158, v158, v46
 v_exp_f32 v158, v158
 mf a[52:55], a[128:131], v[220:223], a[52:55]
 s_waitcnt lgkmcnt(14)
 ds_read_b128 a[128:131], v114 offset:22528
 mf a[56:59], a[132:135], v[212:215], a[56:59]
 v_min_f32 v159, v159, v47
 v_exp_f32 v159, v159
 mf a[60:63], a[132:135], v[220:223], a[60:63]
 s_waitcnt lgkmcnt(14)
 ds_read_b128 a[132:135], v114 offset:23552
 v_cvt_pk_bf16_f32 v207, v158, v159
 mf a[64:67], v[244:247], v[212:215], a[64:67]
 mf a[68:71], v[244:247], v[220:223], a[68:71]
 mf v[140:143], a[72:75], v[160:163], v[236:239]
 s_waitcnt lgkmcnt(11)
 v_min_f32 v164, v164, v48
 v_exp_f32 v164, v164
 mf v[140:143], a[76:79], v[168:171], v[140:143]
 v_min_f32 v165, v165, v49
 v_exp_f32 v165, v165
 mf v[140:143], a[80:83], v[176:179], v[140:143]
 v_min_f32 v166, v166, v50
 v_exp_f32 v166, v166
 mf v[140:143], a[84:87], v[184:187], v[140:143]
 v_min_f32 v167, v167, v51
 v_exp_f32 v167, v167
 mf a[0:3], a[88:91], v[196:199], a[0:3]
 v_min_f32 v180, v180, v56
 v_exp_f32 v180, v180
 mf a[4:7], a[88:91], v[204:207], a[4:7]
 s_waitcnt lgkmcnt(7)
 ds_read_b128 a[88:91], v114 offset:24576
 v_cvt_pk_bf16_f32 v212, v164, v165
 mf a[8:11], a[92:95], v[196:199], a[8:11]
 v_min_f32 v181, v181, v57
 v_exp_f32 v181, v181
 mf a[12:15], a[92:95], v[204:207], a[12:15]
 ds_read_b128 a[92:95], v114 offset:25600
 v_cvt_pk_bf16_f32 v213, v166, v167
 mf a[16:19], a[96:99], v[196:199], a[16:19]
 v_min_f32 v182, v182, v58
 v_exp_f32 v182, v182
 mf a[20:23], a[96:99], v[204:207], a[20:23]
 ds_read_b128 a[96:99], v114 offset:26624
 v_cvt_pk_bf16_f32 v214, v180, v181
 mf a[24:27], a[100:103], v[196:199], a[24:27]
 v_min_f32 v183, v183, v59
 v_exp_f32 v183, v183
 mf a[28:31], a[100:103], v[204:207], a[28:31]
 ds_read_b128 a[100:103], v114 offset:27648
 v_cvt_pk_bf16_f32 v215, v182, v183
 mf v[156:159], a[104:107], v[160:163], v[236:239]
 s_waitcnt lgkmcnt(7)
 v_min_f32 v172, v172, v52
 v_exp_f32 v172, v172
 mf v[156:159], a[108:111], v[168:171], v[156:159]
 v_min_f32 v173, v173, v53
 v_exp_f32 v173, v173
 mf v[156:159], a[112:115], v[176:179], v[156:159]
 v_min_f32 v174, v174, v54
 v_exp_f32 v174, v174
 mf v[156:159], a[116:119], v[184:187], v[156:159]
 v_min_f32 v175, v175, v55
 v_exp_f32 v175, v175
 mf a[32:35], a[120:123], v[196:199], a[32:35]
 v_min_f32 v188, v188, v60
 v_exp_f32 v188, v188
 mf a[36:39], a[120:123], v[204:207], a[36:39]
 s_waitcnt lgkmcnt(3)
 ds_read_b128 a[120:123], v114 offset:28672
 v_cvt_pk_bf16_f32 v220, v172, v173
 mf a[40:43], a[124:127], v[196:199], a[40:43]
 v_min_f32 v189, v189, v61
 v_exp_f32 v189, v189
 mf a[44:47], a[124:127], v[204:207], a[44:47]
 ds_read_b128 a[124:127], v114 offset:29696
 v_cvt_pk_bf16_f32 v221, v174, v175
 mf a[48:51], a[128:131], v[196:199], a[48:51]
 v_min_f32 v190, v190, v62
 v_exp_f32 v190, v190
 mf a[52:55], a[128:131], v[204:207], a[52:55]
 ds_read_b128 a[128:131], v114 offset:30720
 v_cvt_pk_bf16_f32 v222, v188, v189
 mf a[56:59], a[132:135], v[196:199], a[56:59]
 v_min_f32 v191, v191, v63
 v_exp_f32 v191, v191
 mf a[60:63], a[132:135], v[204:207], a[60:63]
 ds_read_b128 a[132:135], v114 offset:31744
 v_cvt_pk_bf16_f32 v223, v190, v191
 mf a[64:67], v[244:247], v[196:199], a[64:67]
 mf a[68:71], v[244:247], v[204:207], a[68:71]
 mf a[0:3], a[88:91], v[212:215], a[0:3]
 v_min_f32 v140, v140, v64
 v_exp_f32 v140, v140
 mf a[4:7], a[88:91], v[220:223], a[4:7]
 s_waitcnt lgkmcnt(4)
 mf a[8:11], a[92:95], v[212:215], a[8:11]
 v_min_f32 v141, v141, v65
 v_exp_f32 v141, v141
 mf a[12:15], a[92:95], v[220:223], a[12:15]
 v_cvt_pk_bf16_f32 v204, v140, v141
 mf a[16:19], a[96:99], v[212:215], a[16:19]
 v_min_f32 v142, v142, v66
 v_exp_f32 v142, v142
 mf a[20:23], a[96:99], v[220:223], a[20:23]
 s_waitcnt vmcnt(1)
 s_waitcnt lgkmcnt(0)
 s_barrier
 mf a[24:27], a[100:103], v[212:215], a[24:27]
 ds_read_b128 a[88:91], v115
 ds_read_b128 a[92:95], v115 offset:1024
 mf a[28:31], a[100:103], v[220:223], a[28:31]
 ds_read_b128 a[96:99], v115 offset:2048
 ds_read_b128 a[100:103], v115 offset:3072
 s_add_u32 m0, s75, 0
 s_add_u32 s60, s77, 0
 buffer_load_dwordx4 v4, s[36:39], s60 offen lds
 mf a[32:35], a[120:123], v[212:215], a[32:35]
 v_min_f32 v143, v143, v67
 v_exp_f32 v143, v143
 buffer_load_dwordx4 v4, s[36:39], s60 offen offset:1024 lds
 mf a[36:39], a[120:123], v[220:223], a[36:39]
 ds_read_b128 a[120:123], v115 offset:4096
 v_cvt_pk_bf16_f32 v205, v142, v143
 buffer_load_dwordx4 v4, s[36:39], s60 offen offset:2048 lds
 mf a[40:43], a[124:127], v[212:215], a[40:43]
 v_min_f32 v156, v156, v68
 v_exp_f32 v156, v156
 buffer_load_dwordx4 v4, s[36:39], s60 offen offset:3072 lds
 mf a[44:47], a[124:127], v[220:223], a[44:47]
 ds_read_b128 a[124:127], v115 offset:5120
 s_add_u32 m0, s75, 0x4000
 s_add_u32 s60, s77, 0x8000
 buffer_load_dwordx4 v4, s[36:39], s60 offen lds
 mf a[48:51], a[128:131], v[212:215], a[48:51]
 v_min_f32 v157, v157, v69
 v_exp_f32 v157, v157
 buffer_load_dwordx4 v4, s[36:39], s60 offen offset:1024 lds
 mf a[52:55], a[128:131], v[220:223], a[52:55]
 ds_read_b128 a[128:131], v115 offset:6144
 v_cvt_pk_bf16_f32 v206, v156, v157
 buffer_load_dwordx4 v4, s[36:39], s60 offen offset:2048 lds
 mf a[56:59], a[132:135], v[212:215], a[56:59]
 v_min_f32 v158, v158, v70
 v_exp_f32 v158, v158
 buffer_load_dwordx4 v4, s[36:39], s60 offen offset:3072 lds
 mf a[60:63], a[132:135], v[220:223], a[60:63]
 ds_read_b128 a[132:135], v115 offset:7168
 s_add_u32 m0, s75, 0x10000
 s_add_u32 s60, s76, 0xc000
 buffer_load_dwordx4 v4, s[44:47], s60 offen lds
 mf a[64:67], v[244:247], v[212:215], a[64:67]
 v_min_f32 v159, v159, v71
 v_exp_f32 v159, v159
 buffer_load_dwordx4 v4, s[44:47], s60 offen offset:1024 lds
 mf a[68:71], v[244:247], v[220:223], a[68:71]
 s_waitcnt lgkmcnt(4)
 v_cvt_pk_bf16_f32 v207, v158, v159
 buffer_load_dwordx4 v4, s[44:47], s60 offen offset:2048 lds
 s_nop 0
 mf a[4:7], a[88:91], v[204:207], a[4:7]
 buffer_load_dwordx4 v4, s[44:47], s60 offen offset:3072 lds
 v_xor_b32 v112, 0x8000, v112
 mf a[12:15], a[92:95], v[204:207], a[12:15]
 s_add_u32 m0, s75, 0x14000
 s_add_u32 s60, s77, 0x4000
 buffer_load_dwordx4 v4, s[36:39], s60 offen lds
 v_xor_b32 v114, 0x8000, v114
 mf a[20:23], a[96:99], v[204:207], a[20:23]
 buffer_load_dwordx4 v4, s[36:39], s60 offen offset:1024 lds
 mf a[28:31], a[100:103], v[204:207], a[28:31]
 s_waitcnt lgkmcnt(2)
 buffer_load_dwordx4 v4, s[36:39], s60 offen offset:2048 lds
 mf a[36:39], a[120:123], v[204:207], a[36:39]
 buffer_load_dwordx4 v4, s[36:39], s60 offen offset:3072 lds
 mf a[44:47], a[124:127], v[204:207], a[44:47]
 s_waitcnt lgkmcnt(1)
 mf a[52:55], a[128:131], v[204:207], a[52:55]
 s_waitcnt lgkmcnt(0)
 mf a[60:63], a[132:135], v[204:207], a[60:63]
 mf a[68:71], v[244:247], v[204:207], a[68:71]
 v_xor_b32 v113, 0x8000, v113
 v_xor_b32 v115, 0x8000, v115
 s_xor_b32 s75, s75, 0x8000
 s_add_u32 s71, s71, 1
 v_accvgpr_read_b32 v28, a64
 s_nop 2
 v_accvgpr_read_b32 v29, a68
 v_mov_b32 v30, 0x4e800000
 v_cmp_nle_f32 vcc, v28, v30
 s_nop 3
 s_mov_b64 s[30:31], vcc
 v_cmp_nle_f32 vcc, v29, v30
 s_nop 3
 s_or_b64 vcc, vcc, s[30:31]
 s_nop 4
 s_cbranch_vccnz f_last0b_x
f_last0b_ok:
 s_branch f_sig
f_last1a:
 mf v[172:175], a[72:75], v[160:163], v[236:239]
 s_waitcnt lgkmcnt(11)
 v_min_f32 v132, v132, v32
 v_exp_f32 v132, v132
 mf v[172:175], a[76:79], v[168:171], v[172:175]
 ds_read_b128 a[72:75], v112 offset:16384
 mf v[172:175], a[80:83], v[176:179], v[172:175]
 ds_read_b128 a[76:79], v112 offset:17408
 mf v[172:175], a[84:87], v[184:187], v[172:175]
 ds_read_b128 a[80:83], v112 offset:18432
 mf a[0:3], a[88:91], v[212:215], a[0:3]
 ds_read_b128 a[84:87], v112 offset:19456
 v_cmp_eq_u32 vcc, v6, v27
 s_nop 3
 s_cmp_eq_u64 vcc, -1
 s_cbranch_scc0 f_ha_spin
f_ha_ok:
 mf a[4:7], a[88:91], v[220:223], a[4:7]
 s_waitcnt lgkmcnt(14)
 ds_read_b128 a[88:91], v114 offset:16384
 s_add_u32 s63, s91, 0
 s_add_u32 m0, s83, 0x20000
 s_nop 0
 buffer_load_dwordx4 v22, s[32:35], s63 offen lds
 mf a[8:11], a[92:95], v[212:215], a[8:11]
 v_min_f32 v133, v133, v33
 v_exp_f32 v133, v133
 s_add_u32 m0, s83, 0x20400
 s_nop 0
 buffer_load_dwordx4 v23, s[32:35], s63 offen lds
 mf a[12:15], a[92:95], v[220:223], a[12:15]
 s_waitcnt lgkmcnt(14)
 ds_read_b128 a[92:95], v114 offset:17408
 v_cvt_pk_bf16_f32 v196, v132, v133
 mf a[16:19], a[96:99], v[212:215], a[16:19]
 v_min_f32 v134, v134, v34
 v_exp_f32 v134, v134
 s_add_u32 m0, s83, 0x20800
 s_nop 0
 buffer_load_dwordx4 v24, s[32:35], s63 offen lds
 mf a[20:23], a[96:99], v[220:223], a[20:23]
 s_waitcnt lgkmcnt(14)
 ds_read_b128 a[96:99], v114 offset:18432
 mf a[24:27], a[100:103], v[212:215], a[24:27]
 v_min_f32 v135, v135, v35
 v_exp_f32 v135, v135
 s_add_u32 m0, s83, 0x20c00
 s_nop 0
 buffer_load_dwordx4 v25, s[32:35], s63 offen lds
 mf a[28:31], a[100:103], v[220:223], a[28:31]
 s_waitcnt lgkmcnt(14)
 ds_read_b128 a[100:103], v114 offset:19456
 v_cvt_pk_bf16_f32 v197, v134, v135
 s_add_u32 m0, s83, 0x21000
 s_nop 0
 buffer_load_dwordx4 v26, s[32:35], s63 offen lds
 mf v[188:191], a[104:107], v[160:163], v[236:239]
 s_waitcnt lgkmcnt(11)
 v_min_f32 v148, v148, v40
 v_exp_f32 v148, v148
 mf v[188:191], a[108:111], v[168:171], v[188:191]
 ds_read_b128 a[104:107], v112 offset:20480
 s_add_u32 s61, s84, 0
 buffer_load_dwordx4 a[136:139], v4, s[40:43], s61 offen
 mf v[188:191], a[112:115], v[176:179], v[188:191]
 ds_read_b128 a[108:111], v112 offset:21504
 mf v[188:191], a[116:119], v[184:187], v[188:191]
 ds_read_b128 a[112:115], v112 offset:22528
 s_add_u32 s61, s84, s17
 s_add_u32 s61, s61, 0
 buffer_load_dwordx4 a[140:143], v4, s[40:43], s61 offen
 mf a[32:35], a[120:123], v[212:215], a[32:35]
 ds_read_b128 a[116:119], v112 offset:23552
 mf a[36:39], a[120:123], v[220:223], a[36:39]
 s_waitcnt lgkmcnt(14)
 ds_read_b128 a[120:123], v114 offset:20480
 s_add_u32 s61, s85, 0
 buffer_load_dwordx4 a[144:147], v4, s[40:43], s61 offen
 mf a[40:43], a[124:127], v[212:215], a[40:43]
 v_min_f32 v149, v149, v41
 v_exp_f32 v149, v149
 s_add_u32 s61, s85, s17
 s_add_u32 s61, s61, 0
 buffer_load_dwordx4 a[148:151], v4, s[40:43], s61 offen
 mf a[44:47], a[124:127], v[220:223], a[44:47]
 s_waitcnt lgkmcnt(14)
 ds_read_b128 a[124:127], v114 offset:21504
 v_cvt_pk_bf16_f32 v198, v148, v149
 mf a[48:51], a[128:131], v[212:215], a[48:51]
 v_min_f32 v150, v150, v42
 v_exp_f32 v150, v150
 s_add_u32 s61, s84, 0
 buffer_load_dwordx4 a[152:155], v4, s[40:43], s61 offen offset:1024
 mf a[52:55], a[128:131], v[220:223], a[52:55]
 s_waitcnt lgkmcnt(14)
 ds_read_b128 a[128:131], v114 offset:22528
 mf a[56:59], a[132:135], v[212:215], a[56:59]
 v_min_f32 v151, v151, v43
 v_exp_f32 v151, v151
 s_add_u32 s61, s84, s17
 s_add_u32 s61, s61, 0
 buffer_load_dwordx4 a[156:159], v4, s[40:43], s61 offen offset:1024
 mf a[60:63], a[132:135], v[220:223], a[60:63]
 s_waitcnt lgkmcnt(14)
 ds_read_b128 a[132:135], v114 offset:23552
 v_cvt_pk_bf16_f32 v199, v150, v151
 s_add_u32 s61, s85, 0
 buffer_load_dwordx4 a[160:163], v4, s[40:43], s61 offen offset:1024
 mf a[64:67], v[244:247], v[212:215], a[64:67]
 v_min_f32 v140, v140, v36
 v_exp_f32 v140, v140
 v_min_f32 v141, v141, v37
 v_exp_f32 v141, v141
 v_min_f32 v142, v142, v38
 v_exp_f32 v142, v142
 v_min_f32 v143, v143, v39
 v_exp_f32 v143, v143
 v_min_f32 v156, v156, v44
 v_exp_f32 v156, v156
 v_min_f32 v157, v157, v45
 v_exp_f32 v157, v157
 v_min_f32 v158, v158, v46
 v_exp_f32 v158, v158
 v_min_f32 v159, v159, v47
 v_exp_f32 v159, v159
 mf a[68:71], v[244:247], v[220:223], a[68:71]
 v_cvt_pk_bf16_f32 v204, v140, v141
 v_cvt_pk_bf16_f32 v205, v142, v143
 v_cvt_pk_bf16_f32 v206, v156, v157
 v_cvt_pk_bf16_f32 v207, v158, v159
 s_add_u32 s61, s85, s17
 s_add_u32 s61, s61, 0
 buffer_load_dwordx4 a[164:167], v4, s[40:43], s61 offen offset:1024
 mf v[140:143], a[72:75], v[160:163], v[236:239]
 s_waitcnt lgkmcnt(11)
 v_min_f32 v172, v172, v52
 v_exp_f32 v172, v172
 mf v[140:143], a[76:79], v[168:171], v[140:143]
 ds_read_b128 a[72:75], v112 offset:24576
 s_add_u32 s61, s84, 0x800
 buffer_load_dwordx4 a[168:171], v4, s[40:43], s61 offen
 mf v[140:143], a[80:83], v[176:179], v[140:143]
 ds_read_b128 a[76:79], v112 offset:25600
 mf v[140:143], a[84:87], v[184:187], v[140:143]
 ds_read_b128 a[80:83], v112 offset:26624
 s_add_u32 s61, s84, s17
 s_add_u32 s61, s61, 0x800
 buffer_load_dwordx4 a[172:175], v4, s[40:43], s61 offen
 mf a[0:3], a[88:91], v[196:199], a[0:3]
 ds_read_b128 a[84:87], v112 offset:27648
 s_add_u32 s61, s85, 0x800
 buffer_load_dwordx4 a[176:179], v4, s[40:43], s61 offen
 mf a[4:7], a[88:91], v[204:207], a[4:7]
 s_waitcnt lgkmcnt(14)
 ds_read_b128 a[88:91], v114 offset:24576
 mf a[8:11], a[92:95], v[196:199], a[8:11]
 v_min_f32 v173, v173, v53
 v_exp_f32 v173, v173
 s_add_u32 s61, s85, s17
 s_add_u32 s61, s61, 0x800
 buffer_load_dwordx4 a[180:183], v4, s[40:43], s61 offen
 mf a[12:15], a[92:95], v[204:207], a[12:15]
 s_waitcnt lgkmcnt(14)
 ds_read_b128 a[92:95], v114 offset:25600
 v_cvt_pk_bf16_f32 v220, v172, v173
 mf a[16:19], a[96:99], v[196:199], a[16:19]
 v_min_f32 v174, v174, v54
 v_exp_f32 v174, v174
 s_add_u32 s61, s84, 0x800
 buffer_load_dwordx4 a[184:187], v4, s[40:43], s61 offen offset:1024
 mf a[20:23], a[96:99], v[204:207], a[20:23]
 s_waitcnt lgkmcnt(14)
 ds_read_b128 a[96:99], v114 offset:26624
 mf a[24:27], a[100:103], v[196:199], a[24:27]
 v_min_f32 v175, v175, v55
 v_exp_f32 v175, v175
 s_add_u32 s61, s84, s17
 s_add_u32 s61, s61, 0x800
 buffer_load_dwordx4 a[188:191], v4, s[40:43], s61 offen offset:1024
 mf a[28:31], a[100:103], v[204:207], a[28:31]
 s_waitcnt lgkmcnt(14)
 ds_read_b128 a[100:103], v114 offset:27648
 v_cvt_pk_bf16_f32 v221, v174, v175
 s_add_u32 s61, s85, 0x800
 buffer_load_dwordx4 a[192:195], v4, s[40:43], s61 offen offset:1024
 mf v[156:159], a[104:107], v[160:163], v[236:239]
 s_waitcnt lgkmcnt(11)
 v_min_f32 v188, v188, v60
 v_exp_f32 v188, v188
 mf v[156:159], a[108:111], v[168:171], v[156:159]
 ds_read_b128 a[104:107], v112 offset:28672
 s_add_u32 s61, s85, s17
 s_add_u32 s61, s61, 0x800
 buffer_load_dwordx4 a[196:199], v4, s[40:43], s61 offen offset:1024
 mf v[156:159], a[112:115], v[176:179], v[156:159]
 ds_read_b128 a[108:111], v112 offset:29696
 mf v[156:159], a[116:119], v[184:187], v[156:159]
 ds_read_b128 a[112:115], v112 offset:30720
 s_add_u32 s61, s84, 0x1000
 buffer_load_dwordx2 a[200:201], v16, s[40:43], s61 offen
 buffer_load_dwordx2 a[202:203], v16, s[40:43], s61 offen offset:512
 mf a[32:35], a[120:123], v[196:199], a[32:35]
 ds_read_b128 a[116:119], v112 offset:31744
 s_add_u32 s61, s84, s17
 s_add_u32 s61, s61, 0x1000
 buffer_load_dwordx2 a[204:205], v16, s[40:43], s61 offen
 buffer_load_dwordx2 a[206:207], v16, s[40:43], s61 offen offset:512
 mf a[36:39], a[120:123], v[204:207], a[36:39]
 s_waitcnt lgkmcnt(14)
 ds_read_b128 a[120:123], v114 offset:28672
 mf a[40:43], a[124:127], v[196:199], a[40:43]
 v_min_f32 v189, v189, v61
 v_exp_f32 v189, v189
 s_add_u32 s61, s85, 0x1000
 buffer_load_dwordx2 a[208:209], v16, s[40:43], s61 offen
 buffer_load_dwordx2 a[210:211], v16, s[40:43], s61 offen offset:512
 mf a[44:47], a[124:127], v[204:207], a[44:47]
 s_waitcnt lgkmcnt(14)
 ds_read_b128 a[124:127], v114 offset:29696
 v_cvt_pk_bf16_f32 v222, v188, v189
 mf a[48:51], a[128:131], v[196:199], a[48:51]
 v_min_f32 v190, v190, v62
 v_exp_f32 v190, v190
 s_add_u32 s61, s85, s17
 s_add_u32 s61, s61, 0x1000
 buffer_load_dwordx2 a[212:213], v16, s[40:43], s61 offen
 buffer_load_dwordx2 a[214:215], v16, s[40:43], s61 offen offset:512
 mf a[52:55], a[128:131], v[204:207], a[52:55]
 s_waitcnt lgkmcnt(14)
 ds_read_b128 a[128:131], v114 offset:30720
 mf a[56:59], a[132:135], v[196:199], a[56:59]
 v_min_f32 v191, v191, v63
 v_exp_f32 v191, v191
 s_add_u32 s61, s84, 0x1000
 buffer_load_dwordx4 a[216:219], v4, s[40:43], s61 offen offset:1024
 mf a[60:63], a[132:135], v[204:207], a[60:63]
 s_waitcnt lgkmcnt(14)
 ds_read_b128 a[132:135], v114 offset:31744
 v_cvt_pk_bf16_f32 v223, v190, v191
 s_add_u32 s61, s84, s17
 s_add_u32 s61, s61, 0x1000
 buffer_load_dwordx4 a[220:223], v4, s[40:43], s61 offen offset:1024
 mf a[64:67], v[244:247], v[196:199], a[64:67]
 mf a[68:71], v[244:247], v[204:207], a[68:71]
 s_add_u32 s61, s85, 0x1000
 buffer_load_dwordx4 a[224:227], v4, s[40:43], s61 offen offset:1024
 mf v[172:175], a[72:75], v[160:163], v[236:239]
 s_waitcnt lgkmcnt(11)
 v_min_f32 v140, v140, v64
 v_exp_f32 v140, v140
 mf v[172:175], a[76:79], v[168:171], v[172:175]
 s_add_u32 s61, s85, s17
 s_add_u32 s61, s61, 0x1000
 buffer_load_dwordx4 a[228:231], v4, s[40:43], s61 offen offset:1024
 mf v[172:175], a[80:83], v[176:179], v[172:175]
 v_min_f32 v141, v141, v65
 v_exp_f32 v141, v141
 mf v[172:175], a[84:87], v[184:187], v[172:175]
 v_cvt_pk_bf16_f32 v204, v140, v141
 mf a[4:7], a[88:91], v[220:223], a[4:7]
 s_waitcnt lgkmcnt(7)
 v_min_f32 v142, v142, v66
 v_exp_f32 v142, v142
 mf a[12:15], a[92:95], v[220:223], a[12:15]
 s_waitcnt vmcnt(34)
 s_waitcnt lgkmcnt(0)
 s_barrier
 mf a[20:23], a[96:99], v[220:223], a[20:23]
 ds_read_b128 a[88:91], v115
 ds_read_b128 a[92:95], v115 offset:1024
 s_add_u32 s63, s91, 0x12000
 s_add_u32 m0, s83, 0
 s_nop 0
 buffer_load_dwordx4 v22, s[32:35], s63 offen lds
 mf a[28:31], a[100:103], v[220:223], a[28:31]
 ds_read_b128 a[96:99], v115 offset:2048
 v_xor_b32 v112, 0x8000, v112
 s_add_u32 m0, s83, 0x400
 s_nop 0
 buffer_load_dwordx4 v23, s[32:35], s63 offen lds
 mf v[188:191], a[104:107], v[160:163], v[236:239]
 ds_read_b128 a[100:103], v115 offset:3072
 v_xor_b32 v114, 0x8000, v114
 mf v[188:191], a[108:111], v[168:171], v[188:191]
 v_min_f32 v143, v143, v67
 v_exp_f32 v143, v143
 s_add_u32 m0, s83, 0x800
 s_nop 0
 buffer_load_dwordx4 v24, s[32:35], s63 offen lds
 mf v[188:191], a[112:115], v[176:179], v[188:191]
 v_cvt_pk_bf16_f32 v205, v142, v143
 mf v[188:191], a[116:119], v[184:187], v[188:191]
 v_min_f32 v156, v156, v68
 v_exp_f32 v156, v156
 s_add_u32 m0, s83, 0xc00
 s_nop 0
 buffer_load_dwordx4 v25, s[32:35], s63 offen lds
 mf a[36:39], a[120:123], v[220:223], a[36:39]
 mf a[44:47], a[124:127], v[220:223], a[44:47]
 ds_read_b128 a[120:123], v115 offset:4096
 s_add_u32 m0, s83, 0x1000
 s_nop 0
 buffer_load_dwordx4 v26, s[32:35], s63 offen lds
 mf a[52:55], a[128:131], v[220:223], a[52:55]
 ds_read_b128 a[124:127], v115 offset:5120
 mf a[60:63], a[132:135], v[220:223], a[60:63]
 ds_read_b128 a[128:131], v115 offset:6144
 v_min_f32 v157, v157, v69
 v_exp_f32 v157, v157
 v_min_f32 v158, v158, v70
 v_exp_f32 v158, v158
 v_min_f32 v159, v159, v71
 v_exp_f32 v159, v159
 s_add_u32 s63, s91, 0x24000
 s_add_u32 m0, s83, 0x5000
 s_nop 0
 buffer_load_dwordx4 v22, s[32:35], s63 offen lds
 mf a[68:71], v[244:247], v[220:223], a[68:71]
 s_waitcnt lgkmcnt(4)
 ds_read_b128 a[132:135], v115 offset:7168
 v_cvt_pk_bf16_f32 v206, v156, v157
 v_cvt_pk_bf16_f32 v207, v158, v159
 s_add_u32 m0, s83, 0x5400
 s_nop 0
 buffer_load_dwordx4 v23, s[32:35], s63 offen lds
 mf a[4:7], a[88:91], v[204:207], a[4:7]
 v_min_f32 v172, v172, v72
 v_exp_f32 v172, v172
 mf a[12:15], a[92:95], v[204:207], a[12:15]
 ds_read_b128 a[88:91], v115 offset:8192
 s_add_u32 m0, s83, 0x5800
 s_nop 0
 buffer_load_dwordx4 v24, s[32:35], s63 offen lds
 mf a[20:23], a[96:99], v[204:207], a[20:23]
 s_waitcnt lgkmcnt(5)
 ds_read_b128 a[92:95], v115 offset:9216
 mf a[28:31], a[100:103], v[204:207], a[28:31]
 s_waitcnt lgkmcnt(5)
 ds_read_b128 a[96:99], v115 offset:10240
 s_add_u32 m0, s83, 0x5c00
 s_nop 0
 buffer_load_dwordx4 v25, s[32:35], s63 offen lds
 mf a[36:39], a[120:123], v[204:207], a[36:39]
 s_waitcnt lgkmcnt(5)
 ds_read_b128 a[100:103], v115 offset:11264
 mf a[44:47], a[124:127], v[204:207], a[44:47]
 s_waitcnt lgkmcnt(5)
 ds_read_b128 a[120:123], v115 offset:12288
 s_add_u32 m0, s83, 0x6000
 s_nop 0
 buffer_load_dwordx4 v26, s[32:35], s63 offen lds
 mf a[52:55], a[128:131], v[204:207], a[52:55]
 s_waitcnt lgkmcnt(5)
 ds_read_b128 a[124:127], v115 offset:13312
 mf a[60:63], a[132:135], v[204:207], a[60:63]
 ds_read_b128 a[128:131], v115 offset:14336
 v_min_f32 v173, v173, v73
 v_exp_f32 v173, v173
 v_min_f32 v174, v174, v74
 v_exp_f32 v174, v174
 v_min_f32 v175, v175, v75
 v_exp_f32 v175, v175
 v_min_f32 v188, v188, v76
 v_exp_f32 v188, v188
 v_min_f32 v189, v189, v77
 v_exp_f32 v189, v189
 v_min_f32 v190, v190, v78
 v_exp_f32 v190, v190
 v_min_f32 v191, v191, v79
 v_exp_f32 v191, v191
 s_add_u32 s63, s91, 0x36000
 s_add_u32 m0, s83, 0xa000
 s_nop 0
 buffer_load_dwordx4 v22, s[32:35], s63 offen lds
 mf a[68:71], v[244:247], v[204:207], a[68:71]
 ds_read_b128 a[132:135], v115 offset:15360
 v_cvt_pk_bf16_f32 v220, v172, v173
 v_cvt_pk_bf16_f32 v221, v174, v175
 v_cvt_pk_bf16_f32 v222, v188, v189
 v_cvt_pk_bf16_f32 v223, v190, v191
 s_add_u32 m0, s83, 0xa400
 s_nop 0
 buffer_load_dwordx4 v23, s[32:35], s63 offen lds
 s_waitcnt lgkmcnt(5)
 mf a[4:7], a[88:91], v[220:223], a[4:7]
 mf a[12:15], a[92:95], v[220:223], a[12:15]
 s_add_u32 m0, s83, 0xa800
 s_nop 0
 buffer_load_dwordx4 v24, s[32:35], s63 offen lds
 mf a[20:23], a[96:99], v[220:223], a[20:23]
 s_waitcnt lgkmcnt(3)
 mf a[28:31], a[100:103], v[220:223], a[28:31]
 s_add_u32 m0, s83, 0xac00
 s_nop 0
 buffer_load_dwordx4 v25, s[32:35], s63 offen lds
 mf a[36:39], a[120:123], v[220:223], a[36:39]
 s_waitcnt lgkmcnt(2)
 mf a[44:47], a[124:127], v[220:223], a[44:47]
 s_waitcnt lgkmcnt(1)
 s_add_u32 m0, s83, 0xb000
 s_nop 0
 buffer_load_dwordx4 v26, s[32:35], s63 offen lds
 mf a[52:55], a[128:131], v[220:223], a[52:55]
 s_waitcnt lgkmcnt(0)
 mf a[60:63], a[132:135], v[220:223], a[60:63]
 mf a[68:71], v[244:247], v[220:223], a[68:71]
 v_xor_b32 v113, 0x8000, v113
 v_xor_b32 v115, 0x8000, v115
 s_xor_b32 s75, s75, 0x8000
 s_add_u32 s71, s71, 1
 v_accvgpr_read_b32 v28, a64
 s_nop 2
 v_accvgpr_read_b32 v29, a68
 v_mov_b32 v30, 0x4e800000
 v_cmp_nle_f32 vcc, v28, v30
 s_nop 3
 s_mov_b64 s[30:31], vcc
 v_cmp_nle_f32 vcc, v29, v30
 s_nop 3
 s_or_b64 vcc, vcc, s[30:31]
 s_nop 4
 s_cbranch_vccnz f_last1a_x
f_last1a_ok:
 s_branch f_epi
f_last1b:
 mf v[164:167], a[72:75], v[128:131], v[228:231]
 v_min_f32 v132, v132, v32
 v_exp_f32 v132, v132
 mf v[172:175], a[72:75], v[160:163], v[236:239]
 s_waitcnt lgkmcnt(14)
 ds_read_b128 a[72:75], v112 offset:16384
 mf v[164:167], a[76:79], v[136:139], v[164:167]
 v_min_f32 v133, v133, v33
 v_exp_f32 v133, v133
 mf v[172:175], a[76:79], v[168:171], v[172:175]
 s_waitcnt lgkmcnt(14)
 ds_read_b128 a[76:79], v112 offset:17408
 v_cvt_pk_bf16_f32 v196, v132, v133
 mf v[164:167], a[80:83], v[144:147], v[164:167]
 v_min_f32 v134, v134, v34
 v_exp_f32 v134, v134
 v_cmp_eq_u32 vcc, v6, v27
 s_nop 3
 s_cmp_eq_u64 vcc, -1
 s_cbranch_scc0 f_hb_spin
f_hb_ok:
 mf v[172:175], a[80:83], v[176:179], v[172:175]
 s_waitcnt lgkmcnt(14)
 ds_read_b128 a[80:83], v112 offset:18432
 s_add_u32 s63, s91, 0
 s_add_u32 m0, s83, 0x20000
 s_nop 0
 buffer_load_dwordx4 v22, s[32:35], s63 offen lds
 mf v[164:167], a[84:87], v[152:155], v[164:167]
 v_min_f32 v135, v135, v35
 v_exp_f32 v135, v135
 mf v[172:175], a[84:87], v[184:187], v[172:175]
 s_waitcnt lgkmcnt(14)
 ds_read_b128 a[84:87], v112 offset:19456
 v_cvt_pk_bf16_f32 v197, v134, v135
 s_add_u32 m0, s83, 0x20400
 s_nop 0
 buffer_load_dwordx4 v23, s[32:35], s63 offen lds
 mf a[0:3], a[88:91], v[212:215], a[0:3]
 v_min_f32 v148, v148, v40
 v_exp_f32 v148, v148
 mf a[4:7], a[88:91], v[220:223], a[4:7]
 s_waitcnt lgkmcnt(14)
 ds_read_b128 a[88:91], v114 offset:16384
 s_add_u32 m0, s83, 0x20800
 s_nop 0
 buffer_load_dwordx4 v24, s[32:35], s63 offen lds
 mf a[8:11], a[92:95], v[212:215], a[8:11]
 v_min_f32 v149, v149, v41
 v_exp_f32 v149, v149
 mf a[12:15], a[92:95], v[220:223], a[12:15]
 s_waitcnt lgkmcnt(14)
 ds_read_b128 a[92:95], v114 offset:17408
 v_cvt_pk_bf16_f32 v198, v148, v149
 s_add_u32 m0, s83, 0x20c00
 s_nop 0
 buffer_load_dwordx4 v25, s[32:35], s63 offen lds
 mf a[16:19], a[96:99], v[212:215], a[16:19]
 v_min_f32 v150, v150, v42
 v_exp_f32 v150, v150
 mf a[20:23], a[96:99], v[220:223], a[20:23]
 s_waitcnt lgkmcnt(14)
 ds_read_b128 a[96:99], v114 offset:18432
 s_add_u32 m0, s83, 0x21000
 s_nop 0
 buffer_load_dwordx4 v26, s[32:35], s63 offen lds
 mf a[24:27], a[100:103], v[212:215], a[24:27]
 v_min_f32 v151, v151, v43
 v_exp_f32 v151, v151
 mf a[28:31], a[100:103], v[220:223], a[28:31]
 s_waitcnt lgkmcnt(14)
 ds_read_b128 a[100:103], v114 offset:19456
 v_cvt_pk_bf16_f32 v199, v150, v151
 s_add_u32 s61, s84, 0
 buffer_load_dwordx4 a[136:139], v4, s[40:43], s61 offen
 mf v[180:183], a[104:107], v[128:131], v[228:231]
 v_min_f32 v140, v140, v36
 v_exp_f32 v140, v140
 mf v[188:191], a[104:107], v[160:163], v[236:239]
 s_waitcnt lgkmcnt(14)
 ds_read_b128 a[104:107], v112 offset:20480
 s_add_u32 s61, s84, s17
 s_add_u32 s61, s61, 0
 buffer_load_dwordx4 a[140:143], v4, s[40:43], s61 offen
 mf v[180:183], a[108:111], v[136:139], v[180:183]
 v_min_f32 v141, v141, v37
 v_exp_f32 v141, v141
 mf v[188:191], a[108:111], v[168:171], v[188:191]
 s_waitcnt lgkmcnt(14)
 ds_read_b128 a[108:111], v112 offset:21504
 v_cvt_pk_bf16_f32 v204, v140, v141
 s_add_u32 s61, s85, 0
 buffer_load_dwordx4 a[144:147], v4, s[40:43], s61 offen
 mf v[180:183], a[112:115], v[144:147], v[180:183]
 v_min_f32 v142, v142, v38
 v_exp_f32 v142, v142
 mf v[188:191], a[112:115], v[176:179], v[188:191]
 s_waitcnt lgkmcnt(14)
 ds_read_b128 a[112:115], v112 offset:22528
 s_add_u32 s61, s85, s17
 s_add_u32 s61, s61, 0
 buffer_load_dwordx4 a[148:151], v4, s[40:43], s61 offen
 mf v[180:183], a[116:119], v[152:155], v[180:183]
 v_min_f32 v143, v143, v39
 v_exp_f32 v143, v143
 mf v[188:191], a[116:119], v[184:187], v[188:191]
 s_waitcnt lgkmcnt(14)
 ds_read_b128 a[116:119], v112 offset:23552
 v_cvt_pk_bf16_f32 v205, v142, v143
 s_add_u32 s61, s84, 0
 buffer_load_dwordx4 a[152:155], v4, s[40:43], s61 offen offset:1024
 mf a[32:35], a[120:123], v[212:215], a[32:35]
 v_min_f32 v156, v156, v44
 v_exp_f32 v156, v156
 mf a[36:39], a[120:123], v[220:223], a[36:39]
 s_waitcnt lgkmcnt(14)
 ds_read_b128 a[120:123], v114 offset:20480
 s_add_u32 s61, s84, s17
 s_add_u32 s61, s61, 0
 buffer_load_dwordx4 a[156:159], v4, s[40:43], s61 offen offset:1024
 mf a[40:43], a[124:127], v[212:215], a[40:43]
 v_min_f32 v157, v157, v45
 v_exp_f32 v157, v157
 mf a[44:47], a[124:127], v[220:223], a[44:47]
 s_waitcnt lgkmcnt(14)
 ds_read_b128 a[124:127], v114 offset:21504
 v_cvt_pk_bf16_f32 v206, v156, v157
 s_add_u32 s61, s85, 0
 buffer_load_dwordx4 a[160:163], v4, s[40:43], s61 offen offset:1024
 mf a[48:51], a[128:131], v[212:215], a[48:51]
 v_min_f32 v158, v158, v46
 v_exp_f32 v158, v158
 mf a[52:55], a[128:131], v[220:223], a[52:55]
 s_waitcnt lgkmcnt(14)
 ds_read_b128 a[128:131], v114 offset:22528
 s_add_u32 s61, s85, s17
 s_add_u32 s61, s61, 0
 buffer_load_dwordx4 a[164:167], v4, s[40:43], s61 offen offset:1024
 mf a[56:59], a[132:135], v[212:215], a[56:59]
 v_min_f32 v159, v159, v47
 v_exp_f32 v159, v159
 mf a[60:63], a[132:135], v[220:223], a[60:63]
 s_waitcnt lgkmcnt(14)
 ds_read_b128 a[132:135], v114 offset:23552
 v_cvt_pk_bf16_f32 v207, v158, v159
 s_add_u32 s61, s84, 0x800
 buffer_load_dwordx4 a[168:171], v4, s[40:43], s61 offen
 mf a[64:67], v[244:247], v[212:215], a[64:67]
 mf a[68:71], v[244:247], v[220:223], a[68:71]
 s_add_u32 s61, s84, s17
 s_add_u32 s61, s61, 0x800
 buffer_load_dwordx4 a[172:175], v4, s[40:43], s61 offen
 mf v[140:143], a[72:75], v[160:163], v[236:239]
 s_waitcnt lgkmcnt(11)
 v_min_f32 v164, v164, v48
 v_exp_f32 v164, v164
 mf v[140:143], a[76:79], v[168:171], v[140:143]
 v_min_f32 v165, v165, v49
 v_exp_f32 v165, v165
 s_add_u32 s61, s85, 0x800
 buffer_load_dwordx4 a[176:179], v4, s[40:43], s61 offen
 mf v[140:143], a[80:83], v[176:179], v[140:143]
 v_min_f32 v166, v166, v50
 v_exp_f32 v166, v166
 mf v[140:143], a[84:87], v[184:187], v[140:143]
 v_min_f32 v167, v167, v51
 v_exp_f32 v167, v167
 s_add_u32 s61, s85, s17
 s_add_u32 s61, s61, 0x800
 buffer_load_dwordx4 a[180:183], v4, s[40:43], s61 offen
 mf a[0:3], a[88:91], v[196:199], a[0:3]
 v_min_f32 v180, v180, v56
 v_exp_f32 v180, v180
 mf a[4:7], a[88:91], v[204:207], a[4:7]
 s_waitcnt lgkmcnt(7)
 ds_read_b128 a[88:91], v114 offset:24576
 v_cvt_pk_bf16_f32 v212, v164, v165
 s_add_u32 s61, s84, 0x800
 buffer_load_dwordx4 a[184:187], v4, s[40:43], s61 offen offset:1024
 mf a[8:11], a[92:95], v[196:199], a[8:11]
 v_min_f32 v181, v181, v57
 v_exp_f32 v181, v181
 mf a[12:15], a[92:95], v[204:207], a[12:15]
 ds_read_b128 a[92:95], v114 offset:25600
 v_cvt_pk_bf16_f32 v213, v166, v167
 s_add_u32 s61, s84, s17
 s_add_u32 s61, s61, 0x800
 buffer_load_dwordx4 a[188:191], v4, s[40:43], s61 offen offset:1024
 mf a[16:19], a[96:99], v[196:199], a[16:19]
 v_min_f32 v182, v182, v58
 v_exp_f32 v182, v182
 mf a[20:23], a[96:99], v[204:207], a[20:23]
 ds_read_b128 a[96:99], v114 offset:26624
 v_cvt_pk_bf16_f32 v214, v180, v181
 s_add_u32 s61, s85, 0x800
 buffer_load_dwordx4 a[192:195], v4, s[40:43], s61 offen offset:1024
 mf a[24:27], a[100:103], v[196:199], a[24:27]
 v_min_f32 v183, v183, v59
 v_exp_f32 v183, v183
 mf a[28:31], a[100:103], v[204:207], a[28:31]
 ds_read_b128 a[100:103], v114 offset:27648
 v_cvt_pk_bf16_f32 v215, v182, v183
 s_add_u32 s61, s85, s17
 s_add_u32 s61, s61, 0x800
 buffer_load_dwordx4 a[196:199], v4, s[40:43], s61 offen offset:1024
 mf v[156:159], a[104:107], v[160:163], v[236:239]
 s_waitcnt lgkmcnt(7)
 v_min_f32 v172, v172, v52
 v_exp_f32 v172, v172
 mf v[156:159], a[108:111], v[168:171], v[156:159]
 v_min_f32 v173, v173, v53
 v_exp_f32 v173, v173
 s_add_u32 s61, s84, 0x1000
 buffer_load_dwordx2 a[200:201], v16, s[40:43], s61 offen
 buffer_load_dwordx2 a[202:203], v16, s[40:43], s61 offen offset:512
 mf v[156:159], a[112:115], v[176:179], v[156:159]
 v_min_f32 v174, v174, v54
 v_exp_f32 v174, v174
 mf v[156:159], a[116:119], v[184:187], v[156:159]
 v_min_f32 v175, v175, v55
 v_exp_f32 v175, v175
 s_add_u32 s61, s84, s17
 s_add_u32 s61, s61, 0x1000
 buffer_load_dwordx2 a[204:205], v16, s[40:43], s61 offen
 buffer_load_dwordx2 a[206:207], v16, s[40:43], s61 offen offset:512
 mf a[32:35], a[120:123], v[196:199], a[32:35]
 v_min_f32 v188, v188, v60
 v_exp_f32 v188, v188
 mf a[36:39], a[120:123], v[204:207], a[36:39]
 s_waitcnt lgkmcnt(3)
 ds_read_b128 a[120:123], v114 offset:28672
 v_cvt_pk_bf16_f32 v220, v172, v173
 s_add_u32 s61, s85, 0x1000
 buffer_load_dwordx2 a[208:209], v16, s[40:43], s61 offen
 buffer_load_dwordx2 a[210:211], v16, s[40:43], s61 offen offset:512
 mf a[40:43], a[124:127], v[196:199], a[40:43]
 v_min_f32 v189, v189, v61
 v_exp_f32 v189, v189
 mf a[44:47], a[124:127], v[204:207], a[44:47]
 ds_read_b128 a[124:127], v114 offset:29696
 v_cvt_pk_bf16_f32 v221, v174, v175
 s_add_u32 s61, s85, s17
 s_add_u32 s61, s61, 0x1000
 buffer_load_dwordx2 a[212:213], v16, s[40:43], s61 offen
 buffer_load_dwordx2 a[214:215], v16, s[40:43], s61 offen offset:512
 mf a[48:51], a[128:131], v[196:199], a[48:51]
 v_min_f32 v190, v190, v62
 v_exp_f32 v190, v190
 mf a[52:55], a[128:131], v[204:207], a[52:55]
 ds_read_b128 a[128:131], v114 offset:30720
 v_cvt_pk_bf16_f32 v222, v188, v189
 s_add_u32 s61, s84, 0x1000
 buffer_load_dwordx4 a[216:219], v4, s[40:43], s61 offen offset:1024
 mf a[56:59], a[132:135], v[196:199], a[56:59]
 v_min_f32 v191, v191, v63
 v_exp_f32 v191, v191
 mf a[60:63], a[132:135], v[204:207], a[60:63]
 ds_read_b128 a[132:135], v114 offset:31744
 v_cvt_pk_bf16_f32 v223, v190, v191
 s_add_u32 s61, s84, s17
 s_add_u32 s61, s61, 0x1000
 buffer_load_dwordx4 a[220:223], v4, s[40:43], s61 offen offset:1024
 mf a[64:67], v[244:247], v[196:199], a[64:67]
 mf a[68:71], v[244:247], v[204:207], a[68:71]
 s_add_u32 s61, s85, 0x1000
 buffer_load_dwordx4 a[224:227], v4, s[40:43], s61 offen offset:1024
 mf a[0:3], a[88:91], v[212:215], a[0:3]
 v_min_f32 v140, v140, v64
 v_exp_f32 v140, v140
 mf a[4:7], a[88:91], v[220:223], a[4:7]
 s_waitcnt lgkmcnt(3)
 s_add_u32 s61, s85, s17
 s_add_u32 s61, s61, 0x1000
 buffer_load_dwordx4 a[228:231], v4, s[40:43], s61 offen offset:1024
 mf a[8:11], a[92:95], v[212:215], a[8:11]
 v_min_f32 v141, v141, v65
 v_exp_f32 v141, v141
 mf a[12:15], a[92:95], v[220:223], a[12:15]
 v_cvt_pk_bf16_f32 v204, v140, v141
 mf a[16:19], a[96:99], v[212:215], a[16:19]
 v_min_f32 v142, v142, v66
 v_exp_f32 v142, v142
 mf a[20:23], a[96:99], v[220:223], a[20:23]
 s_waitcnt vmcnt(34)
 s_waitcnt lgkmcnt(0)
 s_barrier
 mf a[24:27], a[100:103], v[212:215], a[24:27]
 ds_read_b128 a[88:91], v115
 ds_read_b128 a[92:95], v115 offset:1024
 s_add_u32 s63, s91, 0x12000
 s_add_u32 m0, s83, 0
 s_nop 0
 buffer_load_dwordx4 v22, s[32:35], s63 offen lds
 mf a[28:31], a[100:103], v[220:223], a[28:31]
 ds_read_b128 a[96:99], v115 offset:2048
 ds_read_b128 a[100:103], v115 offset:3072
 s_add_u32 m0, s83, 0x400
 s_nop 0
 buffer_load_dwordx4 v23, s[32:35], s63 offen lds
 mf a[32:35], a[120:123], v[212:215], a[32:35]
 v_min_f32 v143, v143, v67
 v_exp_f32 v143, v143
 s_add_u32 m0, s83, 0x800
 s_nop 0
 buffer_load_dwordx4 v24, s[32:35], s63 offen lds
 mf a[36:39], a[120:123], v[220:223], a[36:39]
 ds_read_b128 a[120:123], v115 offset:4096
 v_cvt_pk_bf16_f32 v205, v142, v143
 s_add_u32 m0, s83, 0xc00
 s_nop 0
 buffer_load_dwordx4 v25, s[32:35], s63 offen lds
 mf a[40:43], a[124:127], v[212:215], a[40:43]
 v_min_f32 v156, v156, v68
 v_exp_f32 v156, v156
 mf a[44:47], a[124:127], v[220:223], a[44:47]
 ds_read_b128 a[124:127], v115 offset:5120
 v_xor_b32 v112, 0x8000, v112
 s_add_u32 m0, s83, 0x1000
 s_nop 0
 buffer_load_dwordx4 v26, s[32:35], s63 offen lds
 mf a[48:51], a[128:131], v[212:215], a[48:51]
 v_min_f32 v157, v157, v69
 v_exp_f32 v157, v157
 s_add_u32 s63, s91, 0x24000
 s_add_u32 m0, s83, 0x5000
 s_nop 0
 buffer_load_dwordx4 v22, s[32:35], s63 offen lds
 mf a[52:55], a[128:131], v[220:223], a[52:55]
 ds_read_b128 a[128:131], v115 offset:6144
 v_cvt_pk_bf16_f32 v206, v156, v157
 s_add_u32 m0, s83, 0x5400
 s_nop 0
 buffer_load_dwordx4 v23, s[32:35], s63 offen lds
 mf a[56:59], a[132:135], v[212:215], a[56:59]
 v_min_f32 v158, v158, v70
 v_exp_f32 v158, v158
 s_add_u32 m0, s83, 0x5800
 s_nop 0
 buffer_load_dwordx4 v24, s[32:35], s63 offen lds
 mf a[60:63], a[132:135], v[220:223], a[60:63]
 ds_read_b128 a[132:135], v115 offset:7168
 v_xor_b32 v114, 0x8000, v114
 mf a[64:67], v[244:247], v[212:215], a[64:67]
 v_min_f32 v159, v159, v71
 v_exp_f32 v159, v159
 s_add_u32 m0, s83, 0x5c00
 s_nop 0
 buffer_load_dwordx4 v25, s[32:35], s63 offen lds
 mf a[68:71], v[244:247], v[220:223], a[68:71]
 s_waitcnt lgkmcnt(4)
 v_cvt_pk_bf16_f32 v207, v158, v159
 s_add_u32 m0, s83, 0x6000
 s_nop 0
 buffer_load_dwordx4 v26, s[32:35], s63 offen lds
 mf a[4:7], a[88:91], v[204:207], a[4:7]
 s_add_u32 s63, s91, 0x36000
 s_add_u32 m0, s83, 0xa000
 s_nop 0
 buffer_load_dwordx4 v22, s[32:35], s63 offen lds
 mf a[12:15], a[92:95], v[204:207], a[12:15]
 s_add_u32 m0, s83, 0xa400
 s_nop 0
 buffer_load_dwordx4 v23, s[32:35], s63 offen lds
 mf a[20:23], a[96:99], v[204:207], a[20:23]
 mf a[28:31], a[100:103], v[204:207], a[28:31]
 s_waitcnt lgkmcnt(2)
 s_add_u32 m0, s83, 0xa800
 s_nop 0
 buffer_load_dwordx4 v24, s[32:35], s63 offen lds
 mf a[36:39], a[120:123], v[204:207], a[36:39]
 s_add_u32 m0, s83, 0xac00
 s_nop 0
 buffer_load_dwordx4 v25, s[32:35], s63 offen lds
 mf a[44:47], a[124:127], v[204:207], a[44:47]
 s_waitcnt lgkmcnt(1)
 s_add_u32 m0, s83, 0xb000
 s_nop 0
 buffer_load_dwordx4 v26, s[32:35], s63 offen lds
 mf a[52:55], a[128:131], v[204:207], a[52:55]
 s_waitcnt lgkmcnt(0)
 mf a[60:63], a[132:135], v[204:207], a[60:63]
 mf a[68:71], v[244:247], v[204:207], a[68:71]
 v_xor_b32 v113, 0x8000, v113
 v_xor_b32 v115, 0x8000, v115
 s_xor_b32 s75, s75, 0x8000
 s_add_u32 s71, s71, 1
 v_accvgpr_read_b32 v28, a64
 s_nop 2
 v_accvgpr_read_b32 v29, a68
 v_mov_b32 v30, 0x4e800000
 v_cmp_nle_f32 vcc, v28, v30
 s_nop 3
 s_mov_b64 s[30:31], vcc
 v_cmp_nle_f32 vcc, v29, v30
 s_nop 3
 s_or_b64 vcc, vcc, s[30:31]
 s_nop 4
 s_cbranch_vccnz f_last1b_x
f_last1b_ok:
 s_branch f_epi
f_sig:
 v_and_b32 v30, 1, v1
 v_lshlrev_b32 v30, 7, v30
 v_add_u32 v30, s100, v30
 v_add_u32 v30, f_fin-parallel_sum__compressed_kv_cla__geglu_ffn__prompt_kernel, v30
 v_min_u32 v30, f_done-parallel_sum__compressed_kv_cla__geglu_ffn__prompt_kernel, v30
 v_add_co_u32 v30, vcc, s98, v30
 v_mov_b32 v31, s99
 s_nop 0
 v_addc_co_u32 v31, vcc, 0, v31, vcc
 global_load_dword v20, v[30:31], off
f_epi:
 v_accvgpr_read_b32 v28, a64
 v_rcp_f32 v28, v28
 s_nop 0
 v_mov_b32 v29, v28
 v_accvgpr_read_b32 v30, a68
 v_rcp_f32 v30, v30
 s_nop 0
 v_mov_b32 v31, v30
 v_accvgpr_read_b32 v80, a0
 v_accvgpr_read_b32 v81, a1
 v_accvgpr_read_b32 v82, a2
 v_accvgpr_read_b32 v83, a3
 v_accvgpr_read_b32 v84, a8
 v_accvgpr_read_b32 v85, a9
 v_accvgpr_read_b32 v86, a10
 v_accvgpr_read_b32 v87, a11
 v_pk_mul_f32 v[80:81], v[80:81], v[28:29]
 v_pk_mul_f32 v[82:83], v[82:83], v[28:29]
 v_pk_mul_f32 v[84:85], v[84:85], v[28:29]
 v_pk_mul_f32 v[86:87], v[86:87], v[28:29]
 v_cvt_pk_bf16_f32 v80, v80, v81
 v_cvt_pk_bf16_f32 v81, v82, v83
 v_cvt_pk_bf16_f32 v82, v84, v85
 v_cvt_pk_bf16_f32 v83, v86, v87
 s_add_u32 s62, s78, 0
 buffer_store_dwordx4 v[80:83], v4, s[40:43], s62 offen sc1
 v_accvgpr_read_b32 v88, a16
 v_accvgpr_read_b32 v89, a17
 v_accvgpr_read_b32 v90, a18
 v_accvgpr_read_b32 v91, a19
 v_accvgpr_read_b32 v92, a24
 v_accvgpr_read_b32 v93, a25
 v_accvgpr_read_b32 v94, a26
 v_accvgpr_read_b32 v95, a27
 v_pk_mul_f32 v[88:89], v[88:89], v[28:29]
 v_pk_mul_f32 v[90:91], v[90:91], v[28:29]
 v_pk_mul_f32 v[92:93], v[92:93], v[28:29]
 v_pk_mul_f32 v[94:95], v[94:95], v[28:29]
 v_cvt_pk_bf16_f32 v88, v88, v89
 v_cvt_pk_bf16_f32 v89, v90, v91
 v_cvt_pk_bf16_f32 v90, v92, v93
 v_cvt_pk_bf16_f32 v91, v94, v95
 s_add_u32 s62, s78, 0
 buffer_store_dwordx4 v[88:91], v4, s[40:43], s62 offen offset:1024 sc1
 v_accvgpr_read_b32 v96, a32
 v_accvgpr_read_b32 v97, a33
 v_accvgpr_read_b32 v98, a34
 v_accvgpr_read_b32 v99, a35
 v_accvgpr_read_b32 v100, a40
 v_accvgpr_read_b32 v101, a41
 v_accvgpr_read_b32 v102, a42
 v_accvgpr_read_b32 v103, a43
 v_pk_mul_f32 v[96:97], v[96:97], v[28:29]
 v_pk_mul_f32 v[98:99], v[98:99], v[28:29]
 v_pk_mul_f32 v[100:101], v[100:101], v[28:29]
 v_pk_mul_f32 v[102:103], v[102:103], v[28:29]
 v_cvt_pk_bf16_f32 v96, v96, v97
 v_cvt_pk_bf16_f32 v97, v98, v99
 v_cvt_pk_bf16_f32 v98, v100, v101
 v_cvt_pk_bf16_f32 v99, v102, v103
 s_add_u32 s62, s78, 0
 buffer_store_dwordx4 v[96:99], v4, s[40:43], s62 offen offset:2048 sc1
 v_accvgpr_read_b32 v104, a48
 v_accvgpr_read_b32 v105, a49
 v_accvgpr_read_b32 v106, a50
 v_accvgpr_read_b32 v107, a51
 v_accvgpr_read_b32 v108, a56
 v_accvgpr_read_b32 v109, a57
 v_accvgpr_read_b32 v110, a58
 v_accvgpr_read_b32 v111, a59
 v_pk_mul_f32 v[104:105], v[104:105], v[28:29]
 v_pk_mul_f32 v[106:107], v[106:107], v[28:29]
 v_pk_mul_f32 v[108:109], v[108:109], v[28:29]
 v_pk_mul_f32 v[110:111], v[110:111], v[28:29]
 v_cvt_pk_bf16_f32 v104, v104, v105
 v_cvt_pk_bf16_f32 v105, v106, v107
 v_cvt_pk_bf16_f32 v106, v108, v109
 v_cvt_pk_bf16_f32 v107, v110, v111
 s_add_u32 s62, s78, 0
 buffer_store_dwordx4 v[104:107], v4, s[40:43], s62 offen offset:3072 sc1
 v_accvgpr_read_b32 v80, a4
 v_accvgpr_read_b32 v81, a5
 v_accvgpr_read_b32 v82, a6
 v_accvgpr_read_b32 v83, a7
 v_accvgpr_read_b32 v84, a12
 v_accvgpr_read_b32 v85, a13
 v_accvgpr_read_b32 v86, a14
 v_accvgpr_read_b32 v87, a15
 v_pk_mul_f32 v[80:81], v[80:81], v[30:31]
 v_pk_mul_f32 v[82:83], v[82:83], v[30:31]
 v_pk_mul_f32 v[84:85], v[84:85], v[30:31]
 v_pk_mul_f32 v[86:87], v[86:87], v[30:31]
 v_cvt_pk_bf16_f32 v80, v80, v81
 v_cvt_pk_bf16_f32 v81, v82, v83
 v_cvt_pk_bf16_f32 v82, v84, v85
 v_cvt_pk_bf16_f32 v83, v86, v87
 s_add_u32 s62, s78, s17
 buffer_store_dwordx4 v[80:83], v4, s[40:43], s62 offen sc1
 v_accvgpr_read_b32 v88, a20
 v_accvgpr_read_b32 v89, a21
 v_accvgpr_read_b32 v90, a22
 v_accvgpr_read_b32 v91, a23
 v_accvgpr_read_b32 v92, a28
 v_accvgpr_read_b32 v93, a29
 v_accvgpr_read_b32 v94, a30
 v_accvgpr_read_b32 v95, a31
 v_pk_mul_f32 v[88:89], v[88:89], v[30:31]
 v_pk_mul_f32 v[90:91], v[90:91], v[30:31]
 v_pk_mul_f32 v[92:93], v[92:93], v[30:31]
 v_pk_mul_f32 v[94:95], v[94:95], v[30:31]
 v_cvt_pk_bf16_f32 v88, v88, v89
 v_cvt_pk_bf16_f32 v89, v90, v91
 v_cvt_pk_bf16_f32 v90, v92, v93
 v_cvt_pk_bf16_f32 v91, v94, v95
 s_add_u32 s62, s78, s17
 buffer_store_dwordx4 v[88:91], v4, s[40:43], s62 offen offset:1024 sc1
 v_accvgpr_read_b32 v96, a36
 v_accvgpr_read_b32 v97, a37
 v_accvgpr_read_b32 v98, a38
 v_accvgpr_read_b32 v99, a39
 v_accvgpr_read_b32 v100, a44
 v_accvgpr_read_b32 v101, a45
 v_accvgpr_read_b32 v102, a46
 v_accvgpr_read_b32 v103, a47
 v_pk_mul_f32 v[96:97], v[96:97], v[30:31]
 v_pk_mul_f32 v[98:99], v[98:99], v[30:31]
 v_pk_mul_f32 v[100:101], v[100:101], v[30:31]
 v_pk_mul_f32 v[102:103], v[102:103], v[30:31]
 v_cvt_pk_bf16_f32 v96, v96, v97
 v_cvt_pk_bf16_f32 v97, v98, v99
 v_cvt_pk_bf16_f32 v98, v100, v101
 v_cvt_pk_bf16_f32 v99, v102, v103
 s_add_u32 s62, s78, s17
 buffer_store_dwordx4 v[96:99], v4, s[40:43], s62 offen offset:2048 sc1
 v_accvgpr_read_b32 v104, a52
 v_accvgpr_read_b32 v105, a53
 v_accvgpr_read_b32 v106, a54
 v_accvgpr_read_b32 v107, a55
 v_accvgpr_read_b32 v108, a60
 v_accvgpr_read_b32 v109, a61
 v_accvgpr_read_b32 v110, a62
 v_accvgpr_read_b32 v111, a63
 v_pk_mul_f32 v[104:105], v[104:105], v[30:31]
 v_pk_mul_f32 v[106:107], v[106:107], v[30:31]
 v_pk_mul_f32 v[108:109], v[108:109], v[30:31]
 v_pk_mul_f32 v[110:111], v[110:111], v[30:31]
 v_cvt_pk_bf16_f32 v104, v104, v105
 v_cvt_pk_bf16_f32 v105, v106, v107
 v_cvt_pk_bf16_f32 v106, v108, v109
 v_cvt_pk_bf16_f32 v107, v110, v111
 s_add_u32 s62, s78, s17
 buffer_store_dwordx4 v[104:107], v4, s[40:43], s62 offen offset:3072 sc1
 s_cmp_eq_u32 s79, 1
 s_cbranch_scc1 f_fin
 s_mov_b32 s79, 1
 s_mov_b32 s70, s66
 v_mov_b32 v128, v192
 v_mov_b32 v129, v193
 v_mov_b32 v130, v194
 v_mov_b32 v131, v195
 v_mov_b32 v136, v200
 v_mov_b32 v137, v201
 v_mov_b32 v138, v202
 v_mov_b32 v139, v203
 v_mov_b32 v144, v208
 v_mov_b32 v145, v209
 v_mov_b32 v146, v210
 v_mov_b32 v147, v211
 v_mov_b32 v152, v216
 v_mov_b32 v153, v217
 v_mov_b32 v154, v218
 v_mov_b32 v155, v219
 v_mov_b32 v160, v224
 v_mov_b32 v161, v225
 v_mov_b32 v162, v226
 v_mov_b32 v163, v227
 v_mov_b32 v168, v232
 v_mov_b32 v169, v233
 v_mov_b32 v170, v234
 v_mov_b32 v171, v235
 v_mov_b32 v176, v240
 v_mov_b32 v177, v241
 v_mov_b32 v178, v242
 v_mov_b32 v179, v243
 v_mov_b32 v184, v248
 v_mov_b32 v185, v249
 v_mov_b32 v186, v250
 v_mov_b32 v187, v251
 v_accvgpr_write_b32 a0, 0
 v_accvgpr_write_b32 a1, 0
 v_accvgpr_write_b32 a2, 0
 v_accvgpr_write_b32 a3, 0
 v_accvgpr_write_b32 a4, 0
 v_accvgpr_write_b32 a5, 0
 v_accvgpr_write_b32 a6, 0
 v_accvgpr_write_b32 a7, 0
 v_accvgpr_write_b32 a8, 0
 v_accvgpr_write_b32 a9, 0
 v_accvgpr_write_b32 a10, 0
 v_accvgpr_write_b32 a11, 0
 v_accvgpr_write_b32 a12, 0
 v_accvgpr_write_b32 a13, 0
 v_accvgpr_write_b32 a14, 0
 v_accvgpr_write_b32 a15, 0
 v_accvgpr_write_b32 a16, 0
 v_accvgpr_write_b32 a17, 0
 v_accvgpr_write_b32 a18, 0
 v_accvgpr_write_b32 a19, 0
 v_accvgpr_write_b32 a20, 0
 v_accvgpr_write_b32 a21, 0
 v_accvgpr_write_b32 a22, 0
 v_accvgpr_write_b32 a23, 0
 v_accvgpr_write_b32 a24, 0
 v_accvgpr_write_b32 a25, 0
 v_accvgpr_write_b32 a26, 0
 v_accvgpr_write_b32 a27, 0
 v_accvgpr_write_b32 a28, 0
 v_accvgpr_write_b32 a29, 0
 v_accvgpr_write_b32 a30, 0
 v_accvgpr_write_b32 a31, 0
 v_accvgpr_write_b32 a32, 0
 v_accvgpr_write_b32 a33, 0
 v_accvgpr_write_b32 a34, 0
 v_accvgpr_write_b32 a35, 0
 v_accvgpr_write_b32 a36, 0
 v_accvgpr_write_b32 a37, 0
 v_accvgpr_write_b32 a38, 0
 v_accvgpr_write_b32 a39, 0
 v_accvgpr_write_b32 a40, 0
 v_accvgpr_write_b32 a41, 0
 v_accvgpr_write_b32 a42, 0
 v_accvgpr_write_b32 a43, 0
 v_accvgpr_write_b32 a44, 0
 v_accvgpr_write_b32 a45, 0
 v_accvgpr_write_b32 a46, 0
 v_accvgpr_write_b32 a47, 0
 v_accvgpr_write_b32 a48, 0
 v_accvgpr_write_b32 a49, 0
 v_accvgpr_write_b32 a50, 0
 v_accvgpr_write_b32 a51, 0
 v_accvgpr_write_b32 a52, 0
 v_accvgpr_write_b32 a53, 0
 v_accvgpr_write_b32 a54, 0
 v_accvgpr_write_b32 a55, 0
 v_accvgpr_write_b32 a56, 0
 v_accvgpr_write_b32 a57, 0
 v_accvgpr_write_b32 a58, 0
 v_accvgpr_write_b32 a59, 0
 v_accvgpr_write_b32 a60, 0
 v_accvgpr_write_b32 a61, 0
 v_accvgpr_write_b32 a62, 0
 v_accvgpr_write_b32 a63, 0
 v_accvgpr_write_b32 a64, 0
 v_accvgpr_write_b32 a65, 0
 v_accvgpr_write_b32 a66, 0
 v_accvgpr_write_b32 a67, 0
 v_accvgpr_write_b32 a68, 0
 v_accvgpr_write_b32 a69, 0
 v_accvgpr_write_b32 a70, 0
 v_accvgpr_write_b32 a71, 0
 s_branch f_tile
f_fin:
 s_waitcnt vmcnt(51)
 s_barrier
 ds_read_b64_tr_b16 a[232:233], v8
 ds_read_b64_tr_b16 a[234:235], v8 offset:5120
 ds_read_b64_tr_b16 a[236:237], v9
 ds_read_b64_tr_b16 a[238:239], v9 offset:5120
 ds_read_b64_tr_b16 a[240:241], v8 offset:64
 ds_read_b64_tr_b16 a[242:243], v8 offset:5184
 ds_read_b64_tr_b16 a[244:245], v9 offset:64
 ds_read_b64_tr_b16 a[246:247], v9 offset:5184
 ds_read_b64_tr_b16 a[248:249], v8 offset:128
 ds_read_b64_tr_b16 a[250:251], v8 offset:5248
 ds_read_b64_tr_b16 a[252:253], v9 offset:128
 ds_read_b64_tr_b16 a[254:255], v9 offset:5248
 s_waitcnt vmcnt(50) lgkmcnt(10)
 mf v[32:35], a[232:235], a[136:139], 0
 s_waitcnt vmcnt(49)
 mf v[36:39], a[232:235], a[140:143], 0
 s_waitcnt vmcnt(48)
 mf v[40:43], a[232:235], a[144:147], 0
 s_waitcnt vmcnt(47)
 mf v[44:47], a[232:235], a[148:151], 0
 s_waitcnt lgkmcnt(8)
 ds_read_b64_tr_b16 a[232:233], v8 offset:192
 ds_read_b64_tr_b16 a[234:235], v8 offset:5312
 mf v[48:51], a[236:239], a[136:139], 0
 mf v[52:55], a[236:239], a[140:143], 0
 mf v[56:59], a[236:239], a[144:147], 0
 mf v[60:63], a[236:239], a[148:151], 0
 s_waitcnt lgkmcnt(8)
 ds_read_b64_tr_b16 a[236:237], v9 offset:192
 ds_read_b64_tr_b16 a[238:239], v9 offset:5312
 mf v[64:67], a[240:243], a[136:139], 0
 mf v[68:71], a[240:243], a[140:143], 0
 mf v[72:75], a[240:243], a[144:147], 0
 mf v[76:79], a[240:243], a[148:151], 0
 s_waitcnt lgkmcnt(8)
 ds_read_b64_tr_b16 a[240:241], v8 offset:256
 ds_read_b64_tr_b16 a[242:243], v8 offset:5376
 mf v[80:83], a[244:247], a[136:139], 0
 mf v[84:87], a[244:247], a[140:143], 0
 mf v[88:91], a[244:247], a[144:147], 0
 mf v[92:95], a[244:247], a[148:151], 0
 s_waitcnt lgkmcnt(8)
 ds_read_b64_tr_b16 a[244:245], v8 offset:10240
 ds_read_b64_tr_b16 a[246:247], v8 offset:15360
 mf v[96:99], a[248:251], a[136:139], 0
 mf v[100:103], a[248:251], a[140:143], 0
 mf v[104:107], a[248:251], a[144:147], 0
 mf v[108:111], a[248:251], a[148:151], 0
 s_waitcnt lgkmcnt(8)
 ds_read_b64_tr_b16 a[248:249], v9 offset:10240
 ds_read_b64_tr_b16 a[250:251], v9 offset:15360
 mf v[112:115], a[252:255], a[136:139], 0
 mf v[116:119], a[252:255], a[140:143], 0
 mf v[120:123], a[252:255], a[144:147], 0
 mf v[124:127], a[252:255], a[148:151], 0
 s_waitcnt lgkmcnt(8)
 ds_read_b64_tr_b16 a[252:253], v8 offset:10304
 ds_read_b64_tr_b16 a[254:255], v8 offset:15424
 mf v[128:131], a[232:235], a[136:139], 0
 mf v[132:135], a[232:235], a[140:143], 0
 mf v[136:139], a[232:235], a[144:147], 0
 mf v[140:143], a[232:235], a[148:151], 0
 s_waitcnt lgkmcnt(8)
 ds_read_b64_tr_b16 a[232:233], v9 offset:10304
 ds_read_b64_tr_b16 a[234:235], v9 offset:15424
 mf v[144:147], a[236:239], a[136:139], 0
 mf v[148:151], a[236:239], a[140:143], 0
 mf v[152:155], a[236:239], a[144:147], 0
 mf v[156:159], a[236:239], a[148:151], 0
 s_waitcnt lgkmcnt(8)
 ds_read_b64_tr_b16 a[236:237], v8 offset:10368
 ds_read_b64_tr_b16 a[238:239], v8 offset:15488
 mf v[160:163], a[240:243], a[136:139], 0
 mf v[164:167], a[240:243], a[140:143], 0
 mf v[168:171], a[240:243], a[144:147], 0
 mf v[172:175], a[240:243], a[148:151], 0
 s_waitcnt vmcnt(46) lgkmcnt(8)
 ds_read_b64_tr_b16 a[240:241], v9 offset:10368
 ds_read_b64_tr_b16 a[242:243], v9 offset:15488
 mf v[32:35], a[244:247], a[152:155], v[32:35]
 s_waitcnt vmcnt(45)
 mf v[36:39], a[244:247], a[156:159], v[36:39]
 s_waitcnt vmcnt(44)
 mf v[40:43], a[244:247], a[160:163], v[40:43]
 s_waitcnt vmcnt(43)
 mf v[44:47], a[244:247], a[164:167], v[44:47]
 s_waitcnt lgkmcnt(8)
 ds_read_b64_tr_b16 a[244:245], v8 offset:10432
 ds_read_b64_tr_b16 a[246:247], v8 offset:15552
 mf v[48:51], a[248:251], a[152:155], v[48:51]
 mf v[52:55], a[248:251], a[156:159], v[52:55]
 mf v[56:59], a[248:251], a[160:163], v[56:59]
 mf v[60:63], a[248:251], a[164:167], v[60:63]
 s_waitcnt lgkmcnt(8)
 ds_read_b64_tr_b16 a[248:249], v9 offset:10432
 ds_read_b64_tr_b16 a[250:251], v9 offset:15552
 mf v[64:67], a[252:255], a[152:155], v[64:67]
 mf v[68:71], a[252:255], a[156:159], v[68:71]
 mf v[72:75], a[252:255], a[160:163], v[72:75]
 mf v[76:79], a[252:255], a[164:167], v[76:79]
 s_waitcnt lgkmcnt(8)
 ds_read_b64_tr_b16 a[252:253], v8 offset:10496
 ds_read_b64_tr_b16 a[254:255], v8 offset:15616
 mf v[80:83], a[232:235], a[152:155], v[80:83]
 mf v[84:87], a[232:235], a[156:159], v[84:87]
 mf v[88:91], a[232:235], a[160:163], v[88:91]
 mf v[92:95], a[232:235], a[164:167], v[92:95]
 s_waitcnt lgkmcnt(8)
 mf v[96:99], a[236:239], a[152:155], v[96:99]
 mf v[100:103], a[236:239], a[156:159], v[100:103]
 s_waitcnt vmcnt(18)
 s_waitcnt lgkmcnt(0)
 s_barrier
 mf v[104:107], a[236:239], a[160:163], v[104:107]
 s_add_u32 s60, s91, 0x48000
 ds_read_b64_tr_b16 a[232:233], v10
 ds_read_b64_tr_b16 a[234:235], v10 offset:5120
 mf v[108:111], a[236:239], a[164:167], v[108:111]
 s_add_u32 m0, s83, 0x20000
 ds_read_b64_tr_b16 a[236:237], v11
 ds_read_b64_tr_b16 a[238:239], v11 offset:5120
 mf v[112:115], a[240:243], a[152:155], v[112:115]
 buffer_load_dwordx4 v22, s[32:35], s60 offen lds
 mf v[116:119], a[240:243], a[156:159], v[116:119]
 mf v[120:123], a[240:243], a[160:163], v[120:123]
 mf v[124:127], a[240:243], a[164:167], v[124:127]
 ds_read_b64_tr_b16 a[240:241], v10 offset:64
 ds_read_b64_tr_b16 a[242:243], v10 offset:5184
 mf v[128:131], a[244:247], a[152:155], v[128:131]
 mf v[132:135], a[244:247], a[156:159], v[132:135]
 mf v[136:139], a[244:247], a[160:163], v[136:139]
 s_add_u32 m0, s83, 0x20400
 mf v[140:143], a[244:247], a[164:167], v[140:143]
 ds_read_b64_tr_b16 a[244:245], v11 offset:64
 ds_read_b64_tr_b16 a[246:247], v11 offset:5184
 mf v[144:147], a[248:251], a[152:155], v[144:147]
 buffer_load_dwordx4 v23, s[32:35], s60 offen lds
 mf v[148:151], a[248:251], a[156:159], v[148:151]
 mf v[152:155], a[248:251], a[160:163], v[152:155]
 mf v[156:159], a[248:251], a[164:167], v[156:159]
 ds_read_b64_tr_b16 a[248:249], v10 offset:128
 ds_read_b64_tr_b16 a[250:251], v10 offset:5248
 mf v[160:163], a[252:255], a[152:155], v[160:163]
 mf v[164:167], a[252:255], a[156:159], v[164:167]
 mf v[168:171], a[252:255], a[160:163], v[168:171]
 s_add_u32 m0, s83, 0x20800
 mf v[172:175], a[252:255], a[164:167], v[172:175]
 s_waitcnt lgkmcnt(8)
 ds_read_b64_tr_b16 a[252:253], v11 offset:128
 ds_read_b64_tr_b16 a[254:255], v11 offset:5248
 mf v[32:35], a[232:235], a[168:171], v[32:35]
 s_add_u32 s61, s84, 0x1800
 buffer_load_dwordx4 v24, s[32:35], s60 offen lds
 mf v[36:39], a[232:235], a[172:175], v[36:39]
 buffer_load_dwordx4 a[136:139], v4, s[40:43], s61 offen
 mf v[40:43], a[232:235], a[176:179], v[40:43]
 mf v[44:47], a[232:235], a[180:183], v[44:47]
 s_waitcnt lgkmcnt(8)
 ds_read_b64_tr_b16 a[232:233], v10 offset:192
 ds_read_b64_tr_b16 a[234:235], v10 offset:5312
 mf v[48:51], a[236:239], a[168:171], v[48:51]
 mf v[52:55], a[236:239], a[172:175], v[52:55]
 mf v[56:59], a[236:239], a[176:179], v[56:59]
 s_add_u32 m0, s83, 0x20c00
 mf v[60:63], a[236:239], a[180:183], v[60:63]
 s_waitcnt lgkmcnt(8)
 s_add_u32 s61, s84, s17
 ds_read_b64_tr_b16 a[236:237], v11 offset:192
 ds_read_b64_tr_b16 a[238:239], v11 offset:5312
 mf v[64:67], a[240:243], a[168:171], v[64:67]
 s_add_u32 s61, s61, 0x1800
 buffer_load_dwordx4 v25, s[32:35], s60 offen lds
 mf v[68:71], a[240:243], a[172:175], v[68:71]
 buffer_load_dwordx4 a[140:143], v4, s[40:43], s61 offen
 mf v[72:75], a[240:243], a[176:179], v[72:75]
 mf v[76:79], a[240:243], a[180:183], v[76:79]
 s_waitcnt lgkmcnt(8)
 ds_read_b64_tr_b16 a[240:241], v10 offset:256
 ds_read_b64_tr_b16 a[242:243], v10 offset:5376
 mf v[80:83], a[244:247], a[168:171], v[80:83]
 mf v[84:87], a[244:247], a[172:175], v[84:87]
 mf v[88:91], a[244:247], a[176:179], v[88:91]
 s_add_u32 m0, s83, 0x21000
 mf v[92:95], a[244:247], a[180:183], v[92:95]
 s_waitcnt lgkmcnt(8)
 s_add_u32 s61, s85, 0x1800
 ds_read_b64_tr_b16 a[244:245], v10 offset:10240
 ds_read_b64_tr_b16 a[246:247], v10 offset:15360
 mf v[96:99], a[248:251], a[168:171], v[96:99]
 buffer_load_dwordx4 v26, s[32:35], s60 offen lds
 mf v[100:103], a[248:251], a[172:175], v[100:103]
 buffer_load_dwordx4 a[144:147], v4, s[40:43], s61 offen
 mf v[104:107], a[248:251], a[176:179], v[104:107]
 mf v[108:111], a[248:251], a[180:183], v[108:111]
 s_waitcnt lgkmcnt(8)
 ds_read_b64_tr_b16 a[248:249], v11 offset:10240
 ds_read_b64_tr_b16 a[250:251], v11 offset:15360
 mf v[112:115], a[252:255], a[168:171], v[112:115]
 mf v[116:119], a[252:255], a[172:175], v[116:119]
 mf v[120:123], a[252:255], a[176:179], v[120:123]
 mf v[124:127], a[252:255], a[180:183], v[124:127]
 s_waitcnt lgkmcnt(8)
 s_add_u32 s61, s85, s17
 ds_read_b64_tr_b16 a[252:253], v10 offset:10304
 ds_read_b64_tr_b16 a[254:255], v10 offset:15424
 mf v[128:131], a[232:235], a[168:171], v[128:131]
 s_add_u32 s61, s61, 0x1800
 buffer_load_dwordx4 a[148:151], v4, s[40:43], s61 offen
 mf v[132:135], a[232:235], a[172:175], v[132:135]
 mf v[136:139], a[232:235], a[176:179], v[136:139]
 mf v[140:143], a[232:235], a[180:183], v[140:143]
 s_waitcnt lgkmcnt(8)
 ds_read_b64_tr_b16 a[232:233], v11 offset:10304
 ds_read_b64_tr_b16 a[234:235], v11 offset:15424
 mf v[144:147], a[236:239], a[168:171], v[144:147]
 mf v[148:151], a[236:239], a[172:175], v[148:151]
 mf v[152:155], a[236:239], a[176:179], v[152:155]
 s_add_u32 s61, s84, 0x1800
 buffer_load_dwordx4 a[152:155], v4, s[40:43], s61 offen offset:1024
 mf v[156:159], a[236:239], a[180:183], v[156:159]
 s_waitcnt lgkmcnt(8)
 ds_read_b64_tr_b16 a[236:237], v10 offset:10368
 ds_read_b64_tr_b16 a[238:239], v10 offset:15488
 mf v[160:163], a[240:243], a[168:171], v[160:163]
 mf v[164:167], a[240:243], a[172:175], v[164:167]
 mf v[168:171], a[240:243], a[176:179], v[168:171]
 mf v[172:175], a[240:243], a[180:183], v[172:175]
 s_waitcnt lgkmcnt(8)
 ds_read_b64_tr_b16 a[240:241], v11 offset:10368
 ds_read_b64_tr_b16 a[242:243], v11 offset:15488
 mf v[32:35], a[244:247], a[184:187], v[32:35]
 s_add_u32 s61, s84, s17
 mf v[36:39], a[244:247], a[188:191], v[36:39]
 s_add_u32 s61, s61, 0x1800
 buffer_load_dwordx4 a[156:159], v4, s[40:43], s61 offen offset:1024
 mf v[40:43], a[244:247], a[192:195], v[40:43]
 mf v[44:47], a[244:247], a[196:199], v[44:47]
 s_waitcnt lgkmcnt(8)
 ds_read_b64_tr_b16 a[244:245], v10 offset:10432
 ds_read_b64_tr_b16 a[246:247], v10 offset:15552
 mf v[48:51], a[248:251], a[184:187], v[48:51]
 mf v[52:55], a[248:251], a[188:191], v[52:55]
 mf v[56:59], a[248:251], a[192:195], v[56:59]
 mf v[60:63], a[248:251], a[196:199], v[60:63]
 s_waitcnt lgkmcnt(8)
 s_add_u32 s61, s85, 0x1800
 ds_read_b64_tr_b16 a[248:249], v11 offset:10432
 ds_read_b64_tr_b16 a[250:251], v11 offset:15552
 mf v[64:67], a[252:255], a[184:187], v[64:67]
 buffer_load_dwordx4 a[160:163], v4, s[40:43], s61 offen offset:1024
 mf v[68:71], a[252:255], a[188:191], v[68:71]
 mf v[72:75], a[252:255], a[192:195], v[72:75]
 mf v[76:79], a[252:255], a[196:199], v[76:79]
 s_waitcnt lgkmcnt(8)
 ds_read_b64_tr_b16 a[252:253], v10 offset:10496
 ds_read_b64_tr_b16 a[254:255], v10 offset:15616
 mf v[80:83], a[232:235], a[184:187], v[80:83]
 mf v[84:87], a[232:235], a[188:191], v[84:87]
 mf v[88:91], a[232:235], a[192:195], v[88:91]
 s_add_u32 s61, s85, s17
 mf v[92:95], a[232:235], a[196:199], v[92:95]
 s_waitcnt lgkmcnt(8)
 s_add_u32 s61, s61, 0x1800
 buffer_load_dwordx4 a[164:167], v4, s[40:43], s61 offen offset:1024
 mf v[96:99], a[236:239], a[184:187], v[96:99]
 mf v[100:103], a[236:239], a[188:191], v[100:103]
 s_waitcnt vmcnt(26)
 s_waitcnt lgkmcnt(0)
 s_barrier
 mf v[104:107], a[236:239], a[192:195], v[104:107]
 s_add_u32 s60, s91, 0x5a000
 ds_read_b64_tr_b16 a[232:233], v12
 ds_read_b64_tr_b16 a[234:235], v12 offset:5120
 mf v[108:111], a[236:239], a[196:199], v[108:111]
 s_add_u32 m0, s83, 0
 ds_read_b64_tr_b16 a[236:237], v13
 ds_read_b64_tr_b16 a[238:239], v13 offset:5120
 mf v[112:115], a[240:243], a[184:187], v[112:115]
 buffer_load_dwordx4 v22, s[32:35], s60 offen lds
 mf v[116:119], a[240:243], a[188:191], v[116:119]
 mf v[120:123], a[240:243], a[192:195], v[120:123]
 mf v[124:127], a[240:243], a[196:199], v[124:127]
 ds_read_b64_tr_b16 a[240:241], v12 offset:64
 ds_read_b64_tr_b16 a[242:243], v12 offset:5184
 mf v[128:131], a[244:247], a[184:187], v[128:131]
 mf v[132:135], a[244:247], a[188:191], v[132:135]
 mf v[136:139], a[244:247], a[192:195], v[136:139]
 s_add_u32 m0, s83, 0x400
 mf v[140:143], a[244:247], a[196:199], v[140:143]
 ds_read_b64_tr_b16 a[244:245], v13 offset:64
 ds_read_b64_tr_b16 a[246:247], v13 offset:5184
 mf v[144:147], a[248:251], a[184:187], v[144:147]
 buffer_load_dwordx4 v23, s[32:35], s60 offen lds
 mf v[148:151], a[248:251], a[188:191], v[148:151]
 mf v[152:155], a[248:251], a[192:195], v[152:155]
 mf v[156:159], a[248:251], a[196:199], v[156:159]
 ds_read_b64_tr_b16 a[248:249], v12 offset:128
 ds_read_b64_tr_b16 a[250:251], v12 offset:5248
 mf v[160:163], a[252:255], a[184:187], v[160:163]
 mf v[164:167], a[252:255], a[188:191], v[164:167]
 mf v[168:171], a[252:255], a[192:195], v[168:171]
 s_add_u32 m0, s83, 0x800
 mf v[172:175], a[252:255], a[196:199], v[172:175]
 s_waitcnt lgkmcnt(8)
 ds_read_b64_tr_b16 a[252:253], v13 offset:128
 ds_read_b64_tr_b16 a[254:255], v13 offset:5248
 mf v[32:35], a[232:235], a[200:203], v[32:35]
 s_add_u32 s61, s84, 0x2000
 buffer_load_dwordx4 v24, s[32:35], s60 offen lds
 mf v[36:39], a[232:235], a[204:207], v[36:39]
 buffer_load_dwordx4 a[168:171], v4, s[40:43], s61 offen
 mf v[40:43], a[232:235], a[208:211], v[40:43]
 mf v[44:47], a[232:235], a[212:215], v[44:47]
 s_waitcnt lgkmcnt(8)
 ds_read_b64_tr_b16 a[232:233], v12 offset:192
 ds_read_b64_tr_b16 a[234:235], v12 offset:5312
 mf v[48:51], a[236:239], a[200:203], v[48:51]
 mf v[52:55], a[236:239], a[204:207], v[52:55]
 mf v[56:59], a[236:239], a[208:211], v[56:59]
 s_add_u32 m0, s83, 0xc00
 mf v[60:63], a[236:239], a[212:215], v[60:63]
 s_waitcnt lgkmcnt(8)
 s_add_u32 s61, s84, s17
 ds_read_b64_tr_b16 a[236:237], v13 offset:192
 ds_read_b64_tr_b16 a[238:239], v13 offset:5312
 mf v[64:67], a[240:243], a[200:203], v[64:67]
 s_add_u32 s61, s61, 0x2000
 buffer_load_dwordx4 v25, s[32:35], s60 offen lds
 mf v[68:71], a[240:243], a[204:207], v[68:71]
 buffer_load_dwordx4 a[172:175], v4, s[40:43], s61 offen
 mf v[72:75], a[240:243], a[208:211], v[72:75]
 mf v[76:79], a[240:243], a[212:215], v[76:79]
 s_waitcnt lgkmcnt(8)
 s_lshl_b32 s62, s66, 3
 ds_read_b64_tr_b16 a[240:241], v12 offset:256
 ds_read_b64_tr_b16 a[242:243], v12 offset:5376
 mf v[80:83], a[244:247], a[200:203], v[80:83]
 s_add_u32 s62, s62, s64
 mf v[84:87], a[244:247], a[204:207], v[84:87]
 s_lshl_b32 s62, s62, 2
 mf v[88:91], a[244:247], a[208:211], v[88:91]
 s_add_u32 m0, s83, 0x1000
 mf v[92:95], a[244:247], a[212:215], v[92:95]
 s_waitcnt lgkmcnt(8)
 s_add_u32 s61, s85, 0x2000
 ds_read_b64_tr_b16 a[244:245], v12 offset:10240
 ds_read_b64_tr_b16 a[246:247], v12 offset:15360
 mf v[96:99], a[248:251], a[200:203], v[96:99]
 s_add_u32 s62, s62, s65
 buffer_load_dwordx4 v26, s[32:35], s60 offen lds
 mf v[100:103], a[248:251], a[204:207], v[100:103]
 s_lshl_b32 s62, s62, 7
 buffer_load_dwordx4 a[176:179], v4, s[40:43], s61 offen
 mf v[104:107], a[248:251], a[208:211], v[104:107]
 s_add_u32 s62, s62, 0x18000
 mf v[108:111], a[248:251], a[212:215], v[108:111]
 s_waitcnt lgkmcnt(8)
 ds_read_b64_tr_b16 a[248:249], v13 offset:10240
 ds_read_b64_tr_b16 a[250:251], v13 offset:15360
 mf v[112:115], a[252:255], a[200:203], v[112:115]
 mf v[116:119], a[252:255], a[204:207], v[116:119]
 mf v[120:123], a[252:255], a[208:211], v[120:123]
 mf v[124:127], a[252:255], a[212:215], v[124:127]
 s_waitcnt lgkmcnt(8)
 s_add_u32 s61, s85, s17
 ds_read_b64_tr_b16 a[252:253], v12 offset:10304
 ds_read_b64_tr_b16 a[254:255], v12 offset:15424
 mf v[128:131], a[232:235], a[200:203], v[128:131]
 s_add_u32 s61, s61, 0x2000
 buffer_load_dwordx4 a[180:183], v4, s[40:43], s61 offen
 mf v[132:135], a[232:235], a[204:207], v[132:135]
 mf v[136:139], a[232:235], a[208:211], v[136:139]
 mf v[140:143], a[232:235], a[212:215], v[140:143]
 s_waitcnt lgkmcnt(8)
 ds_read_b64_tr_b16 a[232:233], v13 offset:10304
 ds_read_b64_tr_b16 a[234:235], v13 offset:15424
 mf v[144:147], a[236:239], a[200:203], v[144:147]
 mf v[148:151], a[236:239], a[204:207], v[148:151]
 mf v[152:155], a[236:239], a[208:211], v[152:155]
 s_add_u32 s61, s84, 0x2000
 buffer_load_dwordx4 a[184:187], v4, s[40:43], s61 offen offset:1024
 mf v[156:159], a[236:239], a[212:215], v[156:159]
 s_waitcnt lgkmcnt(8)
 ds_read_b64_tr_b16 a[236:237], v12 offset:10368
 ds_read_b64_tr_b16 a[238:239], v12 offset:15488
 mf v[160:163], a[240:243], a[200:203], v[160:163]
 mf v[164:167], a[240:243], a[204:207], v[164:167]
 mf v[168:171], a[240:243], a[208:211], v[168:171]
 mf v[172:175], a[240:243], a[212:215], v[172:175]
 s_waitcnt lgkmcnt(8)
 ds_read_b64_tr_b16 a[240:241], v13 offset:10368
 ds_read_b64_tr_b16 a[242:243], v13 offset:15488
 mf v[32:35], a[244:247], a[216:219], v[32:35]
 s_add_u32 s61, s84, s17
 mf v[36:39], a[244:247], a[220:223], v[36:39]
 s_add_u32 s61, s61, 0x2000
 buffer_load_dwordx4 a[188:191], v4, s[40:43], s61 offen offset:1024
 mf v[40:43], a[244:247], a[224:227], v[40:43]
 mf v[44:47], a[244:247], a[228:231], v[44:47]
 s_waitcnt lgkmcnt(8)
 ds_read_b64_tr_b16 a[244:245], v12 offset:10432
 ds_read_b64_tr_b16 a[246:247], v12 offset:15552
 mf v[48:51], a[248:251], a[216:219], v[48:51]
 mf v[52:55], a[248:251], a[220:223], v[52:55]
 mf v[56:59], a[248:251], a[224:227], v[56:59]
 mf v[60:63], a[248:251], a[228:231], v[60:63]
 s_waitcnt lgkmcnt(8)
 s_add_u32 s61, s85, 0x2000
 ds_read_b64_tr_b16 a[248:249], v13 offset:10432
 ds_read_b64_tr_b16 a[250:251], v13 offset:15552
 mf v[64:67], a[252:255], a[216:219], v[64:67]
 buffer_load_dwordx4 a[192:195], v4, s[40:43], s61 offen offset:1024
 mf v[68:71], a[252:255], a[220:223], v[68:71]
 mf v[72:75], a[252:255], a[224:227], v[72:75]
 mf v[76:79], a[252:255], a[228:231], v[76:79]
 s_waitcnt lgkmcnt(8)
 ds_read_b64_tr_b16 a[252:253], v12 offset:10496
 ds_read_b64_tr_b16 a[254:255], v12 offset:15616
 mf v[80:83], a[232:235], a[216:219], v[80:83]
 mf v[84:87], a[232:235], a[220:223], v[84:87]
 mf v[88:91], a[232:235], a[224:227], v[88:91]
 s_add_u32 s61, s85, s17
 mf v[92:95], a[232:235], a[228:231], v[92:95]
 s_waitcnt lgkmcnt(8)
 s_add_u32 s61, s61, 0x2000
 buffer_load_dwordx4 a[196:199], v4, s[40:43], s61 offen offset:1024
 mf v[96:99], a[236:239], a[216:219], v[96:99]
 mf v[100:103], a[236:239], a[220:223], v[100:103]
 s_waitcnt vmcnt(26)
 s_waitcnt lgkmcnt(0)
 s_barrier
 mf v[104:107], a[236:239], a[224:227], v[104:107]
 s_add_u32 s60, s91, 0x6c000
 ds_read_b64_tr_b16 a[232:233], v14
 ds_read_b64_tr_b16 a[234:235], v14 offset:5120
 mf v[108:111], a[236:239], a[228:231], v[108:111]
 s_add_u32 m0, s83, 0x5000
 ds_read_b64_tr_b16 a[236:237], v15
 ds_read_b64_tr_b16 a[238:239], v15 offset:5120
 mf v[112:115], a[240:243], a[216:219], v[112:115]
 buffer_load_dwordx4 v22, s[32:35], s60 offen lds
 mf v[116:119], a[240:243], a[220:223], v[116:119]
 buffer_store_dword v6, v5, s[52:55], s62 offen sc1
 mf v[120:123], a[240:243], a[224:227], v[120:123]
 mf v[124:127], a[240:243], a[228:231], v[124:127]
 ds_read_b64_tr_b16 a[240:241], v14 offset:64
 ds_read_b64_tr_b16 a[242:243], v14 offset:5184
 mf v[128:131], a[244:247], a[216:219], v[128:131]
 mf v[132:135], a[244:247], a[220:223], v[132:135]
 mf v[136:139], a[244:247], a[224:227], v[136:139]
 s_add_u32 m0, s83, 0x5400
 mf v[140:143], a[244:247], a[228:231], v[140:143]
 ds_read_b64_tr_b16 a[244:245], v15 offset:64
 ds_read_b64_tr_b16 a[246:247], v15 offset:5184
 mf v[144:147], a[248:251], a[216:219], v[144:147]
 buffer_load_dwordx4 v23, s[32:35], s60 offen lds
 mf v[148:151], a[248:251], a[220:223], v[148:151]
 mf v[152:155], a[248:251], a[224:227], v[152:155]
 mf v[156:159], a[248:251], a[228:231], v[156:159]
 ds_read_b64_tr_b16 a[248:249], v14 offset:128
 ds_read_b64_tr_b16 a[250:251], v14 offset:5248
 mf v[160:163], a[252:255], a[216:219], v[160:163]
 mf v[164:167], a[252:255], a[220:223], v[164:167]
 mf v[168:171], a[252:255], a[224:227], v[168:171]
 s_add_u32 m0, s83, 0x5800
 mf v[172:175], a[252:255], a[228:231], v[172:175]
 s_waitcnt vmcnt(25) lgkmcnt(8)
 ds_read_b64_tr_b16 a[252:253], v15 offset:128
 ds_read_b64_tr_b16 a[254:255], v15 offset:5248
 mf v[32:35], a[232:235], a[136:139], v[32:35]
 s_waitcnt vmcnt(23)
 s_add_u32 s61, s84, 0x2800
 buffer_load_dwordx4 v24, s[32:35], s60 offen lds
 mf v[36:39], a[232:235], a[140:143], v[36:39]
 s_waitcnt vmcnt(22)
 buffer_load_dwordx4 a[200:203], v4, s[40:43], s61 offen
 mf v[40:43], a[232:235], a[144:147], v[40:43]
 s_waitcnt vmcnt(22)
 mf v[44:47], a[232:235], a[148:151], v[44:47]
 s_waitcnt lgkmcnt(8)
 ds_read_b64_tr_b16 a[232:233], v14 offset:192
 ds_read_b64_tr_b16 a[234:235], v14 offset:5312
 mf v[48:51], a[236:239], a[136:139], v[48:51]
 mf v[52:55], a[236:239], a[140:143], v[52:55]
 mf v[56:59], a[236:239], a[144:147], v[56:59]
 s_add_u32 m0, s83, 0x5c00
 mf v[60:63], a[236:239], a[148:151], v[60:63]
 s_waitcnt lgkmcnt(8)
 s_add_u32 s61, s84, s17
 ds_read_b64_tr_b16 a[236:237], v15 offset:192
 ds_read_b64_tr_b16 a[238:239], v15 offset:5312
 mf v[64:67], a[240:243], a[136:139], v[64:67]
 s_add_u32 s61, s61, 0x2800
 buffer_load_dwordx4 v25, s[32:35], s60 offen lds
 mf v[68:71], a[240:243], a[140:143], v[68:71]
 buffer_load_dwordx4 a[204:207], v4, s[40:43], s61 offen
 mf v[72:75], a[240:243], a[144:147], v[72:75]
 mf v[76:79], a[240:243], a[148:151], v[76:79]
 s_waitcnt lgkmcnt(8)
 ds_read_b64_tr_b16 a[240:241], v14 offset:256
 ds_read_b64_tr_b16 a[242:243], v14 offset:5376
 mf v[80:83], a[244:247], a[136:139], v[80:83]
 mf v[84:87], a[244:247], a[140:143], v[84:87]
 mf v[88:91], a[244:247], a[144:147], v[88:91]
 s_add_u32 m0, s83, 0x6000
 mf v[92:95], a[244:247], a[148:151], v[92:95]
 s_waitcnt lgkmcnt(8)
 s_add_u32 s61, s85, 0x2800
 ds_read_b64_tr_b16 a[244:245], v14 offset:10240
 ds_read_b64_tr_b16 a[246:247], v14 offset:15360
 mf v[96:99], a[248:251], a[136:139], v[96:99]
 buffer_load_dwordx4 v26, s[32:35], s60 offen lds
 mf v[100:103], a[248:251], a[140:143], v[100:103]
 buffer_load_dwordx4 a[208:211], v4, s[40:43], s61 offen
 mf v[104:107], a[248:251], a[144:147], v[104:107]
 mf v[108:111], a[248:251], a[148:151], v[108:111]
 s_waitcnt lgkmcnt(8)
 ds_read_b64_tr_b16 a[248:249], v15 offset:10240
 ds_read_b64_tr_b16 a[250:251], v15 offset:15360
 mf v[112:115], a[252:255], a[136:139], v[112:115]
 mf v[116:119], a[252:255], a[140:143], v[116:119]
 mf v[120:123], a[252:255], a[144:147], v[120:123]
 mf v[124:127], a[252:255], a[148:151], v[124:127]
 s_waitcnt lgkmcnt(8)
 s_add_u32 s61, s85, s17
 ds_read_b64_tr_b16 a[252:253], v14 offset:10304
 ds_read_b64_tr_b16 a[254:255], v14 offset:15424
 mf v[128:131], a[232:235], a[136:139], v[128:131]
 s_add_u32 s61, s61, 0x2800
 buffer_load_dwordx4 a[212:215], v4, s[40:43], s61 offen
 mf v[132:135], a[232:235], a[140:143], v[132:135]
 mf v[136:139], a[232:235], a[144:147], v[136:139]
 mf v[140:143], a[232:235], a[148:151], v[140:143]
 s_waitcnt lgkmcnt(8)
 ds_read_b64_tr_b16 a[232:233], v15 offset:10304
 ds_read_b64_tr_b16 a[234:235], v15 offset:15424
 mf v[144:147], a[236:239], a[136:139], v[144:147]
 mf v[148:151], a[236:239], a[140:143], v[148:151]
 mf v[152:155], a[236:239], a[144:147], v[152:155]
 s_add_u32 s61, s84, 0x2800
 buffer_load_dwordx4 a[216:219], v4, s[40:43], s61 offen offset:1024
 mf v[156:159], a[236:239], a[148:151], v[156:159]
 s_waitcnt lgkmcnt(8)
 ds_read_b64_tr_b16 a[236:237], v14 offset:10368
 ds_read_b64_tr_b16 a[238:239], v14 offset:15488
 mf v[160:163], a[240:243], a[136:139], v[160:163]
 mf v[164:167], a[240:243], a[140:143], v[164:167]
 mf v[168:171], a[240:243], a[144:147], v[168:171]
 mf v[172:175], a[240:243], a[148:151], v[172:175]
 s_waitcnt vmcnt(27) lgkmcnt(8)
 ds_read_b64_tr_b16 a[240:241], v15 offset:10368
 ds_read_b64_tr_b16 a[242:243], v15 offset:15488
 mf v[32:35], a[244:247], a[152:155], v[32:35]
 s_waitcnt vmcnt(26)
 s_add_u32 s61, s84, s17
 mf v[36:39], a[244:247], a[156:159], v[36:39]
 s_waitcnt vmcnt(25)
 s_add_u32 s61, s61, 0x2800
 buffer_load_dwordx4 a[220:223], v4, s[40:43], s61 offen offset:1024
 mf v[40:43], a[244:247], a[160:163], v[40:43]
 s_waitcnt vmcnt(25)
 mf v[44:47], a[244:247], a[164:167], v[44:47]
 s_waitcnt lgkmcnt(8)
 ds_read_b64_tr_b16 a[244:245], v14 offset:10432
 ds_read_b64_tr_b16 a[246:247], v14 offset:15552
 mf v[48:51], a[248:251], a[152:155], v[48:51]
 mf v[52:55], a[248:251], a[156:159], v[52:55]
 mf v[56:59], a[248:251], a[160:163], v[56:59]
 mf v[60:63], a[248:251], a[164:167], v[60:63]
 s_waitcnt lgkmcnt(8)
 s_add_u32 s61, s85, 0x2800
 ds_read_b64_tr_b16 a[248:249], v15 offset:10432
 ds_read_b64_tr_b16 a[250:251], v15 offset:15552
 mf v[64:67], a[252:255], a[152:155], v[64:67]
 buffer_load_dwordx4 a[224:227], v4, s[40:43], s61 offen offset:1024
 mf v[68:71], a[252:255], a[156:159], v[68:71]
 mf v[72:75], a[252:255], a[160:163], v[72:75]
 mf v[76:79], a[252:255], a[164:167], v[76:79]
 s_waitcnt lgkmcnt(8)
 ds_read_b64_tr_b16 a[252:253], v14 offset:10496
 ds_read_b64_tr_b16 a[254:255], v14 offset:15616
 mf v[80:83], a[232:235], a[152:155], v[80:83]
 mf v[84:87], a[232:235], a[156:159], v[84:87]
 mf v[88:91], a[232:235], a[160:163], v[88:91]
 s_add_u32 s61, s85, s17
 mf v[92:95], a[232:235], a[164:167], v[92:95]
 s_waitcnt lgkmcnt(8)
 s_add_u32 s61, s61, 0x2800
 buffer_load_dwordx4 a[228:231], v4, s[40:43], s61 offen offset:1024
 mf v[96:99], a[236:239], a[152:155], v[96:99]
 mf v[100:103], a[236:239], a[156:159], v[100:103]
 s_waitcnt lgkmcnt(0)
 s_barrier
 mf v[104:107], a[236:239], a[160:163], v[104:107]
 s_add_u32 s60, s91, 0x7e000
 ds_read_b64_tr_b16 a[232:233], v8
 ds_read_b64_tr_b16 a[234:235], v8 offset:5120
 mf v[108:111], a[236:239], a[164:167], v[108:111]
 s_add_u32 m0, s83, 0xa000
 ds_read_b64_tr_b16 a[236:237], v9
 ds_read_b64_tr_b16 a[238:239], v9 offset:5120
 mf v[112:115], a[240:243], a[152:155], v[112:115]
 buffer_load_dwordx4 v22, s[32:35], s60 offen lds
 mf v[116:119], a[240:243], a[156:159], v[116:119]
 mf v[120:123], a[240:243], a[160:163], v[120:123]
 mf v[124:127], a[240:243], a[164:167], v[124:127]
 ds_read_b64_tr_b16 a[240:241], v8 offset:64
 ds_read_b64_tr_b16 a[242:243], v8 offset:5184
 mf v[128:131], a[244:247], a[152:155], v[128:131]
 mf v[132:135], a[244:247], a[156:159], v[132:135]
 mf v[136:139], a[244:247], a[160:163], v[136:139]
 s_add_u32 m0, s83, 0xa400
 mf v[140:143], a[244:247], a[164:167], v[140:143]
 ds_read_b64_tr_b16 a[244:245], v9 offset:64
 ds_read_b64_tr_b16 a[246:247], v9 offset:5184
 mf v[144:147], a[248:251], a[152:155], v[144:147]
 buffer_load_dwordx4 v23, s[32:35], s60 offen lds
 mf v[148:151], a[248:251], a[156:159], v[148:151]
 mf v[152:155], a[248:251], a[160:163], v[152:155]
 mf v[156:159], a[248:251], a[164:167], v[156:159]
 ds_read_b64_tr_b16 a[248:249], v8 offset:128
 ds_read_b64_tr_b16 a[250:251], v8 offset:5248
 mf v[160:163], a[252:255], a[152:155], v[160:163]
 mf v[164:167], a[252:255], a[156:159], v[164:167]
 mf v[168:171], a[252:255], a[160:163], v[168:171]
 s_add_u32 m0, s83, 0xa800
 mf v[172:175], a[252:255], a[164:167], v[172:175]
 s_waitcnt vmcnt(25) lgkmcnt(8)
 ds_read_b64_tr_b16 a[252:253], v9 offset:128
 ds_read_b64_tr_b16 a[254:255], v9 offset:5248
 mf v[32:35], a[232:235], a[168:171], v[32:35]
 s_waitcnt vmcnt(23)
 s_add_u32 s61, s84, 0x3000
 buffer_load_dwordx4 v24, s[32:35], s60 offen lds
 mf v[36:39], a[232:235], a[172:175], v[36:39]
 s_waitcnt vmcnt(22)
 buffer_load_dwordx4 a[136:139], v4, s[40:43], s61 offen
 mf v[40:43], a[232:235], a[176:179], v[40:43]
 s_waitcnt vmcnt(22)
 mf v[44:47], a[232:235], a[180:183], v[44:47]
 s_waitcnt lgkmcnt(8)
 ds_read_b64_tr_b16 a[232:233], v8 offset:192
 ds_read_b64_tr_b16 a[234:235], v8 offset:5312
 mf v[48:51], a[236:239], a[168:171], v[48:51]
 mf v[52:55], a[236:239], a[172:175], v[52:55]
 mf v[56:59], a[236:239], a[176:179], v[56:59]
 s_add_u32 m0, s83, 0xac00
 mf v[60:63], a[236:239], a[180:183], v[60:63]
 s_waitcnt lgkmcnt(8)
 s_add_u32 s61, s84, s17
 ds_read_b64_tr_b16 a[236:237], v9 offset:192
 ds_read_b64_tr_b16 a[238:239], v9 offset:5312
 mf v[64:67], a[240:243], a[168:171], v[64:67]
 s_add_u32 s61, s61, 0x3000
 buffer_load_dwordx4 v25, s[32:35], s60 offen lds
 mf v[68:71], a[240:243], a[172:175], v[68:71]
 buffer_load_dwordx4 a[140:143], v4, s[40:43], s61 offen
 mf v[72:75], a[240:243], a[176:179], v[72:75]
 mf v[76:79], a[240:243], a[180:183], v[76:79]
 s_waitcnt lgkmcnt(8)
 ds_read_b64_tr_b16 a[240:241], v8 offset:256
 ds_read_b64_tr_b16 a[242:243], v8 offset:5376
 mf v[80:83], a[244:247], a[168:171], v[80:83]
 mf v[84:87], a[244:247], a[172:175], v[84:87]
 mf v[88:91], a[244:247], a[176:179], v[88:91]
 s_add_u32 m0, s83, 0xb000
 mf v[92:95], a[244:247], a[180:183], v[92:95]
 s_waitcnt lgkmcnt(8)
 s_add_u32 s61, s85, 0x3000
 ds_read_b64_tr_b16 a[244:245], v8 offset:10240
 ds_read_b64_tr_b16 a[246:247], v8 offset:15360
 mf v[96:99], a[248:251], a[168:171], v[96:99]
 buffer_load_dwordx4 v26, s[32:35], s60 offen lds
 mf v[100:103], a[248:251], a[172:175], v[100:103]
 buffer_load_dwordx4 a[144:147], v4, s[40:43], s61 offen
 mf v[104:107], a[248:251], a[176:179], v[104:107]
 mf v[108:111], a[248:251], a[180:183], v[108:111]
 s_waitcnt lgkmcnt(8)
 ds_read_b64_tr_b16 a[248:249], v9 offset:10240
 ds_read_b64_tr_b16 a[250:251], v9 offset:15360
 mf v[112:115], a[252:255], a[168:171], v[112:115]
 mf v[116:119], a[252:255], a[172:175], v[116:119]
 mf v[120:123], a[252:255], a[176:179], v[120:123]
 mf v[124:127], a[252:255], a[180:183], v[124:127]
 s_waitcnt lgkmcnt(8)
 s_add_u32 s61, s85, s17
 ds_read_b64_tr_b16 a[252:253], v8 offset:10304
 ds_read_b64_tr_b16 a[254:255], v8 offset:15424
 mf v[128:131], a[232:235], a[168:171], v[128:131]
 s_add_u32 s61, s61, 0x3000
 buffer_load_dwordx4 a[148:151], v4, s[40:43], s61 offen
 mf v[132:135], a[232:235], a[172:175], v[132:135]
 mf v[136:139], a[232:235], a[176:179], v[136:139]
 mf v[140:143], a[232:235], a[180:183], v[140:143]
 s_waitcnt lgkmcnt(8)
 ds_read_b64_tr_b16 a[232:233], v9 offset:10304
 ds_read_b64_tr_b16 a[234:235], v9 offset:15424
 mf v[144:147], a[236:239], a[168:171], v[144:147]
 mf v[148:151], a[236:239], a[172:175], v[148:151]
 mf v[152:155], a[236:239], a[176:179], v[152:155]
 s_add_u32 s61, s84, 0x3000
 buffer_load_dwordx2 a[152:153], v16, s[40:43], s61 offen offset:1024
 mf v[156:159], a[236:239], a[180:183], v[156:159]
 s_waitcnt lgkmcnt(8)
 ds_read_b64_tr_b16 a[236:237], v8 offset:10368
 ds_read_b64_tr_b16 a[238:239], v8 offset:15488
 mf v[160:163], a[240:243], a[168:171], v[160:163]
 buffer_load_dwordx2 a[154:155], v16, s[40:43], s61 offen offset:1536
 mf v[164:167], a[240:243], a[172:175], v[164:167]
 mf v[168:171], a[240:243], a[176:179], v[168:171]
 mf v[172:175], a[240:243], a[180:183], v[172:175]
 s_waitcnt vmcnt(28) lgkmcnt(8)
 ds_read_b64_tr_b16 a[240:241], v9 offset:10368
 ds_read_b64_tr_b16 a[242:243], v9 offset:15488
 mf v[32:35], a[244:247], a[184:187], v[32:35]
 s_waitcnt vmcnt(27)
 mf v[36:39], a[244:247], a[188:191], v[36:39]
 s_waitcnt vmcnt(26)
 mf v[40:43], a[244:247], a[192:195], v[40:43]
 s_waitcnt vmcnt(25)
 s_add_u32 s61, s84, s17
 mf v[44:47], a[244:247], a[196:199], v[44:47]
 s_waitcnt lgkmcnt(8)
 s_add_u32 s61, s61, 0x3000
 ds_read_b64_tr_b16 a[244:245], v8 offset:10432
 ds_read_b64_tr_b16 a[246:247], v8 offset:15552
 mf v[48:51], a[248:251], a[184:187], v[48:51]
 buffer_load_dwordx2 a[156:157], v16, s[40:43], s61 offen offset:1024
 mf v[52:55], a[248:251], a[188:191], v[52:55]
 buffer_load_dwordx2 a[158:159], v16, s[40:43], s61 offen offset:1536
 mf v[56:59], a[248:251], a[192:195], v[56:59]
 mf v[60:63], a[248:251], a[196:199], v[60:63]
 s_waitcnt lgkmcnt(8)
 ds_read_b64_tr_b16 a[248:249], v9 offset:10432
 ds_read_b64_tr_b16 a[250:251], v9 offset:15552
 mf v[64:67], a[252:255], a[184:187], v[64:67]
 mf v[68:71], a[252:255], a[188:191], v[68:71]
 mf v[72:75], a[252:255], a[192:195], v[72:75]
 mf v[76:79], a[252:255], a[196:199], v[76:79]
 s_waitcnt lgkmcnt(8)
 s_add_u32 s61, s85, 0x3000
 ds_read_b64_tr_b16 a[252:253], v8 offset:10496
 ds_read_b64_tr_b16 a[254:255], v8 offset:15616
 mf v[80:83], a[232:235], a[184:187], v[80:83]
 buffer_load_dwordx2 a[160:161], v16, s[40:43], s61 offen offset:1024
 mf v[84:87], a[232:235], a[188:191], v[84:87]
 buffer_load_dwordx2 a[162:163], v16, s[40:43], s61 offen offset:1536
 mf v[88:91], a[232:235], a[192:195], v[88:91]
 mf v[92:95], a[232:235], a[196:199], v[92:95]
 s_waitcnt lgkmcnt(8)
 mf v[96:99], a[236:239], a[184:187], v[96:99]
 mf v[100:103], a[236:239], a[188:191], v[100:103]
 s_waitcnt lgkmcnt(0)
 s_barrier
 mf v[104:107], a[236:239], a[192:195], v[104:107]
 s_add_u32 s60, s91, 0x90000
 ds_read_b64_tr_b16 a[232:233], v10
 ds_read_b64_tr_b16 a[234:235], v10 offset:5120
 mf v[108:111], a[236:239], a[196:199], v[108:111]
 s_add_u32 m0, s83, 0x20000
 ds_read_b64_tr_b16 a[236:237], v11
 ds_read_b64_tr_b16 a[238:239], v11 offset:5120
 mf v[112:115], a[240:243], a[184:187], v[112:115]
 s_add_u32 s61, s85, s17
 buffer_load_dwordx4 v22, s[32:35], s60 offen lds
 mf v[116:119], a[240:243], a[188:191], v[116:119]
 s_add_u32 s61, s61, 0x3000
 buffer_load_dwordx2 a[164:165], v16, s[40:43], s61 offen offset:1024
 mf v[120:123], a[240:243], a[192:195], v[120:123]
 buffer_load_dwordx2 a[166:167], v16, s[40:43], s61 offen offset:1536
 mf v[124:127], a[240:243], a[196:199], v[124:127]
 ds_read_b64_tr_b16 a[240:241], v10 offset:64
 ds_read_b64_tr_b16 a[242:243], v10 offset:5184
 mf v[128:131], a[244:247], a[184:187], v[128:131]
 mf v[132:135], a[244:247], a[188:191], v[132:135]
 mf v[136:139], a[244:247], a[192:195], v[136:139]
 s_add_u32 m0, s83, 0x20400
 mf v[140:143], a[244:247], a[196:199], v[140:143]
 ds_read_b64_tr_b16 a[244:245], v11 offset:64
 ds_read_b64_tr_b16 a[246:247], v11 offset:5184
 mf v[144:147], a[248:251], a[184:187], v[144:147]
 buffer_load_dwordx4 v23, s[32:35], s60 offen lds
 mf v[148:151], a[248:251], a[188:191], v[148:151]
 mf v[152:155], a[248:251], a[192:195], v[152:155]
 mf v[156:159], a[248:251], a[196:199], v[156:159]
 ds_read_b64_tr_b16 a[248:249], v10 offset:128
 ds_read_b64_tr_b16 a[250:251], v10 offset:5248
 mf v[160:163], a[252:255], a[184:187], v[160:163]
 mf v[164:167], a[252:255], a[188:191], v[164:167]
 mf v[168:171], a[252:255], a[192:195], v[168:171]
 s_add_u32 m0, s83, 0x20800
 mf v[172:175], a[252:255], a[196:199], v[172:175]
 s_waitcnt vmcnt(28) lgkmcnt(8)
 ds_read_b64_tr_b16 a[252:253], v11 offset:128
 ds_read_b64_tr_b16 a[254:255], v11 offset:5248
 mf v[32:35], a[232:235], a[200:203], v[32:35]
 s_waitcnt vmcnt(26)
 s_add_u32 s61, s84, 0x3800
 buffer_load_dwordx4 v24, s[32:35], s60 offen lds
 mf v[36:39], a[232:235], a[204:207], v[36:39]
 s_waitcnt vmcnt(25)
 buffer_load_dwordx4 a[168:171], v4, s[40:43], s61 offen
 mf v[40:43], a[232:235], a[208:211], v[40:43]
 s_waitcnt vmcnt(25)
 mf v[44:47], a[232:235], a[212:215], v[44:47]
 s_waitcnt lgkmcnt(8)
 ds_read_b64_tr_b16 a[232:233], v10 offset:192
 ds_read_b64_tr_b16 a[234:235], v10 offset:5312
 mf v[48:51], a[236:239], a[200:203], v[48:51]
 mf v[52:55], a[236:239], a[204:207], v[52:55]
 mf v[56:59], a[236:239], a[208:211], v[56:59]
 s_add_u32 m0, s83, 0x20c00
 mf v[60:63], a[236:239], a[212:215], v[60:63]
 s_waitcnt lgkmcnt(8)
 s_add_u32 s61, s84, s17
 ds_read_b64_tr_b16 a[236:237], v11 offset:192
 ds_read_b64_tr_b16 a[238:239], v11 offset:5312
 mf v[64:67], a[240:243], a[200:203], v[64:67]
 s_add_u32 s61, s61, 0x3800
 buffer_load_dwordx4 v25, s[32:35], s60 offen lds
 mf v[68:71], a[240:243], a[204:207], v[68:71]
 buffer_load_dwordx4 a[172:175], v4, s[40:43], s61 offen
 mf v[72:75], a[240:243], a[208:211], v[72:75]
 mf v[76:79], a[240:243], a[212:215], v[76:79]
 s_waitcnt lgkmcnt(8)
 ds_read_b64_tr_b16 a[240:241], v10 offset:256
 ds_read_b64_tr_b16 a[242:243], v10 offset:5376
 mf v[80:83], a[244:247], a[200:203], v[80:83]
 mf v[84:87], a[244:247], a[204:207], v[84:87]
 mf v[88:91], a[244:247], a[208:211], v[88:91]
 s_add_u32 m0, s83, 0x21000
 mf v[92:95], a[244:247], a[212:215], v[92:95]
 s_waitcnt lgkmcnt(8)
 s_add_u32 s61, s85, 0x3800
 ds_read_b64_tr_b16 a[244:245], v10 offset:10240
 ds_read_b64_tr_b16 a[246:247], v10 offset:15360
 mf v[96:99], a[248:251], a[200:203], v[96:99]
 buffer_load_dwordx4 v26, s[32:35], s60 offen lds
 mf v[100:103], a[248:251], a[204:207], v[100:103]
 buffer_load_dwordx4 a[176:179], v4, s[40:43], s61 offen
 mf v[104:107], a[248:251], a[208:211], v[104:107]
 mf v[108:111], a[248:251], a[212:215], v[108:111]
 s_waitcnt lgkmcnt(8)
 ds_read_b64_tr_b16 a[248:249], v11 offset:10240
 ds_read_b64_tr_b16 a[250:251], v11 offset:15360
 mf v[112:115], a[252:255], a[200:203], v[112:115]
 mf v[116:119], a[252:255], a[204:207], v[116:119]
 mf v[120:123], a[252:255], a[208:211], v[120:123]
 mf v[124:127], a[252:255], a[212:215], v[124:127]
 s_waitcnt lgkmcnt(8)
 s_add_u32 s61, s85, s17
 ds_read_b64_tr_b16 a[252:253], v10 offset:10304
 ds_read_b64_tr_b16 a[254:255], v10 offset:15424
 mf v[128:131], a[232:235], a[200:203], v[128:131]
 s_add_u32 s61, s61, 0x3800
 buffer_load_dwordx4 a[180:183], v4, s[40:43], s61 offen
 mf v[132:135], a[232:235], a[204:207], v[132:135]
 mf v[136:139], a[232:235], a[208:211], v[136:139]
 mf v[140:143], a[232:235], a[212:215], v[140:143]
 s_waitcnt lgkmcnt(8)
 ds_read_b64_tr_b16 a[232:233], v11 offset:10304
 ds_read_b64_tr_b16 a[234:235], v11 offset:15424
 mf v[144:147], a[236:239], a[200:203], v[144:147]
 mf v[148:151], a[236:239], a[204:207], v[148:151]
 mf v[152:155], a[236:239], a[208:211], v[152:155]
 s_add_u32 s61, s84, 0x3800
 buffer_load_dwordx4 a[184:187], v4, s[40:43], s61 offen offset:1024
 mf v[156:159], a[236:239], a[212:215], v[156:159]
 s_waitcnt lgkmcnt(8)
 ds_read_b64_tr_b16 a[236:237], v10 offset:10368
 ds_read_b64_tr_b16 a[238:239], v10 offset:15488
 mf v[160:163], a[240:243], a[200:203], v[160:163]
 mf v[164:167], a[240:243], a[204:207], v[164:167]
 mf v[168:171], a[240:243], a[208:211], v[168:171]
 mf v[172:175], a[240:243], a[212:215], v[172:175]
 s_waitcnt vmcnt(30) lgkmcnt(8)
 ds_read_b64_tr_b16 a[240:241], v11 offset:10368
 ds_read_b64_tr_b16 a[242:243], v11 offset:15488
 mf v[32:35], a[244:247], a[216:219], v[32:35]
 s_waitcnt vmcnt(29)
 s_add_u32 s61, s84, s17
 mf v[36:39], a[244:247], a[220:223], v[36:39]
 s_waitcnt vmcnt(28)
 s_add_u32 s61, s61, 0x3800
 buffer_load_dwordx4 a[188:191], v4, s[40:43], s61 offen offset:1024
 mf v[40:43], a[244:247], a[224:227], v[40:43]
 s_waitcnt vmcnt(28)
 mf v[44:47], a[244:247], a[228:231], v[44:47]
 s_waitcnt lgkmcnt(8)
 ds_read_b64_tr_b16 a[244:245], v10 offset:10432
 ds_read_b64_tr_b16 a[246:247], v10 offset:15552
 mf v[48:51], a[248:251], a[216:219], v[48:51]
 mf v[52:55], a[248:251], a[220:223], v[52:55]
 mf v[56:59], a[248:251], a[224:227], v[56:59]
 mf v[60:63], a[248:251], a[228:231], v[60:63]
 s_waitcnt lgkmcnt(8)
 s_add_u32 s61, s85, 0x3800
 ds_read_b64_tr_b16 a[248:249], v11 offset:10432
 ds_read_b64_tr_b16 a[250:251], v11 offset:15552
 mf v[64:67], a[252:255], a[216:219], v[64:67]
 buffer_load_dwordx4 a[192:195], v4, s[40:43], s61 offen offset:1024
 mf v[68:71], a[252:255], a[220:223], v[68:71]
 mf v[72:75], a[252:255], a[224:227], v[72:75]
 mf v[76:79], a[252:255], a[228:231], v[76:79]
 s_waitcnt lgkmcnt(8)
 ds_read_b64_tr_b16 a[252:253], v10 offset:10496
 ds_read_b64_tr_b16 a[254:255], v10 offset:15616
 mf v[80:83], a[232:235], a[216:219], v[80:83]
 mf v[84:87], a[232:235], a[220:223], v[84:87]
 mf v[88:91], a[232:235], a[224:227], v[88:91]
 s_add_u32 s61, s85, s17
 mf v[92:95], a[232:235], a[228:231], v[92:95]
 s_waitcnt lgkmcnt(8)
 s_add_u32 s61, s61, 0x3800
 buffer_load_dwordx4 a[196:199], v4, s[40:43], s61 offen offset:1024
 mf v[96:99], a[236:239], a[216:219], v[96:99]
 mf v[100:103], a[236:239], a[220:223], v[100:103]
 s_waitcnt lgkmcnt(0)
 s_barrier
 mf v[104:107], a[236:239], a[224:227], v[104:107]
 s_add_u32 s60, s92, 0
 ds_read_b64_tr_b16 a[232:233], v12
 ds_read_b64_tr_b16 a[234:235], v12 offset:5120
 mf v[108:111], a[236:239], a[228:231], v[108:111]
 s_add_u32 m0, s83, 0
 ds_read_b64_tr_b16 a[236:237], v13
 ds_read_b64_tr_b16 a[238:239], v13 offset:5120
 mf v[112:115], a[240:243], a[216:219], v[112:115]
 buffer_load_dwordx4 v22, s[48:51], s60 offen lds
 mf v[116:119], a[240:243], a[220:223], v[116:119]
 mf v[120:123], a[240:243], a[224:227], v[120:123]
 mf v[124:127], a[240:243], a[228:231], v[124:127]
 ds_read_b64_tr_b16 a[240:241], v12 offset:64
 ds_read_b64_tr_b16 a[242:243], v12 offset:5184
 mf v[128:131], a[244:247], a[216:219], v[128:131]
 mf v[132:135], a[244:247], a[220:223], v[132:135]
 mf v[136:139], a[244:247], a[224:227], v[136:139]
 s_add_u32 m0, s83, 0x400
 mf v[140:143], a[244:247], a[228:231], v[140:143]
 ds_read_b64_tr_b16 a[244:245], v13 offset:64
 ds_read_b64_tr_b16 a[246:247], v13 offset:5184
 mf v[144:147], a[248:251], a[216:219], v[144:147]
 buffer_load_dwordx4 v23, s[48:51], s60 offen lds
 mf v[148:151], a[248:251], a[220:223], v[148:151]
 mf v[152:155], a[248:251], a[224:227], v[152:155]
 mf v[156:159], a[248:251], a[228:231], v[156:159]
 ds_read_b64_tr_b16 a[248:249], v12 offset:128
 ds_read_b64_tr_b16 a[250:251], v12 offset:5248
 mf v[160:163], a[252:255], a[216:219], v[160:163]
 mf v[164:167], a[252:255], a[220:223], v[164:167]
 mf v[168:171], a[252:255], a[224:227], v[168:171]
 s_add_u32 m0, s83, 0x800
 mf v[172:175], a[252:255], a[228:231], v[172:175]
 s_waitcnt vmcnt(28) lgkmcnt(8)
 ds_read_b64_tr_b16 a[252:253], v13 offset:128
 ds_read_b64_tr_b16 a[254:255], v13 offset:5248
 mf v[32:35], a[232:235], a[136:139], v[32:35]
 s_waitcnt vmcnt(26)
 s_add_u32 s61, s84, 0x4000
 buffer_load_dwordx4 v24, s[48:51], s60 offen lds
 mf v[36:39], a[232:235], a[140:143], v[36:39]
 s_waitcnt vmcnt(25)
 buffer_load_dwordx4 a[200:203], v4, s[40:43], s61 offen
 mf v[40:43], a[232:235], a[144:147], v[40:43]
 s_waitcnt vmcnt(25)
 mf v[44:47], a[232:235], a[148:151], v[44:47]
 s_waitcnt lgkmcnt(8)
 ds_read_b64_tr_b16 a[232:233], v12 offset:192
 ds_read_b64_tr_b16 a[234:235], v12 offset:5312
 mf v[48:51], a[236:239], a[136:139], v[48:51]
 mf v[52:55], a[236:239], a[140:143], v[52:55]
 mf v[56:59], a[236:239], a[144:147], v[56:59]
 s_add_u32 m0, s83, 0xc00
 mf v[60:63], a[236:239], a[148:151], v[60:63]
 s_waitcnt lgkmcnt(8)
 s_add_u32 s61, s84, s17
 ds_read_b64_tr_b16 a[236:237], v13 offset:192
 ds_read_b64_tr_b16 a[238:239], v13 offset:5312
 mf v[64:67], a[240:243], a[136:139], v[64:67]
 s_add_u32 s61, s61, 0x4000
 buffer_load_dwordx4 v25, s[48:51], s60 offen lds
 mf v[68:71], a[240:243], a[140:143], v[68:71]
 buffer_load_dwordx4 a[204:207], v4, s[40:43], s61 offen
 mf v[72:75], a[240:243], a[144:147], v[72:75]
 v_and_b32 v19, 3, v1
 mf v[76:79], a[240:243], a[148:151], v[76:79]
 s_waitcnt lgkmcnt(8)
 ds_read_b64_tr_b16 a[240:241], v12 offset:256
 ds_read_b64_tr_b16 a[242:243], v12 offset:5376
 mf v[80:83], a[244:247], a[136:139], v[80:83]
 v_lshlrev_b32 v19, 7, v19
 mf v[84:87], a[244:247], a[140:143], v[84:87]
 s_lshl_b32 s63, s66, 3
 mf v[88:91], a[244:247], a[144:147], v[88:91]
 s_add_u32 m0, s83, 0x1000
 mf v[92:95], a[244:247], a[148:151], v[92:95]
 s_waitcnt lgkmcnt(8)
 s_add_u32 s61, s85, 0x4000
 ds_read_b64_tr_b16 a[244:245], v12 offset:10240
 ds_read_b64_tr_b16 a[246:247], v12 offset:15360
 mf v[96:99], a[248:251], a[136:139], v[96:99]
 s_add_u32 s63, s63, s64
 buffer_load_dwordx4 v26, s[48:51], s60 offen lds
 mf v[100:103], a[248:251], a[140:143], v[100:103]
 s_lshl_b32 s63, s63, 9
 buffer_load_dwordx4 a[208:211], v4, s[40:43], s61 offen
 mf v[104:107], a[248:251], a[144:147], v[104:107]
 s_add_u32 s63, s63, 0x18000
 mf v[108:111], a[248:251], a[148:151], v[108:111]
 s_waitcnt lgkmcnt(8)
 ds_read_b64_tr_b16 a[248:249], v13 offset:10240
 ds_read_b64_tr_b16 a[250:251], v13 offset:15360
 mf v[112:115], a[252:255], a[136:139], v[112:115]
 buffer_load_dword v27, v19, s[52:55], s63 offen sc1
 mf v[116:119], a[252:255], a[140:143], v[116:119]
 mf v[120:123], a[252:255], a[144:147], v[120:123]
 mf v[124:127], a[252:255], a[148:151], v[124:127]
 s_waitcnt lgkmcnt(8)
 s_add_u32 s61, s85, s17
 ds_read_b64_tr_b16 a[252:253], v12 offset:10304
 ds_read_b64_tr_b16 a[254:255], v12 offset:15424
 mf v[128:131], a[232:235], a[136:139], v[128:131]
 s_add_u32 s61, s61, 0x4000
 buffer_load_dwordx4 a[212:215], v4, s[40:43], s61 offen
 mf v[132:135], a[232:235], a[140:143], v[132:135]
 mf v[136:139], a[232:235], a[144:147], v[136:139]
 mf v[140:143], a[232:235], a[148:151], v[140:143]
 s_waitcnt lgkmcnt(8)
 ds_read_b64_tr_b16 a[232:233], v13 offset:10304
 ds_read_b64_tr_b16 a[234:235], v13 offset:15424
 mf v[144:147], a[236:239], a[136:139], v[144:147]
 mf v[148:151], a[236:239], a[140:143], v[148:151]
 mf v[152:155], a[236:239], a[144:147], v[152:155]
 s_add_u32 s61, s84, 0x4000
 buffer_load_dwordx4 a[216:219], v4, s[40:43], s61 offen offset:1024
 mf v[156:159], a[236:239], a[148:151], v[156:159]
 s_waitcnt lgkmcnt(8)
 ds_read_b64_tr_b16 a[236:237], v12 offset:10368
 ds_read_b64_tr_b16 a[238:239], v12 offset:15488
 mf v[160:163], a[240:243], a[136:139], v[160:163]
 mf v[164:167], a[240:243], a[140:143], v[164:167]
 mf v[168:171], a[240:243], a[144:147], v[168:171]
 mf v[172:175], a[240:243], a[148:151], v[172:175]
 s_waitcnt vmcnt(30) lgkmcnt(8)
 ds_read_b64_tr_b16 a[240:241], v13 offset:10368
 ds_read_b64_tr_b16 a[242:243], v13 offset:15488
 mf v[32:35], a[244:247], a[152:155], v[32:35]
 s_waitcnt vmcnt(28)
 s_add_u32 s61, s84, s17
 mf v[36:39], a[244:247], a[156:159], v[36:39]
 s_waitcnt vmcnt(26)
 s_add_u32 s61, s61, 0x4000
 buffer_load_dwordx4 a[220:223], v4, s[40:43], s61 offen offset:1024
 mf v[40:43], a[244:247], a[160:163], v[40:43]
 s_waitcnt vmcnt(24)
 mf v[44:47], a[244:247], a[164:167], v[44:47]
 s_waitcnt lgkmcnt(8)
 ds_read_b64_tr_b16 a[244:245], v12 offset:10432
 ds_read_b64_tr_b16 a[246:247], v12 offset:15552
 mf v[48:51], a[248:251], a[152:155], v[48:51]
 mf v[52:55], a[248:251], a[156:159], v[52:55]
 mf v[56:59], a[248:251], a[160:163], v[56:59]
 mf v[60:63], a[248:251], a[164:167], v[60:63]
 s_waitcnt lgkmcnt(8)
 s_add_u32 s61, s85, 0x4000
 ds_read_b64_tr_b16 a[248:249], v13 offset:10432
 ds_read_b64_tr_b16 a[250:251], v13 offset:15552
 mf v[64:67], a[252:255], a[152:155], v[64:67]
 buffer_load_dwordx4 a[224:227], v4, s[40:43], s61 offen offset:1024
 mf v[68:71], a[252:255], a[156:159], v[68:71]
 mf v[72:75], a[252:255], a[160:163], v[72:75]
 mf v[76:79], a[252:255], a[164:167], v[76:79]
 s_waitcnt lgkmcnt(8)
 ds_read_b64_tr_b16 a[252:253], v12 offset:10496
 ds_read_b64_tr_b16 a[254:255], v12 offset:15616
 mf v[80:83], a[232:235], a[152:155], v[80:83]
 mf v[84:87], a[232:235], a[156:159], v[84:87]
 mf v[88:91], a[232:235], a[160:163], v[88:91]
 s_add_u32 s61, s85, s17
 mf v[92:95], a[232:235], a[164:167], v[92:95]
 s_waitcnt lgkmcnt(8)
 s_add_u32 s61, s61, 0x4000
 buffer_load_dwordx4 a[228:231], v4, s[40:43], s61 offen offset:1024
 mf v[96:99], a[236:239], a[152:155], v[96:99]
 mf v[100:103], a[236:239], a[156:159], v[100:103]
 s_waitcnt lgkmcnt(0)
 s_barrier
 mf v[104:107], a[236:239], a[160:163], v[104:107]
 s_add_u32 s60, s92, 0x12000
 ds_read_b64_tr_b16 a[232:233], v14
 ds_read_b64_tr_b16 a[234:235], v14 offset:5120
 mf v[108:111], a[236:239], a[164:167], v[108:111]
 s_add_u32 m0, s83, 0x5000
 ds_read_b64_tr_b16 a[236:237], v15
 ds_read_b64_tr_b16 a[238:239], v15 offset:5120
 mf v[112:115], a[240:243], a[152:155], v[112:115]
 buffer_load_dwordx4 v22, s[48:51], s60 offen lds
 mf v[116:119], a[240:243], a[156:159], v[116:119]
 mf v[120:123], a[240:243], a[160:163], v[120:123]
 mf v[124:127], a[240:243], a[164:167], v[124:127]
 ds_read_b64_tr_b16 a[240:241], v14 offset:64
 ds_read_b64_tr_b16 a[242:243], v14 offset:5184
 mf v[128:131], a[244:247], a[152:155], v[128:131]
 mf v[132:135], a[244:247], a[156:159], v[132:135]
 mf v[136:139], a[244:247], a[160:163], v[136:139]
 s_add_u32 m0, s83, 0x5400
 mf v[140:143], a[244:247], a[164:167], v[140:143]
 ds_read_b64_tr_b16 a[244:245], v15 offset:64
 ds_read_b64_tr_b16 a[246:247], v15 offset:5184
 mf v[144:147], a[248:251], a[152:155], v[144:147]
 buffer_load_dwordx4 v23, s[48:51], s60 offen lds
 mf v[148:151], a[248:251], a[156:159], v[148:151]
 mf v[152:155], a[248:251], a[160:163], v[152:155]
 mf v[156:159], a[248:251], a[164:167], v[156:159]
 ds_read_b64_tr_b16 a[248:249], v14 offset:128
 ds_read_b64_tr_b16 a[250:251], v14 offset:5248
 mf v[160:163], a[252:255], a[152:155], v[160:163]
 mf v[164:167], a[252:255], a[156:159], v[164:167]
 mf v[168:171], a[252:255], a[160:163], v[168:171]
 s_add_u32 m0, s83, 0x5800
 mf v[172:175], a[252:255], a[164:167], v[172:175]
 s_waitcnt vmcnt(25) lgkmcnt(8)
 ds_read_b64_tr_b16 a[252:253], v15 offset:128
 ds_read_b64_tr_b16 a[254:255], v15 offset:5248
 mf v[32:35], a[232:235], a[168:171], v[32:35]
 buffer_load_dwordx4 v24, s[48:51], s60 offen lds
 s_waitcnt vmcnt(8)
 v_cmp_eq_u32 vcc, v6, v27
 s_nop 3
 s_cmp_eq_u64 vcc, -1
 s_cbranch_scc0 f_c_spin
f_c_ok:
 mf v[36:39], a[232:235], a[172:175], v[36:39]
 s_add_u32 s61, s86, 0
 buffer_load_dwordx4 a[136:139], v4, s[40:43], s61 offen
 mf v[40:43], a[232:235], a[176:179], v[40:43]
 mf v[44:47], a[232:235], a[180:183], v[44:47]
 s_waitcnt lgkmcnt(8)
 ds_read_b64_tr_b16 a[232:233], v14 offset:192
 ds_read_b64_tr_b16 a[234:235], v14 offset:5312
 mf v[48:51], a[236:239], a[168:171], v[48:51]
 mf v[52:55], a[236:239], a[172:175], v[52:55]
 mf v[56:59], a[236:239], a[176:179], v[56:59]
 s_add_u32 m0, s83, 0x5c00
 mf v[60:63], a[236:239], a[180:183], v[60:63]
 s_waitcnt lgkmcnt(8)
 s_add_u32 s61, s86, s17
 ds_read_b64_tr_b16 a[236:237], v15 offset:192
 ds_read_b64_tr_b16 a[238:239], v15 offset:5312
 mf v[64:67], a[240:243], a[168:171], v[64:67]
 s_add_u32 s61, s61, 0
 buffer_load_dwordx4 v25, s[48:51], s60 offen lds
 mf v[68:71], a[240:243], a[172:175], v[68:71]
 buffer_load_dwordx4 a[140:143], v4, s[40:43], s61 offen
 mf v[72:75], a[240:243], a[176:179], v[72:75]
 mf v[76:79], a[240:243], a[180:183], v[76:79]
 s_waitcnt lgkmcnt(8)
 ds_read_b64_tr_b16 a[240:241], v14 offset:256
 ds_read_b64_tr_b16 a[242:243], v14 offset:5376
 mf v[80:83], a[244:247], a[168:171], v[80:83]
 mf v[84:87], a[244:247], a[172:175], v[84:87]
 mf v[88:91], a[244:247], a[176:179], v[88:91]
 s_add_u32 m0, s83, 0x6000
 mf v[92:95], a[244:247], a[180:183], v[92:95]
 s_waitcnt lgkmcnt(8)
 s_add_u32 s61, s87, 0
 ds_read_b64_tr_b16 a[244:245], v14 offset:10240
 ds_read_b64_tr_b16 a[246:247], v14 offset:15360
 mf v[96:99], a[248:251], a[168:171], v[96:99]
 buffer_load_dwordx4 v26, s[48:51], s60 offen lds
 mf v[100:103], a[248:251], a[172:175], v[100:103]
 buffer_load_dwordx4 a[144:147], v4, s[40:43], s61 offen
 mf v[104:107], a[248:251], a[176:179], v[104:107]
 mf v[108:111], a[248:251], a[180:183], v[108:111]
 s_waitcnt lgkmcnt(8)
 ds_read_b64_tr_b16 a[248:249], v15 offset:10240
 ds_read_b64_tr_b16 a[250:251], v15 offset:15360
 mf v[112:115], a[252:255], a[168:171], v[112:115]
 mf v[116:119], a[252:255], a[172:175], v[116:119]
 mf v[120:123], a[252:255], a[176:179], v[120:123]
 mf v[124:127], a[252:255], a[180:183], v[124:127]
 s_waitcnt lgkmcnt(8)
 s_add_u32 s61, s87, s17
 ds_read_b64_tr_b16 a[252:253], v14 offset:10304
 ds_read_b64_tr_b16 a[254:255], v14 offset:15424
 mf v[128:131], a[232:235], a[168:171], v[128:131]
 s_add_u32 s61, s61, 0
 buffer_load_dwordx4 a[148:151], v4, s[40:43], s61 offen
 mf v[132:135], a[232:235], a[172:175], v[132:135]
 mf v[136:139], a[232:235], a[176:179], v[136:139]
 mf v[140:143], a[232:235], a[180:183], v[140:143]
 s_waitcnt lgkmcnt(8)
 ds_read_b64_tr_b16 a[232:233], v15 offset:10304
 ds_read_b64_tr_b16 a[234:235], v15 offset:15424
 mf v[144:147], a[236:239], a[168:171], v[144:147]
 mf v[148:151], a[236:239], a[172:175], v[148:151]
 mf v[152:155], a[236:239], a[176:179], v[152:155]
 s_add_u32 s61, s86, 0
 buffer_load_dwordx4 a[152:155], v4, s[40:43], s61 offen offset:1024
 mf v[156:159], a[236:239], a[180:183], v[156:159]
 s_waitcnt lgkmcnt(8)
 ds_read_b64_tr_b16 a[236:237], v14 offset:10368
 ds_read_b64_tr_b16 a[238:239], v14 offset:15488
 mf v[160:163], a[240:243], a[168:171], v[160:163]
 mf v[164:167], a[240:243], a[172:175], v[164:167]
 mf v[168:171], a[240:243], a[176:179], v[168:171]
 mf v[172:175], a[240:243], a[180:183], v[172:175]
 s_waitcnt lgkmcnt(8)
 ds_read_b64_tr_b16 a[240:241], v15 offset:10368
 ds_read_b64_tr_b16 a[242:243], v15 offset:15488
 mf v[32:35], a[244:247], a[184:187], v[32:35]
 s_add_u32 s61, s86, s17
 mf v[36:39], a[244:247], a[188:191], v[36:39]
 s_add_u32 s61, s61, 0
 buffer_load_dwordx4 a[156:159], v4, s[40:43], s61 offen offset:1024
 mf v[40:43], a[244:247], a[192:195], v[40:43]
 mf v[44:47], a[244:247], a[196:199], v[44:47]
 s_waitcnt lgkmcnt(8)
 ds_read_b64_tr_b16 a[244:245], v14 offset:10432
 ds_read_b64_tr_b16 a[246:247], v14 offset:15552
 mf v[48:51], a[248:251], a[184:187], v[48:51]
 mf v[52:55], a[248:251], a[188:191], v[52:55]
 mf v[56:59], a[248:251], a[192:195], v[56:59]
 mf v[60:63], a[248:251], a[196:199], v[60:63]
 s_waitcnt lgkmcnt(8)
 s_add_u32 s61, s87, 0
 ds_read_b64_tr_b16 a[248:249], v15 offset:10432
 ds_read_b64_tr_b16 a[250:251], v15 offset:15552
 mf v[64:67], a[252:255], a[184:187], v[64:67]
 buffer_load_dwordx4 a[160:163], v4, s[40:43], s61 offen offset:1024
 mf v[68:71], a[252:255], a[188:191], v[68:71]
 mf v[72:75], a[252:255], a[192:195], v[72:75]
 mf v[76:79], a[252:255], a[196:199], v[76:79]
 s_waitcnt lgkmcnt(8)
 ds_read_b64_tr_b16 a[252:253], v14 offset:10496
 ds_read_b64_tr_b16 a[254:255], v14 offset:15616
 mf v[80:83], a[232:235], a[184:187], v[80:83]
 mf v[84:87], a[232:235], a[188:191], v[84:87]
 mf v[88:91], a[232:235], a[192:195], v[88:91]
 s_add_u32 s61, s87, s17
 mf v[92:95], a[232:235], a[196:199], v[92:95]
 s_waitcnt lgkmcnt(8)
 s_add_u32 s61, s61, 0
 buffer_load_dwordx4 a[164:167], v4, s[40:43], s61 offen offset:1024
 mf v[96:99], a[236:239], a[184:187], v[96:99]
 mf v[100:103], a[236:239], a[188:191], v[100:103]
 s_waitcnt lgkmcnt(0)
 s_barrier
 mf v[104:107], a[236:239], a[192:195], v[104:107]
 s_add_u32 s60, s92, 0x24000
 ds_read_b64_tr_b16 a[232:233], v8
 ds_read_b64_tr_b16 a[234:235], v8 offset:5120
 mf v[108:111], a[236:239], a[196:199], v[108:111]
 s_add_u32 m0, s83, 0xa000
 ds_read_b64_tr_b16 a[236:237], v9
 ds_read_b64_tr_b16 a[238:239], v9 offset:5120
 mf v[112:115], a[240:243], a[184:187], v[112:115]
 buffer_load_dwordx4 v22, s[48:51], s60 offen lds
 mf v[116:119], a[240:243], a[188:191], v[116:119]
 mf v[120:123], a[240:243], a[192:195], v[120:123]
 mf v[124:127], a[240:243], a[196:199], v[124:127]
 ds_read_b64_tr_b16 a[240:241], v8 offset:64
 ds_read_b64_tr_b16 a[242:243], v8 offset:5184
 mf v[128:131], a[244:247], a[184:187], v[128:131]
 mf v[132:135], a[244:247], a[188:191], v[132:135]
 mf v[136:139], a[244:247], a[192:195], v[136:139]
 s_add_u32 m0, s83, 0xa400
 mf v[140:143], a[244:247], a[196:199], v[140:143]
 ds_read_b64_tr_b16 a[244:245], v9 offset:64
 ds_read_b64_tr_b16 a[246:247], v9 offset:5184
 mf v[144:147], a[248:251], a[184:187], v[144:147]
 buffer_load_dwordx4 v23, s[48:51], s60 offen lds
 mf v[148:151], a[248:251], a[188:191], v[148:151]
 mf v[152:155], a[248:251], a[192:195], v[152:155]
 mf v[156:159], a[248:251], a[196:199], v[156:159]
 ds_read_b64_tr_b16 a[248:249], v8 offset:128
 ds_read_b64_tr_b16 a[250:251], v8 offset:5248
 mf v[160:163], a[252:255], a[184:187], v[160:163]
 mf v[164:167], a[252:255], a[188:191], v[164:167]
 mf v[168:171], a[252:255], a[192:195], v[168:171]
 s_add_u32 m0, s83, 0xa800
 mf v[172:175], a[252:255], a[196:199], v[172:175]
 s_waitcnt lgkmcnt(8)
 ds_read_b64_tr_b16 a[252:253], v9 offset:128
 ds_read_b64_tr_b16 a[254:255], v9 offset:5248
 mf v[32:35], a[232:235], a[200:203], v[32:35]
 s_add_u32 s61, s86, 0x800
 buffer_load_dwordx4 v24, s[48:51], s60 offen lds
 mf v[36:39], a[232:235], a[204:207], v[36:39]
 buffer_load_dwordx4 a[168:171], v4, s[40:43], s61 offen
 mf v[40:43], a[232:235], a[208:211], v[40:43]
 s_waitcnt vmcnt(21)
 mf v[44:47], a[232:235], a[212:215], v[44:47]
 s_waitcnt lgkmcnt(8)
 ds_read_b64_tr_b16 a[232:233], v8 offset:192
 ds_read_b64_tr_b16 a[234:235], v8 offset:5312
 mf v[48:51], a[236:239], a[200:203], v[48:51]
 mf v[52:55], a[236:239], a[204:207], v[52:55]
 mf v[56:59], a[236:239], a[208:211], v[56:59]
 s_add_u32 m0, s83, 0xac00
 mf v[60:63], a[236:239], a[212:215], v[60:63]
 s_waitcnt lgkmcnt(8)
 s_add_u32 s61, s86, s17
 ds_read_b64_tr_b16 a[236:237], v9 offset:192
 ds_read_b64_tr_b16 a[238:239], v9 offset:5312
 mf v[64:67], a[240:243], a[200:203], v[64:67]
 s_add_u32 s61, s61, 0x800
 buffer_load_dwordx4 v25, s[48:51], s60 offen lds
 mf v[68:71], a[240:243], a[204:207], v[68:71]
 buffer_load_dwordx4 a[172:175], v4, s[40:43], s61 offen
 mf v[72:75], a[240:243], a[208:211], v[72:75]
 mf v[76:79], a[240:243], a[212:215], v[76:79]
 s_waitcnt lgkmcnt(8)
 ds_read_b64_tr_b16 a[240:241], v8 offset:256
 ds_read_b64_tr_b16 a[242:243], v8 offset:5376
 mf v[80:83], a[244:247], a[200:203], v[80:83]
 mf v[84:87], a[244:247], a[204:207], v[84:87]
 mf v[88:91], a[244:247], a[208:211], v[88:91]
 s_add_u32 m0, s83, 0xb000
 mf v[92:95], a[244:247], a[212:215], v[92:95]
 s_waitcnt lgkmcnt(8)
 s_add_u32 s61, s87, 0x800
 ds_read_b64_tr_b16 a[244:245], v8 offset:10240
 ds_read_b64_tr_b16 a[246:247], v8 offset:15360
 mf v[96:99], a[248:251], a[200:203], v[96:99]
 buffer_load_dwordx4 v26, s[48:51], s60 offen lds
 mf v[100:103], a[248:251], a[204:207], v[100:103]
 buffer_load_dwordx4 a[176:179], v4, s[40:43], s61 offen
 mf v[104:107], a[248:251], a[208:211], v[104:107]
 mf v[108:111], a[248:251], a[212:215], v[108:111]
 s_waitcnt lgkmcnt(8)
 ds_read_b64_tr_b16 a[248:249], v9 offset:10240
 ds_read_b64_tr_b16 a[250:251], v9 offset:15360
 mf v[112:115], a[252:255], a[200:203], v[112:115]
 mf v[116:119], a[252:255], a[204:207], v[116:119]
 mf v[120:123], a[252:255], a[208:211], v[120:123]
 mf v[124:127], a[252:255], a[212:215], v[124:127]
 s_waitcnt lgkmcnt(8)
 s_add_u32 s61, s87, s17
 ds_read_b64_tr_b16 a[252:253], v8 offset:10304
 ds_read_b64_tr_b16 a[254:255], v8 offset:15424
 mf v[128:131], a[232:235], a[200:203], v[128:131]
 s_add_u32 s61, s61, 0x800
 buffer_load_dwordx4 a[180:183], v4, s[40:43], s61 offen
 mf v[132:135], a[232:235], a[204:207], v[132:135]
 mf v[136:139], a[232:235], a[208:211], v[136:139]
 mf v[140:143], a[232:235], a[212:215], v[140:143]
 s_waitcnt lgkmcnt(8)
 ds_read_b64_tr_b16 a[232:233], v9 offset:10304
 ds_read_b64_tr_b16 a[234:235], v9 offset:15424
 mf v[144:147], a[236:239], a[200:203], v[144:147]
 mf v[148:151], a[236:239], a[204:207], v[148:151]
 mf v[152:155], a[236:239], a[208:211], v[152:155]
 s_add_u32 s61, s86, 0x800
 buffer_load_dwordx4 a[184:187], v4, s[40:43], s61 offen offset:1024
 mf v[156:159], a[236:239], a[212:215], v[156:159]
 s_waitcnt lgkmcnt(8)
 ds_read_b64_tr_b16 a[236:237], v8 offset:10368
 ds_read_b64_tr_b16 a[238:239], v8 offset:15488
 mf v[160:163], a[240:243], a[200:203], v[160:163]
 mf v[164:167], a[240:243], a[204:207], v[164:167]
 mf v[168:171], a[240:243], a[208:211], v[168:171]
 mf v[172:175], a[240:243], a[212:215], v[172:175]
 s_waitcnt vmcnt(26) lgkmcnt(8)
 ds_read_b64_tr_b16 a[240:241], v9 offset:10368
 ds_read_b64_tr_b16 a[242:243], v9 offset:15488
 mf v[32:35], a[244:247], a[216:219], v[32:35]
 s_waitcnt vmcnt(25)
 s_add_u32 s61, s86, s17
 mf v[36:39], a[244:247], a[220:223], v[36:39]
 s_waitcnt vmcnt(24)
 s_add_u32 s61, s61, 0x800
 buffer_load_dwordx4 a[188:191], v4, s[40:43], s61 offen offset:1024
 mf v[40:43], a[244:247], a[224:227], v[40:43]
 s_waitcnt vmcnt(24)
 mf v[44:47], a[244:247], a[228:231], v[44:47]
 s_waitcnt lgkmcnt(8)
 ds_read_b64_tr_b16 a[244:245], v8 offset:10432
 ds_read_b64_tr_b16 a[246:247], v8 offset:15552
 mf v[48:51], a[248:251], a[216:219], v[48:51]
 mf v[52:55], a[248:251], a[220:223], v[52:55]
 mf v[56:59], a[248:251], a[224:227], v[56:59]
 mf v[60:63], a[248:251], a[228:231], v[60:63]
 s_waitcnt lgkmcnt(8)
 s_add_u32 s61, s87, 0x800
 ds_read_b64_tr_b16 a[248:249], v9 offset:10432
 ds_read_b64_tr_b16 a[250:251], v9 offset:15552
 mf v[64:67], a[252:255], a[216:219], v[64:67]
 buffer_load_dwordx4 a[192:195], v4, s[40:43], s61 offen offset:1024
 mf v[68:71], a[252:255], a[220:223], v[68:71]
 mf v[72:75], a[252:255], a[224:227], v[72:75]
 mf v[76:79], a[252:255], a[228:231], v[76:79]
 s_waitcnt lgkmcnt(8)
 ds_read_b64_tr_b16 a[252:253], v8 offset:10496
 ds_read_b64_tr_b16 a[254:255], v8 offset:15616
 mf v[80:83], a[232:235], a[216:219], v[80:83]
 mf v[84:87], a[232:235], a[220:223], v[84:87]
 mf v[88:91], a[232:235], a[224:227], v[88:91]
 s_add_u32 s61, s87, s17
 mf v[92:95], a[232:235], a[228:231], v[92:95]
 s_waitcnt lgkmcnt(8)
 s_add_u32 s61, s61, 0x800
 buffer_load_dwordx4 a[196:199], v4, s[40:43], s61 offen offset:1024
 mf v[96:99], a[236:239], a[216:219], v[96:99]
 mf v[100:103], a[236:239], a[220:223], v[100:103]
 s_waitcnt lgkmcnt(0)
 s_barrier
 mf v[104:107], a[236:239], a[224:227], v[104:107]
 s_add_u32 s60, s92, 0x36000
 ds_read_b64_tr_b16 a[232:233], v10
 ds_read_b64_tr_b16 a[234:235], v10 offset:5120
 mf v[108:111], a[236:239], a[228:231], v[108:111]
 s_add_u32 m0, s83, 0x20000
 ds_read_b64_tr_b16 a[236:237], v11
 ds_read_b64_tr_b16 a[238:239], v11 offset:5120
 mf v[112:115], a[240:243], a[216:219], v[112:115]
 buffer_load_dwordx4 v22, s[48:51], s60 offen lds
 mf v[116:119], a[240:243], a[220:223], v[116:119]
 mf v[120:123], a[240:243], a[224:227], v[120:123]
 mf v[124:127], a[240:243], a[228:231], v[124:127]
 ds_read_b64_tr_b16 a[240:241], v10 offset:64
 ds_read_b64_tr_b16 a[242:243], v10 offset:5184
 mf v[128:131], a[244:247], a[216:219], v[128:131]
 mf v[132:135], a[244:247], a[220:223], v[132:135]
 mf v[136:139], a[244:247], a[224:227], v[136:139]
 s_add_u32 m0, s83, 0x20400
 mf v[140:143], a[244:247], a[228:231], v[140:143]
 ds_read_b64_tr_b16 a[244:245], v11 offset:64
 ds_read_b64_tr_b16 a[246:247], v11 offset:5184
 mf v[144:147], a[248:251], a[216:219], v[144:147]
 buffer_load_dwordx4 v23, s[48:51], s60 offen lds
 mf v[148:151], a[248:251], a[220:223], v[148:151]
 mf v[152:155], a[248:251], a[224:227], v[152:155]
 mf v[156:159], a[248:251], a[228:231], v[156:159]
 ds_read_b64_tr_b16 a[248:249], v10 offset:128
 ds_read_b64_tr_b16 a[250:251], v10 offset:5248
 mf v[160:163], a[252:255], a[216:219], v[160:163]
 mf v[164:167], a[252:255], a[220:223], v[164:167]
 mf v[168:171], a[252:255], a[224:227], v[168:171]
 s_add_u32 m0, s83, 0x20800
 mf v[172:175], a[252:255], a[228:231], v[172:175]
 s_waitcnt vmcnt(24) lgkmcnt(8)
 ds_read_b64_tr_b16 a[252:253], v11 offset:128
 ds_read_b64_tr_b16 a[254:255], v11 offset:5248
 mf v[32:35], a[232:235], a[136:139], v[32:35]
 s_waitcnt vmcnt(22)
 s_add_u32 s61, s86, 0x1000
 buffer_load_dwordx4 v24, s[48:51], s60 offen lds
 mf v[36:39], a[232:235], a[140:143], v[36:39]
 s_waitcnt vmcnt(21)
 buffer_load_dwordx4 a[200:203], v4, s[40:43], s61 offen
 mf v[40:43], a[232:235], a[144:147], v[40:43]
 s_waitcnt vmcnt(21)
 mf v[44:47], a[232:235], a[148:151], v[44:47]
 s_waitcnt lgkmcnt(8)
 ds_read_b64_tr_b16 a[232:233], v10 offset:192
 ds_read_b64_tr_b16 a[234:235], v10 offset:5312
 mf v[48:51], a[236:239], a[136:139], v[48:51]
 mf v[52:55], a[236:239], a[140:143], v[52:55]
 mf v[56:59], a[236:239], a[144:147], v[56:59]
 s_add_u32 m0, s83, 0x20c00
 mf v[60:63], a[236:239], a[148:151], v[60:63]
 s_waitcnt lgkmcnt(8)
 s_add_u32 s61, s86, s17
 ds_read_b64_tr_b16 a[236:237], v11 offset:192
 ds_read_b64_tr_b16 a[238:239], v11 offset:5312
 mf v[64:67], a[240:243], a[136:139], v[64:67]
 s_add_u32 s61, s61, 0x1000
 buffer_load_dwordx4 v25, s[48:51], s60 offen lds
 mf v[68:71], a[240:243], a[140:143], v[68:71]
 buffer_load_dwordx4 a[204:207], v4, s[40:43], s61 offen
 mf v[72:75], a[240:243], a[144:147], v[72:75]
 mf v[76:79], a[240:243], a[148:151], v[76:79]
 s_waitcnt lgkmcnt(8)
 ds_read_b64_tr_b16 a[240:241], v10 offset:256
 ds_read_b64_tr_b16 a[242:243], v10 offset:5376
 mf v[80:83], a[244:247], a[136:139], v[80:83]
 mf v[84:87], a[244:247], a[140:143], v[84:87]
 mf v[88:91], a[244:247], a[144:147], v[88:91]
 s_add_u32 m0, s83, 0x21000
 mf v[92:95], a[244:247], a[148:151], v[92:95]
 s_waitcnt lgkmcnt(8)
 s_add_u32 s61, s87, 0x1000
 ds_read_b64_tr_b16 a[244:245], v10 offset:10240
 ds_read_b64_tr_b16 a[246:247], v10 offset:15360
 mf v[96:99], a[248:251], a[136:139], v[96:99]
 buffer_load_dwordx4 v26, s[48:51], s60 offen lds
 mf v[100:103], a[248:251], a[140:143], v[100:103]
 buffer_load_dwordx4 a[208:211], v4, s[40:43], s61 offen
 mf v[104:107], a[248:251], a[144:147], v[104:107]
 mf v[108:111], a[248:251], a[148:151], v[108:111]
 s_waitcnt lgkmcnt(8)
 ds_read_b64_tr_b16 a[248:249], v11 offset:10240
 ds_read_b64_tr_b16 a[250:251], v11 offset:15360
 mf v[112:115], a[252:255], a[136:139], v[112:115]
 mf v[116:119], a[252:255], a[140:143], v[116:119]
 mf v[120:123], a[252:255], a[144:147], v[120:123]
 mf v[124:127], a[252:255], a[148:151], v[124:127]
 s_waitcnt lgkmcnt(8)
 s_add_u32 s61, s87, s17
 ds_read_b64_tr_b16 a[252:253], v10 offset:10304
 ds_read_b64_tr_b16 a[254:255], v10 offset:15424
 mf v[128:131], a[232:235], a[136:139], v[128:131]
 s_add_u32 s61, s61, 0x1000
 buffer_load_dwordx4 a[212:215], v4, s[40:43], s61 offen
 mf v[132:135], a[232:235], a[140:143], v[132:135]
 mf v[136:139], a[232:235], a[144:147], v[136:139]
 mf v[140:143], a[232:235], a[148:151], v[140:143]
 s_waitcnt lgkmcnt(8)
 ds_read_b64_tr_b16 a[232:233], v11 offset:10304
 ds_read_b64_tr_b16 a[234:235], v11 offset:15424
 mf v[144:147], a[236:239], a[136:139], v[144:147]
 mf v[148:151], a[236:239], a[140:143], v[148:151]
 mf v[152:155], a[236:239], a[144:147], v[152:155]
 s_add_u32 s61, s86, 0x1000
 buffer_load_dwordx4 a[216:219], v4, s[40:43], s61 offen offset:1024
 mf v[156:159], a[236:239], a[148:151], v[156:159]
 s_waitcnt lgkmcnt(8)
 ds_read_b64_tr_b16 a[236:237], v10 offset:10368
 ds_read_b64_tr_b16 a[238:239], v10 offset:15488
 mf v[160:163], a[240:243], a[136:139], v[160:163]
 mf v[164:167], a[240:243], a[140:143], v[164:167]
 mf v[168:171], a[240:243], a[144:147], v[168:171]
 mf v[172:175], a[240:243], a[148:151], v[172:175]
 s_waitcnt vmcnt(26) lgkmcnt(8)
 ds_read_b64_tr_b16 a[240:241], v11 offset:10368
 ds_read_b64_tr_b16 a[242:243], v11 offset:15488
 mf v[32:35], a[244:247], a[152:155], v[32:35]
 s_waitcnt vmcnt(25)
 s_add_u32 s61, s86, s17
 mf v[36:39], a[244:247], a[156:159], v[36:39]
 s_waitcnt vmcnt(24)
 s_add_u32 s61, s61, 0x1000
 buffer_load_dwordx4 a[220:223], v4, s[40:43], s61 offen offset:1024
 mf v[40:43], a[244:247], a[160:163], v[40:43]
 s_waitcnt vmcnt(24)
 mf v[44:47], a[244:247], a[164:167], v[44:47]
 s_waitcnt lgkmcnt(8)
 ds_read_b64_tr_b16 a[244:245], v10 offset:10432
 ds_read_b64_tr_b16 a[246:247], v10 offset:15552
 mf v[48:51], a[248:251], a[152:155], v[48:51]
 mf v[52:55], a[248:251], a[156:159], v[52:55]
 mf v[56:59], a[248:251], a[160:163], v[56:59]
 mf v[60:63], a[248:251], a[164:167], v[60:63]
 s_waitcnt lgkmcnt(8)
 s_add_u32 s61, s87, 0x1000
 ds_read_b64_tr_b16 a[248:249], v11 offset:10432
 ds_read_b64_tr_b16 a[250:251], v11 offset:15552
 mf v[64:67], a[252:255], a[152:155], v[64:67]
 buffer_load_dwordx4 a[224:227], v4, s[40:43], s61 offen offset:1024
 mf v[68:71], a[252:255], a[156:159], v[68:71]
 mf v[72:75], a[252:255], a[160:163], v[72:75]
 mf v[76:79], a[252:255], a[164:167], v[76:79]
 s_waitcnt lgkmcnt(8)
 ds_read_b64_tr_b16 a[252:253], v10 offset:10496
 ds_read_b64_tr_b16 a[254:255], v10 offset:15616
 mf v[80:83], a[232:235], a[152:155], v[80:83]
 mf v[84:87], a[232:235], a[156:159], v[84:87]
 mf v[88:91], a[232:235], a[160:163], v[88:91]
 s_add_u32 s61, s87, s17
 mf v[92:95], a[232:235], a[164:167], v[92:95]
 s_waitcnt lgkmcnt(8)
 s_add_u32 s61, s61, 0x1000
 buffer_load_dwordx4 a[228:231], v4, s[40:43], s61 offen offset:1024
 mf v[96:99], a[236:239], a[152:155], v[96:99]
 mf v[100:103], a[236:239], a[156:159], v[100:103]
 s_waitcnt lgkmcnt(0)
 s_barrier
 mf v[104:107], a[236:239], a[160:163], v[104:107]
 s_add_u32 s60, s92, 0x48000
 ds_read_b64_tr_b16 a[232:233], v12
 ds_read_b64_tr_b16 a[234:235], v12 offset:5120
 mf v[108:111], a[236:239], a[164:167], v[108:111]
 s_add_u32 m0, s83, 0
 ds_read_b64_tr_b16 a[236:237], v13
 ds_read_b64_tr_b16 a[238:239], v13 offset:5120
 mf v[112:115], a[240:243], a[152:155], v[112:115]
 buffer_load_dwordx4 v22, s[48:51], s60 offen lds
 mf v[116:119], a[240:243], a[156:159], v[116:119]
 mf v[120:123], a[240:243], a[160:163], v[120:123]
 mf v[124:127], a[240:243], a[164:167], v[124:127]
 ds_read_b64_tr_b16 a[240:241], v12 offset:64
 ds_read_b64_tr_b16 a[242:243], v12 offset:5184
 mf v[128:131], a[244:247], a[152:155], v[128:131]
 mf v[132:135], a[244:247], a[156:159], v[132:135]
 mf v[136:139], a[244:247], a[160:163], v[136:139]
 s_add_u32 m0, s83, 0x400
 mf v[140:143], a[244:247], a[164:167], v[140:143]
 ds_read_b64_tr_b16 a[244:245], v13 offset:64
 ds_read_b64_tr_b16 a[246:247], v13 offset:5184
 mf v[144:147], a[248:251], a[152:155], v[144:147]
 buffer_load_dwordx4 v23, s[48:51], s60 offen lds
 mf v[148:151], a[248:251], a[156:159], v[148:151]
 mf v[152:155], a[248:251], a[160:163], v[152:155]
 mf v[156:159], a[248:251], a[164:167], v[156:159]
 ds_read_b64_tr_b16 a[248:249], v12 offset:128
 ds_read_b64_tr_b16 a[250:251], v12 offset:5248
 mf v[160:163], a[252:255], a[152:155], v[160:163]
 mf v[164:167], a[252:255], a[156:159], v[164:167]
 mf v[168:171], a[252:255], a[160:163], v[168:171]
 s_add_u32 m0, s83, 0x800
 mf v[172:175], a[252:255], a[164:167], v[172:175]
 s_waitcnt vmcnt(24) lgkmcnt(8)
 ds_read_b64_tr_b16 a[252:253], v13 offset:128
 ds_read_b64_tr_b16 a[254:255], v13 offset:5248
 mf v[32:35], a[232:235], a[168:171], v[32:35]
 s_waitcnt vmcnt(22)
 s_add_u32 s61, s86, 0x1800
 buffer_load_dwordx4 v24, s[48:51], s60 offen lds
 mf v[36:39], a[232:235], a[172:175], v[36:39]
 s_waitcnt vmcnt(21)
 buffer_load_dwordx4 a[136:139], v4, s[40:43], s61 offen
 mf v[40:43], a[232:235], a[176:179], v[40:43]
 s_waitcnt vmcnt(21)
 mf v[44:47], a[232:235], a[180:183], v[44:47]
 s_waitcnt lgkmcnt(8)
 ds_read_b64_tr_b16 a[232:233], v12 offset:192
 ds_read_b64_tr_b16 a[234:235], v12 offset:5312
 mf v[48:51], a[236:239], a[168:171], v[48:51]
 mf v[52:55], a[236:239], a[172:175], v[52:55]
 mf v[56:59], a[236:239], a[176:179], v[56:59]
 s_add_u32 m0, s83, 0xc00
 mf v[60:63], a[236:239], a[180:183], v[60:63]
 s_waitcnt lgkmcnt(8)
 s_add_u32 s61, s86, s17
 ds_read_b64_tr_b16 a[236:237], v13 offset:192
 ds_read_b64_tr_b16 a[238:239], v13 offset:5312
 mf v[64:67], a[240:243], a[168:171], v[64:67]
 s_add_u32 s61, s61, 0x1800
 buffer_load_dwordx4 v25, s[48:51], s60 offen lds
 mf v[68:71], a[240:243], a[172:175], v[68:71]
 buffer_load_dwordx4 a[140:143], v4, s[40:43], s61 offen
 mf v[72:75], a[240:243], a[176:179], v[72:75]
 mf v[76:79], a[240:243], a[180:183], v[76:79]
 s_waitcnt lgkmcnt(8)
 ds_read_b64_tr_b16 a[240:241], v12 offset:256
 ds_read_b64_tr_b16 a[242:243], v12 offset:5376
 mf v[80:83], a[244:247], a[168:171], v[80:83]
 mf v[84:87], a[244:247], a[172:175], v[84:87]
 mf v[88:91], a[244:247], a[176:179], v[88:91]
 s_add_u32 m0, s83, 0x1000
 mf v[92:95], a[244:247], a[180:183], v[92:95]
 s_waitcnt lgkmcnt(8)
 s_add_u32 s61, s87, 0x1800
 ds_read_b64_tr_b16 a[244:245], v12 offset:10240
 ds_read_b64_tr_b16 a[246:247], v12 offset:15360
 mf v[96:99], a[248:251], a[168:171], v[96:99]
 buffer_load_dwordx4 v26, s[48:51], s60 offen lds
 mf v[100:103], a[248:251], a[172:175], v[100:103]
 buffer_load_dwordx4 a[144:147], v4, s[40:43], s61 offen
 mf v[104:107], a[248:251], a[176:179], v[104:107]
 mf v[108:111], a[248:251], a[180:183], v[108:111]
 s_waitcnt lgkmcnt(8)
 ds_read_b64_tr_b16 a[248:249], v13 offset:10240
 ds_read_b64_tr_b16 a[250:251], v13 offset:15360
 mf v[112:115], a[252:255], a[168:171], v[112:115]
 mf v[116:119], a[252:255], a[172:175], v[116:119]
 mf v[120:123], a[252:255], a[176:179], v[120:123]
 mf v[124:127], a[252:255], a[180:183], v[124:127]
 s_waitcnt lgkmcnt(8)
 s_add_u32 s61, s87, s17
 ds_read_b64_tr_b16 a[252:253], v12 offset:10304
 ds_read_b64_tr_b16 a[254:255], v12 offset:15424
 mf v[128:131], a[232:235], a[168:171], v[128:131]
 s_add_u32 s61, s61, 0x1800
 buffer_load_dwordx4 a[148:151], v4, s[40:43], s61 offen
 mf v[132:135], a[232:235], a[172:175], v[132:135]
 mf v[136:139], a[232:235], a[176:179], v[136:139]
 mf v[140:143], a[232:235], a[180:183], v[140:143]
 s_waitcnt lgkmcnt(8)
 ds_read_b64_tr_b16 a[232:233], v13 offset:10304
 ds_read_b64_tr_b16 a[234:235], v13 offset:15424
 mf v[144:147], a[236:239], a[168:171], v[144:147]
 mf v[148:151], a[236:239], a[172:175], v[148:151]
 mf v[152:155], a[236:239], a[176:179], v[152:155]
 s_add_u32 s61, s86, 0x1800
 buffer_load_dwordx4 a[152:155], v4, s[40:43], s61 offen offset:1024
 mf v[156:159], a[236:239], a[180:183], v[156:159]
 s_waitcnt lgkmcnt(8)
 ds_read_b64_tr_b16 a[236:237], v12 offset:10368
 ds_read_b64_tr_b16 a[238:239], v12 offset:15488
 mf v[160:163], a[240:243], a[168:171], v[160:163]
 mf v[164:167], a[240:243], a[172:175], v[164:167]
 mf v[168:171], a[240:243], a[176:179], v[168:171]
 mf v[172:175], a[240:243], a[180:183], v[172:175]
 s_waitcnt vmcnt(26) lgkmcnt(8)
 ds_read_b64_tr_b16 a[240:241], v13 offset:10368
 ds_read_b64_tr_b16 a[242:243], v13 offset:15488
 mf v[32:35], a[244:247], a[184:187], v[32:35]
 s_waitcnt vmcnt(25)
 s_add_u32 s61, s86, s17
 mf v[36:39], a[244:247], a[188:191], v[36:39]
 s_waitcnt vmcnt(24)
 s_add_u32 s61, s61, 0x1800
 buffer_load_dwordx4 a[156:159], v4, s[40:43], s61 offen offset:1024
 mf v[40:43], a[244:247], a[192:195], v[40:43]
 s_waitcnt vmcnt(24)
 mf v[44:47], a[244:247], a[196:199], v[44:47]
 s_waitcnt lgkmcnt(8)
 ds_read_b64_tr_b16 a[244:245], v12 offset:10432
 ds_read_b64_tr_b16 a[246:247], v12 offset:15552
 mf v[48:51], a[248:251], a[184:187], v[48:51]
 mf v[52:55], a[248:251], a[188:191], v[52:55]
 mf v[56:59], a[248:251], a[192:195], v[56:59]
 mf v[60:63], a[248:251], a[196:199], v[60:63]
 s_waitcnt lgkmcnt(8)
 s_add_u32 s61, s87, 0x1800
 ds_read_b64_tr_b16 a[248:249], v13 offset:10432
 ds_read_b64_tr_b16 a[250:251], v13 offset:15552
 mf v[64:67], a[252:255], a[184:187], v[64:67]
 buffer_load_dwordx4 a[160:163], v4, s[40:43], s61 offen offset:1024
 mf v[68:71], a[252:255], a[188:191], v[68:71]
 mf v[72:75], a[252:255], a[192:195], v[72:75]
 mf v[76:79], a[252:255], a[196:199], v[76:79]
 s_waitcnt lgkmcnt(8)
 ds_read_b64_tr_b16 a[252:253], v12 offset:10496
 ds_read_b64_tr_b16 a[254:255], v12 offset:15616
 mf v[80:83], a[232:235], a[184:187], v[80:83]
 mf v[84:87], a[232:235], a[188:191], v[84:87]
 mf v[88:91], a[232:235], a[192:195], v[88:91]
 s_add_u32 s61, s87, s17
 mf v[92:95], a[232:235], a[196:199], v[92:95]
 s_waitcnt lgkmcnt(8)
 s_add_u32 s61, s61, 0x1800
 buffer_load_dwordx4 a[164:167], v4, s[40:43], s61 offen offset:1024
 mf v[96:99], a[236:239], a[184:187], v[96:99]
 mf v[100:103], a[236:239], a[188:191], v[100:103]
 s_waitcnt lgkmcnt(0)
 s_barrier
 mf v[104:107], a[236:239], a[192:195], v[104:107]
 s_add_u32 s60, s92, 0x5a000
 ds_read_b64_tr_b16 a[232:233], v14
 ds_read_b64_tr_b16 a[234:235], v14 offset:5120
 mf v[108:111], a[236:239], a[196:199], v[108:111]
 s_add_u32 m0, s83, 0x5000
 ds_read_b64_tr_b16 a[236:237], v15
 ds_read_b64_tr_b16 a[238:239], v15 offset:5120
 mf v[112:115], a[240:243], a[184:187], v[112:115]
 buffer_load_dwordx4 v22, s[48:51], s60 offen lds
 mf v[116:119], a[240:243], a[188:191], v[116:119]
 mf v[120:123], a[240:243], a[192:195], v[120:123]
 mf v[124:127], a[240:243], a[196:199], v[124:127]
 ds_read_b64_tr_b16 a[240:241], v14 offset:64
 ds_read_b64_tr_b16 a[242:243], v14 offset:5184
 mf v[128:131], a[244:247], a[184:187], v[128:131]
 mf v[132:135], a[244:247], a[188:191], v[132:135]
 mf v[136:139], a[244:247], a[192:195], v[136:139]
 s_add_u32 m0, s83, 0x5400
 mf v[140:143], a[244:247], a[196:199], v[140:143]
 ds_read_b64_tr_b16 a[244:245], v15 offset:64
 ds_read_b64_tr_b16 a[246:247], v15 offset:5184
 mf v[144:147], a[248:251], a[184:187], v[144:147]
 buffer_load_dwordx4 v23, s[48:51], s60 offen lds
 mf v[148:151], a[248:251], a[188:191], v[148:151]
 mf v[152:155], a[248:251], a[192:195], v[152:155]
 mf v[156:159], a[248:251], a[196:199], v[156:159]
 ds_read_b64_tr_b16 a[248:249], v14 offset:128
 ds_read_b64_tr_b16 a[250:251], v14 offset:5248
 mf v[160:163], a[252:255], a[184:187], v[160:163]
 mf v[164:167], a[252:255], a[188:191], v[164:167]
 mf v[168:171], a[252:255], a[192:195], v[168:171]
 s_add_u32 m0, s83, 0x5800
 mf v[172:175], a[252:255], a[196:199], v[172:175]
 s_waitcnt vmcnt(24) lgkmcnt(8)
 ds_read_b64_tr_b16 a[252:253], v15 offset:128
 ds_read_b64_tr_b16 a[254:255], v15 offset:5248
 mf v[32:35], a[232:235], a[200:203], v[32:35]
 s_waitcnt vmcnt(22)
 s_add_u32 s61, s86, 0x2000
 buffer_load_dwordx4 v24, s[48:51], s60 offen lds
 mf v[36:39], a[232:235], a[204:207], v[36:39]
 s_waitcnt vmcnt(21)
 buffer_load_dwordx4 a[168:171], v4, s[40:43], s61 offen
 mf v[40:43], a[232:235], a[208:211], v[40:43]
 s_waitcnt vmcnt(21)
 mf v[44:47], a[232:235], a[212:215], v[44:47]
 s_waitcnt lgkmcnt(8)
 ds_read_b64_tr_b16 a[232:233], v14 offset:192
 ds_read_b64_tr_b16 a[234:235], v14 offset:5312
 mf v[48:51], a[236:239], a[200:203], v[48:51]
 mf v[52:55], a[236:239], a[204:207], v[52:55]
 mf v[56:59], a[236:239], a[208:211], v[56:59]
 s_add_u32 m0, s83, 0x5c00
 mf v[60:63], a[236:239], a[212:215], v[60:63]
 s_waitcnt lgkmcnt(8)
 s_add_u32 s61, s86, s17
 ds_read_b64_tr_b16 a[236:237], v15 offset:192
 ds_read_b64_tr_b16 a[238:239], v15 offset:5312
 mf v[64:67], a[240:243], a[200:203], v[64:67]
 s_add_u32 s61, s61, 0x2000
 buffer_load_dwordx4 v25, s[48:51], s60 offen lds
 mf v[68:71], a[240:243], a[204:207], v[68:71]
 buffer_load_dwordx4 a[172:175], v4, s[40:43], s61 offen
 mf v[72:75], a[240:243], a[208:211], v[72:75]
 mf v[76:79], a[240:243], a[212:215], v[76:79]
 s_waitcnt lgkmcnt(8)
 ds_read_b64_tr_b16 a[240:241], v14 offset:256
 ds_read_b64_tr_b16 a[242:243], v14 offset:5376
 mf v[80:83], a[244:247], a[200:203], v[80:83]
 mf v[84:87], a[244:247], a[204:207], v[84:87]
 mf v[88:91], a[244:247], a[208:211], v[88:91]
 s_add_u32 m0, s83, 0x6000
 mf v[92:95], a[244:247], a[212:215], v[92:95]
 s_waitcnt lgkmcnt(8)
 s_add_u32 s61, s87, 0x2000
 ds_read_b64_tr_b16 a[244:245], v14 offset:10240
 ds_read_b64_tr_b16 a[246:247], v14 offset:15360
 mf v[96:99], a[248:251], a[200:203], v[96:99]
 buffer_load_dwordx4 v26, s[48:51], s60 offen lds
 mf v[100:103], a[248:251], a[204:207], v[100:103]
 buffer_load_dwordx4 a[176:179], v4, s[40:43], s61 offen
 mf v[104:107], a[248:251], a[208:211], v[104:107]
 mf v[108:111], a[248:251], a[212:215], v[108:111]
 s_waitcnt lgkmcnt(8)
 ds_read_b64_tr_b16 a[248:249], v15 offset:10240
 ds_read_b64_tr_b16 a[250:251], v15 offset:15360
 mf v[112:115], a[252:255], a[200:203], v[112:115]
 mf v[116:119], a[252:255], a[204:207], v[116:119]
 mf v[120:123], a[252:255], a[208:211], v[120:123]
 mf v[124:127], a[252:255], a[212:215], v[124:127]
 s_waitcnt lgkmcnt(8)
 s_add_u32 s61, s87, s17
 ds_read_b64_tr_b16 a[252:253], v14 offset:10304
 ds_read_b64_tr_b16 a[254:255], v14 offset:15424
 mf v[128:131], a[232:235], a[200:203], v[128:131]
 s_add_u32 s61, s61, 0x2000
 buffer_load_dwordx4 a[180:183], v4, s[40:43], s61 offen
 mf v[132:135], a[232:235], a[204:207], v[132:135]
 mf v[136:139], a[232:235], a[208:211], v[136:139]
 mf v[140:143], a[232:235], a[212:215], v[140:143]
 s_waitcnt lgkmcnt(8)
 ds_read_b64_tr_b16 a[232:233], v15 offset:10304
 ds_read_b64_tr_b16 a[234:235], v15 offset:15424
 mf v[144:147], a[236:239], a[200:203], v[144:147]
 mf v[148:151], a[236:239], a[204:207], v[148:151]
 mf v[152:155], a[236:239], a[208:211], v[152:155]
 s_add_u32 s61, s86, 0x2000
 buffer_load_dwordx4 a[184:187], v4, s[40:43], s61 offen offset:1024
 mf v[156:159], a[236:239], a[212:215], v[156:159]
 s_waitcnt lgkmcnt(8)
 ds_read_b64_tr_b16 a[236:237], v14 offset:10368
 ds_read_b64_tr_b16 a[238:239], v14 offset:15488
 mf v[160:163], a[240:243], a[200:203], v[160:163]
 mf v[164:167], a[240:243], a[204:207], v[164:167]
 mf v[168:171], a[240:243], a[208:211], v[168:171]
 mf v[172:175], a[240:243], a[212:215], v[172:175]
 s_waitcnt vmcnt(26) lgkmcnt(8)
 ds_read_b64_tr_b16 a[240:241], v15 offset:10368
 ds_read_b64_tr_b16 a[242:243], v15 offset:15488
 mf v[32:35], a[244:247], a[216:219], v[32:35]
 s_waitcnt vmcnt(25)
 s_add_u32 s61, s86, s17
 mf v[36:39], a[244:247], a[220:223], v[36:39]
 s_waitcnt vmcnt(24)
 s_add_u32 s61, s61, 0x2000
 buffer_load_dwordx4 a[188:191], v4, s[40:43], s61 offen offset:1024
 mf v[40:43], a[244:247], a[224:227], v[40:43]
 s_waitcnt vmcnt(24)
 mf v[44:47], a[244:247], a[228:231], v[44:47]
 s_waitcnt lgkmcnt(8)
 ds_read_b64_tr_b16 a[244:245], v14 offset:10432
 ds_read_b64_tr_b16 a[246:247], v14 offset:15552
 mf v[48:51], a[248:251], a[216:219], v[48:51]
 mf v[52:55], a[248:251], a[220:223], v[52:55]
 mf v[56:59], a[248:251], a[224:227], v[56:59]
 mf v[60:63], a[248:251], a[228:231], v[60:63]
 s_waitcnt lgkmcnt(8)
 s_add_u32 s61, s87, 0x2000
 ds_read_b64_tr_b16 a[248:249], v15 offset:10432
 ds_read_b64_tr_b16 a[250:251], v15 offset:15552
 mf v[64:67], a[252:255], a[216:219], v[64:67]
 buffer_load_dwordx4 a[192:195], v4, s[40:43], s61 offen offset:1024
 mf v[68:71], a[252:255], a[220:223], v[68:71]
 mf v[72:75], a[252:255], a[224:227], v[72:75]
 mf v[76:79], a[252:255], a[228:231], v[76:79]
 s_waitcnt lgkmcnt(8)
 ds_read_b64_tr_b16 a[252:253], v14 offset:10496
 ds_read_b64_tr_b16 a[254:255], v14 offset:15616
 mf v[80:83], a[232:235], a[216:219], v[80:83]
 mf v[84:87], a[232:235], a[220:223], v[84:87]
 mf v[88:91], a[232:235], a[224:227], v[88:91]
 s_add_u32 s61, s87, s17
 mf v[92:95], a[232:235], a[228:231], v[92:95]
 s_waitcnt lgkmcnt(8)
 s_add_u32 s61, s61, 0x2000
 buffer_load_dwordx4 a[196:199], v4, s[40:43], s61 offen offset:1024
 mf v[96:99], a[236:239], a[216:219], v[96:99]
 mf v[100:103], a[236:239], a[220:223], v[100:103]
 s_waitcnt lgkmcnt(0)
 s_barrier
 mf v[104:107], a[236:239], a[224:227], v[104:107]
 s_add_u32 s60, s92, 0x6c000
 ds_read_b64_tr_b16 a[232:233], v8
 ds_read_b64_tr_b16 a[234:235], v8 offset:5120
 mf v[108:111], a[236:239], a[228:231], v[108:111]
 s_add_u32 m0, s83, 0xa000
 ds_read_b64_tr_b16 a[236:237], v9
 ds_read_b64_tr_b16 a[238:239], v9 offset:5120
 mf v[112:115], a[240:243], a[216:219], v[112:115]
 buffer_load_dwordx4 v22, s[48:51], s60 offen lds
 mf v[116:119], a[240:243], a[220:223], v[116:119]
 mf v[120:123], a[240:243], a[224:227], v[120:123]
 mf v[124:127], a[240:243], a[228:231], v[124:127]
 ds_read_b64_tr_b16 a[240:241], v8 offset:64
 ds_read_b64_tr_b16 a[242:243], v8 offset:5184
 mf v[128:131], a[244:247], a[216:219], v[128:131]
 mf v[132:135], a[244:247], a[220:223], v[132:135]
 mf v[136:139], a[244:247], a[224:227], v[136:139]
 s_add_u32 m0, s83, 0xa400
 mf v[140:143], a[244:247], a[228:231], v[140:143]
 ds_read_b64_tr_b16 a[244:245], v9 offset:64
 ds_read_b64_tr_b16 a[246:247], v9 offset:5184
 mf v[144:147], a[248:251], a[216:219], v[144:147]
 buffer_load_dwordx4 v23, s[48:51], s60 offen lds
 mf v[148:151], a[248:251], a[220:223], v[148:151]
 mf v[152:155], a[248:251], a[224:227], v[152:155]
 mf v[156:159], a[248:251], a[228:231], v[156:159]
 ds_read_b64_tr_b16 a[248:249], v8 offset:128
 ds_read_b64_tr_b16 a[250:251], v8 offset:5248
 mf v[160:163], a[252:255], a[216:219], v[160:163]
 mf v[164:167], a[252:255], a[220:223], v[164:167]
 mf v[168:171], a[252:255], a[224:227], v[168:171]
 s_add_u32 m0, s83, 0xa800
 mf v[172:175], a[252:255], a[228:231], v[172:175]
 s_waitcnt vmcnt(24) lgkmcnt(8)
 ds_read_b64_tr_b16 a[252:253], v9 offset:128
 ds_read_b64_tr_b16 a[254:255], v9 offset:5248
 mf v[32:35], a[232:235], a[136:139], v[32:35]
 s_waitcnt vmcnt(22)
 s_add_u32 s61, s86, 0x2800
 buffer_load_dwordx4 v24, s[48:51], s60 offen lds
 mf v[36:39], a[232:235], a[140:143], v[36:39]
 s_waitcnt vmcnt(21)
 buffer_load_dwordx4 a[200:203], v4, s[40:43], s61 offen
 mf v[40:43], a[232:235], a[144:147], v[40:43]
 s_waitcnt vmcnt(21)
 mf v[44:47], a[232:235], a[148:151], v[44:47]
 s_waitcnt lgkmcnt(8)
 ds_read_b64_tr_b16 a[232:233], v8 offset:192
 ds_read_b64_tr_b16 a[234:235], v8 offset:5312
 mf v[48:51], a[236:239], a[136:139], v[48:51]
 mf v[52:55], a[236:239], a[140:143], v[52:55]
 mf v[56:59], a[236:239], a[144:147], v[56:59]
 s_add_u32 m0, s83, 0xac00
 mf v[60:63], a[236:239], a[148:151], v[60:63]
 s_waitcnt lgkmcnt(8)
 s_add_u32 s61, s86, s17
 ds_read_b64_tr_b16 a[236:237], v9 offset:192
 ds_read_b64_tr_b16 a[238:239], v9 offset:5312
 mf v[64:67], a[240:243], a[136:139], v[64:67]
 s_add_u32 s61, s61, 0x2800
 buffer_load_dwordx4 v25, s[48:51], s60 offen lds
 mf v[68:71], a[240:243], a[140:143], v[68:71]
 buffer_load_dwordx4 a[204:207], v4, s[40:43], s61 offen
 mf v[72:75], a[240:243], a[144:147], v[72:75]
 mf v[76:79], a[240:243], a[148:151], v[76:79]
 s_waitcnt lgkmcnt(8)
 ds_read_b64_tr_b16 a[240:241], v8 offset:256
 ds_read_b64_tr_b16 a[242:243], v8 offset:5376
 mf v[80:83], a[244:247], a[136:139], v[80:83]
 mf v[84:87], a[244:247], a[140:143], v[84:87]
 mf v[88:91], a[244:247], a[144:147], v[88:91]
 s_add_u32 m0, s83, 0xb000
 mf v[92:95], a[244:247], a[148:151], v[92:95]
 s_waitcnt lgkmcnt(8)
 s_add_u32 s61, s87, 0x2800
 ds_read_b64_tr_b16 a[244:245], v8 offset:10240
 ds_read_b64_tr_b16 a[246:247], v8 offset:15360
 mf v[96:99], a[248:251], a[136:139], v[96:99]
 buffer_load_dwordx4 v26, s[48:51], s60 offen lds
 mf v[100:103], a[248:251], a[140:143], v[100:103]
 buffer_load_dwordx4 a[208:211], v4, s[40:43], s61 offen
 mf v[104:107], a[248:251], a[144:147], v[104:107]
 mf v[108:111], a[248:251], a[148:151], v[108:111]
 s_waitcnt lgkmcnt(8)
 ds_read_b64_tr_b16 a[248:249], v9 offset:10240
 ds_read_b64_tr_b16 a[250:251], v9 offset:15360
 mf v[112:115], a[252:255], a[136:139], v[112:115]
 mf v[116:119], a[252:255], a[140:143], v[116:119]
 mf v[120:123], a[252:255], a[144:147], v[120:123]
 mf v[124:127], a[252:255], a[148:151], v[124:127]
 s_waitcnt lgkmcnt(8)
 s_add_u32 s61, s87, s17
 ds_read_b64_tr_b16 a[252:253], v8 offset:10304
 ds_read_b64_tr_b16 a[254:255], v8 offset:15424
 mf v[128:131], a[232:235], a[136:139], v[128:131]
 s_add_u32 s61, s61, 0x2800
 buffer_load_dwordx4 a[212:215], v4, s[40:43], s61 offen
 mf v[132:135], a[232:235], a[140:143], v[132:135]
 mf v[136:139], a[232:235], a[144:147], v[136:139]
 mf v[140:143], a[232:235], a[148:151], v[140:143]
 s_waitcnt lgkmcnt(8)
 ds_read_b64_tr_b16 a[232:233], v9 offset:10304
 ds_read_b64_tr_b16 a[234:235], v9 offset:15424
 mf v[144:147], a[236:239], a[136:139], v[144:147]
 mf v[148:151], a[236:239], a[140:143], v[148:151]
 mf v[152:155], a[236:239], a[144:147], v[152:155]
 s_add_u32 s61, s86, 0x2800
 buffer_load_dwordx4 a[216:219], v4, s[40:43], s61 offen offset:1024
 mf v[156:159], a[236:239], a[148:151], v[156:159]
 s_waitcnt lgkmcnt(8)
 ds_read_b64_tr_b16 a[236:237], v8 offset:10368
 ds_read_b64_tr_b16 a[238:239], v8 offset:15488
 mf v[160:163], a[240:243], a[136:139], v[160:163]
 mf v[164:167], a[240:243], a[140:143], v[164:167]
 mf v[168:171], a[240:243], a[144:147], v[168:171]
 mf v[172:175], a[240:243], a[148:151], v[172:175]
 s_waitcnt vmcnt(26) lgkmcnt(8)
 ds_read_b64_tr_b16 a[240:241], v9 offset:10368
 ds_read_b64_tr_b16 a[242:243], v9 offset:15488
 mf v[32:35], a[244:247], a[152:155], v[32:35]
 s_waitcnt vmcnt(25)
 s_add_u32 s61, s86, s17
 mf v[36:39], a[244:247], a[156:159], v[36:39]
 s_waitcnt vmcnt(24)
 s_add_u32 s61, s61, 0x2800
 buffer_load_dwordx4 a[220:223], v4, s[40:43], s61 offen offset:1024
 mf v[40:43], a[244:247], a[160:163], v[40:43]
 s_waitcnt vmcnt(24)
 mf v[44:47], a[244:247], a[164:167], v[44:47]
 s_waitcnt lgkmcnt(8)
 ds_read_b64_tr_b16 a[244:245], v8 offset:10432
 ds_read_b64_tr_b16 a[246:247], v8 offset:15552
 mf v[48:51], a[248:251], a[152:155], v[48:51]
 mf v[52:55], a[248:251], a[156:159], v[52:55]
 mf v[56:59], a[248:251], a[160:163], v[56:59]
 mf v[60:63], a[248:251], a[164:167], v[60:63]
 s_waitcnt lgkmcnt(8)
 s_add_u32 s61, s87, 0x2800
 ds_read_b64_tr_b16 a[248:249], v9 offset:10432
 ds_read_b64_tr_b16 a[250:251], v9 offset:15552
 mf v[64:67], a[252:255], a[152:155], v[64:67]
 buffer_load_dwordx4 a[224:227], v4, s[40:43], s61 offen offset:1024
 mf v[68:71], a[252:255], a[156:159], v[68:71]
 mf v[72:75], a[252:255], a[160:163], v[72:75]
 mf v[76:79], a[252:255], a[164:167], v[76:79]
 s_waitcnt lgkmcnt(8)
 ds_read_b64_tr_b16 a[252:253], v8 offset:10496
 ds_read_b64_tr_b16 a[254:255], v8 offset:15616
 mf v[80:83], a[232:235], a[152:155], v[80:83]
 mf v[84:87], a[232:235], a[156:159], v[84:87]
 mf v[88:91], a[232:235], a[160:163], v[88:91]
 s_add_u32 s61, s87, s17
 mf v[92:95], a[232:235], a[164:167], v[92:95]
 s_waitcnt lgkmcnt(8)
 s_add_u32 s61, s61, 0x2800
 buffer_load_dwordx4 a[228:231], v4, s[40:43], s61 offen offset:1024
 mf v[96:99], a[236:239], a[152:155], v[96:99]
 mf v[100:103], a[236:239], a[156:159], v[100:103]
 s_waitcnt lgkmcnt(0)
 s_barrier
 mf v[104:107], a[236:239], a[160:163], v[104:107]
 s_add_u32 s60, s92, 0x7e000
 ds_read_b64_tr_b16 a[232:233], v10
 ds_read_b64_tr_b16 a[234:235], v10 offset:5120
 mf v[108:111], a[236:239], a[164:167], v[108:111]
 s_add_u32 m0, s83, 0x20000
 ds_read_b64_tr_b16 a[236:237], v11
 ds_read_b64_tr_b16 a[238:239], v11 offset:5120
 mf v[112:115], a[240:243], a[152:155], v[112:115]
 buffer_load_dwordx4 v22, s[48:51], s60 offen lds
 mf v[116:119], a[240:243], a[156:159], v[116:119]
 mf v[120:123], a[240:243], a[160:163], v[120:123]
 mf v[124:127], a[240:243], a[164:167], v[124:127]
 ds_read_b64_tr_b16 a[240:241], v10 offset:64
 ds_read_b64_tr_b16 a[242:243], v10 offset:5184
 mf v[128:131], a[244:247], a[152:155], v[128:131]
 mf v[132:135], a[244:247], a[156:159], v[132:135]
 mf v[136:139], a[244:247], a[160:163], v[136:139]
 s_add_u32 m0, s83, 0x20400
 mf v[140:143], a[244:247], a[164:167], v[140:143]
 ds_read_b64_tr_b16 a[244:245], v11 offset:64
 ds_read_b64_tr_b16 a[246:247], v11 offset:5184
 mf v[144:147], a[248:251], a[152:155], v[144:147]
 buffer_load_dwordx4 v23, s[48:51], s60 offen lds
 mf v[148:151], a[248:251], a[156:159], v[148:151]
 mf v[152:155], a[248:251], a[160:163], v[152:155]
 mf v[156:159], a[248:251], a[164:167], v[156:159]
 ds_read_b64_tr_b16 a[248:249], v10 offset:128
 ds_read_b64_tr_b16 a[250:251], v10 offset:5248
 mf v[160:163], a[252:255], a[152:155], v[160:163]
 mf v[164:167], a[252:255], a[156:159], v[164:167]
 mf v[168:171], a[252:255], a[160:163], v[168:171]
 s_add_u32 m0, s83, 0x20800
 mf v[172:175], a[252:255], a[164:167], v[172:175]
 s_waitcnt vmcnt(24) lgkmcnt(8)
 ds_read_b64_tr_b16 a[252:253], v11 offset:128
 ds_read_b64_tr_b16 a[254:255], v11 offset:5248
 mf v[32:35], a[232:235], a[168:171], v[32:35]
 s_waitcnt vmcnt(22)
 s_add_u32 s61, s86, 0x3000
 buffer_load_dwordx4 v24, s[48:51], s60 offen lds
 mf v[36:39], a[232:235], a[172:175], v[36:39]
 s_waitcnt vmcnt(21)
 buffer_load_dwordx4 a[136:139], v4, s[40:43], s61 offen
 mf v[40:43], a[232:235], a[176:179], v[40:43]
 s_waitcnt vmcnt(21)
 mf v[44:47], a[232:235], a[180:183], v[44:47]
 s_waitcnt lgkmcnt(8)
 ds_read_b64_tr_b16 a[232:233], v10 offset:192
 ds_read_b64_tr_b16 a[234:235], v10 offset:5312
 mf v[48:51], a[236:239], a[168:171], v[48:51]
 mf v[52:55], a[236:239], a[172:175], v[52:55]
 mf v[56:59], a[236:239], a[176:179], v[56:59]
 s_add_u32 m0, s83, 0x20c00
 mf v[60:63], a[236:239], a[180:183], v[60:63]
 s_waitcnt lgkmcnt(8)
 s_add_u32 s61, s86, s17
 ds_read_b64_tr_b16 a[236:237], v11 offset:192
 ds_read_b64_tr_b16 a[238:239], v11 offset:5312
 mf v[64:67], a[240:243], a[168:171], v[64:67]
 s_add_u32 s61, s61, 0x3000
 buffer_load_dwordx4 v25, s[48:51], s60 offen lds
 mf v[68:71], a[240:243], a[172:175], v[68:71]
 buffer_load_dwordx4 a[140:143], v4, s[40:43], s61 offen
 mf v[72:75], a[240:243], a[176:179], v[72:75]
 mf v[76:79], a[240:243], a[180:183], v[76:79]
 s_waitcnt lgkmcnt(8)
 ds_read_b64_tr_b16 a[240:241], v10 offset:256
 ds_read_b64_tr_b16 a[242:243], v10 offset:5376
 mf v[80:83], a[244:247], a[168:171], v[80:83]
 mf v[84:87], a[244:247], a[172:175], v[84:87]
 mf v[88:91], a[244:247], a[176:179], v[88:91]
 s_add_u32 m0, s83, 0x21000
 mf v[92:95], a[244:247], a[180:183], v[92:95]
 s_waitcnt lgkmcnt(8)
 s_add_u32 s61, s87, 0x3000
 ds_read_b64_tr_b16 a[244:245], v10 offset:10240
 ds_read_b64_tr_b16 a[246:247], v10 offset:15360
 mf v[96:99], a[248:251], a[168:171], v[96:99]
 buffer_load_dwordx4 v26, s[48:51], s60 offen lds
 mf v[100:103], a[248:251], a[172:175], v[100:103]
 buffer_load_dwordx4 a[144:147], v4, s[40:43], s61 offen
 mf v[104:107], a[248:251], a[176:179], v[104:107]
 mf v[108:111], a[248:251], a[180:183], v[108:111]
 s_waitcnt lgkmcnt(8)
 ds_read_b64_tr_b16 a[248:249], v11 offset:10240
 ds_read_b64_tr_b16 a[250:251], v11 offset:15360
 mf v[112:115], a[252:255], a[168:171], v[112:115]
 mf v[116:119], a[252:255], a[172:175], v[116:119]
 mf v[120:123], a[252:255], a[176:179], v[120:123]
 mf v[124:127], a[252:255], a[180:183], v[124:127]
 s_waitcnt lgkmcnt(8)
 s_add_u32 s61, s87, s17
 ds_read_b64_tr_b16 a[252:253], v10 offset:10304
 ds_read_b64_tr_b16 a[254:255], v10 offset:15424
 mf v[128:131], a[232:235], a[168:171], v[128:131]
 s_add_u32 s61, s61, 0x3000
 buffer_load_dwordx4 a[148:151], v4, s[40:43], s61 offen
 mf v[132:135], a[232:235], a[172:175], v[132:135]
 mf v[136:139], a[232:235], a[176:179], v[136:139]
 mf v[140:143], a[232:235], a[180:183], v[140:143]
 s_waitcnt lgkmcnt(8)
 ds_read_b64_tr_b16 a[232:233], v11 offset:10304
 ds_read_b64_tr_b16 a[234:235], v11 offset:15424
 mf v[144:147], a[236:239], a[168:171], v[144:147]
 mf v[148:151], a[236:239], a[172:175], v[148:151]
 mf v[152:155], a[236:239], a[176:179], v[152:155]
 s_add_u32 s61, s86, 0x3000
 buffer_load_dwordx4 a[152:155], v4, s[40:43], s61 offen offset:1024
 mf v[156:159], a[236:239], a[180:183], v[156:159]
 s_waitcnt lgkmcnt(8)
 ds_read_b64_tr_b16 a[236:237], v10 offset:10368
 ds_read_b64_tr_b16 a[238:239], v10 offset:15488
 mf v[160:163], a[240:243], a[168:171], v[160:163]
 mf v[164:167], a[240:243], a[172:175], v[164:167]
 mf v[168:171], a[240:243], a[176:179], v[168:171]
 mf v[172:175], a[240:243], a[180:183], v[172:175]
 s_waitcnt vmcnt(26) lgkmcnt(8)
 ds_read_b64_tr_b16 a[240:241], v11 offset:10368
 ds_read_b64_tr_b16 a[242:243], v11 offset:15488
 mf v[32:35], a[244:247], a[184:187], v[32:35]
 s_waitcnt vmcnt(25)
 s_add_u32 s61, s86, s17
 mf v[36:39], a[244:247], a[188:191], v[36:39]
 s_waitcnt vmcnt(24)
 s_add_u32 s61, s61, 0x3000
 buffer_load_dwordx4 a[156:159], v4, s[40:43], s61 offen offset:1024
 mf v[40:43], a[244:247], a[192:195], v[40:43]
 s_waitcnt vmcnt(24)
 mf v[44:47], a[244:247], a[196:199], v[44:47]
 s_waitcnt lgkmcnt(8)
 ds_read_b64_tr_b16 a[244:245], v10 offset:10432
 ds_read_b64_tr_b16 a[246:247], v10 offset:15552
 mf v[48:51], a[248:251], a[184:187], v[48:51]
 mf v[52:55], a[248:251], a[188:191], v[52:55]
 mf v[56:59], a[248:251], a[192:195], v[56:59]
 mf v[60:63], a[248:251], a[196:199], v[60:63]
 s_waitcnt lgkmcnt(8)
 s_add_u32 s61, s87, 0x3000
 ds_read_b64_tr_b16 a[248:249], v11 offset:10432
 ds_read_b64_tr_b16 a[250:251], v11 offset:15552
 mf v[64:67], a[252:255], a[184:187], v[64:67]
 buffer_load_dwordx4 a[160:163], v4, s[40:43], s61 offen offset:1024
 mf v[68:71], a[252:255], a[188:191], v[68:71]
 mf v[72:75], a[252:255], a[192:195], v[72:75]
 mf v[76:79], a[252:255], a[196:199], v[76:79]
 s_waitcnt lgkmcnt(8)
 ds_read_b64_tr_b16 a[252:253], v10 offset:10496
 ds_read_b64_tr_b16 a[254:255], v10 offset:15616
 mf v[80:83], a[232:235], a[184:187], v[80:83]
 mf v[84:87], a[232:235], a[188:191], v[84:87]
 mf v[88:91], a[232:235], a[192:195], v[88:91]
 s_add_u32 s61, s87, s17
 mf v[92:95], a[232:235], a[196:199], v[92:95]
 s_waitcnt lgkmcnt(8)
 s_add_u32 s61, s61, 0x3000
 buffer_load_dwordx4 a[164:167], v4, s[40:43], s61 offen offset:1024
 mf v[96:99], a[236:239], a[184:187], v[96:99]
 mf v[100:103], a[236:239], a[188:191], v[100:103]
 s_waitcnt lgkmcnt(0)
 s_barrier
 mf v[104:107], a[236:239], a[192:195], v[104:107]
 ds_read_b64_tr_b16 a[232:233], v12
 ds_read_b64_tr_b16 a[234:235], v12 offset:5120
 mf v[108:111], a[236:239], a[196:199], v[108:111]
 ds_read_b64_tr_b16 a[236:237], v13
 ds_read_b64_tr_b16 a[238:239], v13 offset:5120
 mf v[112:115], a[240:243], a[184:187], v[112:115]
 mf v[116:119], a[240:243], a[188:191], v[116:119]
 mf v[120:123], a[240:243], a[192:195], v[120:123]
 mf v[124:127], a[240:243], a[196:199], v[124:127]
 ds_read_b64_tr_b16 a[240:241], v12 offset:64
 ds_read_b64_tr_b16 a[242:243], v12 offset:5184
 mf v[128:131], a[244:247], a[184:187], v[128:131]
 mf v[132:135], a[244:247], a[188:191], v[132:135]
 mf v[136:139], a[244:247], a[192:195], v[136:139]
 mf v[140:143], a[244:247], a[196:199], v[140:143]
 ds_read_b64_tr_b16 a[244:245], v13 offset:64
 ds_read_b64_tr_b16 a[246:247], v13 offset:5184
 mf v[144:147], a[248:251], a[184:187], v[144:147]
 mf v[148:151], a[248:251], a[188:191], v[148:151]
 mf v[152:155], a[248:251], a[192:195], v[152:155]
 mf v[156:159], a[248:251], a[196:199], v[156:159]
 ds_read_b64_tr_b16 a[248:249], v12 offset:128
 ds_read_b64_tr_b16 a[250:251], v12 offset:5248
 mf v[160:163], a[252:255], a[184:187], v[160:163]
 mf v[164:167], a[252:255], a[188:191], v[164:167]
 mf v[168:171], a[252:255], a[192:195], v[168:171]
 mf v[172:175], a[252:255], a[196:199], v[172:175]
 s_waitcnt vmcnt(22) lgkmcnt(8)
 ds_read_b64_tr_b16 a[252:253], v13 offset:128
 ds_read_b64_tr_b16 a[254:255], v13 offset:5248
 mf v[32:35], a[232:235], a[200:203], v[32:35]
 s_waitcnt vmcnt(20)
 s_add_u32 s61, s86, 0x3800
 buffer_load_dwordx4 a[168:171], v4, s[40:43], s61 offen
 mf v[36:39], a[232:235], a[204:207], v[36:39]
 s_waitcnt vmcnt(19)
 mf v[40:43], a[232:235], a[208:211], v[40:43]
 s_waitcnt vmcnt(18)
 mf v[44:47], a[232:235], a[212:215], v[44:47]
 s_waitcnt lgkmcnt(8)
 ds_read_b64_tr_b16 a[232:233], v12 offset:192
 ds_read_b64_tr_b16 a[234:235], v12 offset:5312
 mf v[48:51], a[236:239], a[200:203], v[48:51]
 mf v[52:55], a[236:239], a[204:207], v[52:55]
 mf v[56:59], a[236:239], a[208:211], v[56:59]
 s_add_u32 s61, s86, s17
 mf v[60:63], a[236:239], a[212:215], v[60:63]
 s_waitcnt lgkmcnt(8)
 s_add_u32 s61, s61, 0x3800
 ds_read_b64_tr_b16 a[236:237], v13 offset:192
 ds_read_b64_tr_b16 a[238:239], v13 offset:5312
 mf v[64:67], a[240:243], a[200:203], v[64:67]
 buffer_load_dwordx4 a[172:175], v4, s[40:43], s61 offen
 mf v[68:71], a[240:243], a[204:207], v[68:71]
 mf v[72:75], a[240:243], a[208:211], v[72:75]
 mf v[76:79], a[240:243], a[212:215], v[76:79]
 s_waitcnt lgkmcnt(8)
 ds_read_b64_tr_b16 a[240:241], v12 offset:256
 ds_read_b64_tr_b16 a[242:243], v12 offset:5376
 mf v[80:83], a[244:247], a[200:203], v[80:83]
 mf v[84:87], a[244:247], a[204:207], v[84:87]
 mf v[88:91], a[244:247], a[208:211], v[88:91]
 s_add_u32 s61, s87, 0x3800
 buffer_load_dwordx4 a[176:179], v4, s[40:43], s61 offen
 mf v[92:95], a[244:247], a[212:215], v[92:95]
 s_waitcnt lgkmcnt(8)
 ds_read_b64_tr_b16 a[244:245], v12 offset:10240
 ds_read_b64_tr_b16 a[246:247], v12 offset:15360
 mf v[96:99], a[248:251], a[200:203], v[96:99]
 mf v[100:103], a[248:251], a[204:207], v[100:103]
 mf v[104:107], a[248:251], a[208:211], v[104:107]
 mf v[108:111], a[248:251], a[212:215], v[108:111]
 s_waitcnt lgkmcnt(8)
 ds_read_b64_tr_b16 a[248:249], v13 offset:10240
 ds_read_b64_tr_b16 a[250:251], v13 offset:15360
 mf v[112:115], a[252:255], a[200:203], v[112:115]
 s_add_u32 s61, s87, s17
 mf v[116:119], a[252:255], a[204:207], v[116:119]
 s_add_u32 s61, s61, 0x3800
 buffer_load_dwordx4 a[180:183], v4, s[40:43], s61 offen
 mf v[120:123], a[252:255], a[208:211], v[120:123]
 mf v[124:127], a[252:255], a[212:215], v[124:127]
 s_waitcnt lgkmcnt(8)
 ds_read_b64_tr_b16 a[252:253], v12 offset:10304
 ds_read_b64_tr_b16 a[254:255], v12 offset:15424
 mf v[128:131], a[232:235], a[200:203], v[128:131]
 mf v[132:135], a[232:235], a[204:207], v[132:135]
 mf v[136:139], a[232:235], a[208:211], v[136:139]
 mf v[140:143], a[232:235], a[212:215], v[140:143]
 s_waitcnt lgkmcnt(8)
 s_add_u32 s61, s86, 0x3800
 ds_read_b64_tr_b16 a[232:233], v13 offset:10304
 ds_read_b64_tr_b16 a[234:235], v13 offset:15424
 mf v[144:147], a[236:239], a[200:203], v[144:147]
 buffer_load_dwordx4 a[184:187], v4, s[40:43], s61 offen offset:1024
 mf v[148:151], a[236:239], a[204:207], v[148:151]
 mf v[152:155], a[236:239], a[208:211], v[152:155]
 mf v[156:159], a[236:239], a[212:215], v[156:159]
 s_waitcnt lgkmcnt(8)
 ds_read_b64_tr_b16 a[236:237], v12 offset:10368
 ds_read_b64_tr_b16 a[238:239], v12 offset:15488
 mf v[160:163], a[240:243], a[200:203], v[160:163]
 mf v[164:167], a[240:243], a[204:207], v[164:167]
 mf v[168:171], a[240:243], a[208:211], v[168:171]
 s_add_u32 s61, s86, s17
 mf v[172:175], a[240:243], a[212:215], v[172:175]
 s_waitcnt vmcnt(21) lgkmcnt(8)
 s_add_u32 s61, s61, 0x3800
 ds_read_b64_tr_b16 a[240:241], v13 offset:10368
 ds_read_b64_tr_b16 a[242:243], v13 offset:15488
 mf v[32:35], a[244:247], a[216:219], v[32:35]
 s_waitcnt vmcnt(20)
 buffer_load_dwordx4 a[188:191], v4, s[40:43], s61 offen offset:1024
 mf v[36:39], a[244:247], a[220:223], v[36:39]
 s_waitcnt vmcnt(20)
 mf v[40:43], a[244:247], a[224:227], v[40:43]
 s_waitcnt vmcnt(19)
 mf v[44:47], a[244:247], a[228:231], v[44:47]
 s_waitcnt lgkmcnt(8)
 ds_read_b64_tr_b16 a[244:245], v12 offset:10432
 ds_read_b64_tr_b16 a[246:247], v12 offset:15552
 mf v[48:51], a[248:251], a[216:219], v[48:51]
 mf v[52:55], a[248:251], a[220:223], v[52:55]
 mf v[56:59], a[248:251], a[224:227], v[56:59]
 s_add_u32 s61, s87, 0x3800
 buffer_load_dwordx4 a[192:195], v4, s[40:43], s61 offen offset:1024
 mf v[60:63], a[248:251], a[228:231], v[60:63]
 s_waitcnt lgkmcnt(8)
 ds_read_b64_tr_b16 a[248:249], v13 offset:10432
 ds_read_b64_tr_b16 a[250:251], v13 offset:15552
 mf v[64:67], a[252:255], a[216:219], v[64:67]
 mf v[68:71], a[252:255], a[220:223], v[68:71]
 mf v[72:75], a[252:255], a[224:227], v[72:75]
 mf v[76:79], a[252:255], a[228:231], v[76:79]
 s_waitcnt lgkmcnt(8)
 ds_read_b64_tr_b16 a[252:253], v12 offset:10496
 ds_read_b64_tr_b16 a[254:255], v12 offset:15616
 mf v[80:83], a[232:235], a[216:219], v[80:83]
 s_add_u32 s61, s87, s17
 mf v[84:87], a[232:235], a[220:223], v[84:87]
 s_add_u32 s61, s61, 0x3800
 buffer_load_dwordx4 a[196:199], v4, s[40:43], s61 offen offset:1024
 mf v[88:91], a[232:235], a[224:227], v[88:91]
 mf v[92:95], a[232:235], a[228:231], v[92:95]
 s_waitcnt lgkmcnt(8)
 mf v[96:99], a[236:239], a[216:219], v[96:99]
 mf v[100:103], a[236:239], a[220:223], v[100:103]
 s_waitcnt lgkmcnt(0)
 s_barrier
 mf v[104:107], a[236:239], a[224:227], v[104:107]
 ds_read_b64_tr_b16 a[232:233], v14
 ds_read_b64_tr_b16 a[234:235], v14 offset:5120
 mf v[108:111], a[236:239], a[228:231], v[108:111]
 ds_read_b64_tr_b16 a[236:237], v15
 ds_read_b64_tr_b16 a[238:239], v15 offset:5120
 mf v[112:115], a[240:243], a[216:219], v[112:115]
 mf v[116:119], a[240:243], a[220:223], v[116:119]
 mf v[120:123], a[240:243], a[224:227], v[120:123]
 mf v[124:127], a[240:243], a[228:231], v[124:127]
 ds_read_b64_tr_b16 a[240:241], v14 offset:64
 ds_read_b64_tr_b16 a[242:243], v14 offset:5184
 mf v[128:131], a[244:247], a[216:219], v[128:131]
 mf v[132:135], a[244:247], a[220:223], v[132:135]
 mf v[136:139], a[244:247], a[224:227], v[136:139]
 mf v[140:143], a[244:247], a[228:231], v[140:143]
 ds_read_b64_tr_b16 a[244:245], v15 offset:64
 ds_read_b64_tr_b16 a[246:247], v15 offset:5184
 mf v[144:147], a[248:251], a[216:219], v[144:147]
 mf v[148:151], a[248:251], a[220:223], v[148:151]
 mf v[152:155], a[248:251], a[224:227], v[152:155]
 mf v[156:159], a[248:251], a[228:231], v[156:159]
 ds_read_b64_tr_b16 a[248:249], v14 offset:128
 ds_read_b64_tr_b16 a[250:251], v14 offset:5248
 mf v[160:163], a[252:255], a[216:219], v[160:163]
 mf v[164:167], a[252:255], a[220:223], v[164:167]
 mf v[168:171], a[252:255], a[224:227], v[168:171]
 mf v[172:175], a[252:255], a[228:231], v[172:175]
 s_waitcnt vmcnt(17) lgkmcnt(8)
 ds_read_b64_tr_b16 a[252:253], v15 offset:128
 ds_read_b64_tr_b16 a[254:255], v15 offset:5248
 mf v[32:35], a[232:235], a[136:139], v[32:35]
 s_waitcnt vmcnt(15)
 mf v[36:39], a[232:235], a[140:143], v[36:39]
 s_waitcnt vmcnt(13)
 mf v[40:43], a[232:235], a[144:147], v[40:43]
 s_waitcnt vmcnt(12)
 mf v[44:47], a[232:235], a[148:151], v[44:47]
 s_waitcnt lgkmcnt(8)
 ds_read_b64_tr_b16 a[232:233], v14 offset:192
 ds_read_b64_tr_b16 a[234:235], v14 offset:5312
 mf v[48:51], a[236:239], a[136:139], v[48:51]
 mf v[52:55], a[236:239], a[140:143], v[52:55]
 mf v[56:59], a[236:239], a[144:147], v[56:59]
 mf v[60:63], a[236:239], a[148:151], v[60:63]
 s_waitcnt lgkmcnt(8)
 ds_read_b64_tr_b16 a[236:237], v15 offset:192
 ds_read_b64_tr_b16 a[238:239], v15 offset:5312
 mf v[64:67], a[240:243], a[136:139], v[64:67]
 mf v[68:71], a[240:243], a[140:143], v[68:71]
 mf v[72:75], a[240:243], a[144:147], v[72:75]
 mf v[76:79], a[240:243], a[148:151], v[76:79]
 s_waitcnt lgkmcnt(8)
 ds_read_b64_tr_b16 a[240:241], v14 offset:256
 ds_read_b64_tr_b16 a[242:243], v14 offset:5376
 mf v[80:83], a[244:247], a[136:139], v[80:83]
 mf v[84:87], a[244:247], a[140:143], v[84:87]
 mf v[88:91], a[244:247], a[144:147], v[88:91]
 mf v[92:95], a[244:247], a[148:151], v[92:95]
 s_waitcnt lgkmcnt(8)
 ds_read_b64_tr_b16 a[244:245], v14 offset:10240
 ds_read_b64_tr_b16 a[246:247], v14 offset:15360
 mf v[96:99], a[248:251], a[136:139], v[96:99]
 mf v[100:103], a[248:251], a[140:143], v[100:103]
 mf v[104:107], a[248:251], a[144:147], v[104:107]
 mf v[108:111], a[248:251], a[148:151], v[108:111]
 s_waitcnt lgkmcnt(8)
 ds_read_b64_tr_b16 a[248:249], v15 offset:10240
 ds_read_b64_tr_b16 a[250:251], v15 offset:15360
 mf v[112:115], a[252:255], a[136:139], v[112:115]
 mf v[116:119], a[252:255], a[140:143], v[116:119]
 mf v[120:123], a[252:255], a[144:147], v[120:123]
 mf v[124:127], a[252:255], a[148:151], v[124:127]
 s_waitcnt lgkmcnt(8)
 ds_read_b64_tr_b16 a[252:253], v14 offset:10304
 ds_read_b64_tr_b16 a[254:255], v14 offset:15424
 mf v[128:131], a[232:235], a[136:139], v[128:131]
 mf v[132:135], a[232:235], a[140:143], v[132:135]
 mf v[136:139], a[232:235], a[144:147], v[136:139]
 mf v[140:143], a[232:235], a[148:151], v[140:143]
 s_waitcnt lgkmcnt(8)
 ds_read_b64_tr_b16 a[232:233], v15 offset:10304
 ds_read_b64_tr_b16 a[234:235], v15 offset:15424
 mf v[144:147], a[236:239], a[136:139], v[144:147]
 mf v[148:151], a[236:239], a[140:143], v[148:151]
 mf v[152:155], a[236:239], a[144:147], v[152:155]
 mf v[156:159], a[236:239], a[148:151], v[156:159]
 s_waitcnt lgkmcnt(8)
 ds_read_b64_tr_b16 a[236:237], v14 offset:10368
 ds_read_b64_tr_b16 a[238:239], v14 offset:15488
 mf v[160:163], a[240:243], a[136:139], v[160:163]
 mf v[164:167], a[240:243], a[140:143], v[164:167]
 mf v[168:171], a[240:243], a[144:147], v[168:171]
 mf v[172:175], a[240:243], a[148:151], v[172:175]
 s_waitcnt vmcnt(11) lgkmcnt(8)
 ds_read_b64_tr_b16 a[240:241], v15 offset:10368
 ds_read_b64_tr_b16 a[242:243], v15 offset:15488
 mf v[32:35], a[244:247], a[152:155], v[32:35]
 s_waitcnt vmcnt(10)
 mf v[36:39], a[244:247], a[156:159], v[36:39]
 s_waitcnt vmcnt(9)
 mf v[40:43], a[244:247], a[160:163], v[40:43]
 s_waitcnt vmcnt(8)
 mf v[44:47], a[244:247], a[164:167], v[44:47]
 s_waitcnt lgkmcnt(8)
 ds_read_b64_tr_b16 a[244:245], v14 offset:10432
 ds_read_b64_tr_b16 a[246:247], v14 offset:15552
 mf v[48:51], a[248:251], a[152:155], v[48:51]
 mf v[52:55], a[248:251], a[156:159], v[52:55]
 mf v[56:59], a[248:251], a[160:163], v[56:59]
 mf v[60:63], a[248:251], a[164:167], v[60:63]
 s_waitcnt lgkmcnt(8)
 ds_read_b64_tr_b16 a[248:249], v15 offset:10432
 ds_read_b64_tr_b16 a[250:251], v15 offset:15552
 mf v[64:67], a[252:255], a[152:155], v[64:67]
 mf v[68:71], a[252:255], a[156:159], v[68:71]
 mf v[72:75], a[252:255], a[160:163], v[72:75]
 mf v[76:79], a[252:255], a[164:167], v[76:79]
 s_waitcnt lgkmcnt(8)
 ds_read_b64_tr_b16 a[252:253], v14 offset:10496
 ds_read_b64_tr_b16 a[254:255], v14 offset:15616
 mf v[80:83], a[232:235], a[152:155], v[80:83]
 mf v[84:87], a[232:235], a[156:159], v[84:87]
 mf v[88:91], a[232:235], a[160:163], v[88:91]
 mf v[92:95], a[232:235], a[164:167], v[92:95]
 s_waitcnt lgkmcnt(8)
 mf v[96:99], a[236:239], a[152:155], v[96:99]
 mf v[100:103], a[236:239], a[156:159], v[100:103]
 s_waitcnt lgkmcnt(0)
 s_barrier
 mf v[104:107], a[236:239], a[160:163], v[104:107]
 ds_read_b64_tr_b16 a[232:233], v8
 ds_read_b64_tr_b16 a[234:235], v8 offset:5120
 mf v[108:111], a[236:239], a[164:167], v[108:111]
 ds_read_b64_tr_b16 a[236:237], v9
 ds_read_b64_tr_b16 a[238:239], v9 offset:5120
 mf v[112:115], a[240:243], a[152:155], v[112:115]
 mf v[116:119], a[240:243], a[156:159], v[116:119]
 mf v[120:123], a[240:243], a[160:163], v[120:123]
 mf v[124:127], a[240:243], a[164:167], v[124:127]
 ds_read_b64_tr_b16 a[240:241], v8 offset:64
 ds_read_b64_tr_b16 a[242:243], v8 offset:5184
 mf v[128:131], a[244:247], a[152:155], v[128:131]
 mf v[132:135], a[244:247], a[156:159], v[132:135]
 mf v[136:139], a[244:247], a[160:163], v[136:139]
 mf v[140:143], a[244:247], a[164:167], v[140:143]
 ds_read_b64_tr_b16 a[244:245], v9 offset:64
 ds_read_b64_tr_b16 a[246:247], v9 offset:5184
 mf v[144:147], a[248:251], a[152:155], v[144:147]
 mf v[148:151], a[248:251], a[156:159], v[148:151]
 mf v[152:155], a[248:251], a[160:163], v[152:155]
 mf v[156:159], a[248:251], a[164:167], v[156:159]
 ds_read_b64_tr_b16 a[248:249], v8 offset:128
 ds_read_b64_tr_b16 a[250:251], v8 offset:5248
 mf v[160:163], a[252:255], a[152:155], v[160:163]
 mf v[164:167], a[252:255], a[156:159], v[164:167]
 mf v[168:171], a[252:255], a[160:163], v[168:171]
 mf v[172:175], a[252:255], a[164:167], v[172:175]
 s_waitcnt vmcnt(7) lgkmcnt(8)
 ds_read_b64_tr_b16 a[252:253], v9 offset:128
 ds_read_b64_tr_b16 a[254:255], v9 offset:5248
 mf v[32:35], a[232:235], a[168:171], v[32:35]
 s_waitcnt vmcnt(6)
 mf v[36:39], a[232:235], a[172:175], v[36:39]
 s_waitcnt vmcnt(5)
 mf v[40:43], a[232:235], a[176:179], v[40:43]
 s_waitcnt vmcnt(4)
 mf v[44:47], a[232:235], a[180:183], v[44:47]
 s_waitcnt lgkmcnt(8)
 ds_read_b64_tr_b16 a[232:233], v8 offset:192
 ds_read_b64_tr_b16 a[234:235], v8 offset:5312
 mf v[48:51], a[236:239], a[168:171], v[48:51]
 mf v[52:55], a[236:239], a[172:175], v[52:55]
 mf v[56:59], a[236:239], a[176:179], v[56:59]
 mf v[60:63], a[236:239], a[180:183], v[60:63]
 s_waitcnt lgkmcnt(8)
 ds_read_b64_tr_b16 a[236:237], v9 offset:192
 ds_read_b64_tr_b16 a[238:239], v9 offset:5312
 mf v[64:67], a[240:243], a[168:171], v[64:67]
 mf v[68:71], a[240:243], a[172:175], v[68:71]
 mf v[72:75], a[240:243], a[176:179], v[72:75]
 mf v[76:79], a[240:243], a[180:183], v[76:79]
 s_waitcnt lgkmcnt(8)
 ds_read_b64_tr_b16 a[240:241], v8 offset:256
 ds_read_b64_tr_b16 a[242:243], v8 offset:5376
 mf v[80:83], a[244:247], a[168:171], v[80:83]
 mf v[84:87], a[244:247], a[172:175], v[84:87]
 mf v[88:91], a[244:247], a[176:179], v[88:91]
 mf v[92:95], a[244:247], a[180:183], v[92:95]
 s_waitcnt lgkmcnt(8)
 ds_read_b64_tr_b16 a[244:245], v8 offset:10240
 ds_read_b64_tr_b16 a[246:247], v8 offset:15360
 mf v[96:99], a[248:251], a[168:171], v[96:99]
 mf v[100:103], a[248:251], a[172:175], v[100:103]
 mf v[104:107], a[248:251], a[176:179], v[104:107]
 mf v[108:111], a[248:251], a[180:183], v[108:111]
 s_waitcnt lgkmcnt(8)
 ds_read_b64_tr_b16 a[248:249], v9 offset:10240
 ds_read_b64_tr_b16 a[250:251], v9 offset:15360
 mf v[112:115], a[252:255], a[168:171], v[112:115]
 mf v[116:119], a[252:255], a[172:175], v[116:119]
 mf v[120:123], a[252:255], a[176:179], v[120:123]
 mf v[124:127], a[252:255], a[180:183], v[124:127]
 s_waitcnt lgkmcnt(8)
 ds_read_b64_tr_b16 a[252:253], v8 offset:10304
 ds_read_b64_tr_b16 a[254:255], v8 offset:15424
 mf v[128:131], a[232:235], a[168:171], v[128:131]
 mf v[132:135], a[232:235], a[172:175], v[132:135]
 mf v[136:139], a[232:235], a[176:179], v[136:139]
 mf v[140:143], a[232:235], a[180:183], v[140:143]
 s_waitcnt lgkmcnt(8)
 ds_read_b64_tr_b16 a[232:233], v9 offset:10304
 ds_read_b64_tr_b16 a[234:235], v9 offset:15424
 mf v[144:147], a[236:239], a[168:171], v[144:147]
 mf v[148:151], a[236:239], a[172:175], v[148:151]
 mf v[152:155], a[236:239], a[176:179], v[152:155]
 mf v[156:159], a[236:239], a[180:183], v[156:159]
 s_waitcnt lgkmcnt(8)
 ds_read_b64_tr_b16 a[236:237], v8 offset:10368
 ds_read_b64_tr_b16 a[238:239], v8 offset:15488
 mf v[160:163], a[240:243], a[168:171], v[160:163]
 mf v[164:167], a[240:243], a[172:175], v[164:167]
 mf v[168:171], a[240:243], a[176:179], v[168:171]
 mf v[172:175], a[240:243], a[180:183], v[172:175]
 s_waitcnt vmcnt(3) lgkmcnt(8)
 ds_read_b64_tr_b16 a[240:241], v9 offset:10368
 ds_read_b64_tr_b16 a[242:243], v9 offset:15488
 mf v[32:35], a[244:247], a[184:187], v[32:35]
 s_waitcnt vmcnt(2)
 mf v[36:39], a[244:247], a[188:191], v[36:39]
 s_waitcnt vmcnt(1)
 mf v[40:43], a[244:247], a[192:195], v[40:43]
 s_waitcnt vmcnt(0)
 mf v[44:47], a[244:247], a[196:199], v[44:47]
 s_waitcnt lgkmcnt(8)
 ds_read_b64_tr_b16 a[244:245], v8 offset:10432
 ds_read_b64_tr_b16 a[246:247], v8 offset:15552
 mf v[48:51], a[248:251], a[184:187], v[48:51]
 mf v[52:55], a[248:251], a[188:191], v[52:55]
 mf v[56:59], a[248:251], a[192:195], v[56:59]
 mf v[60:63], a[248:251], a[196:199], v[60:63]
 s_waitcnt lgkmcnt(8)
 ds_read_b64_tr_b16 a[248:249], v9 offset:10432
 ds_read_b64_tr_b16 a[250:251], v9 offset:15552
 mf v[64:67], a[252:255], a[184:187], v[64:67]
 mf v[68:71], a[252:255], a[188:191], v[68:71]
 mf v[72:75], a[252:255], a[192:195], v[72:75]
 mf v[76:79], a[252:255], a[196:199], v[76:79]
 s_waitcnt lgkmcnt(8)
 ds_read_b64_tr_b16 a[252:253], v8 offset:10496
 ds_read_b64_tr_b16 a[254:255], v8 offset:15616
 mf v[80:83], a[232:235], a[184:187], v[80:83]
 mf v[84:87], a[232:235], a[188:191], v[84:87]
 mf v[88:91], a[232:235], a[192:195], v[88:91]
 mf v[92:95], a[232:235], a[196:199], v[92:95]
 s_waitcnt lgkmcnt(8)
 mf v[96:99], a[236:239], a[184:187], v[96:99]
 mf v[100:103], a[236:239], a[188:191], v[100:103]
 mf v[104:107], a[236:239], a[192:195], v[104:107]
 mf v[108:111], a[236:239], a[196:199], v[108:111]
 s_waitcnt lgkmcnt(6)
 mf v[112:115], a[240:243], a[184:187], v[112:115]
 mf v[116:119], a[240:243], a[188:191], v[116:119]
 mf v[120:123], a[240:243], a[192:195], v[120:123]
 mf v[124:127], a[240:243], a[196:199], v[124:127]
 s_waitcnt lgkmcnt(4)
 mf v[128:131], a[244:247], a[184:187], v[128:131]
 mf v[132:135], a[244:247], a[188:191], v[132:135]
 mf v[136:139], a[244:247], a[192:195], v[136:139]
 mf v[140:143], a[244:247], a[196:199], v[140:143]
 s_waitcnt lgkmcnt(2)
 mf v[144:147], a[248:251], a[184:187], v[144:147]
 mf v[148:151], a[248:251], a[188:191], v[148:151]
 mf v[152:155], a[248:251], a[192:195], v[152:155]
 mf v[156:159], a[248:251], a[196:199], v[156:159]
 s_waitcnt lgkmcnt(0)
 mf v[160:163], a[252:255], a[184:187], v[160:163]
 mf v[164:167], a[252:255], a[188:191], v[164:167]
 mf v[168:171], a[252:255], a[192:195], v[168:171]
 mf v[172:175], a[252:255], a[196:199], v[172:175]
 s_add_u32 s44, s28, 0x5000000
 s_addc_u32 s45, s29, 0
 s_mov_b32 s46, 0x1200000
 s_mov_b32 s47, 0x20000
 v_cvt_pk_bf16_f32 v32, v32, v33
 v_cvt_pk_bf16_f32 v33, v34, v35
 v_cvt_pk_bf16_f32 v34, v36, v37
 v_cvt_pk_bf16_f32 v35, v38, v39
 s_add_u32 s62, s88, 0
 buffer_store_dwordx4 v[32:35], v4, s[44:47], s62 offen sc1
 v_cvt_pk_bf16_f32 v48, v48, v49
 v_cvt_pk_bf16_f32 v49, v50, v51
 v_cvt_pk_bf16_f32 v50, v52, v53
 v_cvt_pk_bf16_f32 v51, v54, v55
 s_add_u32 s62, s88, 0
 buffer_store_dwordx4 v[48:51], v4, s[44:47], s62 offen offset:1024 sc1
 v_cvt_pk_bf16_f32 v64, v64, v65
 v_cvt_pk_bf16_f32 v65, v66, v67
 v_cvt_pk_bf16_f32 v66, v68, v69
 v_cvt_pk_bf16_f32 v67, v70, v71
 s_add_u32 s62, s88, 0
 buffer_store_dwordx4 v[64:67], v4, s[44:47], s62 offen offset:2048 sc1
 v_cvt_pk_bf16_f32 v80, v80, v81
 v_cvt_pk_bf16_f32 v81, v82, v83
 v_cvt_pk_bf16_f32 v82, v84, v85
 v_cvt_pk_bf16_f32 v83, v86, v87
 s_add_u32 s62, s88, 0
 buffer_store_dwordx4 v[80:83], v4, s[44:47], s62 offen offset:3072 sc1
 v_cvt_pk_bf16_f32 v96, v96, v97
 v_cvt_pk_bf16_f32 v97, v98, v99
 v_cvt_pk_bf16_f32 v98, v100, v101
 v_cvt_pk_bf16_f32 v99, v102, v103
 s_add_u32 s62, s88, 0x1000
 buffer_store_dwordx4 v[96:99], v4, s[44:47], s62 offen sc1
 v_cvt_pk_bf16_f32 v112, v112, v113
 v_cvt_pk_bf16_f32 v113, v114, v115
 v_cvt_pk_bf16_f32 v114, v116, v117
 v_cvt_pk_bf16_f32 v115, v118, v119
 s_add_u32 s62, s88, 0x1000
 buffer_store_dwordx4 v[112:115], v4, s[44:47], s62 offen offset:1024 sc1
 v_cvt_pk_bf16_f32 v128, v128, v129
 v_cvt_pk_bf16_f32 v129, v130, v131
 v_cvt_pk_bf16_f32 v130, v132, v133
 v_cvt_pk_bf16_f32 v131, v134, v135
 s_add_u32 s62, s88, 0x1000
 buffer_store_dwordx4 v[128:131], v4, s[44:47], s62 offen offset:2048 sc1
 v_cvt_pk_bf16_f32 v144, v144, v145
 v_cvt_pk_bf16_f32 v145, v146, v147
 v_cvt_pk_bf16_f32 v146, v148, v149
 v_cvt_pk_bf16_f32 v147, v150, v151
 s_add_u32 s62, s88, 0x1000
 buffer_store_dwordx4 v[144:147], v4, s[44:47], s62 offen offset:3072 sc1
 v_cvt_pk_bf16_f32 v160, v160, v161
 v_cvt_pk_bf16_f32 v161, v162, v163
 v_cvt_pk_bf16_f32 v162, v164, v165
 v_cvt_pk_bf16_f32 v163, v166, v167
 s_add_u32 s62, s88, 0x2000
 buffer_store_dwordx4 v[160:163], v4, s[44:47], s62 offen sc1
 v_cvt_pk_bf16_f32 v40, v40, v41
 v_cvt_pk_bf16_f32 v41, v42, v43
 v_cvt_pk_bf16_f32 v42, v44, v45
 v_cvt_pk_bf16_f32 v43, v46, v47
 s_add_u32 s62, s89, 0
 buffer_store_dwordx4 v[40:43], v4, s[44:47], s62 offen sc1
 v_cvt_pk_bf16_f32 v56, v56, v57
 v_cvt_pk_bf16_f32 v57, v58, v59
 v_cvt_pk_bf16_f32 v58, v60, v61
 v_cvt_pk_bf16_f32 v59, v62, v63
 s_add_u32 s62, s89, 0
 buffer_store_dwordx4 v[56:59], v4, s[44:47], s62 offen offset:1024 sc1
 v_cvt_pk_bf16_f32 v72, v72, v73
 v_cvt_pk_bf16_f32 v73, v74, v75
 v_cvt_pk_bf16_f32 v74, v76, v77
 v_cvt_pk_bf16_f32 v75, v78, v79
 s_add_u32 s62, s89, 0
 buffer_store_dwordx4 v[72:75], v4, s[44:47], s62 offen offset:2048 sc1
 v_cvt_pk_bf16_f32 v88, v88, v89
 v_cvt_pk_bf16_f32 v89, v90, v91
 v_cvt_pk_bf16_f32 v90, v92, v93
 v_cvt_pk_bf16_f32 v91, v94, v95
 s_add_u32 s62, s89, 0
 buffer_store_dwordx4 v[88:91], v4, s[44:47], s62 offen offset:3072 sc1
 v_cvt_pk_bf16_f32 v104, v104, v105
 v_cvt_pk_bf16_f32 v105, v106, v107
 v_cvt_pk_bf16_f32 v106, v108, v109
 v_cvt_pk_bf16_f32 v107, v110, v111
 s_add_u32 s62, s89, 0x1000
 buffer_store_dwordx4 v[104:107], v4, s[44:47], s62 offen sc1
 v_cvt_pk_bf16_f32 v120, v120, v121
 v_cvt_pk_bf16_f32 v121, v122, v123
 v_cvt_pk_bf16_f32 v122, v124, v125
 v_cvt_pk_bf16_f32 v123, v126, v127
 s_add_u32 s62, s89, 0x1000
 buffer_store_dwordx4 v[120:123], v4, s[44:47], s62 offen offset:1024 sc1
 v_cvt_pk_bf16_f32 v136, v136, v137
 v_cvt_pk_bf16_f32 v137, v138, v139
 v_cvt_pk_bf16_f32 v138, v140, v141
 v_cvt_pk_bf16_f32 v139, v142, v143
 s_add_u32 s62, s89, 0x1000
 buffer_store_dwordx4 v[136:139], v4, s[44:47], s62 offen offset:2048 sc1
 v_cvt_pk_bf16_f32 v152, v152, v153
 v_cvt_pk_bf16_f32 v153, v154, v155
 v_cvt_pk_bf16_f32 v154, v156, v157
 v_cvt_pk_bf16_f32 v155, v158, v159
 s_add_u32 s62, s89, 0x1000
 buffer_store_dwordx4 v[152:155], v4, s[44:47], s62 offen offset:3072 sc1
 v_cvt_pk_bf16_f32 v168, v168, v169
 v_cvt_pk_bf16_f32 v169, v170, v171
 v_cvt_pk_bf16_f32 v170, v172, v173
 v_cvt_pk_bf16_f32 v171, v174, v175
 s_add_u32 s62, s89, 0x2000
 buffer_store_dwordx4 v[168:171], v4, s[44:47], s62 offen sc1
 s_mov_b32 s32, s4
 s_mov_b32 s33, s5
 s_mov_b32 s34, 0x240000
 s_mov_b32 s35, 0x20000
 s_mov_b32 s36, s24
 s_mov_b32 s37, s25
 s_mov_b32 s38, 0x240000
 s_mov_b32 s39, 0x20000
 s_sub_u32 s30, 15, s66
 s_cmp_lt_u32 s64, 4
 s_cselect_b32 s30, s30, s66
 s_lshl_b32 s30, s30, 2
 s_and_b32 s31, s64, 3
 s_add_u32 s72, s30, s31
 s_mul_i32 s71, s72, 36
 s_and_b32 s31, s64, 3
 s_lshl_b32 s30, s72, 1
 s_sub_u32 s30, s30, s31
 s_lshl_b32 s30, s30, 4
 s_lshl_b32 s31, s31, 1
 s_sub_u32 s31, 7, s31
 s_mul_i32 s73, s31, 0x4800
 v_add_u32 v17, s30, v3
 s_movk_i32 s31, 0x480
 v_mul_lo_u32 v17, v17, s31
 v_lshl_add_u32 v17, v2, 3, v17
 s_mul_i32 s30, s65, 9
 s_add_u32 s30, s30, s3
 s_add_u32 s71, s71, s30
 s_lshl_b32 s71, s71, 10
 s_lshl_b32 s30, s30, 5
 v_add_u32 v17, s30, v17
 v_add_u32 v8, 0, v17
 v_add_u32 v14, 0, v4
 v_add_u32 v10, 0x80, v17
 v_add_u32 v15, 0x1000, v4
 v_add_u32 v12, 0x100, v17
 v_add_u32 v16, 0x2000, v4
 s_cmp_eq_u32 s3, 0
 s_cselect_b32 s30, 0, 0x7ff00000
 v_add_u32 v12, s30, v12
 v_add_u32 v16, s30, v16
 v_add_u32 v9, s73, v8
 v_add_u32 v11, s73, v10
 v_add_u32 v13, s73, v12
 buffer_load_dwordx2 v[176:177], v8, s[32:35], 0 offen
 buffer_load_dwordx2 v[178:179], v9, s[32:35], 0 offen
 buffer_load_dwordx2 v[180:181], v10, s[32:35], 0 offen
 buffer_load_dwordx2 v[182:183], v11, s[32:35], 0 offen
 buffer_load_dwordx2 v[184:185], v12, s[32:35], 0 offen
 buffer_load_dwordx2 v[186:187], v13, s[32:35], 0 offen
 s_lshl_b32 s62, s66, 2
 s_add_u32 s62, s62, s65
 s_lshl_b32 s62, s62, 3
 s_add_u32 s62, s62, s64
 s_lshl_b32 s62, s62, 7
 s_add_u32 s62, s62, 0x20000
 s_waitcnt vmcnt(6)
 s_barrier
 buffer_store_dword v6, v5, s[52:55], s62 offen sc1
 v_and_b32 v19, 7, v1
 v_lshlrev_b32 v19, 7, v19
 s_lshl_b32 s63, s66, 2
 s_add_u32 s63, s63, s65
 s_lshl_b32 s63, s63, 10
 s_add_u32 s63, s63, 0x20000
 buffer_load_dword v27, v19, s[52:55], s63 offen sc1
 s_waitcnt vmcnt(0)
 v_cmp_eq_u32 vcc, v6, v27
 s_nop 3
 s_cmp_eq_u64 vcc, -1
 s_cbranch_scc0 f_p_spin
f_p_ok:
 s_add_u32 s61, s71, 0
 buffer_load_dwordx4 v[32:35], v14, s[44:47], s61 offen
 s_add_u32 s61, s71, 0x240000
 buffer_load_dwordx4 v[36:39], v14, s[44:47], s61 offen
 s_add_u32 s61, s71, 0x480000
 buffer_load_dwordx4 v[40:43], v14, s[44:47], s61 offen
 s_add_u32 s61, s71, 0x6c0000
 buffer_load_dwordx4 v[44:47], v14, s[44:47], s61 offen
 s_add_u32 s61, s71, 0x900000
 buffer_load_dwordx4 v[48:51], v14, s[44:47], s61 offen
 s_add_u32 s61, s71, 0xb40000
 buffer_load_dwordx4 v[52:55], v14, s[44:47], s61 offen
 s_add_u32 s61, s71, 0xd80000
 buffer_load_dwordx4 v[56:59], v14, s[44:47], s61 offen
 s_add_u32 s61, s71, 0xfc0000
 buffer_load_dwordx4 v[60:63], v14, s[44:47], s61 offen
 s_add_u32 s61, s71, 0
 buffer_load_dwordx4 v[64:67], v15, s[44:47], s61 offen
 s_add_u32 s61, s71, 0x240000
 buffer_load_dwordx4 v[68:71], v15, s[44:47], s61 offen
 s_add_u32 s61, s71, 0x480000
 buffer_load_dwordx4 v[72:75], v15, s[44:47], s61 offen
 s_add_u32 s61, s71, 0x6c0000
 buffer_load_dwordx4 v[76:79], v15, s[44:47], s61 offen
 s_add_u32 s61, s71, 0x900000
 buffer_load_dwordx4 v[80:83], v15, s[44:47], s61 offen
 s_add_u32 s61, s71, 0xb40000
 buffer_load_dwordx4 v[84:87], v15, s[44:47], s61 offen
 s_add_u32 s61, s71, 0xd80000
 buffer_load_dwordx4 v[88:91], v15, s[44:47], s61 offen
 s_add_u32 s61, s71, 0xfc0000
 buffer_load_dwordx4 v[92:95], v15, s[44:47], s61 offen
 s_add_u32 s61, s71, 0
 buffer_load_dwordx4 v[96:99], v16, s[44:47], s61 offen
 s_add_u32 s61, s71, 0x240000
 buffer_load_dwordx4 v[100:103], v16, s[44:47], s61 offen
 s_add_u32 s61, s71, 0x480000
 buffer_load_dwordx4 v[104:107], v16, s[44:47], s61 offen
 s_add_u32 s61, s71, 0x6c0000
 buffer_load_dwordx4 v[108:111], v16, s[44:47], s61 offen
 s_add_u32 s61, s71, 0x900000
 buffer_load_dwordx4 v[112:115], v16, s[44:47], s61 offen
 s_add_u32 s61, s71, 0xb40000
 buffer_load_dwordx4 v[116:119], v16, s[44:47], s61 offen
 s_add_u32 s61, s71, 0xd80000
 buffer_load_dwordx4 v[120:123], v16, s[44:47], s61 offen
 s_add_u32 s61, s71, 0xfc0000
 buffer_load_dwordx4 v[124:127], v16, s[44:47], s61 offen
 s_waitcnt vmcnt(23)
 v_lshlrev_b32 v136, 16, v32
 v_and_b32 v137, 0xffff0000, v32
 v_lshlrev_b32 v138, 16, v33
 v_and_b32 v139, 0xffff0000, v33
 v_lshlrev_b32 v140, 16, v34
 v_and_b32 v141, 0xffff0000, v34
 v_lshlrev_b32 v142, 16, v35
 v_and_b32 v143, 0xffff0000, v35
 s_waitcnt vmcnt(22)
 v_lshlrev_b32 v160, 16, v36
 v_and_b32 v161, 0xffff0000, v36
 v_pk_add_f32 v[136:137], v[136:137], v[160:161]
 v_lshlrev_b32 v162, 16, v37
 v_and_b32 v163, 0xffff0000, v37
 v_pk_add_f32 v[138:139], v[138:139], v[162:163]
 v_lshlrev_b32 v160, 16, v38
 v_and_b32 v161, 0xffff0000, v38
 v_pk_add_f32 v[140:141], v[140:141], v[160:161]
 v_lshlrev_b32 v162, 16, v39
 v_and_b32 v163, 0xffff0000, v39
 v_pk_add_f32 v[142:143], v[142:143], v[162:163]
 s_waitcnt vmcnt(21)
 v_lshlrev_b32 v160, 16, v40
 v_and_b32 v161, 0xffff0000, v40
 v_pk_add_f32 v[136:137], v[136:137], v[160:161]
 v_lshlrev_b32 v162, 16, v41
 v_and_b32 v163, 0xffff0000, v41
 v_pk_add_f32 v[138:139], v[138:139], v[162:163]
 v_lshlrev_b32 v160, 16, v42
 v_and_b32 v161, 0xffff0000, v42
 v_pk_add_f32 v[140:141], v[140:141], v[160:161]
 v_lshlrev_b32 v162, 16, v43
 v_and_b32 v163, 0xffff0000, v43
 v_pk_add_f32 v[142:143], v[142:143], v[162:163]
 s_waitcnt vmcnt(20)
 v_lshlrev_b32 v160, 16, v44
 v_and_b32 v161, 0xffff0000, v44
 v_pk_add_f32 v[136:137], v[136:137], v[160:161]
 v_lshlrev_b32 v162, 16, v45
 v_and_b32 v163, 0xffff0000, v45
 v_pk_add_f32 v[138:139], v[138:139], v[162:163]
 v_lshlrev_b32 v160, 16, v46
 v_and_b32 v161, 0xffff0000, v46
 v_pk_add_f32 v[140:141], v[140:141], v[160:161]
 v_lshlrev_b32 v162, 16, v47
 v_and_b32 v163, 0xffff0000, v47
 v_pk_add_f32 v[142:143], v[142:143], v[162:163]
 s_waitcnt vmcnt(19)
 v_lshlrev_b32 v160, 16, v48
 v_and_b32 v161, 0xffff0000, v48
 v_pk_add_f32 v[136:137], v[136:137], v[160:161]
 v_lshlrev_b32 v162, 16, v49
 v_and_b32 v163, 0xffff0000, v49
 v_pk_add_f32 v[138:139], v[138:139], v[162:163]
 v_lshlrev_b32 v160, 16, v50
 v_and_b32 v161, 0xffff0000, v50
 v_pk_add_f32 v[140:141], v[140:141], v[160:161]
 v_lshlrev_b32 v162, 16, v51
 v_and_b32 v163, 0xffff0000, v51
 v_pk_add_f32 v[142:143], v[142:143], v[162:163]
 s_waitcnt vmcnt(18)
 v_lshlrev_b32 v160, 16, v52
 v_and_b32 v161, 0xffff0000, v52
 v_pk_add_f32 v[136:137], v[136:137], v[160:161]
 v_lshlrev_b32 v162, 16, v53
 v_and_b32 v163, 0xffff0000, v53
 v_pk_add_f32 v[138:139], v[138:139], v[162:163]
 v_lshlrev_b32 v160, 16, v54
 v_and_b32 v161, 0xffff0000, v54
 v_pk_add_f32 v[140:141], v[140:141], v[160:161]
 v_lshlrev_b32 v162, 16, v55
 v_and_b32 v163, 0xffff0000, v55
 v_pk_add_f32 v[142:143], v[142:143], v[162:163]
 s_waitcnt vmcnt(17)
 v_lshlrev_b32 v160, 16, v56
 v_and_b32 v161, 0xffff0000, v56
 v_pk_add_f32 v[136:137], v[136:137], v[160:161]
 v_lshlrev_b32 v162, 16, v57
 v_and_b32 v163, 0xffff0000, v57
 v_pk_add_f32 v[138:139], v[138:139], v[162:163]
 v_lshlrev_b32 v160, 16, v58
 v_and_b32 v161, 0xffff0000, v58
 v_pk_add_f32 v[140:141], v[140:141], v[160:161]
 v_lshlrev_b32 v162, 16, v59
 v_and_b32 v163, 0xffff0000, v59
 v_pk_add_f32 v[142:143], v[142:143], v[162:163]
 s_waitcnt vmcnt(16)
 v_lshlrev_b32 v160, 16, v60
 v_and_b32 v161, 0xffff0000, v60
 v_pk_add_f32 v[136:137], v[136:137], v[160:161]
 v_lshlrev_b32 v162, 16, v61
 v_and_b32 v163, 0xffff0000, v61
 v_pk_add_f32 v[138:139], v[138:139], v[162:163]
 v_lshlrev_b32 v160, 16, v62
 v_and_b32 v161, 0xffff0000, v62
 v_pk_add_f32 v[140:141], v[140:141], v[160:161]
 v_lshlrev_b32 v162, 16, v63
 v_and_b32 v163, 0xffff0000, v63
 v_pk_add_f32 v[142:143], v[142:143], v[162:163]
 v_lshlrev_b32 v160, 16, v176
 v_and_b32 v161, 0xffff0000, v176
 v_pk_add_f32 v[136:137], v[136:137], v[160:161]
 v_lshlrev_b32 v162, 16, v177
 v_and_b32 v163, 0xffff0000, v177
 v_pk_add_f32 v[138:139], v[138:139], v[162:163]
 v_lshlrev_b32 v160, 16, v178
 v_and_b32 v161, 0xffff0000, v178
 v_pk_add_f32 v[140:141], v[140:141], v[160:161]
 v_lshlrev_b32 v162, 16, v179
 v_and_b32 v163, 0xffff0000, v179
 v_pk_add_f32 v[142:143], v[142:143], v[162:163]
 v_cvt_pk_bf16_f32 v176, v136, v137
 v_cvt_pk_bf16_f32 v177, v138, v139
 v_cvt_pk_bf16_f32 v178, v140, v141
 v_cvt_pk_bf16_f32 v179, v142, v143
 buffer_store_dwordx2 v[176:177], v8, s[36:39], 0 offen
 buffer_store_dwordx2 v[178:179], v9, s[36:39], 0 offen
 s_waitcnt vmcnt(17)
 v_lshlrev_b32 v144, 16, v64
 v_and_b32 v145, 0xffff0000, v64
 v_lshlrev_b32 v146, 16, v65
 v_and_b32 v147, 0xffff0000, v65
 v_lshlrev_b32 v148, 16, v66
 v_and_b32 v149, 0xffff0000, v66
 v_lshlrev_b32 v150, 16, v67
 v_and_b32 v151, 0xffff0000, v67
 s_waitcnt vmcnt(16)
 v_lshlrev_b32 v160, 16, v68
 v_and_b32 v161, 0xffff0000, v68
 v_pk_add_f32 v[144:145], v[144:145], v[160:161]
 v_lshlrev_b32 v162, 16, v69
 v_and_b32 v163, 0xffff0000, v69
 v_pk_add_f32 v[146:147], v[146:147], v[162:163]
 v_lshlrev_b32 v160, 16, v70
 v_and_b32 v161, 0xffff0000, v70
 v_pk_add_f32 v[148:149], v[148:149], v[160:161]
 v_lshlrev_b32 v162, 16, v71
 v_and_b32 v163, 0xffff0000, v71
 v_pk_add_f32 v[150:151], v[150:151], v[162:163]
 s_waitcnt vmcnt(15)
 v_lshlrev_b32 v160, 16, v72
 v_and_b32 v161, 0xffff0000, v72
 v_pk_add_f32 v[144:145], v[144:145], v[160:161]
 v_lshlrev_b32 v162, 16, v73
 v_and_b32 v163, 0xffff0000, v73
 v_pk_add_f32 v[146:147], v[146:147], v[162:163]
 v_lshlrev_b32 v160, 16, v74
 v_and_b32 v161, 0xffff0000, v74
 v_pk_add_f32 v[148:149], v[148:149], v[160:161]
 v_lshlrev_b32 v162, 16, v75
 v_and_b32 v163, 0xffff0000, v75
 v_pk_add_f32 v[150:151], v[150:151], v[162:163]
 s_waitcnt vmcnt(14)
 v_lshlrev_b32 v160, 16, v76
 v_and_b32 v161, 0xffff0000, v76
 v_pk_add_f32 v[144:145], v[144:145], v[160:161]
 v_lshlrev_b32 v162, 16, v77
 v_and_b32 v163, 0xffff0000, v77
 v_pk_add_f32 v[146:147], v[146:147], v[162:163]
 v_lshlrev_b32 v160, 16, v78
 v_and_b32 v161, 0xffff0000, v78
 v_pk_add_f32 v[148:149], v[148:149], v[160:161]
 v_lshlrev_b32 v162, 16, v79
 v_and_b32 v163, 0xffff0000, v79
 v_pk_add_f32 v[150:151], v[150:151], v[162:163]
 s_waitcnt vmcnt(13)
 v_lshlrev_b32 v160, 16, v80
 v_and_b32 v161, 0xffff0000, v80
 v_pk_add_f32 v[144:145], v[144:145], v[160:161]
 v_lshlrev_b32 v162, 16, v81
 v_and_b32 v163, 0xffff0000, v81
 v_pk_add_f32 v[146:147], v[146:147], v[162:163]
 v_lshlrev_b32 v160, 16, v82
 v_and_b32 v161, 0xffff0000, v82
 v_pk_add_f32 v[148:149], v[148:149], v[160:161]
 v_lshlrev_b32 v162, 16, v83
 v_and_b32 v163, 0xffff0000, v83
 v_pk_add_f32 v[150:151], v[150:151], v[162:163]
 s_waitcnt vmcnt(12)
 v_lshlrev_b32 v160, 16, v84
 v_and_b32 v161, 0xffff0000, v84
 v_pk_add_f32 v[144:145], v[144:145], v[160:161]
 v_lshlrev_b32 v162, 16, v85
 v_and_b32 v163, 0xffff0000, v85
 v_pk_add_f32 v[146:147], v[146:147], v[162:163]
 v_lshlrev_b32 v160, 16, v86
 v_and_b32 v161, 0xffff0000, v86
 v_pk_add_f32 v[148:149], v[148:149], v[160:161]
 v_lshlrev_b32 v162, 16, v87
 v_and_b32 v163, 0xffff0000, v87
 v_pk_add_f32 v[150:151], v[150:151], v[162:163]
 s_waitcnt vmcnt(11)
 v_lshlrev_b32 v160, 16, v88
 v_and_b32 v161, 0xffff0000, v88
 v_pk_add_f32 v[144:145], v[144:145], v[160:161]
 v_lshlrev_b32 v162, 16, v89
 v_and_b32 v163, 0xffff0000, v89
 v_pk_add_f32 v[146:147], v[146:147], v[162:163]
 v_lshlrev_b32 v160, 16, v90
 v_and_b32 v161, 0xffff0000, v90
 v_pk_add_f32 v[148:149], v[148:149], v[160:161]
 v_lshlrev_b32 v162, 16, v91
 v_and_b32 v163, 0xffff0000, v91
 v_pk_add_f32 v[150:151], v[150:151], v[162:163]
 s_waitcnt vmcnt(10)
 v_lshlrev_b32 v160, 16, v92
 v_and_b32 v161, 0xffff0000, v92
 v_pk_add_f32 v[144:145], v[144:145], v[160:161]
 v_lshlrev_b32 v162, 16, v93
 v_and_b32 v163, 0xffff0000, v93
 v_pk_add_f32 v[146:147], v[146:147], v[162:163]
 v_lshlrev_b32 v160, 16, v94
 v_and_b32 v161, 0xffff0000, v94
 v_pk_add_f32 v[148:149], v[148:149], v[160:161]
 v_lshlrev_b32 v162, 16, v95
 v_and_b32 v163, 0xffff0000, v95
 v_pk_add_f32 v[150:151], v[150:151], v[162:163]
 v_lshlrev_b32 v160, 16, v180
 v_and_b32 v161, 0xffff0000, v180
 v_pk_add_f32 v[144:145], v[144:145], v[160:161]
 v_lshlrev_b32 v162, 16, v181
 v_and_b32 v163, 0xffff0000, v181
 v_pk_add_f32 v[146:147], v[146:147], v[162:163]
 v_lshlrev_b32 v160, 16, v182
 v_and_b32 v161, 0xffff0000, v182
 v_pk_add_f32 v[148:149], v[148:149], v[160:161]
 v_lshlrev_b32 v162, 16, v183
 v_and_b32 v163, 0xffff0000, v183
 v_pk_add_f32 v[150:151], v[150:151], v[162:163]
 v_cvt_pk_bf16_f32 v180, v144, v145
 v_cvt_pk_bf16_f32 v181, v146, v147
 v_cvt_pk_bf16_f32 v182, v148, v149
 v_cvt_pk_bf16_f32 v183, v150, v151
 buffer_store_dwordx2 v[180:181], v10, s[36:39], 0 offen
 buffer_store_dwordx2 v[182:183], v11, s[36:39], 0 offen
 s_waitcnt vmcnt(11)
 v_lshlrev_b32 v152, 16, v96
 v_and_b32 v153, 0xffff0000, v96
 v_lshlrev_b32 v154, 16, v97
 v_and_b32 v155, 0xffff0000, v97
 v_lshlrev_b32 v156, 16, v98
 v_and_b32 v157, 0xffff0000, v98
 v_lshlrev_b32 v158, 16, v99
 v_and_b32 v159, 0xffff0000, v99
 s_waitcnt vmcnt(10)
 v_lshlrev_b32 v160, 16, v100
 v_and_b32 v161, 0xffff0000, v100
 v_pk_add_f32 v[152:153], v[152:153], v[160:161]
 v_lshlrev_b32 v162, 16, v101
 v_and_b32 v163, 0xffff0000, v101
 v_pk_add_f32 v[154:155], v[154:155], v[162:163]
 v_lshlrev_b32 v160, 16, v102
 v_and_b32 v161, 0xffff0000, v102
 v_pk_add_f32 v[156:157], v[156:157], v[160:161]
 v_lshlrev_b32 v162, 16, v103
 v_and_b32 v163, 0xffff0000, v103
 v_pk_add_f32 v[158:159], v[158:159], v[162:163]
 s_waitcnt vmcnt(9)
 v_lshlrev_b32 v160, 16, v104
 v_and_b32 v161, 0xffff0000, v104
 v_pk_add_f32 v[152:153], v[152:153], v[160:161]
 v_lshlrev_b32 v162, 16, v105
 v_and_b32 v163, 0xffff0000, v105
 v_pk_add_f32 v[154:155], v[154:155], v[162:163]
 v_lshlrev_b32 v160, 16, v106
 v_and_b32 v161, 0xffff0000, v106
 v_pk_add_f32 v[156:157], v[156:157], v[160:161]
 v_lshlrev_b32 v162, 16, v107
 v_and_b32 v163, 0xffff0000, v107
 v_pk_add_f32 v[158:159], v[158:159], v[162:163]
 s_waitcnt vmcnt(8)
 v_lshlrev_b32 v160, 16, v108
 v_and_b32 v161, 0xffff0000, v108
 v_pk_add_f32 v[152:153], v[152:153], v[160:161]
 v_lshlrev_b32 v162, 16, v109
 v_and_b32 v163, 0xffff0000, v109
 v_pk_add_f32 v[154:155], v[154:155], v[162:163]
 v_lshlrev_b32 v160, 16, v110
 v_and_b32 v161, 0xffff0000, v110
 v_pk_add_f32 v[156:157], v[156:157], v[160:161]
 v_lshlrev_b32 v162, 16, v111
 v_and_b32 v163, 0xffff0000, v111
 v_pk_add_f32 v[158:159], v[158:159], v[162:163]
 s_waitcnt vmcnt(7)
 v_lshlrev_b32 v160, 16, v112
 v_and_b32 v161, 0xffff0000, v112
 v_pk_add_f32 v[152:153], v[152:153], v[160:161]
 v_lshlrev_b32 v162, 16, v113
 v_and_b32 v163, 0xffff0000, v113
 v_pk_add_f32 v[154:155], v[154:155], v[162:163]
 v_lshlrev_b32 v160, 16, v114
 v_and_b32 v161, 0xffff0000, v114
 v_pk_add_f32 v[156:157], v[156:157], v[160:161]
 v_lshlrev_b32 v162, 16, v115
 v_and_b32 v163, 0xffff0000, v115
 v_pk_add_f32 v[158:159], v[158:159], v[162:163]
 s_waitcnt vmcnt(6)
 v_lshlrev_b32 v160, 16, v116
 v_and_b32 v161, 0xffff0000, v116
 v_pk_add_f32 v[152:153], v[152:153], v[160:161]
 v_lshlrev_b32 v162, 16, v117
 v_and_b32 v163, 0xffff0000, v117
 v_pk_add_f32 v[154:155], v[154:155], v[162:163]
 v_lshlrev_b32 v160, 16, v118
 v_and_b32 v161, 0xffff0000, v118
 v_pk_add_f32 v[156:157], v[156:157], v[160:161]
 v_lshlrev_b32 v162, 16, v119
 v_and_b32 v163, 0xffff0000, v119
 v_pk_add_f32 v[158:159], v[158:159], v[162:163]
 s_waitcnt vmcnt(5)
 v_lshlrev_b32 v160, 16, v120
 v_and_b32 v161, 0xffff0000, v120
 v_pk_add_f32 v[152:153], v[152:153], v[160:161]
 v_lshlrev_b32 v162, 16, v121
 v_and_b32 v163, 0xffff0000, v121
 v_pk_add_f32 v[154:155], v[154:155], v[162:163]
 v_lshlrev_b32 v160, 16, v122
 v_and_b32 v161, 0xffff0000, v122
 v_pk_add_f32 v[156:157], v[156:157], v[160:161]
 v_lshlrev_b32 v162, 16, v123
 v_and_b32 v163, 0xffff0000, v123
 v_pk_add_f32 v[158:159], v[158:159], v[162:163]
 s_waitcnt vmcnt(4)
 v_lshlrev_b32 v160, 16, v124
 v_and_b32 v161, 0xffff0000, v124
 v_pk_add_f32 v[152:153], v[152:153], v[160:161]
 v_lshlrev_b32 v162, 16, v125
 v_and_b32 v163, 0xffff0000, v125
 v_pk_add_f32 v[154:155], v[154:155], v[162:163]
 v_lshlrev_b32 v160, 16, v126
 v_and_b32 v161, 0xffff0000, v126
 v_pk_add_f32 v[156:157], v[156:157], v[160:161]
 v_lshlrev_b32 v162, 16, v127
 v_and_b32 v163, 0xffff0000, v127
 v_pk_add_f32 v[158:159], v[158:159], v[162:163]
 v_lshlrev_b32 v160, 16, v184
 v_and_b32 v161, 0xffff0000, v184
 v_pk_add_f32 v[152:153], v[152:153], v[160:161]
 v_lshlrev_b32 v162, 16, v185
 v_and_b32 v163, 0xffff0000, v185
 v_pk_add_f32 v[154:155], v[154:155], v[162:163]
 v_lshlrev_b32 v160, 16, v186
 v_and_b32 v161, 0xffff0000, v186
 v_pk_add_f32 v[156:157], v[156:157], v[160:161]
 v_lshlrev_b32 v162, 16, v187
 v_and_b32 v163, 0xffff0000, v187
 v_pk_add_f32 v[158:159], v[158:159], v[162:163]
 v_cvt_pk_bf16_f32 v184, v152, v153
 v_cvt_pk_bf16_f32 v185, v154, v155
 v_cvt_pk_bf16_f32 v186, v156, v157
 v_cvt_pk_bf16_f32 v187, v158, v159
 buffer_store_dwordx2 v[184:185], v12, s[36:39], 0 offen
 buffer_store_dwordx2 v[186:187], v13, s[36:39], 0 offen
 s_cmp_eq_u32 s2, 0
 s_cselect_b32 s30, 0, 0x7ff00000
 v_add_u32 v17, s30, v5
 s_mov_b32 s31, 0x100000
 buffer_store_dword v6, v17, s[52:55], s31 offen sc1
 s_endpgm
f_ln0_spin:
 s_mov_b32 s95, 0
f_ln0_again:
 s_sleep 2
 v_and_b32 v8, 15, v1
 v_lshlrev_b32 v8, 7, v8
 v_bfe_u32 v9, v1, 4, 1
 s_sub_u32 s30, 15, s66
 s_sub_u32 s31, s66, s30
 s_lshl_b32 s31, s31, 11
 s_lshl_b32 s30, s30, 11
 v_mul_lo_u32 v9, v9, s31
 v_add_u32 v8, v8, v9
 v_add_u32 v8, s30, v8
 buffer_load_dword v10, v8, s[52:55], 0 offen sc1
 s_waitcnt vmcnt(0)
 v_cmp_eq_u32 vcc, v6, v10
 s_nop 3
 s_cmp_eq_u64 vcc, -1
 s_cbranch_scc1 f_ln0_leave
 s_add_u32 s95, s95, 1
 s_cmp_lt_u32 s95, 0x40000
 s_cbranch_scc1 f_ln0_again
f_ln0_leave:
 s_nop 4
 s_branch f_ln0_ok
f_ln1_spin:
 s_mov_b32 s95, 0
f_ln1_again:
 s_sleep 2
 v_and_b32 v8, 15, v1
 v_lshlrev_b32 v8, 7, v8
 v_bfe_u32 v9, v1, 4, 1
 s_sub_u32 s30, 15, s66
 s_sub_u32 s31, s66, s30
 s_lshl_b32 s31, s31, 11
 s_lshl_b32 s30, s30, 11
 v_mul_lo_u32 v9, v9, s31
 v_add_u32 v8, v8, v9
 v_add_u32 v8, s30, v8
 buffer_load_dword v10, v8, s[52:55], 0 offen sc1
 s_waitcnt vmcnt(0)
 v_cmp_eq_u32 vcc, v6, v10
 s_nop 3
 s_cmp_eq_u64 vcc, -1
 s_cbranch_scc1 f_ln1_leave
 s_add_u32 s95, s95, 1
 s_cmp_lt_u32 s95, 0x40000
 s_cbranch_scc1 f_ln1_again
f_ln1_leave:
 s_nop 4
 s_branch f_ln1_ok
f_kv_spin:
 s_mov_b32 s95, 0
f_kv_again:
 s_sleep 2
 v_and_b32 v31, 15, v1
 v_lshlrev_b32 v31, 7, v31
 s_lshr_b32 s63, s67, 1
 s_lshl_b32 s63, s63, 11
 s_add_u32 s63, s63, 0x8000
 buffer_load_dword v30, v31, s[52:55], s63 offen sc1
 s_waitcnt vmcnt(0)
 v_cmp_eq_u32 vcc, v6, v30
 s_nop 3
 s_cmp_eq_u64 vcc, -1
 s_cbranch_scc1 f_kv_leave
 s_add_u32 s95, s95, 1
 s_cmp_lt_u32 s95, 0x40000
 s_cbranch_scc1 f_kv_again
f_kv_leave:
 s_nop 4
 s_branch f_kv_ok
f_ha_spin:
 s_mov_b32 s95, 0
f_ha_again:
 s_sleep 2
 v_and_b32 v19, 3, v1
 v_lshlrev_b32 v19, 7, v19
 s_lshl_b32 s63, s66, 3
 s_add_u32 s63, s63, s64
 s_lshl_b32 s63, s63, 9
 s_add_u32 s63, s63, 0x10000
 buffer_load_dword v27, v19, s[52:55], s63 offen sc1
 s_waitcnt vmcnt(0)
 v_cmp_eq_u32 vcc, v6, v27
 s_nop 3
 s_cmp_eq_u64 vcc, -1
 s_cbranch_scc1 f_ha_leave
 s_add_u32 s95, s95, 1
 s_cmp_lt_u32 s95, 0x40000
 s_cbranch_scc1 f_ha_again
f_ha_leave:
 s_nop 4
 s_branch f_ha_ok
f_hb_spin:
 s_mov_b32 s95, 0
f_hb_again:
 s_sleep 2
 v_and_b32 v19, 3, v1
 v_lshlrev_b32 v19, 7, v19
 s_lshl_b32 s63, s66, 3
 s_add_u32 s63, s63, s64
 s_lshl_b32 s63, s63, 9
 s_add_u32 s63, s63, 0x10000
 buffer_load_dword v27, v19, s[52:55], s63 offen sc1
 s_waitcnt vmcnt(0)
 v_cmp_eq_u32 vcc, v6, v27
 s_nop 3
 s_cmp_eq_u64 vcc, -1
 s_cbranch_scc1 f_hb_leave
 s_add_u32 s95, s95, 1
 s_cmp_lt_u32 s95, 0x40000
 s_cbranch_scc1 f_hb_again
f_hb_leave:
 s_nop 4
 s_branch f_hb_ok
f_c_spin:
 s_mov_b32 s95, 0
f_c_again:
 s_sleep 2
 v_and_b32 v19, 3, v1
 v_lshlrev_b32 v19, 7, v19
 s_lshl_b32 s63, s66, 3
 s_add_u32 s63, s63, s64
 s_lshl_b32 s63, s63, 9
 s_add_u32 s63, s63, 0x18000
 buffer_load_dword v27, v19, s[52:55], s63 offen sc1
 s_waitcnt vmcnt(0)
 v_cmp_eq_u32 vcc, v6, v27
 s_nop 3
 s_cmp_eq_u64 vcc, -1
 s_cbranch_scc1 f_c_leave
 s_add_u32 s95, s95, 1
 s_cmp_lt_u32 s95, 0x40000
 s_cbranch_scc1 f_c_again
f_c_leave:
 s_nop 4
 s_branch f_c_ok
f_p_spin:
 s_mov_b32 s95, 0
f_p_again:
 s_sleep 2
 v_and_b32 v19, 7, v1
 v_lshlrev_b32 v19, 7, v19
 s_lshl_b32 s63, s66, 2
 s_add_u32 s63, s63, s65
 s_lshl_b32 s63, s63, 10
 s_add_u32 s63, s63, 0x20000
 buffer_load_dword v27, v19, s[52:55], s63 offen sc1
 s_waitcnt vmcnt(0)
 v_cmp_eq_u32 vcc, v6, v27
 s_nop 3
 s_cmp_eq_u64 vcc, -1
 s_cbranch_scc1 f_p_leave
 s_add_u32 s95, s95, 1
 s_cmp_lt_u32 s95, 0x40000
 s_cbranch_scc1 f_p_again
f_p_leave:
 s_nop 4
 s_branch f_p_ok
f_last0a_x:
f_last0b_x:
f_last1a_x:
f_last1b_x:
 s_waitcnt vmcnt(0) lgkmcnt(0)
 s_add_u32 s56, s28, 0x400000
 s_addc_u32 s57, s29, 0
 s_mov_b32 s58, 0x2000000
 s_mov_b32 s59, 0x20000
 s_add_u32 s76, s70, 1
 s_lshl_b32 s76, s76, 1
 v_mov_b32 v31, 0xff800000
 v_mov_b32 v28, 0xff800000
 v_mov_b32 v29, 0xff800000
 s_mov_b32 s73, 0
 s_lshl_b32 s62, s67, 20
f_ex1:
 s_add_u32 s63, s62, 0
 buffer_load_dwordx4 a[72:75], v4, s[56:59], s63 offen
 buffer_load_dwordx4 a[76:79], v4, s[56:59], s63 offen offset:1024
 buffer_load_dwordx4 a[80:83], v4, s[56:59], s63 offen offset:2048
 buffer_load_dwordx4 a[84:87], v4, s[56:59], s63 offen offset:3072
 s_add_u32 s63, s62, 0x1000
 buffer_load_dwordx4 a[88:91], v4, s[56:59], s63 offen
 buffer_load_dwordx4 a[92:95], v4, s[56:59], s63 offen offset:1024
 buffer_load_dwordx4 a[96:99], v4, s[56:59], s63 offen offset:2048
 buffer_load_dwordx4 a[100:103], v4, s[56:59], s63 offen offset:3072
 s_add_u32 s63, s62, 0x2000
 buffer_load_dwordx4 a[104:107], v4, s[56:59], s63 offen
 buffer_load_dwordx4 a[108:111], v4, s[56:59], s63 offen offset:1024
 buffer_load_dwordx4 a[112:115], v4, s[56:59], s63 offen offset:2048
 buffer_load_dwordx4 a[116:119], v4, s[56:59], s63 offen offset:3072
 s_add_u32 s63, s62, 0x3000
 buffer_load_dwordx4 a[120:123], v4, s[56:59], s63 offen
 buffer_load_dwordx4 a[124:127], v4, s[56:59], s63 offen offset:1024
 buffer_load_dwordx4 a[128:131], v4, s[56:59], s63 offen offset:2048
 buffer_load_dwordx4 a[132:135], v4, s[56:59], s63 offen offset:3072
 s_waitcnt vmcnt(0)
 mf v[132:135], a[72:75], v[128:131], 0
 mf v[140:143], a[72:75], v[160:163], 0
 mf v[132:135], a[76:79], v[136:139], v[132:135]
 mf v[140:143], a[76:79], v[168:171], v[140:143]
 mf v[132:135], a[80:83], v[144:147], v[132:135]
 mf v[140:143], a[80:83], v[176:179], v[140:143]
 mf v[132:135], a[84:87], v[152:155], v[132:135]
 mf v[140:143], a[84:87], v[184:187], v[140:143]
 mf v[148:151], a[88:91], v[128:131], 0
 mf v[156:159], a[88:91], v[160:163], 0
 mf v[148:151], a[92:95], v[136:139], v[148:151]
 mf v[156:159], a[92:95], v[168:171], v[156:159]
 mf v[148:151], a[96:99], v[144:147], v[148:151]
 mf v[156:159], a[96:99], v[176:179], v[156:159]
 mf v[148:151], a[100:103], v[152:155], v[148:151]
 mf v[156:159], a[100:103], v[184:187], v[156:159]
 mf v[164:167], a[104:107], v[128:131], 0
 mf v[172:175], a[104:107], v[160:163], 0
 mf v[164:167], a[108:111], v[136:139], v[164:167]
 mf v[172:175], a[108:111], v[168:171], v[172:175]
 mf v[164:167], a[112:115], v[144:147], v[164:167]
 mf v[172:175], a[112:115], v[176:179], v[172:175]
 mf v[164:167], a[116:119], v[152:155], v[164:167]
 mf v[172:175], a[116:119], v[184:187], v[172:175]
 mf v[180:183], a[120:123], v[128:131], 0
 mf v[188:191], a[120:123], v[160:163], 0
 mf v[180:183], a[124:127], v[136:139], v[180:183]
 mf v[188:191], a[124:127], v[168:171], v[188:191]
 mf v[180:183], a[128:131], v[144:147], v[180:183]
 mf v[188:191], a[128:131], v[176:179], v[188:191]
 mf v[180:183], a[132:135], v[152:155], v[180:183]
 mf v[188:191], a[132:135], v[184:187], v[188:191]
 s_nop 7
 s_nop 1
 s_lshl_b32 s61, s70, 7
 s_lshl_b32 s30, s73, 6
 s_sub_i32 s61, s61, s30
 s_lshl_b32 s31, s3, 4
 s_add_i32 s31, s31, s61
 s_add_i32 s30, s31, 0
 v_cmp_ge_i32 vcc, s30, v116
 s_nop 1
 v_cndmask_b32 v132, v31, v132, vcc
 s_add_i32 s30, s31, -1
 v_cmp_ge_i32 vcc, s30, v116
 s_nop 1
 v_cndmask_b32 v133, v31, v133, vcc
 s_add_i32 s30, s31, -2
 v_cmp_ge_i32 vcc, s30, v116
 s_nop 1
 v_cndmask_b32 v134, v31, v134, vcc
 s_add_i32 s30, s31, -3
 v_cmp_ge_i32 vcc, s30, v116
 s_nop 1
 v_cndmask_b32 v135, v31, v135, vcc
 s_add_i32 s30, s31, -16
 v_cmp_ge_i32 vcc, s30, v116
 s_nop 1
 v_cndmask_b32 v148, v31, v148, vcc
 s_add_i32 s30, s31, 0xffffffef
 v_cmp_ge_i32 vcc, s30, v116
 s_nop 1
 v_cndmask_b32 v149, v31, v149, vcc
 s_add_i32 s30, s31, 0xffffffee
 v_cmp_ge_i32 vcc, s30, v116
 s_nop 1
 v_cndmask_b32 v150, v31, v150, vcc
 s_add_i32 s30, s31, 0xffffffed
 v_cmp_ge_i32 vcc, s30, v116
 s_nop 1
 v_cndmask_b32 v151, v31, v151, vcc
 s_add_i32 s30, s31, 0xffffffe0
 v_cmp_ge_i32 vcc, s30, v116
 s_nop 1
 v_cndmask_b32 v164, v31, v164, vcc
 s_add_i32 s30, s31, 0xffffffdf
 v_cmp_ge_i32 vcc, s30, v116
 s_nop 1
 v_cndmask_b32 v165, v31, v165, vcc
 s_add_i32 s30, s31, 0xffffffde
 v_cmp_ge_i32 vcc, s30, v116
 s_nop 1
 v_cndmask_b32 v166, v31, v166, vcc
 s_add_i32 s30, s31, 0xffffffdd
 v_cmp_ge_i32 vcc, s30, v116
 s_nop 1
 v_cndmask_b32 v167, v31, v167, vcc
 s_add_i32 s30, s31, 0xffffffd0
 v_cmp_ge_i32 vcc, s30, v116
 s_nop 1
 v_cndmask_b32 v180, v31, v180, vcc
 s_add_i32 s30, s31, 0xffffffcf
 v_cmp_ge_i32 vcc, s30, v116
 s_nop 1
 v_cndmask_b32 v181, v31, v181, vcc
 s_add_i32 s30, s31, 0xffffffce
 v_cmp_ge_i32 vcc, s30, v116
 s_nop 1
 v_cndmask_b32 v182, v31, v182, vcc
 s_add_i32 s30, s31, 0xffffffcd
 v_cmp_ge_i32 vcc, s30, v116
 s_nop 1
 v_cndmask_b32 v183, v31, v183, vcc
 s_lshl_b32 s31, s3, 4
 s_sub_u32 s31, 0x70, s31
 s_add_i32 s31, s31, s61
 s_add_i32 s30, s31, 0
 v_cmp_ge_i32 vcc, s30, v116
 s_nop 1
 v_cndmask_b32 v140, v31, v140, vcc
 s_add_i32 s30, s31, -1
 v_cmp_ge_i32 vcc, s30, v116
 s_nop 1
 v_cndmask_b32 v141, v31, v141, vcc
 s_add_i32 s30, s31, -2
 v_cmp_ge_i32 vcc, s30, v116
 s_nop 1
 v_cndmask_b32 v142, v31, v142, vcc
 s_add_i32 s30, s31, -3
 v_cmp_ge_i32 vcc, s30, v116
 s_nop 1
 v_cndmask_b32 v143, v31, v143, vcc
 s_add_i32 s30, s31, -16
 v_cmp_ge_i32 vcc, s30, v116
 s_nop 1
 v_cndmask_b32 v156, v31, v156, vcc
 s_add_i32 s30, s31, 0xffffffef
 v_cmp_ge_i32 vcc, s30, v116
 s_nop 1
 v_cndmask_b32 v157, v31, v157, vcc
 s_add_i32 s30, s31, 0xffffffee
 v_cmp_ge_i32 vcc, s30, v116
 s_nop 1
 v_cndmask_b32 v158, v31, v158, vcc
 s_add_i32 s30, s31, 0xffffffed
 v_cmp_ge_i32 vcc, s30, v116
 s_nop 1
 v_cndmask_b32 v159, v31, v159, vcc
 s_add_i32 s30, s31, 0xffffffe0
 v_cmp_ge_i32 vcc, s30, v116
 s_nop 1
 v_cndmask_b32 v172, v31, v172, vcc
 s_add_i32 s30, s31, 0xffffffdf
 v_cmp_ge_i32 vcc, s30, v116
 s_nop 1
 v_cndmask_b32 v173, v31, v173, vcc
 s_add_i32 s30, s31, 0xffffffde
 v_cmp_ge_i32 vcc, s30, v116
 s_nop 1
 v_cndmask_b32 v174, v31, v174, vcc
 s_add_i32 s30, s31, 0xffffffdd
 v_cmp_ge_i32 vcc, s30, v116
 s_nop 1
 v_cndmask_b32 v175, v31, v175, vcc
 s_add_i32 s30, s31, 0xffffffd0
 v_cmp_ge_i32 vcc, s30, v116
 s_nop 1
 v_cndmask_b32 v188, v31, v188, vcc
 s_add_i32 s30, s31, 0xffffffcf
 v_cmp_ge_i32 vcc, s30, v116
 s_nop 1
 v_cndmask_b32 v189, v31, v189, vcc
 s_add_i32 s30, s31, 0xffffffce
 v_cmp_ge_i32 vcc, s30, v116
 s_nop 1
 v_cndmask_b32 v190, v31, v190, vcc
 s_add_i32 s30, s31, 0xffffffcd
 v_cmp_ge_i32 vcc, s30, v116
 s_nop 1
 v_cndmask_b32 v191, v31, v191, vcc
 v_max3_f32 v28, v28, v132, v133
 v_max3_f32 v28, v28, v134, v135
 v_max3_f32 v28, v28, v148, v149
 v_max3_f32 v28, v28, v150, v151
 v_max3_f32 v28, v28, v164, v165
 v_max3_f32 v28, v28, v166, v167
 v_max3_f32 v28, v28, v180, v181
 v_max3_f32 v28, v28, v182, v183
 v_max3_f32 v29, v29, v140, v141
 v_max3_f32 v29, v29, v142, v143
 v_max3_f32 v29, v29, v156, v157
 v_max3_f32 v29, v29, v158, v159
 v_max3_f32 v29, v29, v172, v173
 v_max3_f32 v29, v29, v174, v175
 v_max3_f32 v29, v29, v188, v189
 v_max3_f32 v29, v29, v190, v191
 s_add_u32 s62, s62, 0x8000
 s_add_u32 s73, s73, 1
 s_cmp_lt_u32 s73, s76
 s_cbranch_scc1 f_ex1
 v_mov_b32 v30, v28
 s_nop 1
 v_permlane16_swap_b32 v28, v30
 v_max_f32 v28, v28, v30
 v_mov_b32 v30, v28
 s_nop 1
 v_permlane32_swap_b32 v28, v30
 v_max_f32 v28, v28, v30
 v_sub_f32 v228, 0, v28
 v_sub_f32 v229, 0, v28
 v_sub_f32 v230, 0, v28
 v_sub_f32 v231, 0, v28
 v_mov_b32 v30, v29
 s_nop 1
 v_permlane16_swap_b32 v29, v30
 v_max_f32 v29, v29, v30
 v_mov_b32 v30, v29
 s_nop 1
 v_permlane32_swap_b32 v29, v30
 v_max_f32 v29, v29, v30
 v_sub_f32 v236, 0, v29
 v_sub_f32 v237, 0, v29
 v_sub_f32 v238, 0, v29
 v_sub_f32 v239, 0, v29
 v_accvgpr_write_b32 a0, 0
 v_accvgpr_write_b32 a1, 0
 v_accvgpr_write_b32 a2, 0
 v_accvgpr_write_b32 a3, 0
 v_accvgpr_write_b32 a4, 0
 v_accvgpr_write_b32 a5, 0
 v_accvgpr_write_b32 a6, 0
 v_accvgpr_write_b32 a7, 0
 v_accvgpr_write_b32 a8, 0
 v_accvgpr_write_b32 a9, 0
 v_accvgpr_write_b32 a10, 0
 v_accvgpr_write_b32 a11, 0
 v_accvgpr_write_b32 a12, 0
 v_accvgpr_write_b32 a13, 0
 v_accvgpr_write_b32 a14, 0
 v_accvgpr_write_b32 a15, 0
 v_accvgpr_write_b32 a16, 0
 v_accvgpr_write_b32 a17, 0
 v_accvgpr_write_b32 a18, 0
 v_accvgpr_write_b32 a19, 0
 v_accvgpr_write_b32 a20, 0
 v_accvgpr_write_b32 a21, 0
 v_accvgpr_write_b32 a22, 0
 v_accvgpr_write_b32 a23, 0
 v_accvgpr_write_b32 a24, 0
 v_accvgpr_write_b32 a25, 0
 v_accvgpr_write_b32 a26, 0
 v_accvgpr_write_b32 a27, 0
 v_accvgpr_write_b32 a28, 0
 v_accvgpr_write_b32 a29, 0
 v_accvgpr_write_b32 a30, 0
 v_accvgpr_write_b32 a31, 0
 v_accvgpr_write_b32 a32, 0
 v_accvgpr_write_b32 a33, 0
 v_accvgpr_write_b32 a34, 0
 v_accvgpr_write_b32 a35, 0
 v_accvgpr_write_b32 a36, 0
 v_accvgpr_write_b32 a37, 0
 v_accvgpr_write_b32 a38, 0
 v_accvgpr_write_b32 a39, 0
 v_accvgpr_write_b32 a40, 0
 v_accvgpr_write_b32 a41, 0
 v_accvgpr_write_b32 a42, 0
 v_accvgpr_write_b32 a43, 0
 v_accvgpr_write_b32 a44, 0
 v_accvgpr_write_b32 a45, 0
 v_accvgpr_write_b32 a46, 0
 v_accvgpr_write_b32 a47, 0
 v_accvgpr_write_b32 a48, 0
 v_accvgpr_write_b32 a49, 0
 v_accvgpr_write_b32 a50, 0
 v_accvgpr_write_b32 a51, 0
 v_accvgpr_write_b32 a52, 0
 v_accvgpr_write_b32 a53, 0
 v_accvgpr_write_b32 a54, 0
 v_accvgpr_write_b32 a55, 0
 v_accvgpr_write_b32 a56, 0
 v_accvgpr_write_b32 a57, 0
 v_accvgpr_write_b32 a58, 0
 v_accvgpr_write_b32 a59, 0
 v_accvgpr_write_b32 a60, 0
 v_accvgpr_write_b32 a61, 0
 v_accvgpr_write_b32 a62, 0
 v_accvgpr_write_b32 a63, 0
 v_accvgpr_write_b32 a64, 0
 v_accvgpr_write_b32 a65, 0
 v_accvgpr_write_b32 a66, 0
 v_accvgpr_write_b32 a67, 0
 v_accvgpr_write_b32 a68, 0
 v_accvgpr_write_b32 a69, 0
 v_accvgpr_write_b32 a70, 0
 v_accvgpr_write_b32 a71, 0
 s_mov_b32 s73, 0
 s_lshl_b32 s62, s67, 20
f_ex2:
 s_add_u32 s63, s62, 0
 buffer_load_dwordx4 a[72:75], v4, s[56:59], s63 offen
 buffer_load_dwordx4 a[76:79], v4, s[56:59], s63 offen offset:1024
 buffer_load_dwordx4 a[80:83], v4, s[56:59], s63 offen offset:2048
 buffer_load_dwordx4 a[84:87], v4, s[56:59], s63 offen offset:3072
 s_add_u32 s63, s62, 0x1000
 buffer_load_dwordx4 a[88:91], v4, s[56:59], s63 offen
 buffer_load_dwordx4 a[92:95], v4, s[56:59], s63 offen offset:1024
 buffer_load_dwordx4 a[96:99], v4, s[56:59], s63 offen offset:2048
 buffer_load_dwordx4 a[100:103], v4, s[56:59], s63 offen offset:3072
 s_add_u32 s63, s62, 0x2000
 buffer_load_dwordx4 a[104:107], v4, s[56:59], s63 offen
 buffer_load_dwordx4 a[108:111], v4, s[56:59], s63 offen offset:1024
 buffer_load_dwordx4 a[112:115], v4, s[56:59], s63 offen offset:2048
 buffer_load_dwordx4 a[116:119], v4, s[56:59], s63 offen offset:3072
 s_add_u32 s63, s62, 0x3000
 buffer_load_dwordx4 a[120:123], v4, s[56:59], s63 offen
 buffer_load_dwordx4 a[124:127], v4, s[56:59], s63 offen offset:1024
 buffer_load_dwordx4 a[128:131], v4, s[56:59], s63 offen offset:2048
 buffer_load_dwordx4 a[132:135], v4, s[56:59], s63 offen offset:3072
 s_waitcnt vmcnt(0)
 mf v[132:135], a[72:75], v[128:131], v[228:231]
 mf v[140:143], a[72:75], v[160:163], v[236:239]
 mf v[132:135], a[76:79], v[136:139], v[132:135]
 mf v[140:143], a[76:79], v[168:171], v[140:143]
 mf v[132:135], a[80:83], v[144:147], v[132:135]
 mf v[140:143], a[80:83], v[176:179], v[140:143]
 mf v[132:135], a[84:87], v[152:155], v[132:135]
 mf v[140:143], a[84:87], v[184:187], v[140:143]
 mf v[148:151], a[88:91], v[128:131], v[228:231]
 mf v[156:159], a[88:91], v[160:163], v[236:239]
 mf v[148:151], a[92:95], v[136:139], v[148:151]
 mf v[156:159], a[92:95], v[168:171], v[156:159]
 mf v[148:151], a[96:99], v[144:147], v[148:151]
 mf v[156:159], a[96:99], v[176:179], v[156:159]
 mf v[148:151], a[100:103], v[152:155], v[148:151]
 mf v[156:159], a[100:103], v[184:187], v[156:159]
 mf v[164:167], a[104:107], v[128:131], v[228:231]
 mf v[172:175], a[104:107], v[160:163], v[236:239]
 mf v[164:167], a[108:111], v[136:139], v[164:167]
 mf v[172:175], a[108:111], v[168:171], v[172:175]
 mf v[164:167], a[112:115], v[144:147], v[164:167]
 mf v[172:175], a[112:115], v[176:179], v[172:175]
 mf v[164:167], a[116:119], v[152:155], v[164:167]
 mf v[172:175], a[116:119], v[184:187], v[172:175]
 mf v[180:183], a[120:123], v[128:131], v[228:231]
 mf v[188:191], a[120:123], v[160:163], v[236:239]
 mf v[180:183], a[124:127], v[136:139], v[180:183]
 mf v[188:191], a[124:127], v[168:171], v[188:191]
 mf v[180:183], a[128:131], v[144:147], v[180:183]
 mf v[188:191], a[128:131], v[176:179], v[188:191]
 mf v[180:183], a[132:135], v[152:155], v[180:183]
 mf v[188:191], a[132:135], v[184:187], v[188:191]
 s_nop 7
 s_nop 1
 s_lshl_b32 s61, s70, 7
 s_lshl_b32 s30, s73, 6
 s_sub_i32 s61, s61, s30
 s_lshl_b32 s31, s3, 4
 s_add_i32 s31, s31, s61
 s_add_i32 s30, s31, 0
 v_cmp_ge_i32 vcc, s30, v116
 s_nop 1
 v_cndmask_b32 v132, v31, v132, vcc
 s_add_i32 s30, s31, -1
 v_cmp_ge_i32 vcc, s30, v116
 s_nop 1
 v_cndmask_b32 v133, v31, v133, vcc
 s_add_i32 s30, s31, -2
 v_cmp_ge_i32 vcc, s30, v116
 s_nop 1
 v_cndmask_b32 v134, v31, v134, vcc
 s_add_i32 s30, s31, -3
 v_cmp_ge_i32 vcc, s30, v116
 s_nop 1
 v_cndmask_b32 v135, v31, v135, vcc
 s_add_i32 s30, s31, -16
 v_cmp_ge_i32 vcc, s30, v116
 s_nop 1
 v_cndmask_b32 v148, v31, v148, vcc
 s_add_i32 s30, s31, 0xffffffef
 v_cmp_ge_i32 vcc, s30, v116
 s_nop 1
 v_cndmask_b32 v149, v31, v149, vcc
 s_add_i32 s30, s31, 0xffffffee
 v_cmp_ge_i32 vcc, s30, v116
 s_nop 1
 v_cndmask_b32 v150, v31, v150, vcc
 s_add_i32 s30, s31, 0xffffffed
 v_cmp_ge_i32 vcc, s30, v116
 s_nop 1
 v_cndmask_b32 v151, v31, v151, vcc
 s_add_i32 s30, s31, 0xffffffe0
 v_cmp_ge_i32 vcc, s30, v116
 s_nop 1
 v_cndmask_b32 v164, v31, v164, vcc
 s_add_i32 s30, s31, 0xffffffdf
 v_cmp_ge_i32 vcc, s30, v116
 s_nop 1
 v_cndmask_b32 v165, v31, v165, vcc
 s_add_i32 s30, s31, 0xffffffde
 v_cmp_ge_i32 vcc, s30, v116
 s_nop 1
 v_cndmask_b32 v166, v31, v166, vcc
 s_add_i32 s30, s31, 0xffffffdd
 v_cmp_ge_i32 vcc, s30, v116
 s_nop 1
 v_cndmask_b32 v167, v31, v167, vcc
 s_add_i32 s30, s31, 0xffffffd0
 v_cmp_ge_i32 vcc, s30, v116
 s_nop 1
 v_cndmask_b32 v180, v31, v180, vcc
 s_add_i32 s30, s31, 0xffffffcf
 v_cmp_ge_i32 vcc, s30, v116
 s_nop 1
 v_cndmask_b32 v181, v31, v181, vcc
 s_add_i32 s30, s31, 0xffffffce
 v_cmp_ge_i32 vcc, s30, v116
 s_nop 1
 v_cndmask_b32 v182, v31, v182, vcc
 s_add_i32 s30, s31, 0xffffffcd
 v_cmp_ge_i32 vcc, s30, v116
 s_nop 1
 v_cndmask_b32 v183, v31, v183, vcc
 s_lshl_b32 s31, s3, 4
 s_sub_u32 s31, 0x70, s31
 s_add_i32 s31, s31, s61
 s_add_i32 s30, s31, 0
 v_cmp_ge_i32 vcc, s30, v116
 s_nop 1
 v_cndmask_b32 v140, v31, v140, vcc
 s_add_i32 s30, s31, -1
 v_cmp_ge_i32 vcc, s30, v116
 s_nop 1
 v_cndmask_b32 v141, v31, v141, vcc
 s_add_i32 s30, s31, -2
 v_cmp_ge_i32 vcc, s30, v116
 s_nop 1
 v_cndmask_b32 v142, v31, v142, vcc
 s_add_i32 s30, s31, -3
 v_cmp_ge_i32 vcc, s30, v116
 s_nop 1
 v_cndmask_b32 v143, v31, v143, vcc
 s_add_i32 s30, s31, -16
 v_cmp_ge_i32 vcc, s30, v116
 s_nop 1
 v_cndmask_b32 v156, v31, v156, vcc
 s_add_i32 s30, s31, 0xffffffef
 v_cmp_ge_i32 vcc, s30, v116
 s_nop 1
 v_cndmask_b32 v157, v31, v157, vcc
 s_add_i32 s30, s31, 0xffffffee
 v_cmp_ge_i32 vcc, s30, v116
 s_nop 1
 v_cndmask_b32 v158, v31, v158, vcc
 s_add_i32 s30, s31, 0xffffffed
 v_cmp_ge_i32 vcc, s30, v116
 s_nop 1
 v_cndmask_b32 v159, v31, v159, vcc
 s_add_i32 s30, s31, 0xffffffe0
 v_cmp_ge_i32 vcc, s30, v116
 s_nop 1
 v_cndmask_b32 v172, v31, v172, vcc
 s_add_i32 s30, s31, 0xffffffdf
 v_cmp_ge_i32 vcc, s30, v116
 s_nop 1
 v_cndmask_b32 v173, v31, v173, vcc
 s_add_i32 s30, s31, 0xffffffde
 v_cmp_ge_i32 vcc, s30, v116
 s_nop 1
 v_cndmask_b32 v174, v31, v174, vcc
 s_add_i32 s30, s31, 0xffffffdd
 v_cmp_ge_i32 vcc, s30, v116
 s_nop 1
 v_cndmask_b32 v175, v31, v175, vcc
 s_add_i32 s30, s31, 0xffffffd0
 v_cmp_ge_i32 vcc, s30, v116
 s_nop 1
 v_cndmask_b32 v188, v31, v188, vcc
 s_add_i32 s30, s31, 0xffffffcf
 v_cmp_ge_i32 vcc, s30, v116
 s_nop 1
 v_cndmask_b32 v189, v31, v189, vcc
 s_add_i32 s30, s31, 0xffffffce
 v_cmp_ge_i32 vcc, s30, v116
 s_nop 1
 v_cndmask_b32 v190, v31, v190, vcc
 s_add_i32 s30, s31, 0xffffffcd
 v_cmp_ge_i32 vcc, s30, v116
 s_nop 1
 v_cndmask_b32 v191, v31, v191, vcc
 v_exp_f32 v132, v132
 v_exp_f32 v133, v133
 v_exp_f32 v134, v134
 v_exp_f32 v135, v135
 s_nop 0
 v_cvt_pk_bf16_f32 v196, v132, v133
 v_cvt_pk_bf16_f32 v197, v134, v135
 v_exp_f32 v140, v140
 v_exp_f32 v141, v141
 v_exp_f32 v142, v142
 v_exp_f32 v143, v143
 s_nop 0
 v_cvt_pk_bf16_f32 v204, v140, v141
 v_cvt_pk_bf16_f32 v205, v142, v143
 v_exp_f32 v148, v148
 v_exp_f32 v149, v149
 v_exp_f32 v150, v150
 v_exp_f32 v151, v151
 s_nop 0
 v_cvt_pk_bf16_f32 v198, v148, v149
 v_cvt_pk_bf16_f32 v199, v150, v151
 v_exp_f32 v156, v156
 v_exp_f32 v157, v157
 v_exp_f32 v158, v158
 v_exp_f32 v159, v159
 s_nop 0
 v_cvt_pk_bf16_f32 v206, v156, v157
 v_cvt_pk_bf16_f32 v207, v158, v159
 v_exp_f32 v164, v164
 v_exp_f32 v165, v165
 v_exp_f32 v166, v166
 v_exp_f32 v167, v167
 s_nop 0
 v_cvt_pk_bf16_f32 v212, v164, v165
 v_cvt_pk_bf16_f32 v213, v166, v167
 v_exp_f32 v172, v172
 v_exp_f32 v173, v173
 v_exp_f32 v174, v174
 v_exp_f32 v175, v175
 s_nop 0
 v_cvt_pk_bf16_f32 v220, v172, v173
 v_cvt_pk_bf16_f32 v221, v174, v175
 v_exp_f32 v180, v180
 v_exp_f32 v181, v181
 v_exp_f32 v182, v182
 v_exp_f32 v183, v183
 s_nop 0
 v_cvt_pk_bf16_f32 v214, v180, v181
 v_cvt_pk_bf16_f32 v215, v182, v183
 v_exp_f32 v188, v188
 v_exp_f32 v189, v189
 v_exp_f32 v190, v190
 v_exp_f32 v191, v191
 s_nop 0
 v_cvt_pk_bf16_f32 v222, v188, v189
 v_cvt_pk_bf16_f32 v223, v190, v191
 s_add_u32 s63, s62, 0x4000
 buffer_load_dwordx4 a[72:75], v4, s[56:59], s63 offen
 buffer_load_dwordx4 a[76:79], v4, s[56:59], s63 offen offset:1024
 buffer_load_dwordx4 a[80:83], v4, s[56:59], s63 offen offset:2048
 buffer_load_dwordx4 a[84:87], v4, s[56:59], s63 offen offset:3072
 s_add_u32 s63, s62, 0x5000
 buffer_load_dwordx4 a[88:91], v4, s[56:59], s63 offen
 buffer_load_dwordx4 a[92:95], v4, s[56:59], s63 offen offset:1024
 buffer_load_dwordx4 a[96:99], v4, s[56:59], s63 offen offset:2048
 buffer_load_dwordx4 a[100:103], v4, s[56:59], s63 offen offset:3072
 s_add_u32 s63, s62, 0x6000
 buffer_load_dwordx4 a[104:107], v4, s[56:59], s63 offen
 buffer_load_dwordx4 a[108:111], v4, s[56:59], s63 offen offset:1024
 buffer_load_dwordx4 a[112:115], v4, s[56:59], s63 offen offset:2048
 buffer_load_dwordx4 a[116:119], v4, s[56:59], s63 offen offset:3072
 s_add_u32 s63, s62, 0x7000
 buffer_load_dwordx4 a[120:123], v4, s[56:59], s63 offen
 buffer_load_dwordx4 a[124:127], v4, s[56:59], s63 offen offset:1024
 buffer_load_dwordx4 a[128:131], v4, s[56:59], s63 offen offset:2048
 buffer_load_dwordx4 a[132:135], v4, s[56:59], s63 offen offset:3072
 s_waitcnt vmcnt(0)
 mf a[0:3], a[72:75], v[196:199], a[0:3]
 mf a[4:7], a[72:75], v[204:207], a[4:7]
 mf a[8:11], a[76:79], v[196:199], a[8:11]
 mf a[12:15], a[76:79], v[204:207], a[12:15]
 mf a[16:19], a[80:83], v[196:199], a[16:19]
 mf a[20:23], a[80:83], v[204:207], a[20:23]
 mf a[24:27], a[84:87], v[196:199], a[24:27]
 mf a[28:31], a[84:87], v[204:207], a[28:31]
 mf a[32:35], a[88:91], v[196:199], a[32:35]
 mf a[36:39], a[88:91], v[204:207], a[36:39]
 mf a[40:43], a[92:95], v[196:199], a[40:43]
 mf a[44:47], a[92:95], v[204:207], a[44:47]
 mf a[48:51], a[96:99], v[196:199], a[48:51]
 mf a[52:55], a[96:99], v[204:207], a[52:55]
 mf a[56:59], a[100:103], v[196:199], a[56:59]
 mf a[60:63], a[100:103], v[204:207], a[60:63]
 mf a[64:67], v[244:247], v[196:199], a[64:67]
 mf a[68:71], v[244:247], v[204:207], a[68:71]
 mf a[0:3], a[104:107], v[212:215], a[0:3]
 mf a[4:7], a[104:107], v[220:223], a[4:7]
 mf a[8:11], a[108:111], v[212:215], a[8:11]
 mf a[12:15], a[108:111], v[220:223], a[12:15]
 mf a[16:19], a[112:115], v[212:215], a[16:19]
 mf a[20:23], a[112:115], v[220:223], a[20:23]
 mf a[24:27], a[116:119], v[212:215], a[24:27]
 mf a[28:31], a[116:119], v[220:223], a[28:31]
 mf a[32:35], a[120:123], v[212:215], a[32:35]
 mf a[36:39], a[120:123], v[220:223], a[36:39]
 mf a[40:43], a[124:127], v[212:215], a[40:43]
 mf a[44:47], a[124:127], v[220:223], a[44:47]
 mf a[48:51], a[128:131], v[212:215], a[48:51]
 mf a[52:55], a[128:131], v[220:223], a[52:55]
 mf a[56:59], a[132:135], v[212:215], a[56:59]
 mf a[60:63], a[132:135], v[220:223], a[60:63]
 mf a[64:67], v[244:247], v[212:215], a[64:67]
 mf a[68:71], v[244:247], v[220:223], a[68:71]
 s_nop 7
 s_add_u32 s62, s62, 0x8000
 s_add_u32 s73, s73, 1
 s_cmp_lt_u32 s73, s76
 s_cbranch_scc1 f_ex2
 s_nop 7
 s_nop 7
 s_cmp_eq_u32 s79, 1
 s_cbranch_scc1 f_epi
 s_branch f_sig
f_done:
 s_endpgm
.section .rodata,"a"
.p2align 6
.amdhsa_kernel parallel_sum__compressed_kv_cla__geglu_ffn__prompt_kernel
 .amdhsa_next_free_vgpr 512
 .amdhsa_next_free_sgpr 102
 .amdhsa_accum_offset 256
 .amdhsa_group_segment_fixed_size 0
 .amdhsa_kernarg_size 104
 .amdhsa_user_sgpr_count 2
 .amdhsa_user_sgpr_kernarg_segment_ptr 1
 .amdhsa_system_sgpr_workgroup_id_x 1
 .amdhsa_float_denorm_mode_32 3
.end_amdhsa_kernel
```
